```python
import torch

def _softmax(x, axis=-1):
    return torch.softmax(x, dim=axis)
def _gelu(x):
    return torch.nn.functional.gelu(x, approximate="tanh")
def _silu(x):
    return torch.nn.functional.silu(x)
def _sigmoid(x):
    return torch.sigmoid(x)
def _layernorm(x, axis=-1, eps=1e-5):
    m = x.mean(dim=axis, keepdim=True)
    v = x.var(dim=axis, keepdim=True, unbiased=False)
    return (x - m) / torch.sqrt(v + eps)
def _scatter_add(tgt, idx, src, axis=0):
    return tgt.clone().index_add_(axis, idx, src)
def _segment_sum(src, seg, n):
    out = torch.zeros((n,) + src.shape[1:], dtype=src.dtype)
    return out.index_add_(0, seg, src)
def _pad(x, pw):
    flat = tuple(v for pair in reversed(pw) for v in pair)
    return torch.nn.functional.pad(x, flat)

kernel_name = 'recurrent_scan__compressed_kv_cla__dense_activation_mish__prompt'

def setup_inputs():

    _w = (lambda a: (lambda t: t.to(torch.bfloat16) if t.is_floating_point() else t)(torch.as_tensor(a)))
    def _A_setup():
        B, H, Sq, Sk, D, M = 1, 32, 2048, 2048, 128, 640
        Dc = 4 * D
        return {
            "x": _w((lambda *s: torch.randn(*s, dtype=torch.bfloat16) * 0.05)(B, Sq, M)),
            "c_kv": _w((lambda *s: torch.randn(*s, dtype=torch.bfloat16) * 0.8)(B, Sk, Dc)),
            "w_q": _w((lambda *s: torch.randn(*s, dtype=torch.bfloat16) * 1.6)(M, H, D) * (M ** -0.5)),
            "w_uk": _w((lambda *s: torch.randn(*s, dtype=torch.bfloat16) * 1.6)(Dc, H, D) * (Dc ** -0.5)),
            "w_uv": _w((lambda *s: torch.randn(*s, dtype=torch.bfloat16) * 0.8)(Dc, H, D) * (Dc ** -0.5)),
            "w_o": _w((lambda *s: torch.randn(*s, dtype=torch.bfloat16) * 0.8)(H, D, M) * ((H * D) ** -0.5)),
        }
    _A_in = _A_setup()

    def _B_setup():
        B, S, D, F = 1, 2048, 640, 1728
        return {
            "x": _w((lambda *s: torch.randn(*s, dtype=torch.bfloat16) * 0.05)(B, S, D)),
            "w1": _w((lambda *s: torch.randn(*s, dtype=torch.bfloat16) * 0.8)(D, F) * (D ** -0.5)),
            "b1": _w((lambda *s: torch.randn(*s, dtype=torch.bfloat16) * 0.8)(F)),
            "w2": _w((lambda *s: torch.randn(*s, dtype=torch.bfloat16) * 0.2)(F, D) * (F ** -0.5)),
        }
    _B_in = _B_setup()

    return {
        "A_x": _A_in["x"],
        "A_c_kv": _A_in["c_kv"],
        "A_w_q": _A_in["w_q"],
        "A_w_uk": _A_in["w_uk"],
        "A_w_uv": _A_in["w_uv"],
        "A_w_o": _A_in["w_o"],
        "B_x": _B_in["x"],
        "B_w1": _B_in["w1"],
        "B_b1": _B_in["b1"],
        "B_w2": _B_in["w2"],
    }

def reference(A_x, A_c_kv, A_w_q, A_w_uk, A_w_uv, A_w_o, B_x, B_w1, B_b1, B_w2):
    def _A_ref(x, c_kv, w_q, w_uk, w_uv, w_o):
        B, Sq, M = x.shape[0], x.shape[1], x.shape[2]
        Sk = c_kv.shape[1]
        H, D = w_q.shape[1], w_q.shape[2]
        q = torch.einsum("bqm,mhd->bhqd", x, w_q)
        k = torch.einsum("bkc,chd->bhkd", c_kv, w_uk)
        v = torch.einsum("bkc,chd->bhkd", c_kv, w_uv)
        scores = torch.einsum("bhqd,bhkd->bhqk", q, k) * (D ** -0.5)
        off = Sk - Sq
        qi = torch.arange(Sq)[:, None]
        kj = torch.arange(Sk)[None, :]
        cmask = kj <= (qi + off)
        scores = torch.where(cmask[None, None], scores, -1e9)
        p = _softmax(scores, axis=-1)
        ctx = torch.einsum("bhqk,bhkd->bhqd", p, v)
        return torch.einsum("bhqd,hdm->bqm", ctx, w_o)

    def _B_ref(x, w1, b1, w2):
        h = torch.einsum("bsd,df->bsf", x, w1) + b1
        sp = torch.log1p(torch.exp(-torch.abs(h))) + torch.where(h > 0, h, torch.zeros_like(h))
        act = h * torch.tanh(sp)
        return torch.einsum("bsf,fd->bsd", act, w2)

    x = A_x
    xn = _layernorm(x, axis=-1)
    s = _A_ref(xn, A_c_kv, A_w_q, A_w_uk, A_w_uv, A_w_o)
    g = _silu(_B_ref(xn, B_w1, B_b1, B_w2))
    return x + s * g
```

```asm
; @launch kernel=ka_kernel grid=(256,1,1) block=(512,1,1) lds=163840
.amdgcn_target "amdgcn-amd-amdhsa--gfx950"
.text
.globl ka_kernel
.p2align 8
.type ka_kernel,@function
ka_kernel:
    s_cmp_ge_u32 s2, 256
    s_cbranch_scc1 KB_END
    s_load_dwordx4 s[4:7], s[0:1], 0
    s_load_dwordx4 s[8:11], s[0:1], 24
    s_load_dwordx2 s[28:29], s[0:1], 96
    s_load_dwordx2 s[12:13], s[0:1], 16
    s_load_dwordx2 s[14:15], s[0:1], 56
    s_load_dwordx2 s[16:17], s[0:1], 64
    s_load_dwordx2 s[18:19], s[0:1], 40
    s_load_dwordx2 s[20:21], s[0:1], 72
    s_load_dwordx2 s[22:23], s[0:1], 88
    s_getpc_b64 s[68:69]
KB_PC:
    s_lshr_b32 s77, s2, 3
    s_mul_i32 s77, s77, 3072
    s_add_u32 s68, s68, s77
    s_addc_u32 s69, s69, 0
    s_sub_u32 s70, KB_CODE_END-KB_PC, s77
    s_cselect_b32 s70, 0, s70
    s_min_u32 s70, s70, 3072
    s_mov_b32 s71, 0x20000
    v_lshlrev_b32 v254, 7, v0
    buffer_load_dword v254, v254, s[68:71], 0 offen
    v_lshrrev_b32 v192, 6, v0
    v_and_b32 v193, 63, v0
    v_readfirstlane_b32 s3, v192
    v_lshlrev_b32 v240, 4, v193
    v_lshlrev_b32 v190, 7, v193
    v_lshrrev_b32 v194, 4, v193
    v_and_b32 v195, 1, v192
    v_lshlrev_b32 v195, 1, v195
    v_lshl_add_u32 v195, v194, 2, v195
    v_and_b32 v196, 15, v193
    v_xor_b32 v195, v195, v196
    v_lshlrev_b32 v198, 4, v195
    v_lshl_add_u32 v244, v194, 13, v198
    v_and_b32 v195, 7, v193
    v_xor_b32 v195, v195, v194
    v_lshlrev_b32 v195, 4, v195
    v_lshrrev_b32 v196, 3, v193
    v_lshl_add_u32 v243, v196, 10, v195
    v_xor_b32 v183, 64, v243
    v_add_u32 v183, 7168, v183
    s_and_b32 s72, s2, 31
    s_lshr_b32 s73, s2, 5
    s_and_b32 s76, s3, 3
    s_lshl_b32 s83, s3, 11
    s_lshl_b32 s86, s3, 3
    s_add_u32 s86, s86, s73
    s_lshl_b32 s86, s86, 15
    s_lshl_b32 s81, s3, 12
    s_lshl_b32 s88, s76, 16
    s_lshl_b32 s77, s72, 8
    s_add_u32 s88, s88, s77
    s_mov_b32 s98, s88
    s_lshl_b32 s77, s2, 3
    s_lshl_b32 s78, s76, 1
    s_add_u32 s77, s77, s78
    v_bfe_u32 v199, v193, 2, 1
    v_add_u32 v195, s77, v199
    v_lshrrev_b32 v199, 3, v193
    v_and_b32 v196, 3, v193
    v_lshl_add_u32 v196, v199, 2, v196
    s_movk_i32 s78, 1280
    v_mul_lo_u32 v178, v195, s78
    v_lshl_add_u32 v178, v196, 4, v178
    v_cmp_gt_u32 vcc, 16, v196
    v_mov_b32 v197, 0x40000000
    v_mov_b32 v182, 0
    v_cndmask_b32 v179, v197, v178, vcc
    s_waitcnt lgkmcnt(0)
    s_mov_b32 s32, s6
    s_mov_b32 s33, s7
    s_mov_b32 s34, 2097152
    s_mov_b32 s35, 0x20000
    s_cmp_ge_u32 s3, 4
    s_cselect_b32 s36, s8, s10
    s_cselect_b32 s37, s9, s11
    s_mov_b32 s38, 4194304
    s_mov_b32 s39, 0x20000
    s_add_u32 m0, s81, 0
    s_add_u32 s87, s86, 14336
    buffer_load_dwordx4 v243, s[32:35], s86 offen lds
    buffer_load_dwordx4 v183, s[32:35], s86 offen offset:1024 lds
    buffer_load_dwordx4 v243, s[32:35], s87 offen offset:2048 lds
    buffer_load_dwordx4 v183, s[32:35], s87 offen offset:3072 lds
    s_add_u32 s86, s86, 128
    s_add_u32 m0, s83, 32768
    s_add_u32 s89, s88, 31744
    buffer_load_dwordx4 v244, s[36:39], s88 offen nt lds
    buffer_load_dwordx4 v244, s[36:39], s89 offen offset:1024 nt lds
    s_add_u32 s88, s88, 262144
    s_cmp_ge_u32 s3, 4
    s_cbranch_scc1 KB_Y
    s_mov_b32 s64, s4
    s_mov_b32 s65, s5
    s_mov_b32 s66, 2621440
    s_mov_b32 s67, 0x20000
    s_add_u32 s52, s28, 71303168
    s_addc_u32 s53, s29, 0
    s_mov_b32 s54, 69632
    s_mov_b32 s55, 0x20000
    v_mov_b32 v186, 0
    v_mov_b32 v187, 0
    v_mov_b32 v188, 0
    v_mov_b32 v189, 0
    s_mov_b32 s40, s28
    s_mov_b32 s41, s29
    s_mov_b32 s42, 33554432
    s_mov_b32 s43, 0x20000
    s_add_u32 s44, s28, 33554432
    s_addc_u32 s45, s29, 0
    s_mov_b32 s46, 2621440
    s_mov_b32 s47, 0x20000
    s_add_u32 s56, s28, 37748736
    s_addc_u32 s57, s29, 0
    s_mov_b32 s58, 23855104
    s_mov_b32 s59, 0x20000
    s_mov_b32 s60, s22
    s_mov_b32 s61, s23
    s_mov_b32 s62, 256
    s_mov_b32 s63, 0x20000
    v_bfe_u32 v202, v193, 1, 2
    v_and_b32 v203, 1, v193
    v_lshrrev_b32 v200, 3, v193
    v_lshl_add_u32 v200, v200, 5, v202
    v_lshlrev_b32 v200, 13, v200
    v_lshl_add_u32 v200, v203, 7, v200
    v_lshrrev_b32 v201, 2, v193
    v_and_b32 v202, 3, v193
    v_lshl_add_u32 v201, v201, 5, v202
    s_movk_i32 s77, 3456
    v_mul_lo_u32 v201, v201, s77
    s_lshl_b32 s101, s76, 6
    s_add_u32 s101, s101, s73
    s_lshl_b32 s101, s101, 15
    s_lshl_b32 s78, s72, 8
    s_add_u32 s101, s101, s78
    s_mul_i32 s77, s73, 13824
    s_min_u32 s78, s72, 26
    s_lshl_b32 s78, s78, 7
    s_add_u32 s77, s77, s78
    s_mov_b32 s50, 5242880
    s_cmp_eq_u32 s76, 3
    s_cselect_b32 s101, s77, s101
    s_cselect_b32 s30, 1769472, 0
    s_cselect_b32 s48, s14, s12
    s_cselect_b32 s49, s15, s13
    s_cselect_b32 s50, 2211840, s50
    s_mov_b32 s51, 0x20000
    s_cselect_b64 s[84:85], -1, 0
    v_cndmask_b32_e64 v184, v200, v201, s[84:85]
    v_cndmask_b32 v182, v182, 1.0, vcc
    v_lshrrev_b32 v180, 5, v195
    s_mov_b32 s78, 40960
    v_mul_lo_u32 v180, v180, s78
    v_bfe_u32 v200, v195, 4, 1
    v_lshl_add_u32 v180, v200, 10, v180
    v_and_b32 v195, 15, v195
    v_lshl_add_u32 v180, v195, 6, v180
    v_lshrrev_b32 v195, 2, v195
    v_sub_u32 v195, 0, v195
    v_xor_b32 v195, v195, v196
    v_and_b32 v195, 3, v195
    v_lshl_add_u32 v180, v195, 4, v180
    v_lshrrev_b32 v195, 2, v196
    v_lshl_add_u32 v180, v195, 11, v180
    v_cndmask_b32 v181, v197, v180, vcc
    s_mov_b32 s92, 16384
    s_mov_b32 s93, 32768
    s_mov_b32 s74, s73
    s_sub_u32 s75, 15, s73
    s_lshl_b32 s31, s72, 19
    s_lshl_b32 s77, s73, 13
    s_add_u32 s31, s31, s77
    s_and_b32 s78, s3, 1
    s_lshl_b32 s79, s78, 12
    s_add_u32 s31, s31, s79
    s_bitcmp1_b32 s3, 1
    s_cselect_b32 s79, 0, 16777216
    s_cselect_b32 s90, 0x3e0293ee, 1.0
    s_cselect_b32 s77, 8192, 0
    s_mov_b32 s91, s90
    s_add_u32 s77, s77, 32768
    s_add_u32 s31, s31, s79
    v_bfe_u32 v200, v193, 2, 2
    v_bfe_u32 v201, v193, 1, 3
    v_xor_b32 v201, v201, v194
    v_lshlrev_b32 v201, 4, v201
    v_and_b32 v202, 15, v193
    v_lshl_add_u32 v245, v202, 7, v201
    v_lshlrev_b32 v201, 2, v194
    v_sub_u32 v241, v202, v201
    v_lshl_add_u32 v201, v194, 3, v200
    v_and_b32 v203, 3, v193
    v_lshlrev_b32 v203, 3, v203
    v_and_b32 v202, 1, v194
    v_lshl_add_u32 v204, v200, 1, v202
    v_lshl_add_u32 v205, v201, 8, v203
    v_lshl_add_u32 v205, v204, 5, v205
    s_lshl_b32 s78, s78, 7
    v_xor_b32 v246, s78, v205
    v_add_u32 v246, s77, v246
    v_xor_b32 v247, 32, v246
    v_xor_b32 v248, 64, v246
    v_xor_b32 v249, 96, v246
    v_add_u32 v250, 131072, v205
    v_xor_b32 v251, 32, v250
    v_xor_b32 v252, 64, v250
    v_xor_b32 v253, 96, v250
    s_lshl_b32 s78, s76, 11
    s_add_u32 s78, s78, 147456
    v_bfe_u32 v200, v193, 2, 2
    v_sub_u32 v200, 0, v200
    v_xor_b32 v200, v200, v194
    v_and_b32 v200, 3, v200
    v_and_b32 v202, 15, v193
    v_lshlrev_b32 v202, 6, v202
    v_lshl_add_u32 v202, v200, 4, v202
    v_add_u32 v242, s78, v202
    s_mov_b32 s97, 0x3fb8aa3b
    s_add_u32 m0, s83, 49152
    s_add_u32 s89, s88, 31744
    buffer_load_dwordx4 v244, s[36:39], s88 offen nt lds
    buffer_load_dwordx4 v244, s[36:39], s89 offen offset:1024 nt lds
    s_add_u32 s88, s88, 262144
    buffer_load_dwordx4 v[128:131], v178, s[64:67], 0 offen nt
    buffer_load_dwordx4 v[132:135], v178, s[64:67], 0 offen offset:512 nt
    buffer_load_dwordx4 v[136:139], v179, s[64:67], 0 offen offset:1024 nt
    s_add_u32 m0, s81, 65536
    s_add_u32 s87, s86, 14336
    buffer_load_dwordx4 v243, s[32:35], s86 offen lds
    buffer_load_dwordx4 v183, s[32:35], s86 offen offset:1024 lds
    buffer_load_dwordx4 v243, s[32:35], s87 offen offset:2048 lds
    buffer_load_dwordx4 v183, s[32:35], s87 offen offset:3072 lds
    s_add_u32 s86, s86, 128
    s_add_u32 m0, s83, 98304
    s_add_u32 s89, s88, 31744
    buffer_load_dwordx4 v244, s[36:39], s88 offen nt lds
    buffer_load_dwordx4 v244, s[36:39], s89 offen offset:1024 nt lds
    s_add_u32 s88, s88, 262144
    s_lshr_b32 s77, s83, 1
    s_lshl_b32 s78, s2, 17
    s_add_u32 s77, s77, s78
    buffer_store_dwordx4 v[186:189], v240, s[52:55], s77 offen sc1
    v_lshlrev_b32 v185, 4, v240
    s_lshl_b32 s77, s76, 14
    s_add_u32 s77, s77, s78
    s_add_u32 s77, s77, 4096
    buffer_store_dwordx4 v[186:189], v185, s[52:55], s77 offen sc1
    buffer_store_dwordx4 v[186:189], v185, s[52:55], s77 offen offset:16 sc1
    v_lshlrev_b32 v185, 12, v0
    s_nop 0
    v_mov_b32 v186, 1
    s_waitcnt vmcnt(14)
    s_barrier
    ds_read_b128 v[192:195], v245 offset:0
    ds_read_b128 v[196:199], v245 offset:2048
    ds_read_b128 v[200:203], v245 offset:4096
    ds_read_b128 v[204:207], v245 offset:6144
    ds_read_b64_tr_b16 v[224:225], v246 offset:0
    ds_read_b64_tr_b16 v[226:227], v246 offset:1024
    ds_read_b64_tr_b16 v[228:229], v247 offset:0
    ds_read_b64_tr_b16 v[230:231], v247 offset:1024
    ds_read_b64_tr_b16 v[232:233], v248 offset:0
    ds_read_b64_tr_b16 v[234:235], v248 offset:1024
    ds_read_b64_tr_b16 v[236:237], v249 offset:0
    ds_read_b64_tr_b16 v[238:239], v249 offset:1024
    s_bitcmp1_b32 s3, 1
    s_cbranch_scc1 KB_XK
    s_waitcnt lgkmcnt(6)
    v_mfma_f32_16x16x32_bf16 v[0:3], v[192:195], v[224:227], 0
    ds_read_b128 v[208:211], v245 offset:8192
    s_add_u32 m0, s83, 114688
    v_mfma_f32_16x16x32_bf16 v[4:7], v[196:199], v[224:227], 0
    ds_read_b128 v[212:215], v245 offset:10240
    s_add_u32 s89, s88, 31744
    v_mfma_f32_16x16x32_bf16 v[32:35], v[200:203], v[224:227], 0
    ds_read_b128 v[216:219], v245 offset:12288
    v_mfma_f32_16x16x32_bf16 v[36:39], v[204:207], v[224:227], 0
    ds_read_b128 v[220:223], v245 offset:14336
    buffer_load_dwordx4 v244, s[36:39], s88 offen nt lds
    s_waitcnt lgkmcnt(8)
    v_mfma_f32_16x16x32_bf16 v[8:11], v[192:195], v[228:231], 0
    v_xor_b32 v245, 64, v245
    v_mfma_f32_16x16x32_bf16 v[12:15], v[196:199], v[228:231], 0
    buffer_load_dwordx4 v244, s[36:39], s89 offen offset:1024 nt lds
    v_mfma_f32_16x16x32_bf16 v[40:43], v[200:203], v[228:231], 0
    v_mfma_f32_16x16x32_bf16 v[44:47], v[204:207], v[228:231], 0
    s_add_u32 s88, s88, 262144
    s_waitcnt lgkmcnt(6)
    v_mfma_f32_16x16x32_bf16 v[16:19], v[192:195], v[232:235], 0
    s_add_u32 m0, s81, 131072
    v_mfma_f32_16x16x32_bf16 v[20:23], v[196:199], v[232:235], 0
    v_mfma_f32_16x16x32_bf16 v[48:51], v[200:203], v[232:235], 0
    s_nop 0
    v_mfma_f32_16x16x32_bf16 v[52:55], v[204:207], v[232:235], 0
    s_waitcnt lgkmcnt(4)
    v_mfma_f32_16x16x32_bf16 v[24:27], v[192:195], v[236:239], 0
    buffer_load_dwordx4 v243, s[32:35], s86 offen lds
    v_mfma_f32_16x16x32_bf16 v[28:31], v[196:199], v[236:239], 0
    v_mfma_f32_16x16x32_bf16 v[56:59], v[200:203], v[236:239], 0
    buffer_load_dwordx4 v183, s[32:35], s86 offen offset:1024 lds
    v_mfma_f32_16x16x32_bf16 v[60:63], v[204:207], v[236:239], 0
    s_waitcnt vmcnt(16) lgkmcnt(0)
    s_barrier
    v_mfma_f32_16x16x32_bf16 v[64:67], v[208:211], v[224:227], 0
    ds_read_b128 v[192:195], v245 offset:0
    s_add_u32 m0, s81, 131072
    s_add_u32 s87, s86, 14336
    buffer_load_dwordx4 v243, s[32:35], s87 offen offset:2048 lds
    buffer_load_dwordx4 v183, s[32:35], s87 offen offset:3072 lds
    v_mfma_f32_16x16x32_bf16 v[68:71], v[212:215], v[224:227], 0
    ds_read_b128 v[196:199], v245 offset:2048
    s_add_u32 s86, s86, 128
    s_add_u32 m0, s83, 32768
    s_add_u32 s89, s88, 31744
    v_mfma_f32_16x16x32_bf16 v[96:99], v[216:219], v[224:227], 0
    ds_read_b128 v[200:203], v245 offset:4096
    buffer_load_dwordx4 v244, s[36:39], s88 offen nt lds
    buffer_load_dwordx4 v244, s[36:39], s89 offen offset:1024 nt lds
    s_add_u32 s88, s88, 262144
    v_mfma_f32_16x16x32_bf16 v[100:103], v[220:223], v[224:227], 0
    ds_read_b64_tr_b16 v[224:225], v246 offset:16384
    ds_read_b64_tr_b16 v[226:227], v246 offset:17408
    ds_read_b128 v[204:207], v245 offset:6144
    s_waitcnt vmcnt(17)
    v_lshlrev_b32 v140, 16, v128
    v_and_b32 v141, 0xffff0000, v128
    v_mfma_f32_16x16x32_bf16 v[72:75], v[208:211], v[228:231], 0
    v_lshlrev_b32 v142, 16, v129
    v_and_b32 v143, 0xffff0000, v129
    v_lshlrev_b32 v144, 16, v130
    v_mfma_f32_16x16x32_bf16 v[76:79], v[212:215], v[228:231], 0
    v_and_b32 v145, 0xffff0000, v130
    v_lshlrev_b32 v146, 16, v131
    v_and_b32 v147, 0xffff0000, v131
    v_mfma_f32_16x16x32_bf16 v[104:107], v[216:219], v[228:231], 0
    v_lshlrev_b32 v148, 16, v132
    v_and_b32 v149, 0xffff0000, v132
    v_lshlrev_b32 v150, 16, v133
    v_mfma_f32_16x16x32_bf16 v[108:111], v[220:223], v[228:231], 0
    ds_read_b64_tr_b16 v[228:229], v247 offset:16384
    ds_read_b64_tr_b16 v[230:231], v247 offset:17408
    v_and_b32 v151, 0xffff0000, v133
    v_lshlrev_b32 v152, 16, v134
    v_and_b32 v153, 0xffff0000, v134
    v_mfma_f32_16x16x32_bf16 v[80:83], v[208:211], v[232:235], 0
    v_lshlrev_b32 v154, 16, v135
    v_and_b32 v155, 0xffff0000, v135
    v_lshlrev_b32 v156, 16, v136
    v_and_b32 v157, 0xffff0000, v136
    v_mfma_f32_16x16x32_bf16 v[84:87], v[212:215], v[232:235], 0
    v_lshlrev_b32 v158, 16, v137
    v_and_b32 v159, 0xffff0000, v137
    v_lshlrev_b32 v160, 16, v138
    v_mfma_f32_16x16x32_bf16 v[112:115], v[216:219], v[232:235], 0
    v_and_b32 v161, 0xffff0000, v138
    v_lshlrev_b32 v162, 16, v139
    v_and_b32 v163, 0xffff0000, v139
    v_mfma_f32_16x16x32_bf16 v[116:119], v[220:223], v[232:235], 0
    ds_read_b64_tr_b16 v[232:233], v248 offset:16384
    ds_read_b64_tr_b16 v[234:235], v248 offset:17408
    v_add_f32 v164, v140, v141
    v_add_f32 v165, v142, v143
    v_add_f32 v164, v164, v144
    v_mfma_f32_16x16x32_bf16 v[88:91], v[208:211], v[236:239], 0
    v_add_f32 v165, v165, v145
    v_add_f32 v164, v164, v146
    v_add_f32 v165, v165, v147
    v_mfma_f32_16x16x32_bf16 v[92:95], v[212:215], v[236:239], 0
    v_add_f32 v164, v164, v148
    v_add_f32 v165, v165, v149
    v_add_f32 v164, v164, v150
    v_mfma_f32_16x16x32_bf16 v[120:123], v[216:219], v[236:239], 0
    v_add_f32 v165, v165, v151
    v_add_f32 v164, v164, v152
    v_add_f32 v165, v165, v153
    v_mfma_f32_16x16x32_bf16 v[124:127], v[220:223], v[236:239], 0
    ds_read_b64_tr_b16 v[236:237], v249 offset:16384
    ds_read_b64_tr_b16 v[238:239], v249 offset:17408
    v_add_f32 v164, v164, v154
    v_add_f32 v165, v165, v155
    v_add_f32 v164, v164, v156
    s_waitcnt lgkmcnt(6)
    v_mfma_f32_16x16x32_bf16 v[0:3], v[192:195], v[224:227], v[0:3]
    ds_read_b128 v[208:211], v245 offset:8192
    v_add_f32 v165, v165, v157
    v_add_f32 v164, v164, v158
    v_add_f32 v165, v165, v159
    v_mfma_f32_16x16x32_bf16 v[4:7], v[196:199], v[224:227], v[4:7]
    ds_read_b128 v[212:215], v245 offset:10240
    v_add_f32 v164, v164, v160
    v_add_f32 v165, v165, v161
    v_mfma_f32_16x16x32_bf16 v[32:35], v[200:203], v[224:227], v[32:35]
    ds_read_b128 v[216:219], v245 offset:12288
    v_add_f32 v164, v164, v162
    v_add_f32 v165, v165, v163
    v_add_f32 v164, v164, v165
    v_mfma_f32_16x16x32_bf16 v[36:39], v[204:207], v[224:227], v[36:39]
    ds_read_b128 v[220:223], v245 offset:14336
    s_nop 1
    v_add_f32_dpp v164, v164, v164 quad_perm:[1,0,3,2] row_mask:0xf bank_mask:0xf
    s_waitcnt lgkmcnt(8)
    v_mfma_f32_16x16x32_bf16 v[8:11], v[192:195], v[228:231], v[8:11]
    v_xor_b32 v245, 64, v245
    s_nop 1
    v_add_f32_dpp v164, v164, v164 quad_perm:[2,3,0,1] row_mask:0xf bank_mask:0xf
    s_nop 1
    v_mfma_f32_16x16x32_bf16 v[12:15], v[196:199], v[228:231], v[12:15]
    v_add_u32 v245, 0x10000, v245
    v_add_f32_dpp v164, v164, v164 row_ror:8 row_mask:0xf bank_mask:0xf
    v_mov_b32 v169, v164
    v_mfma_f32_16x16x32_bf16 v[40:43], v[200:203], v[228:231], v[40:43]
    v_xor_b32 v246, 0x10000, v246
    s_nop 1
    v_permlane16_swap_b32 v164, v169
    v_add_f32 v164, v164, v169
    v_mfma_f32_16x16x32_bf16 v[44:47], v[204:207], v[228:231], v[44:47]
    v_xor_b32 v247, 0x10000, v247
    v_mov_b32 v169, v164
    s_nop 1
    s_waitcnt lgkmcnt(6)
    v_mfma_f32_16x16x32_bf16 v[16:19], v[192:195], v[232:235], v[16:19]
    v_xor_b32 v248, 0x10000, v248
    v_permlane32_swap_b32 v164, v169
    v_add_f32 v164, v164, v169
    v_mul_f32 v171, 0x3acccccd, v164
    v_mfma_f32_16x16x32_bf16 v[20:23], v[196:199], v[232:235], v[20:23]
    v_xor_b32 v249, 0x10000, v249
    v_sub_f32 v174, v140, v171
    v_mul_f32 v166, v174, v174
    v_mfma_f32_16x16x32_bf16 v[48:51], v[200:203], v[232:235], v[48:51]
    v_sub_f32 v175, v141, v171
    v_mul_f32 v167, v175, v175
    v_sub_f32 v176, v142, v171
    v_mfma_f32_16x16x32_bf16 v[52:55], v[204:207], v[232:235], v[52:55]
    v_fmac_f32 v166, v176, v176
    v_sub_f32 v177, v143, v171
    s_waitcnt lgkmcnt(4)
    v_mfma_f32_16x16x32_bf16 v[24:27], v[192:195], v[236:239], v[24:27]
    v_fmac_f32 v167, v177, v177
    v_sub_f32 v174, v144, v171
    v_fmac_f32 v166, v174, v174
    v_mfma_f32_16x16x32_bf16 v[28:31], v[196:199], v[236:239], v[28:31]
    v_sub_f32 v175, v145, v171
    v_fmac_f32 v167, v175, v175
    v_mfma_f32_16x16x32_bf16 v[56:59], v[200:203], v[236:239], v[56:59]
    v_sub_f32 v176, v146, v171
    v_fmac_f32 v166, v176, v176
    v_sub_f32 v177, v147, v171
    v_mfma_f32_16x16x32_bf16 v[60:63], v[204:207], v[236:239], v[60:63]
    v_fmac_f32 v167, v177, v177
    v_sub_f32 v174, v148, v171
    s_waitcnt vmcnt(8) lgkmcnt(0)
    s_barrier
    v_mfma_f32_16x16x32_bf16 v[64:67], v[208:211], v[224:227], v[64:67]
    ds_read_b128 v[192:195], v245 offset:0
    s_lshl_b32 s77, s2, 12
    buffer_store_dword v186, v185, s[60:63], s77 offen sc1
    s_add_u32 m0, s83, 49152
    s_add_u32 s89, s88, 31744
    v_mfma_f32_16x16x32_bf16 v[68:71], v[212:215], v[224:227], v[68:71]
    ds_read_b128 v[196:199], v245 offset:2048
    buffer_load_dwordx4 v244, s[36:39], s88 offen nt lds
    buffer_load_dwordx4 v244, s[36:39], s89 offen offset:1024 nt lds
    s_add_u32 s88, s88, 262144
    v_mfma_f32_16x16x32_bf16 v[96:99], v[216:219], v[224:227], v[96:99]
    ds_read_b128 v[200:203], v245 offset:4096
    s_add_u32 m0, s81, 0
    s_nop 0
    buffer_load_dwordx4 v243, s[32:35], s86 offen lds
    v_mfma_f32_16x16x32_bf16 v[100:103], v[220:223], v[224:227], v[100:103]
    ds_read_b64_tr_b16 v[224:225], v246 offset:0
    ds_read_b64_tr_b16 v[226:227], v246 offset:1024
    ds_read_b128 v[204:207], v245 offset:6144
    buffer_load_dwordx4 v183, s[32:35], s86 offen offset:1024 lds
    v_fmac_f32 v166, v174, v174
    v_sub_f32 v175, v149, v171
    v_mfma_f32_16x16x32_bf16 v[72:75], v[208:211], v[228:231], v[72:75]
    v_fmac_f32 v167, v175, v175
    v_sub_f32 v176, v150, v171
    v_fmac_f32 v166, v176, v176
    v_mfma_f32_16x16x32_bf16 v[76:79], v[212:215], v[228:231], v[76:79]
    v_sub_f32 v177, v151, v171
    v_fmac_f32 v167, v177, v177
    v_sub_f32 v174, v152, v171
    v_fmac_f32 v166, v174, v174
    v_mfma_f32_16x16x32_bf16 v[104:107], v[216:219], v[228:231], v[104:107]
    v_sub_f32 v175, v153, v171
    v_fmac_f32 v167, v175, v175
    v_sub_f32 v176, v154, v171
    v_mfma_f32_16x16x32_bf16 v[108:111], v[220:223], v[228:231], v[108:111]
    ds_read_b64_tr_b16 v[228:229], v247 offset:0
    ds_read_b64_tr_b16 v[230:231], v247 offset:1024
    v_fmac_f32 v166, v176, v176
    v_sub_f32 v177, v155, v171
    v_fmac_f32 v167, v177, v177
    v_mfma_f32_16x16x32_bf16 v[80:83], v[208:211], v[232:235], v[80:83]
    v_sub_f32 v174, v156, v171
    v_mul_f32 v168, v174, v174
    v_sub_f32 v175, v157, v171
    v_mfma_f32_16x16x32_bf16 v[84:87], v[212:215], v[232:235], v[84:87]
    v_fmac_f32 v168, v175, v175
    v_sub_f32 v176, v158, v171
    v_fmac_f32 v168, v176, v176
    v_mfma_f32_16x16x32_bf16 v[112:115], v[216:219], v[232:235], v[112:115]
    v_sub_f32 v177, v159, v171
    v_fmac_f32 v168, v177, v177
    v_sub_f32 v174, v160, v171
    v_fmac_f32 v168, v174, v174
    v_mfma_f32_16x16x32_bf16 v[116:119], v[220:223], v[232:235], v[116:119]
    ds_read_b64_tr_b16 v[232:233], v248 offset:0
    ds_read_b64_tr_b16 v[234:235], v248 offset:1024
    v_sub_f32 v175, v161, v171
    v_fmac_f32 v168, v175, v175
    v_sub_f32 v176, v162, v171
    v_mfma_f32_16x16x32_bf16 v[88:91], v[208:211], v[236:239], v[88:91]
    v_fmac_f32 v168, v176, v176
    v_sub_f32 v177, v163, v171
    v_fmac_f32 v168, v177, v177
    v_mfma_f32_16x16x32_bf16 v[92:95], v[212:215], v[236:239], v[92:95]
    v_add_f32 v166, v166, v167
    v_fmac_f32 v166, v168, v182
    s_nop 1
    v_mfma_f32_16x16x32_bf16 v[120:123], v[216:219], v[236:239], v[120:123]
    v_add_f32_dpp v166, v166, v166 quad_perm:[1,0,3,2] row_mask:0xf bank_mask:0xf
    s_nop 1
    v_add_f32_dpp v166, v166, v166 quad_perm:[2,3,0,1] row_mask:0xf bank_mask:0xf
    v_mfma_f32_16x16x32_bf16 v[124:127], v[220:223], v[236:239], v[124:127]
    ds_read_b64_tr_b16 v[236:237], v249 offset:0
    ds_read_b64_tr_b16 v[238:239], v249 offset:1024
    s_nop 1
    v_add_f32_dpp v166, v166, v166 row_ror:8 row_mask:0xf bank_mask:0xf
    v_mov_b32 v169, v166
    s_waitcnt lgkmcnt(6)
    v_mfma_f32_16x16x32_bf16 v[0:3], v[192:195], v[224:227], v[0:3]
    ds_read_b128 v[208:211], v245 offset:8192
    s_nop 1
    v_permlane16_swap_b32 v166, v169
    v_add_f32 v166, v166, v169
    v_mfma_f32_16x16x32_bf16 v[4:7], v[196:199], v[224:227], v[4:7]
    ds_read_b128 v[212:215], v245 offset:10240
    v_mov_b32 v169, v166
    s_nop 1
    v_mfma_f32_16x16x32_bf16 v[32:35], v[200:203], v[224:227], v[32:35]
    ds_read_b128 v[216:219], v245 offset:12288
    v_permlane32_swap_b32 v166, v169
    v_add_f32 v166, v166, v169
    v_mul_f32 v166, 0x3acccccd, v166
    v_mfma_f32_16x16x32_bf16 v[36:39], v[204:207], v[224:227], v[36:39]
    ds_read_b128 v[220:223], v245 offset:14336
    v_cvt_pk_bf16_f32 v172, v171, v171
    v_and_b32 v172, 0xffff0000, v172
    s_waitcnt lgkmcnt(8)
    v_mfma_f32_16x16x32_bf16 v[8:11], v[192:195], v[228:231], v[8:11]
    v_xor_b32 v245, 64, v245
    v_cvt_pk_bf16_f32 v166, v166, v166
    v_and_b32 v166, 0xffff0000, v166
    v_add_f32 v166, 0x3727c5ac, v166
    v_mfma_f32_16x16x32_bf16 v[12:15], v[196:199], v[228:231], v[12:15]
    v_cvt_pk_bf16_f32 v166, v166, v166
    v_and_b32 v166, 0xffff0000, v166
    v_mfma_f32_16x16x32_bf16 v[40:43], v[200:203], v[228:231], v[40:43]
    v_sqrt_f32 v166, v166
    s_nop 0
    v_cvt_pk_bf16_f32 v166, v166, v166
    v_mfma_f32_16x16x32_bf16 v[44:47], v[204:207], v[228:231], v[44:47]
    v_and_b32 v166, 0xffff0000, v166
    v_rcp_f32 v173, v166
    s_waitcnt lgkmcnt(6)
    v_mfma_f32_16x16x32_bf16 v[16:19], v[192:195], v[232:235], v[16:19]
    v_sub_f32 v140, v140, v172
    v_sub_f32 v141, v141, v172
    v_cvt_pk_bf16_f32 v170, v140, v141
    v_mfma_f32_16x16x32_bf16 v[20:23], v[196:199], v[232:235], v[20:23]
    v_lshlrev_b32 v140, 16, v170
    v_and_b32 v141, 0xffff0000, v170
    v_mfma_f32_16x16x32_bf16 v[48:51], v[200:203], v[232:235], v[48:51]
    v_mul_f32 v140, v140, v173
    v_mul_f32 v141, v141, v173
    v_cvt_pk_bf16_f32 v128, v140, v141
    v_mfma_f32_16x16x32_bf16 v[52:55], v[204:207], v[232:235], v[52:55]
    v_sub_f32 v142, v142, v172
    v_sub_f32 v143, v143, v172
    s_waitcnt lgkmcnt(4)
    v_mfma_f32_16x16x32_bf16 v[24:27], v[192:195], v[236:239], v[24:27]
    v_cvt_pk_bf16_f32 v170, v142, v143
    v_lshlrev_b32 v142, 16, v170
    v_and_b32 v143, 0xffff0000, v170
    v_mfma_f32_16x16x32_bf16 v[28:31], v[196:199], v[236:239], v[28:31]
    v_mul_f32 v142, v142, v173
    v_mul_f32 v143, v143, v173
    v_mfma_f32_16x16x32_bf16 v[56:59], v[200:203], v[236:239], v[56:59]
    v_cvt_pk_bf16_f32 v129, v142, v143
    v_sub_f32 v144, v144, v172
    v_sub_f32 v145, v145, v172
    v_mfma_f32_16x16x32_bf16 v[60:63], v[204:207], v[236:239], v[60:63]
    v_cvt_pk_bf16_f32 v170, v144, v145
    v_lshlrev_b32 v144, 16, v170
    s_waitcnt vmcnt(11) lgkmcnt(0)
    s_barrier
    v_mfma_f32_16x16x32_bf16 v[64:67], v[208:211], v[224:227], v[64:67]
    ds_read_b128 v[192:195], v245 offset:0
    s_add_u32 m0, s81, 0
    s_add_u32 s87, s86, 14336
    buffer_load_dwordx4 v243, s[32:35], s87 offen offset:2048 lds
    buffer_load_dwordx4 v183, s[32:35], s87 offen offset:3072 lds
    v_mfma_f32_16x16x32_bf16 v[68:71], v[212:215], v[224:227], v[68:71]
    ds_read_b128 v[196:199], v245 offset:2048
    s_add_u32 s86, s86, 128
    s_add_u32 m0, s83, 98304
    s_add_u32 s89, s88, 31744
    v_mfma_f32_16x16x32_bf16 v[96:99], v[216:219], v[224:227], v[96:99]
    ds_read_b128 v[200:203], v245 offset:4096
    buffer_load_dwordx4 v244, s[36:39], s88 offen nt lds
    buffer_load_dwordx4 v244, s[36:39], s89 offen offset:1024 nt lds
    s_add_u32 s88, s88, 262144
    v_mfma_f32_16x16x32_bf16 v[100:103], v[220:223], v[224:227], v[100:103]
    ds_read_b64_tr_b16 v[224:225], v246 offset:16384
    ds_read_b64_tr_b16 v[226:227], v246 offset:17408
    ds_read_b128 v[204:207], v245 offset:6144
    v_and_b32 v145, 0xffff0000, v170
    v_mul_f32 v144, v144, v173
    v_mul_f32 v145, v145, v173
    v_mfma_f32_16x16x32_bf16 v[72:75], v[208:211], v[228:231], v[72:75]
    v_cvt_pk_bf16_f32 v130, v144, v145
    v_sub_f32 v146, v146, v172
    v_sub_f32 v147, v147, v172
    v_mfma_f32_16x16x32_bf16 v[76:79], v[212:215], v[228:231], v[76:79]
    v_cvt_pk_bf16_f32 v170, v146, v147
    v_lshlrev_b32 v146, 16, v170
    v_and_b32 v147, 0xffff0000, v170
    v_mfma_f32_16x16x32_bf16 v[104:107], v[216:219], v[228:231], v[104:107]
    v_mul_f32 v146, v146, v173
    v_mul_f32 v147, v147, v173
    v_cvt_pk_bf16_f32 v131, v146, v147
    v_mfma_f32_16x16x32_bf16 v[108:111], v[220:223], v[228:231], v[108:111]
    ds_read_b64_tr_b16 v[228:229], v247 offset:16384
    ds_read_b64_tr_b16 v[230:231], v247 offset:17408
    v_sub_f32 v148, v148, v172
    v_sub_f32 v149, v149, v172
    v_cvt_pk_bf16_f32 v170, v148, v149
    v_mfma_f32_16x16x32_bf16 v[80:83], v[208:211], v[232:235], v[80:83]
    v_lshlrev_b32 v148, 16, v170
    v_and_b32 v149, 0xffff0000, v170
    v_mul_f32 v148, v148, v173
    v_mul_f32 v149, v149, v173
    v_mfma_f32_16x16x32_bf16 v[84:87], v[212:215], v[232:235], v[84:87]
    v_cvt_pk_bf16_f32 v132, v148, v149
    v_sub_f32 v150, v150, v172
    v_sub_f32 v151, v151, v172
    v_mfma_f32_16x16x32_bf16 v[112:115], v[216:219], v[232:235], v[112:115]
    v_cvt_pk_bf16_f32 v170, v150, v151
    v_lshlrev_b32 v150, 16, v170
    v_and_b32 v151, 0xffff0000, v170
    v_mfma_f32_16x16x32_bf16 v[116:119], v[220:223], v[232:235], v[116:119]
    ds_read_b64_tr_b16 v[232:233], v248 offset:16384
    ds_read_b64_tr_b16 v[234:235], v248 offset:17408
    v_mul_f32 v150, v150, v173
    v_mul_f32 v151, v151, v173
    v_cvt_pk_bf16_f32 v133, v150, v151
    v_mfma_f32_16x16x32_bf16 v[88:91], v[208:211], v[236:239], v[88:91]
    v_sub_f32 v152, v152, v172
    v_sub_f32 v153, v153, v172
    v_cvt_pk_bf16_f32 v170, v152, v153
    v_mfma_f32_16x16x32_bf16 v[92:95], v[212:215], v[236:239], v[92:95]
    v_lshlrev_b32 v152, 16, v170
    v_and_b32 v153, 0xffff0000, v170
    v_mul_f32 v152, v152, v173
    v_mfma_f32_16x16x32_bf16 v[120:123], v[216:219], v[236:239], v[120:123]
    v_mul_f32 v153, v153, v173
    v_cvt_pk_bf16_f32 v134, v152, v153
    v_sub_f32 v154, v154, v172
    v_mfma_f32_16x16x32_bf16 v[124:127], v[220:223], v[236:239], v[124:127]
    ds_read_b64_tr_b16 v[236:237], v249 offset:16384
    ds_read_b64_tr_b16 v[238:239], v249 offset:17408
    v_sub_f32 v155, v155, v172
    v_cvt_pk_bf16_f32 v170, v154, v155
    v_lshlrev_b32 v154, 16, v170
    s_waitcnt lgkmcnt(6)
    v_mfma_f32_16x16x32_bf16 v[0:3], v[192:195], v[224:227], v[0:3]
    ds_read_b128 v[208:211], v245 offset:8192
    v_and_b32 v155, 0xffff0000, v170
    v_mul_f32 v154, v154, v173
    v_mul_f32 v155, v155, v173
    v_mfma_f32_16x16x32_bf16 v[4:7], v[196:199], v[224:227], v[4:7]
    ds_read_b128 v[212:215], v245 offset:10240
    v_cvt_pk_bf16_f32 v135, v154, v155
    v_sub_f32 v156, v156, v172
    v_mfma_f32_16x16x32_bf16 v[32:35], v[200:203], v[224:227], v[32:35]
    ds_read_b128 v[216:219], v245 offset:12288
    v_sub_f32 v157, v157, v172
    v_cvt_pk_bf16_f32 v170, v156, v157
    v_lshlrev_b32 v156, 16, v170
    v_mfma_f32_16x16x32_bf16 v[36:39], v[204:207], v[224:227], v[36:39]
    ds_read_b128 v[220:223], v245 offset:14336
    v_and_b32 v157, 0xffff0000, v170
    v_mul_f32 v156, v156, v173
    s_waitcnt lgkmcnt(8)
    v_mfma_f32_16x16x32_bf16 v[8:11], v[192:195], v[228:231], v[8:11]
    v_xor_b32 v245, 64, v245
    v_mul_f32 v157, v157, v173
    v_cvt_pk_bf16_f32 v136, v156, v157
    v_sub_f32 v158, v158, v172
    v_mfma_f32_16x16x32_bf16 v[12:15], v[196:199], v[228:231], v[12:15]
    v_add_u32 v245, 0x10000, v245
    v_sub_f32 v159, v159, v172
    v_cvt_pk_bf16_f32 v170, v158, v159
    v_mfma_f32_16x16x32_bf16 v[40:43], v[200:203], v[228:231], v[40:43]
    v_xor_b32 v246, 0x10000, v246
    v_lshlrev_b32 v158, 16, v170
    v_and_b32 v159, 0xffff0000, v170
    v_mul_f32 v158, v158, v173
    v_mfma_f32_16x16x32_bf16 v[44:47], v[204:207], v[228:231], v[44:47]
    v_xor_b32 v247, 0x10000, v247
    v_mul_f32 v159, v159, v173
    v_cvt_pk_bf16_f32 v137, v158, v159
    s_waitcnt lgkmcnt(6)
    v_mfma_f32_16x16x32_bf16 v[16:19], v[192:195], v[232:235], v[16:19]
    v_xor_b32 v248, 0x10000, v248
    v_sub_f32 v160, v160, v172
    v_sub_f32 v161, v161, v172
    v_mfma_f32_16x16x32_bf16 v[20:23], v[196:199], v[232:235], v[20:23]
    v_xor_b32 v249, 0x10000, v249
    v_cvt_pk_bf16_f32 v170, v160, v161
    v_lshlrev_b32 v160, 16, v170
    v_and_b32 v161, 0xffff0000, v170
    v_mfma_f32_16x16x32_bf16 v[48:51], v[200:203], v[232:235], v[48:51]
    v_mul_f32 v160, v160, v173
    v_mul_f32 v161, v161, v173
    v_mfma_f32_16x16x32_bf16 v[52:55], v[204:207], v[232:235], v[52:55]
    v_cvt_pk_bf16_f32 v138, v160, v161
    v_sub_f32 v162, v162, v172
    v_sub_f32 v163, v163, v172
    s_waitcnt lgkmcnt(4)
    v_mfma_f32_16x16x32_bf16 v[24:27], v[192:195], v[236:239], v[24:27]
    v_cvt_pk_bf16_f32 v170, v162, v163
    v_lshlrev_b32 v162, 16, v170
    v_mfma_f32_16x16x32_bf16 v[28:31], v[196:199], v[236:239], v[28:31]
    v_and_b32 v163, 0xffff0000, v170
    v_mul_f32 v162, v162, v173
    v_mul_f32 v163, v163, v173
    v_mfma_f32_16x16x32_bf16 v[56:59], v[200:203], v[236:239], v[56:59]
    v_cvt_pk_bf16_f32 v139, v162, v163
    buffer_store_dwordx4 v[128:131], v180, s[44:47], 0 offen sc1
    v_mfma_f32_16x16x32_bf16 v[60:63], v[204:207], v[236:239], v[60:63]
    buffer_store_dwordx4 v[132:135], v180, s[44:47], s92 offen sc1
    buffer_store_dwordx4 v[136:139], v181, s[44:47], s93 offen sc1
    s_waitcnt vmcnt(12) lgkmcnt(0)
    s_barrier
    v_mfma_f32_16x16x32_bf16 v[64:67], v[208:211], v[224:227], v[64:67]
    ds_read_b128 v[192:195], v245 offset:0
    s_add_u32 m0, s83, 114688
    v_mfma_f32_16x16x32_bf16 v[68:71], v[212:215], v[224:227], v[68:71]
    ds_read_b128 v[196:199], v245 offset:2048
    s_add_u32 s89, s88, 31744
    v_mfma_f32_16x16x32_bf16 v[96:99], v[216:219], v[224:227], v[96:99]
    ds_read_b128 v[200:203], v245 offset:4096
    v_mfma_f32_16x16x32_bf16 v[100:103], v[220:223], v[224:227], v[100:103]
    ds_read_b64_tr_b16 v[224:225], v246 offset:0
    ds_read_b64_tr_b16 v[226:227], v246 offset:1024
    ds_read_b128 v[204:207], v245 offset:6144
    buffer_load_dwordx4 v244, s[36:39], s88 offen nt lds
    v_mfma_f32_16x16x32_bf16 v[72:75], v[208:211], v[228:231], v[72:75]
    v_mfma_f32_16x16x32_bf16 v[76:79], v[212:215], v[228:231], v[76:79]
    buffer_load_dwordx4 v244, s[36:39], s89 offen offset:1024 nt lds
    v_mfma_f32_16x16x32_bf16 v[104:107], v[216:219], v[228:231], v[104:107]
    v_mfma_f32_16x16x32_bf16 v[108:111], v[220:223], v[228:231], v[108:111]
    ds_read_b64_tr_b16 v[228:229], v247 offset:0
    ds_read_b64_tr_b16 v[230:231], v247 offset:1024
    s_add_u32 s88, s88, 262144
    v_mfma_f32_16x16x32_bf16 v[80:83], v[208:211], v[232:235], v[80:83]
    s_add_u32 m0, s81, 65536
    v_mfma_f32_16x16x32_bf16 v[84:87], v[212:215], v[232:235], v[84:87]
    v_mfma_f32_16x16x32_bf16 v[112:115], v[216:219], v[232:235], v[112:115]
    s_nop 0
    v_mfma_f32_16x16x32_bf16 v[116:119], v[220:223], v[232:235], v[116:119]
    ds_read_b64_tr_b16 v[232:233], v248 offset:0
    ds_read_b64_tr_b16 v[234:235], v248 offset:1024
    v_mfma_f32_16x16x32_bf16 v[88:91], v[208:211], v[236:239], v[88:91]
    buffer_load_dwordx4 v243, s[32:35], s86 offen lds
    v_mfma_f32_16x16x32_bf16 v[92:95], v[212:215], v[236:239], v[92:95]
    v_mfma_f32_16x16x32_bf16 v[120:123], v[216:219], v[236:239], v[120:123]
    buffer_load_dwordx4 v183, s[32:35], s86 offen offset:1024 lds
    v_mfma_f32_16x16x32_bf16 v[124:127], v[220:223], v[236:239], v[124:127]
    ds_read_b64_tr_b16 v[236:237], v249 offset:0
    ds_read_b64_tr_b16 v[238:239], v249 offset:1024
    s_waitcnt lgkmcnt(6)
    v_mfma_f32_16x16x32_bf16 v[0:3], v[192:195], v[224:227], v[0:3]
    ds_read_b128 v[208:211], v245 offset:8192
    v_mfma_f32_16x16x32_bf16 v[4:7], v[196:199], v[224:227], v[4:7]
    ds_read_b128 v[212:215], v245 offset:10240
    v_mfma_f32_16x16x32_bf16 v[32:35], v[200:203], v[224:227], v[32:35]
    ds_read_b128 v[216:219], v245 offset:12288
    v_mfma_f32_16x16x32_bf16 v[36:39], v[204:207], v[224:227], v[36:39]
    ds_read_b128 v[220:223], v245 offset:14336
    s_waitcnt lgkmcnt(8)
    v_mfma_f32_16x16x32_bf16 v[8:11], v[192:195], v[228:231], v[8:11]
    v_xor_b32 v245, 64, v245
    v_mfma_f32_16x16x32_bf16 v[12:15], v[196:199], v[228:231], v[12:15]
    v_mfma_f32_16x16x32_bf16 v[40:43], v[200:203], v[228:231], v[40:43]
    v_mfma_f32_16x16x32_bf16 v[44:47], v[204:207], v[228:231], v[44:47]
    s_waitcnt lgkmcnt(6)
    v_mfma_f32_16x16x32_bf16 v[16:19], v[192:195], v[232:235], v[16:19]
    v_mfma_f32_16x16x32_bf16 v[20:23], v[196:199], v[232:235], v[20:23]
    v_mfma_f32_16x16x32_bf16 v[48:51], v[200:203], v[232:235], v[48:51]
    v_mfma_f32_16x16x32_bf16 v[52:55], v[204:207], v[232:235], v[52:55]
    s_waitcnt lgkmcnt(4)
    v_mfma_f32_16x16x32_bf16 v[24:27], v[192:195], v[236:239], v[24:27]
    v_mfma_f32_16x16x32_bf16 v[28:31], v[196:199], v[236:239], v[28:31]
    v_mfma_f32_16x16x32_bf16 v[56:59], v[200:203], v[236:239], v[56:59]
    v_mfma_f32_16x16x32_bf16 v[60:63], v[204:207], v[236:239], v[60:63]
    s_waitcnt vmcnt(13) lgkmcnt(0)
    s_barrier
    v_mfma_f32_16x16x32_bf16 v[64:67], v[208:211], v[224:227], v[64:67]
    ds_read_b128 v[192:195], v245 offset:0
    s_add_u32 m0, s81, 65536
    v_mfma_f32_16x16x32_bf16 v[68:71], v[212:215], v[224:227], v[68:71]
    ds_read_b128 v[196:199], v245 offset:2048
    s_add_u32 s87, s86, 14336
    v_mfma_f32_16x16x32_bf16 v[96:99], v[216:219], v[224:227], v[96:99]
    ds_read_b128 v[200:203], v245 offset:4096
    v_mfma_f32_16x16x32_bf16 v[100:103], v[220:223], v[224:227], v[100:103]
    ds_read_b64_tr_b16 v[224:225], v246 offset:16384
    ds_read_b64_tr_b16 v[226:227], v246 offset:17408
    ds_read_b128 v[204:207], v245 offset:6144
    buffer_load_dwordx4 v243, s[32:35], s87 offen offset:2048 lds
    v_mfma_f32_16x16x32_bf16 v[72:75], v[208:211], v[228:231], v[72:75]
    buffer_load_dwordx4 v183, s[32:35], s87 offen offset:3072 lds
    v_mfma_f32_16x16x32_bf16 v[76:79], v[212:215], v[228:231], v[76:79]
    v_mfma_f32_16x16x32_bf16 v[104:107], v[216:219], v[228:231], v[104:107]
    s_add_u32 s86, s86, 128
    v_mfma_f32_16x16x32_bf16 v[108:111], v[220:223], v[228:231], v[108:111]
    ds_read_b64_tr_b16 v[228:229], v247 offset:16384
    ds_read_b64_tr_b16 v[230:231], v247 offset:17408
    v_mfma_f32_16x16x32_bf16 v[80:83], v[208:211], v[232:235], v[80:83]
    s_add_u32 m0, s83, 32768
    v_mfma_f32_16x16x32_bf16 v[84:87], v[212:215], v[232:235], v[84:87]
    s_add_u32 s89, s88, 31744
    v_mfma_f32_16x16x32_bf16 v[112:115], v[216:219], v[232:235], v[112:115]
    v_mfma_f32_16x16x32_bf16 v[116:119], v[220:223], v[232:235], v[116:119]
    ds_read_b64_tr_b16 v[232:233], v248 offset:16384
    ds_read_b64_tr_b16 v[234:235], v248 offset:17408
    buffer_load_dwordx4 v244, s[36:39], s88 offen nt lds
    v_mfma_f32_16x16x32_bf16 v[88:91], v[208:211], v[236:239], v[88:91]
    buffer_load_dwordx4 v244, s[36:39], s89 offen offset:1024 nt lds
    v_mfma_f32_16x16x32_bf16 v[92:95], v[212:215], v[236:239], v[92:95]
    v_mfma_f32_16x16x32_bf16 v[120:123], v[216:219], v[236:239], v[120:123]
    s_add_u32 s88, s88, 262144
    v_mfma_f32_16x16x32_bf16 v[124:127], v[220:223], v[236:239], v[124:127]
    ds_read_b64_tr_b16 v[236:237], v249 offset:16384
    ds_read_b64_tr_b16 v[238:239], v249 offset:17408
    s_waitcnt lgkmcnt(6)
    v_mfma_f32_16x16x32_bf16 v[0:3], v[192:195], v[224:227], v[0:3]
    ds_read_b128 v[208:211], v245 offset:8192
    s_cmp_eq_u32 s76, 0
    v_mfma_f32_16x16x32_bf16 v[4:7], v[196:199], v[224:227], v[4:7]
    ds_read_b128 v[212:215], v245 offset:10240
    v_mfma_f32_16x16x32_bf16 v[32:35], v[200:203], v[224:227], v[32:35]
    ds_read_b128 v[216:219], v245 offset:12288
    v_mfma_f32_16x16x32_bf16 v[36:39], v[204:207], v[224:227], v[36:39]
    ds_read_b128 v[220:223], v245 offset:14336
    s_waitcnt lgkmcnt(8)
    v_mfma_f32_16x16x32_bf16 v[8:11], v[192:195], v[228:231], v[8:11]
    v_xor_b32 v245, 64, v245
    v_mfma_f32_16x16x32_bf16 v[12:15], v[196:199], v[228:231], v[12:15]
    v_add_u32 v245, 0xfffe0000, v245
    s_cselect_b32 s78, s101, 0x40000000
    v_mfma_f32_16x16x32_bf16 v[40:43], v[200:203], v[228:231], v[40:43]
    v_xor_b32 v246, 0x10000, v246
    v_mfma_f32_16x16x32_bf16 v[44:47], v[204:207], v[228:231], v[44:47]
    v_xor_b32 v247, 0x10000, v247
    s_waitcnt lgkmcnt(6)
    v_mfma_f32_16x16x32_bf16 v[16:19], v[192:195], v[232:235], v[16:19]
    v_xor_b32 v248, 0x10000, v248
    v_mfma_f32_16x16x32_bf16 v[20:23], v[196:199], v[232:235], v[20:23]
    v_xor_b32 v249, 0x10000, v249
    v_mfma_f32_16x16x32_bf16 v[48:51], v[200:203], v[232:235], v[48:51]
    buffer_load_dword v254, v184, s[48:51], s78 offen
    v_mfma_f32_16x16x32_bf16 v[52:55], v[204:207], v[232:235], v[52:55]
    s_waitcnt lgkmcnt(4)
    v_mfma_f32_16x16x32_bf16 v[24:27], v[192:195], v[236:239], v[24:27]
    v_mfma_f32_16x16x32_bf16 v[28:31], v[196:199], v[236:239], v[28:31]
    v_mfma_f32_16x16x32_bf16 v[56:59], v[200:203], v[236:239], v[56:59]
    v_mfma_f32_16x16x32_bf16 v[60:63], v[204:207], v[236:239], v[60:63]
    s_waitcnt vmcnt(12) lgkmcnt(0)
    s_barrier
    v_mfma_f32_16x16x32_bf16 v[64:67], v[208:211], v[224:227], v[64:67]
    ds_read_b128 v[192:195], v245 offset:0
    s_add_u32 m0, s83, 49152
    v_mfma_f32_16x16x32_bf16 v[68:71], v[212:215], v[224:227], v[68:71]
    ds_read_b128 v[196:199], v245 offset:2048
    s_add_u32 s89, s88, 31744
    v_mfma_f32_16x16x32_bf16 v[96:99], v[216:219], v[224:227], v[96:99]
    ds_read_b128 v[200:203], v245 offset:4096
    v_mfma_f32_16x16x32_bf16 v[100:103], v[220:223], v[224:227], v[100:103]
    ds_read_b64_tr_b16 v[224:225], v246 offset:0
    ds_read_b64_tr_b16 v[226:227], v246 offset:1024
    ds_read_b128 v[204:207], v245 offset:6144
    buffer_load_dwordx4 v244, s[36:39], s88 offen nt lds
    v_mfma_f32_16x16x32_bf16 v[72:75], v[208:211], v[228:231], v[72:75]
    v_mfma_f32_16x16x32_bf16 v[76:79], v[212:215], v[228:231], v[76:79]
    buffer_load_dwordx4 v244, s[36:39], s89 offen offset:1024 nt lds
    v_mfma_f32_16x16x32_bf16 v[104:107], v[216:219], v[228:231], v[104:107]
    v_mfma_f32_16x16x32_bf16 v[108:111], v[220:223], v[228:231], v[108:111]
    ds_read_b64_tr_b16 v[228:229], v247 offset:0
    ds_read_b64_tr_b16 v[230:231], v247 offset:1024
    s_add_u32 s88, s88, 262144
    v_mfma_f32_16x16x32_bf16 v[80:83], v[208:211], v[232:235], v[80:83]
    s_add_u32 m0, s81, 131072
    v_mfma_f32_16x16x32_bf16 v[84:87], v[212:215], v[232:235], v[84:87]
    v_mfma_f32_16x16x32_bf16 v[112:115], v[216:219], v[232:235], v[112:115]
    s_nop 0
    v_mfma_f32_16x16x32_bf16 v[116:119], v[220:223], v[232:235], v[116:119]
    ds_read_b64_tr_b16 v[232:233], v248 offset:0
    ds_read_b64_tr_b16 v[234:235], v248 offset:1024
    v_mfma_f32_16x16x32_bf16 v[88:91], v[208:211], v[236:239], v[88:91]
    buffer_load_dwordx4 v243, s[32:35], s86 offen lds
    v_mfma_f32_16x16x32_bf16 v[92:95], v[212:215], v[236:239], v[92:95]
    v_mfma_f32_16x16x32_bf16 v[120:123], v[216:219], v[236:239], v[120:123]
    buffer_load_dwordx4 v183, s[32:35], s86 offen offset:1024 lds
    v_mfma_f32_16x16x32_bf16 v[124:127], v[220:223], v[236:239], v[124:127]
    ds_read_b64_tr_b16 v[236:237], v249 offset:0
    ds_read_b64_tr_b16 v[238:239], v249 offset:1024
    s_waitcnt lgkmcnt(6)
    v_mfma_f32_16x16x32_bf16 v[0:3], v[192:195], v[224:227], v[0:3]
    ds_read_b128 v[208:211], v245 offset:8192
    v_mfma_f32_16x16x32_bf16 v[4:7], v[196:199], v[224:227], v[4:7]
    ds_read_b128 v[212:215], v245 offset:10240
    v_mfma_f32_16x16x32_bf16 v[32:35], v[200:203], v[224:227], v[32:35]
    ds_read_b128 v[216:219], v245 offset:12288
    v_mfma_f32_16x16x32_bf16 v[36:39], v[204:207], v[224:227], v[36:39]
    ds_read_b128 v[220:223], v245 offset:14336
    s_waitcnt lgkmcnt(8)
    v_mfma_f32_16x16x32_bf16 v[8:11], v[192:195], v[228:231], v[8:11]
    v_xor_b32 v245, 64, v245
    v_mfma_f32_16x16x32_bf16 v[12:15], v[196:199], v[228:231], v[12:15]
    v_mfma_f32_16x16x32_bf16 v[40:43], v[200:203], v[228:231], v[40:43]
    v_mfma_f32_16x16x32_bf16 v[44:47], v[204:207], v[228:231], v[44:47]
    s_waitcnt lgkmcnt(6)
    v_mfma_f32_16x16x32_bf16 v[16:19], v[192:195], v[232:235], v[16:19]
    v_mfma_f32_16x16x32_bf16 v[20:23], v[196:199], v[232:235], v[20:23]
    v_mfma_f32_16x16x32_bf16 v[48:51], v[200:203], v[232:235], v[48:51]
    v_mfma_f32_16x16x32_bf16 v[52:55], v[204:207], v[232:235], v[52:55]
    s_waitcnt lgkmcnt(4)
    v_mfma_f32_16x16x32_bf16 v[24:27], v[192:195], v[236:239], v[24:27]
    v_mfma_f32_16x16x32_bf16 v[28:31], v[196:199], v[236:239], v[28:31]
    v_mfma_f32_16x16x32_bf16 v[56:59], v[200:203], v[236:239], v[56:59]
    v_mfma_f32_16x16x32_bf16 v[60:63], v[204:207], v[236:239], v[60:63]
    s_waitcnt vmcnt(11) lgkmcnt(0)
    s_barrier
    v_mfma_f32_16x16x32_bf16 v[64:67], v[208:211], v[224:227], v[64:67]
    ds_read_b128 v[192:195], v245 offset:0
    s_add_u32 m0, s81, 131072
    v_mfma_f32_16x16x32_bf16 v[68:71], v[212:215], v[224:227], v[68:71]
    ds_read_b128 v[196:199], v245 offset:2048
    s_add_u32 s87, s86, 14336
    v_mfma_f32_16x16x32_bf16 v[96:99], v[216:219], v[224:227], v[96:99]
    ds_read_b128 v[200:203], v245 offset:4096
    v_mfma_f32_16x16x32_bf16 v[100:103], v[220:223], v[224:227], v[100:103]
    ds_read_b64_tr_b16 v[224:225], v246 offset:16384
    ds_read_b64_tr_b16 v[226:227], v246 offset:17408
    ds_read_b128 v[204:207], v245 offset:6144
    buffer_load_dwordx4 v243, s[32:35], s87 offen offset:2048 lds
    v_mfma_f32_16x16x32_bf16 v[72:75], v[208:211], v[228:231], v[72:75]
    buffer_load_dwordx4 v183, s[32:35], s87 offen offset:3072 lds
    v_mfma_f32_16x16x32_bf16 v[76:79], v[212:215], v[228:231], v[76:79]
    v_mfma_f32_16x16x32_bf16 v[104:107], v[216:219], v[228:231], v[104:107]
    s_add_u32 s86, s86, 128
    v_mfma_f32_16x16x32_bf16 v[108:111], v[220:223], v[228:231], v[108:111]
    ds_read_b64_tr_b16 v[228:229], v247 offset:16384
    ds_read_b64_tr_b16 v[230:231], v247 offset:17408
    v_mfma_f32_16x16x32_bf16 v[80:83], v[208:211], v[232:235], v[80:83]
    s_add_u32 m0, s83, 98304
    v_mfma_f32_16x16x32_bf16 v[84:87], v[212:215], v[232:235], v[84:87]
    s_add_u32 s89, s88, 31744
    v_mfma_f32_16x16x32_bf16 v[112:115], v[216:219], v[232:235], v[112:115]
    v_mfma_f32_16x16x32_bf16 v[116:119], v[220:223], v[232:235], v[116:119]
    ds_read_b64_tr_b16 v[232:233], v248 offset:16384
    ds_read_b64_tr_b16 v[234:235], v248 offset:17408
    buffer_load_dwordx4 v244, s[36:39], s88 offen nt lds
    v_mfma_f32_16x16x32_bf16 v[88:91], v[208:211], v[236:239], v[88:91]
    buffer_load_dwordx4 v244, s[36:39], s89 offen offset:1024 nt lds
    v_mfma_f32_16x16x32_bf16 v[92:95], v[212:215], v[236:239], v[92:95]
    v_mfma_f32_16x16x32_bf16 v[120:123], v[216:219], v[236:239], v[120:123]
    s_add_u32 s88, s88, 262144
    v_mfma_f32_16x16x32_bf16 v[124:127], v[220:223], v[236:239], v[124:127]
    ds_read_b64_tr_b16 v[236:237], v249 offset:16384
    ds_read_b64_tr_b16 v[238:239], v249 offset:17408
    s_waitcnt lgkmcnt(6)
    v_mfma_f32_16x16x32_bf16 v[0:3], v[192:195], v[224:227], v[0:3]
    ds_read_b128 v[208:211], v245 offset:8192
    s_cmp_eq_u32 s76, 3
    v_mfma_f32_16x16x32_bf16 v[4:7], v[196:199], v[224:227], v[4:7]
    ds_read_b128 v[212:215], v245 offset:10240
    v_mfma_f32_16x16x32_bf16 v[32:35], v[200:203], v[224:227], v[32:35]
    ds_read_b128 v[216:219], v245 offset:12288
    v_mfma_f32_16x16x32_bf16 v[36:39], v[204:207], v[224:227], v[36:39]
    ds_read_b128 v[220:223], v245 offset:14336
    s_waitcnt lgkmcnt(8)
    v_mfma_f32_16x16x32_bf16 v[8:11], v[192:195], v[228:231], v[8:11]
    v_xor_b32 v245, 64, v245
    s_cselect_b32 s78, s101, 0x40000000
    v_mfma_f32_16x16x32_bf16 v[12:15], v[196:199], v[228:231], v[12:15]
    v_add_u32 v245, 0x10000, v245
    v_mfma_f32_16x16x32_bf16 v[40:43], v[200:203], v[228:231], v[40:43]
    v_xor_b32 v246, 0x10000, v246
    v_mfma_f32_16x16x32_bf16 v[44:47], v[204:207], v[228:231], v[44:47]
    v_xor_b32 v247, 0x10000, v247
    s_waitcnt lgkmcnt(6)
    v_mfma_f32_16x16x32_bf16 v[16:19], v[192:195], v[232:235], v[16:19]
    v_xor_b32 v248, 0x10000, v248
    buffer_load_dword v254, v184, s[48:51], s78 offen
    v_mfma_f32_16x16x32_bf16 v[20:23], v[196:199], v[232:235], v[20:23]
    v_xor_b32 v249, 0x10000, v249
    v_mfma_f32_16x16x32_bf16 v[48:51], v[200:203], v[232:235], v[48:51]
    v_mfma_f32_16x16x32_bf16 v[52:55], v[204:207], v[232:235], v[52:55]
    s_waitcnt lgkmcnt(4)
    v_mfma_f32_16x16x32_bf16 v[24:27], v[192:195], v[236:239], v[24:27]
    s_add_u32 s101, s101, s30
    v_mfma_f32_16x16x32_bf16 v[28:31], v[196:199], v[236:239], v[28:31]
    v_mfma_f32_16x16x32_bf16 v[56:59], v[200:203], v[236:239], v[56:59]
    v_mfma_f32_16x16x32_bf16 v[60:63], v[204:207], v[236:239], v[60:63]
    s_waitcnt vmcnt(10) lgkmcnt(0)
    s_barrier
    v_mfma_f32_16x16x32_bf16 v[64:67], v[208:211], v[224:227], v[64:67]
    ds_read_b128 v[192:195], v245 offset:0
    s_add_u32 m0, s83, 114688
    v_mfma_f32_16x16x32_bf16 v[68:71], v[212:215], v[224:227], v[68:71]
    ds_read_b128 v[196:199], v245 offset:2048
    s_add_u32 s89, s88, 31744
    v_mfma_f32_16x16x32_bf16 v[96:99], v[216:219], v[224:227], v[96:99]
    ds_read_b128 v[200:203], v245 offset:4096
    v_mfma_f32_16x16x32_bf16 v[100:103], v[220:223], v[224:227], v[100:103]
    ds_read_b64_tr_b16 v[224:225], v246 offset:0
    ds_read_b64_tr_b16 v[226:227], v246 offset:1024
    ds_read_b128 v[204:207], v245 offset:6144
    buffer_load_dwordx4 v244, s[36:39], s88 offen nt lds
    v_mfma_f32_16x16x32_bf16 v[72:75], v[208:211], v[228:231], v[72:75]
    v_mfma_f32_16x16x32_bf16 v[76:79], v[212:215], v[228:231], v[76:79]
    buffer_load_dwordx4 v244, s[36:39], s89 offen offset:1024 nt lds
    v_mfma_f32_16x16x32_bf16 v[104:107], v[216:219], v[228:231], v[104:107]
    v_mfma_f32_16x16x32_bf16 v[108:111], v[220:223], v[228:231], v[108:111]
    ds_read_b64_tr_b16 v[228:229], v247 offset:0
    ds_read_b64_tr_b16 v[230:231], v247 offset:1024
    s_add_u32 s88, s88, 262144
    v_mfma_f32_16x16x32_bf16 v[80:83], v[208:211], v[232:235], v[80:83]
    s_add_u32 m0, s81, 0
    v_mfma_f32_16x16x32_bf16 v[84:87], v[212:215], v[232:235], v[84:87]
    v_mfma_f32_16x16x32_bf16 v[112:115], v[216:219], v[232:235], v[112:115]
    s_nop 0
    v_mfma_f32_16x16x32_bf16 v[116:119], v[220:223], v[232:235], v[116:119]
    ds_read_b64_tr_b16 v[232:233], v248 offset:0
    ds_read_b64_tr_b16 v[234:235], v248 offset:1024
    v_mfma_f32_16x16x32_bf16 v[88:91], v[208:211], v[236:239], v[88:91]
    buffer_load_dwordx4 v243, s[32:35], s86 offen lds
    v_mfma_f32_16x16x32_bf16 v[92:95], v[212:215], v[236:239], v[92:95]
    v_mfma_f32_16x16x32_bf16 v[120:123], v[216:219], v[236:239], v[120:123]
    buffer_load_dwordx4 v183, s[32:35], s86 offen offset:1024 lds
    v_mfma_f32_16x16x32_bf16 v[124:127], v[220:223], v[236:239], v[124:127]
    ds_read_b64_tr_b16 v[236:237], v249 offset:0
    ds_read_b64_tr_b16 v[238:239], v249 offset:1024
    s_waitcnt lgkmcnt(6)
    v_mfma_f32_16x16x32_bf16 v[0:3], v[192:195], v[224:227], v[0:3]
    ds_read_b128 v[208:211], v245 offset:8192
    v_mfma_f32_16x16x32_bf16 v[4:7], v[196:199], v[224:227], v[4:7]
    ds_read_b128 v[212:215], v245 offset:10240
    v_mfma_f32_16x16x32_bf16 v[32:35], v[200:203], v[224:227], v[32:35]
    ds_read_b128 v[216:219], v245 offset:12288
    v_mfma_f32_16x16x32_bf16 v[36:39], v[204:207], v[224:227], v[36:39]
    ds_read_b128 v[220:223], v245 offset:14336
    s_waitcnt lgkmcnt(8)
    v_mfma_f32_16x16x32_bf16 v[8:11], v[192:195], v[228:231], v[8:11]
    v_xor_b32 v245, 64, v245
    v_mfma_f32_16x16x32_bf16 v[12:15], v[196:199], v[228:231], v[12:15]
    v_mfma_f32_16x16x32_bf16 v[40:43], v[200:203], v[228:231], v[40:43]
    v_mfma_f32_16x16x32_bf16 v[44:47], v[204:207], v[228:231], v[44:47]
    s_waitcnt lgkmcnt(6)
    v_mfma_f32_16x16x32_bf16 v[16:19], v[192:195], v[232:235], v[16:19]
    v_mfma_f32_16x16x32_bf16 v[20:23], v[196:199], v[232:235], v[20:23]
    v_mfma_f32_16x16x32_bf16 v[48:51], v[200:203], v[232:235], v[48:51]
    v_mfma_f32_16x16x32_bf16 v[52:55], v[204:207], v[232:235], v[52:55]
    s_waitcnt lgkmcnt(4)
    v_mfma_f32_16x16x32_bf16 v[24:27], v[192:195], v[236:239], v[24:27]
    v_mfma_f32_16x16x32_bf16 v[28:31], v[196:199], v[236:239], v[28:31]
    v_mfma_f32_16x16x32_bf16 v[56:59], v[200:203], v[236:239], v[56:59]
    v_mfma_f32_16x16x32_bf16 v[60:63], v[204:207], v[236:239], v[60:63]
    s_waitcnt vmcnt(11) lgkmcnt(0)
    s_barrier
    v_mfma_f32_16x16x32_bf16 v[64:67], v[208:211], v[224:227], v[64:67]
    ds_read_b128 v[192:195], v245 offset:0
    s_add_u32 m0, s81, 0
    v_mfma_f32_16x16x32_bf16 v[68:71], v[212:215], v[224:227], v[68:71]
    ds_read_b128 v[196:199], v245 offset:2048
    s_add_u32 s87, s86, 14336
    v_mfma_f32_16x16x32_bf16 v[96:99], v[216:219], v[224:227], v[96:99]
    ds_read_b128 v[200:203], v245 offset:4096
    v_mfma_f32_16x16x32_bf16 v[100:103], v[220:223], v[224:227], v[100:103]
    ds_read_b64_tr_b16 v[224:225], v246 offset:16384
    ds_read_b64_tr_b16 v[226:227], v246 offset:17408
    ds_read_b128 v[204:207], v245 offset:6144
    buffer_load_dwordx4 v243, s[32:35], s87 offen offset:2048 lds
    v_mfma_f32_16x16x32_bf16 v[72:75], v[208:211], v[228:231], v[72:75]
    buffer_load_dwordx4 v183, s[32:35], s87 offen offset:3072 lds
    v_mfma_f32_16x16x32_bf16 v[76:79], v[212:215], v[228:231], v[76:79]
    v_mfma_f32_16x16x32_bf16 v[104:107], v[216:219], v[228:231], v[104:107]
    s_add_u32 s86, s86, 128
    v_mfma_f32_16x16x32_bf16 v[108:111], v[220:223], v[228:231], v[108:111]
    ds_read_b64_tr_b16 v[228:229], v247 offset:16384
    ds_read_b64_tr_b16 v[230:231], v247 offset:17408
    v_mfma_f32_16x16x32_bf16 v[80:83], v[208:211], v[232:235], v[80:83]
    s_add_u32 m0, s83, 32768
    v_mfma_f32_16x16x32_bf16 v[84:87], v[212:215], v[232:235], v[84:87]
    s_add_u32 s89, s88, 31744
    v_mfma_f32_16x16x32_bf16 v[112:115], v[216:219], v[232:235], v[112:115]
    v_mfma_f32_16x16x32_bf16 v[116:119], v[220:223], v[232:235], v[116:119]
    ds_read_b64_tr_b16 v[232:233], v248 offset:16384
    ds_read_b64_tr_b16 v[234:235], v248 offset:17408
    buffer_load_dwordx4 v244, s[36:39], s88 offen nt lds
    v_mfma_f32_16x16x32_bf16 v[88:91], v[208:211], v[236:239], v[88:91]
    buffer_load_dwordx4 v244, s[36:39], s89 offen offset:1024 nt lds
    v_mfma_f32_16x16x32_bf16 v[92:95], v[212:215], v[236:239], v[92:95]
    v_mfma_f32_16x16x32_bf16 v[120:123], v[216:219], v[236:239], v[120:123]
    s_add_u32 s88, s88, 262144
    v_mfma_f32_16x16x32_bf16 v[124:127], v[220:223], v[236:239], v[124:127]
    ds_read_b64_tr_b16 v[236:237], v249 offset:16384
    ds_read_b64_tr_b16 v[238:239], v249 offset:17408
    s_waitcnt lgkmcnt(6)
    v_mfma_f32_16x16x32_bf16 v[0:3], v[192:195], v[224:227], v[0:3]
    ds_read_b128 v[208:211], v245 offset:8192
    s_cmp_eq_u32 s76, 1
    v_mfma_f32_16x16x32_bf16 v[4:7], v[196:199], v[224:227], v[4:7]
    ds_read_b128 v[212:215], v245 offset:10240
    v_mfma_f32_16x16x32_bf16 v[32:35], v[200:203], v[224:227], v[32:35]
    ds_read_b128 v[216:219], v245 offset:12288
    v_mfma_f32_16x16x32_bf16 v[36:39], v[204:207], v[224:227], v[36:39]
    ds_read_b128 v[220:223], v245 offset:14336
    s_waitcnt lgkmcnt(8)
    v_mfma_f32_16x16x32_bf16 v[8:11], v[192:195], v[228:231], v[8:11]
    v_xor_b32 v245, 64, v245
    v_mfma_f32_16x16x32_bf16 v[12:15], v[196:199], v[228:231], v[12:15]
    v_add_u32 v245, 0x10000, v245
    s_cselect_b32 s78, s101, 0x40000000
    v_mfma_f32_16x16x32_bf16 v[40:43], v[200:203], v[228:231], v[40:43]
    v_xor_b32 v246, 0x10000, v246
    v_mfma_f32_16x16x32_bf16 v[44:47], v[204:207], v[228:231], v[44:47]
    v_xor_b32 v247, 0x10000, v247
    s_waitcnt lgkmcnt(6)
    v_mfma_f32_16x16x32_bf16 v[16:19], v[192:195], v[232:235], v[16:19]
    v_xor_b32 v248, 0x10000, v248
    v_mfma_f32_16x16x32_bf16 v[20:23], v[196:199], v[232:235], v[20:23]
    v_xor_b32 v249, 0x10000, v249
    v_mfma_f32_16x16x32_bf16 v[48:51], v[200:203], v[232:235], v[48:51]
    buffer_load_dword v254, v184, s[48:51], s78 offen
    v_mfma_f32_16x16x32_bf16 v[52:55], v[204:207], v[232:235], v[52:55]
    s_waitcnt lgkmcnt(4)
    v_mfma_f32_16x16x32_bf16 v[24:27], v[192:195], v[236:239], v[24:27]
    v_mfma_f32_16x16x32_bf16 v[28:31], v[196:199], v[236:239], v[28:31]
    v_mfma_f32_16x16x32_bf16 v[56:59], v[200:203], v[236:239], v[56:59]
    v_mfma_f32_16x16x32_bf16 v[60:63], v[204:207], v[236:239], v[60:63]
    s_waitcnt vmcnt(10) lgkmcnt(0)
    s_barrier
    v_mfma_f32_16x16x32_bf16 v[64:67], v[208:211], v[224:227], v[64:67]
    ds_read_b128 v[192:195], v245 offset:0
    s_add_u32 m0, s83, 49152
    v_mfma_f32_16x16x32_bf16 v[68:71], v[212:215], v[224:227], v[68:71]
    ds_read_b128 v[196:199], v245 offset:2048
    s_add_u32 s89, s88, 31744
    v_mfma_f32_16x16x32_bf16 v[96:99], v[216:219], v[224:227], v[96:99]
    ds_read_b128 v[200:203], v245 offset:4096
    v_mfma_f32_16x16x32_bf16 v[100:103], v[220:223], v[224:227], v[100:103]
    ds_read_b64_tr_b16 v[224:225], v246 offset:0
    ds_read_b64_tr_b16 v[226:227], v246 offset:1024
    ds_read_b128 v[204:207], v245 offset:6144
    buffer_load_dwordx4 v244, s[36:39], s88 offen nt lds
    v_mfma_f32_16x16x32_bf16 v[72:75], v[208:211], v[228:231], v[72:75]
    v_mfma_f32_16x16x32_bf16 v[76:79], v[212:215], v[228:231], v[76:79]
    buffer_load_dwordx4 v244, s[36:39], s89 offen offset:1024 nt lds
    v_mfma_f32_16x16x32_bf16 v[104:107], v[216:219], v[228:231], v[104:107]
    v_mfma_f32_16x16x32_bf16 v[108:111], v[220:223], v[228:231], v[108:111]
    ds_read_b64_tr_b16 v[228:229], v247 offset:0
    ds_read_b64_tr_b16 v[230:231], v247 offset:1024
    s_add_u32 s88, s88, 262144
    v_mfma_f32_16x16x32_bf16 v[80:83], v[208:211], v[232:235], v[80:83]
    s_add_u32 m0, s81, 65536
    v_mfma_f32_16x16x32_bf16 v[84:87], v[212:215], v[232:235], v[84:87]
    v_mfma_f32_16x16x32_bf16 v[112:115], v[216:219], v[232:235], v[112:115]
    s_nop 0
    v_mfma_f32_16x16x32_bf16 v[116:119], v[220:223], v[232:235], v[116:119]
    ds_read_b64_tr_b16 v[232:233], v248 offset:0
    ds_read_b64_tr_b16 v[234:235], v248 offset:1024
    v_mfma_f32_16x16x32_bf16 v[88:91], v[208:211], v[236:239], v[88:91]
    buffer_load_dwordx4 v243, s[32:35], s86 offen lds
    v_mfma_f32_16x16x32_bf16 v[92:95], v[212:215], v[236:239], v[92:95]
    v_mfma_f32_16x16x32_bf16 v[120:123], v[216:219], v[236:239], v[120:123]
    buffer_load_dwordx4 v183, s[32:35], s86 offen offset:1024 lds
    v_mfma_f32_16x16x32_bf16 v[124:127], v[220:223], v[236:239], v[124:127]
    ds_read_b64_tr_b16 v[236:237], v249 offset:0
    ds_read_b64_tr_b16 v[238:239], v249 offset:1024
    s_waitcnt lgkmcnt(6)
    v_mfma_f32_16x16x32_bf16 v[0:3], v[192:195], v[224:227], v[0:3]
    ds_read_b128 v[208:211], v245 offset:8192
    v_mfma_f32_16x16x32_bf16 v[4:7], v[196:199], v[224:227], v[4:7]
    ds_read_b128 v[212:215], v245 offset:10240
    v_mfma_f32_16x16x32_bf16 v[32:35], v[200:203], v[224:227], v[32:35]
    ds_read_b128 v[216:219], v245 offset:12288
    v_mfma_f32_16x16x32_bf16 v[36:39], v[204:207], v[224:227], v[36:39]
    ds_read_b128 v[220:223], v245 offset:14336
    s_waitcnt lgkmcnt(8)
    v_mfma_f32_16x16x32_bf16 v[8:11], v[192:195], v[228:231], v[8:11]
    v_xor_b32 v245, 64, v245
    v_mfma_f32_16x16x32_bf16 v[12:15], v[196:199], v[228:231], v[12:15]
    v_mfma_f32_16x16x32_bf16 v[40:43], v[200:203], v[228:231], v[40:43]
    v_mfma_f32_16x16x32_bf16 v[44:47], v[204:207], v[228:231], v[44:47]
    s_waitcnt lgkmcnt(6)
    v_mfma_f32_16x16x32_bf16 v[16:19], v[192:195], v[232:235], v[16:19]
    v_mfma_f32_16x16x32_bf16 v[20:23], v[196:199], v[232:235], v[20:23]
    v_mfma_f32_16x16x32_bf16 v[48:51], v[200:203], v[232:235], v[48:51]
    v_mfma_f32_16x16x32_bf16 v[52:55], v[204:207], v[232:235], v[52:55]
    s_waitcnt lgkmcnt(4)
    v_mfma_f32_16x16x32_bf16 v[24:27], v[192:195], v[236:239], v[24:27]
    v_mfma_f32_16x16x32_bf16 v[28:31], v[196:199], v[236:239], v[28:31]
    v_mfma_f32_16x16x32_bf16 v[56:59], v[200:203], v[236:239], v[56:59]
    v_mfma_f32_16x16x32_bf16 v[60:63], v[204:207], v[236:239], v[60:63]
    s_waitcnt vmcnt(11) lgkmcnt(0)
    s_barrier
    v_mfma_f32_16x16x32_bf16 v[64:67], v[208:211], v[224:227], v[64:67]
    ds_read_b128 v[192:195], v245 offset:0
    s_add_u32 m0, s81, 65536
    v_mfma_f32_16x16x32_bf16 v[68:71], v[212:215], v[224:227], v[68:71]
    ds_read_b128 v[196:199], v245 offset:2048
    s_add_u32 s87, s86, 14336
    v_mfma_f32_16x16x32_bf16 v[96:99], v[216:219], v[224:227], v[96:99]
    ds_read_b128 v[200:203], v245 offset:4096
    v_mfma_f32_16x16x32_bf16 v[100:103], v[220:223], v[224:227], v[100:103]
    ds_read_b64_tr_b16 v[224:225], v246 offset:16384
    ds_read_b64_tr_b16 v[226:227], v246 offset:17408
    ds_read_b128 v[204:207], v245 offset:6144
    buffer_load_dwordx4 v243, s[32:35], s87 offen offset:2048 lds
    v_mfma_f32_16x16x32_bf16 v[72:75], v[208:211], v[228:231], v[72:75]
    buffer_load_dwordx4 v183, s[32:35], s87 offen offset:3072 lds
    v_mfma_f32_16x16x32_bf16 v[76:79], v[212:215], v[228:231], v[76:79]
    v_mfma_f32_16x16x32_bf16 v[104:107], v[216:219], v[228:231], v[104:107]
    s_add_u32 s86, s86, 128
    v_mfma_f32_16x16x32_bf16 v[108:111], v[220:223], v[228:231], v[108:111]
    ds_read_b64_tr_b16 v[228:229], v247 offset:16384
    ds_read_b64_tr_b16 v[230:231], v247 offset:17408
    v_mfma_f32_16x16x32_bf16 v[80:83], v[208:211], v[232:235], v[80:83]
    s_add_u32 m0, s83, 98304
    v_mfma_f32_16x16x32_bf16 v[84:87], v[212:215], v[232:235], v[84:87]
    s_add_u32 s89, s88, 31744
    v_mfma_f32_16x16x32_bf16 v[112:115], v[216:219], v[232:235], v[112:115]
    v_mfma_f32_16x16x32_bf16 v[116:119], v[220:223], v[232:235], v[116:119]
    ds_read_b64_tr_b16 v[232:233], v248 offset:16384
    ds_read_b64_tr_b16 v[234:235], v248 offset:17408
    buffer_load_dwordx4 v244, s[36:39], s88 offen nt lds
    v_mfma_f32_16x16x32_bf16 v[88:91], v[208:211], v[236:239], v[88:91]
    buffer_load_dwordx4 v244, s[36:39], s89 offen offset:1024 nt lds
    v_mfma_f32_16x16x32_bf16 v[92:95], v[212:215], v[236:239], v[92:95]
    v_mfma_f32_16x16x32_bf16 v[120:123], v[216:219], v[236:239], v[120:123]
    s_add_u32 s88, s88, 262144
    v_mfma_f32_16x16x32_bf16 v[124:127], v[220:223], v[236:239], v[124:127]
    ds_read_b64_tr_b16 v[236:237], v249 offset:16384
    ds_read_b64_tr_b16 v[238:239], v249 offset:17408
    s_waitcnt lgkmcnt(6)
    v_mfma_f32_16x16x32_bf16 v[0:3], v[192:195], v[224:227], v[0:3]
    ds_read_b128 v[208:211], v245 offset:8192
    s_cmp_ge_u32 s76, 2
    v_mfma_f32_16x16x32_bf16 v[4:7], v[196:199], v[224:227], v[4:7]
    ds_read_b128 v[212:215], v245 offset:10240
    v_mfma_f32_16x16x32_bf16 v[32:35], v[200:203], v[224:227], v[32:35]
    ds_read_b128 v[216:219], v245 offset:12288
    v_mfma_f32_16x16x32_bf16 v[36:39], v[204:207], v[224:227], v[36:39]
    ds_read_b128 v[220:223], v245 offset:14336
    s_waitcnt lgkmcnt(8)
    v_mfma_f32_16x16x32_bf16 v[8:11], v[192:195], v[228:231], v[8:11]
    v_xor_b32 v245, 64, v245
    v_mfma_f32_16x16x32_bf16 v[12:15], v[196:199], v[228:231], v[12:15]
    v_add_u32 v245, 0xfffe0000, v245
    s_cselect_b32 s78, s101, 0x40000000
    v_mfma_f32_16x16x32_bf16 v[40:43], v[200:203], v[228:231], v[40:43]
    v_xor_b32 v246, 0x10000, v246
    v_mfma_f32_16x16x32_bf16 v[44:47], v[204:207], v[228:231], v[44:47]
    v_xor_b32 v247, 0x10000, v247
    s_waitcnt lgkmcnt(6)
    v_mfma_f32_16x16x32_bf16 v[16:19], v[192:195], v[232:235], v[16:19]
    v_xor_b32 v248, 0x10000, v248
    v_mfma_f32_16x16x32_bf16 v[20:23], v[196:199], v[232:235], v[20:23]
    v_xor_b32 v249, 0x10000, v249
    v_mfma_f32_16x16x32_bf16 v[48:51], v[200:203], v[232:235], v[48:51]
    buffer_load_dword v254, v184, s[48:51], s78 offen
    v_mfma_f32_16x16x32_bf16 v[52:55], v[204:207], v[232:235], v[52:55]
    s_waitcnt lgkmcnt(4)
    v_mfma_f32_16x16x32_bf16 v[24:27], v[192:195], v[236:239], v[24:27]
    v_mfma_f32_16x16x32_bf16 v[28:31], v[196:199], v[236:239], v[28:31]
    v_mfma_f32_16x16x32_bf16 v[56:59], v[200:203], v[236:239], v[56:59]
    v_mfma_f32_16x16x32_bf16 v[60:63], v[204:207], v[236:239], v[60:63]
    s_waitcnt vmcnt(10) lgkmcnt(0)
    s_barrier
    v_mfma_f32_16x16x32_bf16 v[64:67], v[208:211], v[224:227], v[64:67]
    ds_read_b128 v[192:195], v245 offset:0
    s_add_u32 m0, s83, 114688
    v_mfma_f32_16x16x32_bf16 v[68:71], v[212:215], v[224:227], v[68:71]
    ds_read_b128 v[196:199], v245 offset:2048
    v_mfma_f32_16x16x32_bf16 v[96:99], v[216:219], v[224:227], v[96:99]
    ds_read_b128 v[200:203], v245 offset:4096
    v_mfma_f32_16x16x32_bf16 v[100:103], v[220:223], v[224:227], v[100:103]
    ds_read_b64_tr_b16 v[224:225], v246 offset:0
    ds_read_b64_tr_b16 v[226:227], v246 offset:1024
    ds_read_b128 v[204:207], v245 offset:6144
    s_add_u32 s89, s88, 31744
    v_mfma_f32_16x16x32_bf16 v[72:75], v[208:211], v[228:231], v[72:75]
    v_mfma_f32_16x16x32_bf16 v[76:79], v[212:215], v[228:231], v[76:79]
    v_mfma_f32_16x16x32_bf16 v[104:107], v[216:219], v[228:231], v[104:107]
    buffer_load_dwordx4 v244, s[36:39], s88 offen nt lds
    v_mfma_f32_16x16x32_bf16 v[108:111], v[220:223], v[228:231], v[108:111]
    ds_read_b64_tr_b16 v[228:229], v247 offset:0
    ds_read_b64_tr_b16 v[230:231], v247 offset:1024
    v_mfma_f32_16x16x32_bf16 v[80:83], v[208:211], v[232:235], v[80:83]
    v_mfma_f32_16x16x32_bf16 v[84:87], v[212:215], v[232:235], v[84:87]
    buffer_load_dwordx4 v244, s[36:39], s89 offen offset:1024 nt lds
    v_mfma_f32_16x16x32_bf16 v[112:115], v[216:219], v[232:235], v[112:115]
    v_mfma_f32_16x16x32_bf16 v[116:119], v[220:223], v[232:235], v[116:119]
    ds_read_b64_tr_b16 v[232:233], v248 offset:0
    ds_read_b64_tr_b16 v[234:235], v248 offset:1024
    v_mfma_f32_16x16x32_bf16 v[88:91], v[208:211], v[236:239], v[88:91]
    s_add_u32 s88, s88, 262144
    v_mfma_f32_16x16x32_bf16 v[92:95], v[212:215], v[236:239], v[92:95]
    v_mfma_f32_16x16x32_bf16 v[120:123], v[216:219], v[236:239], v[120:123]
    v_mfma_f32_16x16x32_bf16 v[124:127], v[220:223], v[236:239], v[124:127]
    ds_read_b64_tr_b16 v[236:237], v249 offset:0
    ds_read_b64_tr_b16 v[238:239], v249 offset:1024
    s_waitcnt lgkmcnt(6)
    v_mfma_f32_16x16x32_bf16 v[0:3], v[192:195], v[224:227], v[0:3]
    ds_read_b128 v[208:211], v245 offset:8192
    v_mfma_f32_16x16x32_bf16 v[4:7], v[196:199], v[224:227], v[4:7]
    ds_read_b128 v[212:215], v245 offset:10240
    v_mfma_f32_16x16x32_bf16 v[32:35], v[200:203], v[224:227], v[32:35]
    ds_read_b128 v[216:219], v245 offset:12288
    v_mfma_f32_16x16x32_bf16 v[36:39], v[204:207], v[224:227], v[36:39]
    ds_read_b128 v[220:223], v245 offset:14336
    s_waitcnt lgkmcnt(8)
    v_mfma_f32_16x16x32_bf16 v[8:11], v[192:195], v[228:231], v[8:11]
    v_xor_b32 v245, 64, v245
    v_mfma_f32_16x16x32_bf16 v[12:15], v[196:199], v[228:231], v[12:15]
    v_mfma_f32_16x16x32_bf16 v[40:43], v[200:203], v[228:231], v[40:43]
    v_mfma_f32_16x16x32_bf16 v[44:47], v[204:207], v[228:231], v[44:47]
    s_waitcnt lgkmcnt(6)
    v_mfma_f32_16x16x32_bf16 v[16:19], v[192:195], v[232:235], v[16:19]
    v_mfma_f32_16x16x32_bf16 v[20:23], v[196:199], v[232:235], v[20:23]
    v_mfma_f32_16x16x32_bf16 v[48:51], v[200:203], v[232:235], v[48:51]
    v_mfma_f32_16x16x32_bf16 v[52:55], v[204:207], v[232:235], v[52:55]
    s_waitcnt lgkmcnt(4)
    v_mfma_f32_16x16x32_bf16 v[24:27], v[192:195], v[236:239], v[24:27]
    v_mfma_f32_16x16x32_bf16 v[28:31], v[196:199], v[236:239], v[28:31]
    v_mfma_f32_16x16x32_bf16 v[56:59], v[200:203], v[236:239], v[56:59]
    v_mfma_f32_16x16x32_bf16 v[60:63], v[204:207], v[236:239], v[60:63]
    s_waitcnt vmcnt(9) lgkmcnt(0)
    s_barrier
    v_mfma_f32_16x16x32_bf16 v[64:67], v[208:211], v[224:227], v[64:67]
    ds_read_b128 v[192:195], v245 offset:0
    v_mfma_f32_16x16x32_bf16 v[68:71], v[212:215], v[224:227], v[68:71]
    ds_read_b128 v[196:199], v245 offset:2048
    v_mfma_f32_16x16x32_bf16 v[96:99], v[216:219], v[224:227], v[96:99]
    ds_read_b128 v[200:203], v245 offset:4096
    v_mfma_f32_16x16x32_bf16 v[100:103], v[220:223], v[224:227], v[100:103]
    ds_read_b64_tr_b16 v[224:225], v246 offset:16384
    ds_read_b64_tr_b16 v[226:227], v246 offset:17408
    ds_read_b128 v[204:207], v245 offset:6144
    v_mfma_f32_16x16x32_bf16 v[72:75], v[208:211], v[228:231], v[72:75]
    v_mfma_f32_16x16x32_bf16 v[76:79], v[212:215], v[228:231], v[76:79]
    v_mfma_f32_16x16x32_bf16 v[104:107], v[216:219], v[228:231], v[104:107]
    v_mfma_f32_16x16x32_bf16 v[108:111], v[220:223], v[228:231], v[108:111]
    ds_read_b64_tr_b16 v[228:229], v247 offset:16384
    ds_read_b64_tr_b16 v[230:231], v247 offset:17408
    v_mfma_f32_16x16x32_bf16 v[80:83], v[208:211], v[232:235], v[80:83]
    v_mfma_f32_16x16x32_bf16 v[84:87], v[212:215], v[232:235], v[84:87]
    v_mfma_f32_16x16x32_bf16 v[112:115], v[216:219], v[232:235], v[112:115]
    v_mfma_f32_16x16x32_bf16 v[116:119], v[220:223], v[232:235], v[116:119]
    ds_read_b64_tr_b16 v[232:233], v248 offset:16384
    ds_read_b64_tr_b16 v[234:235], v248 offset:17408
    v_mfma_f32_16x16x32_bf16 v[88:91], v[208:211], v[236:239], v[88:91]
    v_mfma_f32_16x16x32_bf16 v[92:95], v[212:215], v[236:239], v[92:95]
    v_mfma_f32_16x16x32_bf16 v[120:123], v[216:219], v[236:239], v[120:123]
    v_mfma_f32_16x16x32_bf16 v[124:127], v[220:223], v[236:239], v[124:127]
    ds_read_b64_tr_b16 v[236:237], v249 offset:16384
    ds_read_b64_tr_b16 v[238:239], v249 offset:17408
    s_waitcnt lgkmcnt(6)
    v_mfma_f32_16x16x32_bf16 v[0:3], v[192:195], v[224:227], v[0:3]
    ds_read_b128 v[208:211], v245 offset:8192
    v_mfma_f32_16x16x32_bf16 v[4:7], v[196:199], v[224:227], v[4:7]
    ds_read_b128 v[212:215], v245 offset:10240
    v_mfma_f32_16x16x32_bf16 v[32:35], v[200:203], v[224:227], v[32:35]
    ds_read_b128 v[216:219], v245 offset:12288
    v_mfma_f32_16x16x32_bf16 v[36:39], v[204:207], v[224:227], v[36:39]
    ds_read_b128 v[220:223], v245 offset:14336
    s_waitcnt lgkmcnt(8)
    v_mfma_f32_16x16x32_bf16 v[8:11], v[192:195], v[228:231], v[8:11]
    v_xor_b32 v245, 64, v245
    v_mfma_f32_16x16x32_bf16 v[12:15], v[196:199], v[228:231], v[12:15]
    v_add_u32 v245, 0x10000, v245
    v_mfma_f32_16x16x32_bf16 v[40:43], v[200:203], v[228:231], v[40:43]
    v_xor_b32 v246, 0x10000, v246
    v_mfma_f32_16x16x32_bf16 v[44:47], v[204:207], v[228:231], v[44:47]
    v_xor_b32 v247, 0x10000, v247
    s_waitcnt lgkmcnt(6)
    v_mfma_f32_16x16x32_bf16 v[16:19], v[192:195], v[232:235], v[16:19]
    v_xor_b32 v248, 0x10000, v248
    v_mfma_f32_16x16x32_bf16 v[20:23], v[196:199], v[232:235], v[20:23]
    v_xor_b32 v249, 0x10000, v249
    v_mfma_f32_16x16x32_bf16 v[48:51], v[200:203], v[232:235], v[48:51]
    v_mfma_f32_16x16x32_bf16 v[52:55], v[204:207], v[232:235], v[52:55]
    s_waitcnt lgkmcnt(4)
    v_mfma_f32_16x16x32_bf16 v[24:27], v[192:195], v[236:239], v[24:27]
    v_mfma_f32_16x16x32_bf16 v[28:31], v[196:199], v[236:239], v[28:31]
    v_mfma_f32_16x16x32_bf16 v[56:59], v[200:203], v[236:239], v[56:59]
    v_mfma_f32_16x16x32_bf16 v[60:63], v[204:207], v[236:239], v[60:63]
    s_waitcnt vmcnt(3) lgkmcnt(0)
    s_barrier
    v_mfma_f32_16x16x32_bf16 v[64:67], v[208:211], v[224:227], v[64:67]
    ds_read_b128 v[192:195], v245 offset:0
    v_mfma_f32_16x16x32_bf16 v[68:71], v[212:215], v[224:227], v[68:71]
    ds_read_b128 v[196:199], v245 offset:2048
    v_mfma_f32_16x16x32_bf16 v[96:99], v[216:219], v[224:227], v[96:99]
    ds_read_b128 v[200:203], v245 offset:4096
    v_mfma_f32_16x16x32_bf16 v[100:103], v[220:223], v[224:227], v[100:103]
    ds_read_b64_tr_b16 v[224:225], v246 offset:0
    ds_read_b64_tr_b16 v[226:227], v246 offset:1024
    ds_read_b128 v[204:207], v245 offset:6144
    v_mfma_f32_16x16x32_bf16 v[72:75], v[208:211], v[228:231], v[72:75]
    v_mfma_f32_16x16x32_bf16 v[76:79], v[212:215], v[228:231], v[76:79]
    v_mfma_f32_16x16x32_bf16 v[104:107], v[216:219], v[228:231], v[104:107]
    v_mfma_f32_16x16x32_bf16 v[108:111], v[220:223], v[228:231], v[108:111]
    ds_read_b64_tr_b16 v[228:229], v247 offset:0
    ds_read_b64_tr_b16 v[230:231], v247 offset:1024
    v_mfma_f32_16x16x32_bf16 v[80:83], v[208:211], v[232:235], v[80:83]
    v_mfma_f32_16x16x32_bf16 v[84:87], v[212:215], v[232:235], v[84:87]
    v_mfma_f32_16x16x32_bf16 v[112:115], v[216:219], v[232:235], v[112:115]
    v_mfma_f32_16x16x32_bf16 v[116:119], v[220:223], v[232:235], v[116:119]
    ds_read_b64_tr_b16 v[232:233], v248 offset:0
    ds_read_b64_tr_b16 v[234:235], v248 offset:1024
    v_mfma_f32_16x16x32_bf16 v[88:91], v[208:211], v[236:239], v[88:91]
    v_mfma_f32_16x16x32_bf16 v[92:95], v[212:215], v[236:239], v[92:95]
    v_mfma_f32_16x16x32_bf16 v[120:123], v[216:219], v[236:239], v[120:123]
    v_mfma_f32_16x16x32_bf16 v[124:127], v[220:223], v[236:239], v[124:127]
    ds_read_b64_tr_b16 v[236:237], v249 offset:0
    ds_read_b64_tr_b16 v[238:239], v249 offset:1024
    s_waitcnt lgkmcnt(6)
    v_mfma_f32_16x16x32_bf16 v[0:3], v[192:195], v[224:227], v[0:3]
    ds_read_b128 v[208:211], v245 offset:8192
    v_mfma_f32_16x16x32_bf16 v[4:7], v[196:199], v[224:227], v[4:7]
    ds_read_b128 v[212:215], v245 offset:10240
    v_mfma_f32_16x16x32_bf16 v[32:35], v[200:203], v[224:227], v[32:35]
    ds_read_b128 v[216:219], v245 offset:12288
    v_mfma_f32_16x16x32_bf16 v[36:39], v[204:207], v[224:227], v[36:39]
    ds_read_b128 v[220:223], v245 offset:14336
    s_waitcnt lgkmcnt(8)
    v_mfma_f32_16x16x32_bf16 v[8:11], v[192:195], v[228:231], v[8:11]
    v_xor_b32 v245, 64, v245
    v_mfma_f32_16x16x32_bf16 v[12:15], v[196:199], v[228:231], v[12:15]
    v_mfma_f32_16x16x32_bf16 v[40:43], v[200:203], v[228:231], v[40:43]
    v_mfma_f32_16x16x32_bf16 v[44:47], v[204:207], v[228:231], v[44:47]
    s_waitcnt lgkmcnt(6)
    v_mfma_f32_16x16x32_bf16 v[16:19], v[192:195], v[232:235], v[16:19]
    v_mfma_f32_16x16x32_bf16 v[20:23], v[196:199], v[232:235], v[20:23]
    v_mfma_f32_16x16x32_bf16 v[48:51], v[200:203], v[232:235], v[48:51]
    v_mfma_f32_16x16x32_bf16 v[52:55], v[204:207], v[232:235], v[52:55]
    s_waitcnt lgkmcnt(4)
    v_mfma_f32_16x16x32_bf16 v[24:27], v[192:195], v[236:239], v[24:27]
    v_mfma_f32_16x16x32_bf16 v[28:31], v[196:199], v[236:239], v[28:31]
    v_mfma_f32_16x16x32_bf16 v[56:59], v[200:203], v[236:239], v[56:59]
    v_mfma_f32_16x16x32_bf16 v[60:63], v[204:207], v[236:239], v[60:63]
    s_waitcnt vmcnt(0) lgkmcnt(0)
    s_barrier
    v_mfma_f32_16x16x32_bf16 v[64:67], v[208:211], v[224:227], v[64:67]
    ds_read_b128 v[192:195], v245 offset:0
    v_mfma_f32_16x16x32_bf16 v[68:71], v[212:215], v[224:227], v[68:71]
    ds_read_b128 v[196:199], v245 offset:2048
    v_mfma_f32_16x16x32_bf16 v[96:99], v[216:219], v[224:227], v[96:99]
    ds_read_b128 v[200:203], v245 offset:4096
    v_mfma_f32_16x16x32_bf16 v[100:103], v[220:223], v[224:227], v[100:103]
    ds_read_b64_tr_b16 v[224:225], v246 offset:16384
    ds_read_b64_tr_b16 v[226:227], v246 offset:17408
    ds_read_b128 v[204:207], v245 offset:6144
    v_mfma_f32_16x16x32_bf16 v[72:75], v[208:211], v[228:231], v[72:75]
    v_mfma_f32_16x16x32_bf16 v[76:79], v[212:215], v[228:231], v[76:79]
    v_mfma_f32_16x16x32_bf16 v[104:107], v[216:219], v[228:231], v[104:107]
    v_mfma_f32_16x16x32_bf16 v[108:111], v[220:223], v[228:231], v[108:111]
    ds_read_b64_tr_b16 v[228:229], v247 offset:16384
    ds_read_b64_tr_b16 v[230:231], v247 offset:17408
    v_mfma_f32_16x16x32_bf16 v[80:83], v[208:211], v[232:235], v[80:83]
    v_mfma_f32_16x16x32_bf16 v[84:87], v[212:215], v[232:235], v[84:87]
    v_mfma_f32_16x16x32_bf16 v[112:115], v[216:219], v[232:235], v[112:115]
    v_mfma_f32_16x16x32_bf16 v[116:119], v[220:223], v[232:235], v[116:119]
    ds_read_b64_tr_b16 v[232:233], v248 offset:16384
    ds_read_b64_tr_b16 v[234:235], v248 offset:17408
    v_mfma_f32_16x16x32_bf16 v[88:91], v[208:211], v[236:239], v[88:91]
    v_mfma_f32_16x16x32_bf16 v[92:95], v[212:215], v[236:239], v[92:95]
    v_mfma_f32_16x16x32_bf16 v[120:123], v[216:219], v[236:239], v[120:123]
    v_mfma_f32_16x16x32_bf16 v[124:127], v[220:223], v[236:239], v[124:127]
    ds_read_b64_tr_b16 v[236:237], v249 offset:16384
    ds_read_b64_tr_b16 v[238:239], v249 offset:17408
    s_waitcnt lgkmcnt(6)
    v_mfma_f32_16x16x32_bf16 v[0:3], v[192:195], v[224:227], v[0:3]
    ds_read_b128 v[208:211], v245 offset:8192
    v_mfma_f32_16x16x32_bf16 v[4:7], v[196:199], v[224:227], v[4:7]
    ds_read_b128 v[212:215], v245 offset:10240
    v_mfma_f32_16x16x32_bf16 v[32:35], v[200:203], v[224:227], v[32:35]
    ds_read_b128 v[216:219], v245 offset:12288
    v_mfma_f32_16x16x32_bf16 v[36:39], v[204:207], v[224:227], v[36:39]
    ds_read_b128 v[220:223], v245 offset:14336
    s_waitcnt lgkmcnt(8)
    v_mfma_f32_16x16x32_bf16 v[8:11], v[192:195], v[228:231], v[8:11]
    v_xor_b32 v245, 128, v250
    v_mfma_f32_16x16x32_bf16 v[12:15], v[196:199], v[228:231], v[12:15]
    v_xor_b32 v246, 128, v251
    v_mfma_f32_16x16x32_bf16 v[40:43], v[200:203], v[228:231], v[40:43]
    v_xor_b32 v247, 128, v252
    v_mfma_f32_16x16x32_bf16 v[44:47], v[204:207], v[228:231], v[44:47]
    v_xor_b32 v248, 128, v253
    s_waitcnt lgkmcnt(6)
    v_mfma_f32_16x16x32_bf16 v[16:19], v[192:195], v[232:235], v[16:19]
    v_mfma_f32_16x16x32_bf16 v[20:23], v[196:199], v[232:235], v[20:23]
    v_mfma_f32_16x16x32_bf16 v[48:51], v[200:203], v[232:235], v[48:51]
    v_mfma_f32_16x16x32_bf16 v[52:55], v[204:207], v[232:235], v[52:55]
    s_waitcnt lgkmcnt(4)
    v_mfma_f32_16x16x32_bf16 v[24:27], v[192:195], v[236:239], v[24:27]
    v_mfma_f32_16x16x32_bf16 v[28:31], v[196:199], v[236:239], v[28:31]
    v_mfma_f32_16x16x32_bf16 v[56:59], v[200:203], v[236:239], v[56:59]
    v_mfma_f32_16x16x32_bf16 v[60:63], v[204:207], v[236:239], v[60:63]
    s_waitcnt lgkmcnt(0)
    s_barrier
    v_mfma_f32_16x16x32_bf16 v[64:67], v[208:211], v[224:227], v[64:67]
    ds_read_b64_tr_b16 v[192:193], v250 offset:0
    v_cvt_pk_bf16_f32 v0, v0, v1
    v_cvt_pk_bf16_f32 v1, v2, v3
    v_mfma_f32_16x16x32_bf16 v[68:71], v[212:215], v[224:227], v[68:71]
    ds_read_b64_tr_b16 v[194:195], v250 offset:1024
    v_cvt_pk_bf16_f32 v2, v4, v5
    v_cvt_pk_bf16_f32 v3, v6, v7
    v_mfma_f32_16x16x32_bf16 v[96:99], v[216:219], v[224:227], v[96:99]
    ds_read_b64_tr_b16 v[196:197], v251 offset:0
    v_cvt_pk_bf16_f32 v4, v8, v9
    v_cvt_pk_bf16_f32 v5, v10, v11
    v_mfma_f32_16x16x32_bf16 v[100:103], v[220:223], v[224:227], v[100:103]
    ds_read_b128 v[224:227], v242 offset:8192
    ds_read_b64_tr_b16 v[198:199], v251 offset:1024
    v_cvt_pk_bf16_f32 v6, v12, v13
    v_cvt_pk_bf16_f32 v7, v14, v15
    v_mfma_f32_16x16x32_bf16 v[72:75], v[208:211], v[228:231], v[72:75]
    ds_read_b64_tr_b16 v[200:201], v252 offset:0
    v_cvt_pk_bf16_f32 v8, v16, v17
    v_cvt_pk_bf16_f32 v9, v18, v19
    v_mfma_f32_16x16x32_bf16 v[76:79], v[212:215], v[228:231], v[76:79]
    ds_read_b64_tr_b16 v[202:203], v252 offset:1024
    v_cvt_pk_bf16_f32 v10, v20, v21
    v_cvt_pk_bf16_f32 v11, v22, v23
    v_mfma_f32_16x16x32_bf16 v[104:107], v[216:219], v[228:231], v[104:107]
    ds_read_b64_tr_b16 v[204:205], v253 offset:0
    v_cvt_pk_bf16_f32 v12, v24, v25
    v_cvt_pk_bf16_f32 v13, v26, v27
    v_mfma_f32_16x16x32_bf16 v[108:111], v[220:223], v[228:231], v[108:111]
    ds_read_b128 v[228:231], v242 offset:9216
    ds_read_b64_tr_b16 v[206:207], v253 offset:1024
    v_cvt_pk_bf16_f32 v14, v28, v29
    v_cvt_pk_bf16_f32 v15, v30, v31
    v_mfma_f32_16x16x32_bf16 v[80:83], v[208:211], v[232:235], v[80:83]
    v_cvt_pk_bf16_f32 v16, v32, v33
    v_cvt_pk_bf16_f32 v17, v34, v35
    v_mfma_f32_16x16x32_bf16 v[84:87], v[212:215], v[232:235], v[84:87]
    v_cvt_pk_bf16_f32 v18, v36, v37
    v_cvt_pk_bf16_f32 v19, v38, v39
    v_mfma_f32_16x16x32_bf16 v[112:115], v[216:219], v[232:235], v[112:115]
    v_cvt_pk_bf16_f32 v20, v40, v41
    v_cvt_pk_bf16_f32 v21, v42, v43
    v_mfma_f32_16x16x32_bf16 v[116:119], v[220:223], v[232:235], v[116:119]
    ds_read_b128 v[232:235], v242 offset:0
    v_cvt_pk_bf16_f32 v22, v44, v45
    v_cvt_pk_bf16_f32 v23, v46, v47
    v_mfma_f32_16x16x32_bf16 v[88:91], v[208:211], v[236:239], v[88:91]
    v_cvt_pk_bf16_f32 v24, v48, v49
    v_cvt_pk_bf16_f32 v25, v50, v51
    v_mfma_f32_16x16x32_bf16 v[92:95], v[212:215], v[236:239], v[92:95]
    v_cvt_pk_bf16_f32 v26, v52, v53
    v_cvt_pk_bf16_f32 v27, v54, v55
    v_mfma_f32_16x16x32_bf16 v[120:123], v[216:219], v[236:239], v[120:123]
    v_cvt_pk_bf16_f32 v28, v56, v57
    v_cvt_pk_bf16_f32 v29, v58, v59
    v_mfma_f32_16x16x32_bf16 v[124:127], v[220:223], v[236:239], v[124:127]
    ds_read_b128 v[236:239], v242 offset:1024
    v_cvt_pk_bf16_f32 v30, v60, v61
    v_cvt_pk_bf16_f32 v31, v62, v63
KB_XT2:
    s_waitcnt lgkmcnt(2)
    v_mfma_f32_16x16x32_bf16 v[128:131], v[192:195], v[224:227], 0
    ds_read_b64_tr_b16 v[208:209], v245 offset:0
    ds_read_b64_tr_b16 v[210:211], v245 offset:1024
    v_pk_mul_f32 v[64:65], v[64:65], s[90:91]
    v_pk_mul_f32 v[66:67], v[66:67], s[90:91]
    v_pk_mul_f32 v[68:69], v[68:69], s[90:91]
    v_pk_mul_f32 v[70:71], v[70:71], s[90:91]
    v_mfma_f32_16x16x32_bf16 v[132:135], v[196:199], v[224:227], 0
    ds_read_b64_tr_b16 v[212:213], v246 offset:0
    ds_read_b64_tr_b16 v[214:215], v246 offset:1024
    v_pk_mul_f32 v[72:73], v[72:73], s[90:91]
    v_pk_mul_f32 v[74:75], v[74:75], s[90:91]
    v_pk_mul_f32 v[76:77], v[76:77], s[90:91]
    v_pk_mul_f32 v[78:79], v[78:79], s[90:91]
    v_mfma_f32_16x16x32_bf16 v[144:147], v[200:203], v[224:227], 0
    ds_read_b64_tr_b16 v[216:217], v247 offset:0
    ds_read_b64_tr_b16 v[218:219], v247 offset:1024
    v_cvt_pk_bf16_f32 v32, v64, v65
    v_cvt_pk_bf16_f32 v33, v66, v67
    v_cvt_pk_bf16_f32 v34, v68, v69
    v_cvt_pk_bf16_f32 v35, v70, v71
    v_mfma_f32_16x16x32_bf16 v[148:151], v[204:207], v[224:227], 0
    ds_read_b64_tr_b16 v[220:221], v248 offset:0
    ds_read_b64_tr_b16 v[222:223], v248 offset:1024
    v_cvt_pk_bf16_f32 v36, v72, v73
    v_cvt_pk_bf16_f32 v37, v74, v75
    v_cvt_pk_bf16_f32 v38, v76, v77
    v_cvt_pk_bf16_f32 v39, v78, v79
    v_mfma_f32_16x16x32_bf16 v[136:139], v[192:195], v[228:231], 0
    v_add_u32 v250, 0xfffe0000, v250
    v_add_u32 v251, 0xfffe0000, v251
    v_pk_mul_f32 v[80:81], v[80:81], s[90:91]
    v_pk_mul_f32 v[82:83], v[82:83], s[90:91]
    v_pk_mul_f32 v[84:85], v[84:85], s[90:91]
    v_pk_mul_f32 v[86:87], v[86:87], s[90:91]
    v_mfma_f32_16x16x32_bf16 v[140:143], v[196:199], v[228:231], 0
    v_add_u32 v252, 0xfffe0000, v252
    v_add_u32 v253, 0xfffe0000, v253
    v_pk_mul_f32 v[88:89], v[88:89], s[90:91]
    v_pk_mul_f32 v[90:91], v[90:91], s[90:91]
    v_pk_mul_f32 v[92:93], v[92:93], s[90:91]
    v_pk_mul_f32 v[94:95], v[94:95], s[90:91]
    v_mfma_f32_16x16x32_bf16 v[152:155], v[200:203], v[228:231], 0
    v_add_u32 v245, 0xfffe0000, v245
    v_add_u32 v246, 0xfffe0000, v246
    v_cvt_pk_bf16_f32 v40, v80, v81
    v_cvt_pk_bf16_f32 v41, v82, v83
    v_cvt_pk_bf16_f32 v42, v84, v85
    v_cvt_pk_bf16_f32 v43, v86, v87
    v_mfma_f32_16x16x32_bf16 v[156:159], v[204:207], v[228:231], 0
    v_add_u32 v247, 0xfffe0000, v247
    v_add_u32 v248, 0xfffe0000, v248
    v_cvt_pk_bf16_f32 v44, v88, v89
    v_cvt_pk_bf16_f32 v45, v90, v91
    v_cvt_pk_bf16_f32 v46, v92, v93
    v_cvt_pk_bf16_f32 v47, v94, v95
    v_add_u32 v242, 0xfffe0000, v242
    s_waitcnt lgkmcnt(9)
    v_mfma_f32_16x16x32_bf16 v[64:67], v[192:195], v[232:235], 0
    v_pk_mul_f32 v[96:97], v[96:97], s[90:91]
    v_pk_mul_f32 v[98:99], v[98:99], s[90:91]
    v_mfma_f32_16x16x32_bf16 v[68:71], v[196:199], v[232:235], 0
    v_pk_mul_f32 v[100:101], v[100:101], s[90:91]
    v_pk_mul_f32 v[102:103], v[102:103], s[90:91]
    v_mfma_f32_16x16x32_bf16 v[80:83], v[200:203], v[232:235], 0
    v_pk_mul_f32 v[104:105], v[104:105], s[90:91]
    v_pk_mul_f32 v[106:107], v[106:107], s[90:91]
    v_mfma_f32_16x16x32_bf16 v[84:87], v[204:207], v[232:235], 0
    v_pk_mul_f32 v[108:109], v[108:109], s[90:91]
    v_pk_mul_f32 v[110:111], v[110:111], s[90:91]
    s_waitcnt lgkmcnt(8)
    v_mfma_f32_16x16x32_bf16 v[72:75], v[192:195], v[236:239], 0
    v_cvt_pk_bf16_f32 v48, v96, v97
    v_cvt_pk_bf16_f32 v49, v98, v99
    v_mfma_f32_16x16x32_bf16 v[76:79], v[196:199], v[236:239], 0
    v_cvt_pk_bf16_f32 v50, v100, v101
    v_cvt_pk_bf16_f32 v51, v102, v103
    v_mfma_f32_16x16x32_bf16 v[88:91], v[200:203], v[236:239], 0
    v_cvt_pk_bf16_f32 v52, v104, v105
    v_cvt_pk_bf16_f32 v53, v106, v107
    v_mfma_f32_16x16x32_bf16 v[92:95], v[204:207], v[236:239], 0
    v_cvt_pk_bf16_f32 v54, v108, v109
    v_cvt_pk_bf16_f32 v55, v110, v111
    s_waitcnt lgkmcnt(0)
    s_barrier
    v_mfma_f32_16x16x32_bf16 v[160:163], v[208:211], v[224:227], 0
    ds_read_b64_tr_b16 v[192:193], v250 offset:0
    v_pk_mul_f32 v[112:113], v[112:113], s[90:91]
    v_pk_mul_f32 v[114:115], v[114:115], s[90:91]
    v_mfma_f32_16x16x32_bf16 v[164:167], v[212:215], v[224:227], 0
    ds_read_b64_tr_b16 v[194:195], v250 offset:1024
    v_pk_mul_f32 v[116:117], v[116:117], s[90:91]
    v_pk_mul_f32 v[118:119], v[118:119], s[90:91]
    v_mfma_f32_16x16x32_bf16 v[176:179], v[216:219], v[224:227], 0
    ds_read_b64_tr_b16 v[196:197], v251 offset:0
    v_pk_mul_f32 v[120:121], v[120:121], s[90:91]
    v_pk_mul_f32 v[122:123], v[122:123], s[90:91]
    v_mfma_f32_16x16x32_bf16 v[180:183], v[220:223], v[224:227], 0
    ds_read_b128 v[224:227], v242 offset:8192
    ds_read_b64_tr_b16 v[198:199], v251 offset:1024
    v_pk_mul_f32 v[124:125], v[124:125], s[90:91]
    v_pk_mul_f32 v[126:127], v[126:127], s[90:91]
    v_mfma_f32_16x16x32_bf16 v[168:171], v[208:211], v[228:231], 0
    ds_read_b64_tr_b16 v[200:201], v252 offset:0
    v_cvt_pk_bf16_f32 v56, v112, v113
    v_cvt_pk_bf16_f32 v57, v114, v115
    v_mfma_f32_16x16x32_bf16 v[172:175], v[212:215], v[228:231], 0
    ds_read_b64_tr_b16 v[202:203], v252 offset:1024
    v_cvt_pk_bf16_f32 v58, v116, v117
    v_cvt_pk_bf16_f32 v59, v118, v119
    v_mfma_f32_16x16x32_bf16 v[184:187], v[216:219], v[228:231], 0
    ds_read_b64_tr_b16 v[204:205], v253 offset:0
    v_cvt_pk_bf16_f32 v60, v120, v121
    v_cvt_pk_bf16_f32 v61, v122, v123
    v_mfma_f32_16x16x32_bf16 v[188:191], v[220:223], v[228:231], 0
    ds_read_b128 v[228:231], v242 offset:9216
    ds_read_b64_tr_b16 v[206:207], v253 offset:1024
    v_cvt_pk_bf16_f32 v62, v124, v125
    v_cvt_pk_bf16_f32 v63, v126, v127
    v_mfma_f32_16x16x32_bf16 v[96:99], v[208:211], v[232:235], 0
    s_add_u32 s78, s31, 0
    v_mfma_f32_16x16x32_bf16 v[100:103], v[212:215], v[232:235], 0
    v_mfma_f32_16x16x32_bf16 v[112:115], v[216:219], v[232:235], 0
    v_mfma_f32_16x16x32_bf16 v[116:119], v[220:223], v[232:235], 0
    ds_read_b128 v[232:235], v242 offset:0
    v_mfma_f32_16x16x32_bf16 v[104:107], v[208:211], v[236:239], 0
    buffer_store_dwordx4 v[0:3], v240, s[40:43], s78 offen offset:0 sc1
    v_mfma_f32_16x16x32_bf16 v[108:111], v[212:215], v[236:239], 0
    v_mfma_f32_16x16x32_bf16 v[120:123], v[216:219], v[236:239], 0
    v_mfma_f32_16x16x32_bf16 v[124:127], v[220:223], v[236:239], 0
    ds_read_b128 v[236:239], v242 offset:1024
    s_waitcnt lgkmcnt(2)
    v_mfma_f32_16x16x32_bf16 v[128:131], v[192:195], v[224:227], v[128:131]
    ds_read_b64_tr_b16 v[208:209], v245 offset:0
    v_mfma_f32_16x16x32_bf16 v[132:135], v[196:199], v[224:227], v[132:135]
    ds_read_b64_tr_b16 v[210:211], v245 offset:1024
    v_mfma_f32_16x16x32_bf16 v[144:147], v[200:203], v[224:227], v[144:147]
    ds_read_b64_tr_b16 v[212:213], v246 offset:0
    v_mfma_f32_16x16x32_bf16 v[148:151], v[204:207], v[224:227], v[148:151]
    ds_read_b64_tr_b16 v[214:215], v246 offset:1024
    v_mfma_f32_16x16x32_bf16 v[136:139], v[192:195], v[228:231], v[136:139]
    ds_read_b64_tr_b16 v[216:217], v247 offset:0
    v_mfma_f32_16x16x32_bf16 v[140:143], v[196:199], v[228:231], v[140:143]
    ds_read_b64_tr_b16 v[218:219], v247 offset:1024
    v_mfma_f32_16x16x32_bf16 v[152:155], v[200:203], v[228:231], v[152:155]
    ds_read_b64_tr_b16 v[220:221], v248 offset:0
    v_mfma_f32_16x16x32_bf16 v[156:159], v[204:207], v[228:231], v[156:159]
    ds_read_b64_tr_b16 v[222:223], v248 offset:1024
    s_waitcnt lgkmcnt(9)
    v_mfma_f32_16x16x32_bf16 v[64:67], v[192:195], v[232:235], v[64:67]
    v_mfma_f32_16x16x32_bf16 v[68:71], v[196:199], v[232:235], v[68:71]
    v_mfma_f32_16x16x32_bf16 v[80:83], v[200:203], v[232:235], v[80:83]
    v_mfma_f32_16x16x32_bf16 v[84:87], v[204:207], v[232:235], v[84:87]
    s_waitcnt lgkmcnt(8)
    v_mfma_f32_16x16x32_bf16 v[72:75], v[192:195], v[236:239], v[72:75]
    v_mfma_f32_16x16x32_bf16 v[76:79], v[196:199], v[236:239], v[76:79]
    v_mfma_f32_16x16x32_bf16 v[88:91], v[200:203], v[236:239], v[88:91]
    v_mfma_f32_16x16x32_bf16 v[92:95], v[204:207], v[236:239], v[92:95]
    s_waitcnt lgkmcnt(0)
    s_barrier
    v_mfma_f32_16x16x32_bf16 v[160:163], v[208:211], v[224:227], v[160:163]
    ds_read_b64_tr_b16 v[192:193], v250 offset:32768
    s_add_u32 s78, s31, 0
    v_mfma_f32_16x16x32_bf16 v[164:167], v[212:215], v[224:227], v[164:167]
    ds_read_b64_tr_b16 v[194:195], v250 offset:33792
    v_mfma_f32_16x16x32_bf16 v[176:179], v[216:219], v[224:227], v[176:179]
    ds_read_b64_tr_b16 v[196:197], v251 offset:32768
    v_mfma_f32_16x16x32_bf16 v[180:183], v[220:223], v[224:227], v[180:183]
    ds_read_b128 v[224:227], v242 offset:40960
    ds_read_b64_tr_b16 v[198:199], v251 offset:33792
    v_mfma_f32_16x16x32_bf16 v[168:171], v[208:211], v[228:231], v[168:171]
    ds_read_b64_tr_b16 v[200:201], v252 offset:32768
    v_mfma_f32_16x16x32_bf16 v[172:175], v[212:215], v[228:231], v[172:175]
    ds_read_b64_tr_b16 v[202:203], v252 offset:33792
    v_mfma_f32_16x16x32_bf16 v[184:187], v[216:219], v[228:231], v[184:187]
    ds_read_b64_tr_b16 v[204:205], v253 offset:32768
    v_mfma_f32_16x16x32_bf16 v[188:191], v[220:223], v[228:231], v[188:191]
    ds_read_b128 v[228:231], v242 offset:41984
    ds_read_b64_tr_b16 v[206:207], v253 offset:33792
    v_mfma_f32_16x16x32_bf16 v[96:99], v[208:211], v[232:235], v[96:99]
    buffer_store_dwordx4 v[4:7], v240, s[40:43], s78 offen offset:1024 sc1
    v_mfma_f32_16x16x32_bf16 v[100:103], v[212:215], v[232:235], v[100:103]
    v_mfma_f32_16x16x32_bf16 v[112:115], v[216:219], v[232:235], v[112:115]
    v_mfma_f32_16x16x32_bf16 v[116:119], v[220:223], v[232:235], v[116:119]
    ds_read_b128 v[232:235], v242 offset:32768
    v_mfma_f32_16x16x32_bf16 v[104:107], v[208:211], v[236:239], v[104:107]
    v_mfma_f32_16x16x32_bf16 v[108:111], v[212:215], v[236:239], v[108:111]
    v_mfma_f32_16x16x32_bf16 v[120:123], v[216:219], v[236:239], v[120:123]
    v_mfma_f32_16x16x32_bf16 v[124:127], v[220:223], v[236:239], v[124:127]
    ds_read_b128 v[236:239], v242 offset:33792
    s_waitcnt lgkmcnt(2)
    v_mfma_f32_16x16x32_bf16 v[128:131], v[192:195], v[224:227], v[128:131]
    ds_read_b64_tr_b16 v[208:209], v245 offset:32768
    ds_read_b64_tr_b16 v[210:211], v245 offset:33792
    v_mfma_f32_16x16x32_bf16 v[132:135], v[196:199], v[224:227], v[132:135]
    ds_read_b64_tr_b16 v[212:213], v246 offset:32768
    ds_read_b64_tr_b16 v[214:215], v246 offset:33792
    v_mfma_f32_16x16x32_bf16 v[144:147], v[200:203], v[224:227], v[144:147]
    ds_read_b64_tr_b16 v[216:217], v247 offset:32768
    ds_read_b64_tr_b16 v[218:219], v247 offset:33792
    v_mfma_f32_16x16x32_bf16 v[148:151], v[204:207], v[224:227], v[148:151]
    ds_read_b64_tr_b16 v[220:221], v248 offset:32768
    ds_read_b64_tr_b16 v[222:223], v248 offset:33792
    v_mfma_f32_16x16x32_bf16 v[136:139], v[192:195], v[228:231], v[136:139]
    v_add_u32 v250, 0x10000, v250
    v_add_u32 v251, 0x10000, v251
    v_mfma_f32_16x16x32_bf16 v[140:143], v[196:199], v[228:231], v[140:143]
    v_add_u32 v252, 0x10000, v252
    v_add_u32 v253, 0x10000, v253
    v_mfma_f32_16x16x32_bf16 v[152:155], v[200:203], v[228:231], v[152:155]
    v_add_u32 v245, 0x10000, v245
    v_add_u32 v246, 0x10000, v246
    v_mfma_f32_16x16x32_bf16 v[156:159], v[204:207], v[228:231], v[156:159]
    v_add_u32 v247, 0x10000, v247
    v_add_u32 v248, 0x10000, v248
    s_waitcnt lgkmcnt(9)
    v_mfma_f32_16x16x32_bf16 v[64:67], v[192:195], v[232:235], v[64:67]
    v_add_u32 v242, 0x10000, v242
    v_mfma_f32_16x16x32_bf16 v[68:71], v[196:199], v[232:235], v[68:71]
    v_mfma_f32_16x16x32_bf16 v[80:83], v[200:203], v[232:235], v[80:83]
    v_mfma_f32_16x16x32_bf16 v[84:87], v[204:207], v[232:235], v[84:87]
    s_waitcnt lgkmcnt(8)
    v_mfma_f32_16x16x32_bf16 v[72:75], v[192:195], v[236:239], v[72:75]
    v_mfma_f32_16x16x32_bf16 v[76:79], v[196:199], v[236:239], v[76:79]
    v_mfma_f32_16x16x32_bf16 v[88:91], v[200:203], v[236:239], v[88:91]
    v_mfma_f32_16x16x32_bf16 v[92:95], v[204:207], v[236:239], v[92:95]
    s_waitcnt lgkmcnt(0)
    s_barrier
    v_mfma_f32_16x16x32_bf16 v[160:163], v[208:211], v[224:227], v[160:163]
    ds_read_b64_tr_b16 v[192:193], v250 offset:0
    s_add_u32 s78, s31, 2048
    v_mfma_f32_16x16x32_bf16 v[164:167], v[212:215], v[224:227], v[164:167]
    ds_read_b64_tr_b16 v[194:195], v250 offset:1024
    v_mfma_f32_16x16x32_bf16 v[176:179], v[216:219], v[224:227], v[176:179]
    ds_read_b64_tr_b16 v[196:197], v251 offset:0
    v_mfma_f32_16x16x32_bf16 v[180:183], v[220:223], v[224:227], v[180:183]
    ds_read_b128 v[224:227], v242 offset:8192
    ds_read_b64_tr_b16 v[198:199], v251 offset:1024
    v_mfma_f32_16x16x32_bf16 v[168:171], v[208:211], v[228:231], v[168:171]
    ds_read_b64_tr_b16 v[200:201], v252 offset:0
    v_mfma_f32_16x16x32_bf16 v[172:175], v[212:215], v[228:231], v[172:175]
    ds_read_b64_tr_b16 v[202:203], v252 offset:1024
    v_mfma_f32_16x16x32_bf16 v[184:187], v[216:219], v[228:231], v[184:187]
    ds_read_b64_tr_b16 v[204:205], v253 offset:0
    v_mfma_f32_16x16x32_bf16 v[188:191], v[220:223], v[228:231], v[188:191]
    ds_read_b128 v[228:231], v242 offset:9216
    ds_read_b64_tr_b16 v[206:207], v253 offset:1024
    v_mfma_f32_16x16x32_bf16 v[96:99], v[208:211], v[232:235], v[96:99]
    buffer_store_dwordx4 v[8:11], v240, s[40:43], s78 offen offset:0 sc1
    v_mfma_f32_16x16x32_bf16 v[100:103], v[212:215], v[232:235], v[100:103]
    v_mfma_f32_16x16x32_bf16 v[112:115], v[216:219], v[232:235], v[112:115]
    v_mfma_f32_16x16x32_bf16 v[116:119], v[220:223], v[232:235], v[116:119]
    ds_read_b128 v[232:235], v242 offset:0
    v_mfma_f32_16x16x32_bf16 v[104:107], v[208:211], v[236:239], v[104:107]
    v_mfma_f32_16x16x32_bf16 v[108:111], v[212:215], v[236:239], v[108:111]
    v_mfma_f32_16x16x32_bf16 v[120:123], v[216:219], v[236:239], v[120:123]
    v_mfma_f32_16x16x32_bf16 v[124:127], v[220:223], v[236:239], v[124:127]
    ds_read_b128 v[236:239], v242 offset:1024
    s_waitcnt lgkmcnt(2)
    v_mfma_f32_16x16x32_bf16 v[128:131], v[192:195], v[224:227], v[128:131]
    ds_read_b64_tr_b16 v[208:209], v245 offset:0
    v_mfma_f32_16x16x32_bf16 v[132:135], v[196:199], v[224:227], v[132:135]
    ds_read_b64_tr_b16 v[210:211], v245 offset:1024
    v_mfma_f32_16x16x32_bf16 v[144:147], v[200:203], v[224:227], v[144:147]
    ds_read_b64_tr_b16 v[212:213], v246 offset:0
    v_mfma_f32_16x16x32_bf16 v[148:151], v[204:207], v[224:227], v[148:151]
    ds_read_b64_tr_b16 v[214:215], v246 offset:1024
    v_mfma_f32_16x16x32_bf16 v[136:139], v[192:195], v[228:231], v[136:139]
    ds_read_b64_tr_b16 v[216:217], v247 offset:0
    v_mfma_f32_16x16x32_bf16 v[140:143], v[196:199], v[228:231], v[140:143]
    ds_read_b64_tr_b16 v[218:219], v247 offset:1024
    v_mfma_f32_16x16x32_bf16 v[152:155], v[200:203], v[228:231], v[152:155]
    ds_read_b64_tr_b16 v[220:221], v248 offset:0
    v_mfma_f32_16x16x32_bf16 v[156:159], v[204:207], v[228:231], v[156:159]
    ds_read_b64_tr_b16 v[222:223], v248 offset:1024
    s_waitcnt lgkmcnt(9)
    v_mfma_f32_16x16x32_bf16 v[64:67], v[192:195], v[232:235], v[64:67]
    v_mfma_f32_16x16x32_bf16 v[68:71], v[196:199], v[232:235], v[68:71]
    v_mfma_f32_16x16x32_bf16 v[80:83], v[200:203], v[232:235], v[80:83]
    v_mfma_f32_16x16x32_bf16 v[84:87], v[204:207], v[232:235], v[84:87]
    s_waitcnt lgkmcnt(8)
    v_mfma_f32_16x16x32_bf16 v[72:75], v[192:195], v[236:239], v[72:75]
    v_mfma_f32_16x16x32_bf16 v[76:79], v[196:199], v[236:239], v[76:79]
    v_mfma_f32_16x16x32_bf16 v[88:91], v[200:203], v[236:239], v[88:91]
    v_mfma_f32_16x16x32_bf16 v[92:95], v[204:207], v[236:239], v[92:95]
    s_waitcnt lgkmcnt(0)
    s_barrier
    v_mfma_f32_16x16x32_bf16 v[160:163], v[208:211], v[224:227], v[160:163]
    ds_read_b64_tr_b16 v[192:193], v250 offset:32768
    s_add_u32 s78, s31, 2048
    v_mfma_f32_16x16x32_bf16 v[164:167], v[212:215], v[224:227], v[164:167]
    ds_read_b64_tr_b16 v[194:195], v250 offset:33792
    v_mfma_f32_16x16x32_bf16 v[176:179], v[216:219], v[224:227], v[176:179]
    ds_read_b64_tr_b16 v[196:197], v251 offset:32768
    v_mfma_f32_16x16x32_bf16 v[180:183], v[220:223], v[224:227], v[180:183]
    ds_read_b128 v[224:227], v242 offset:40960
    ds_read_b64_tr_b16 v[198:199], v251 offset:33792
    v_mfma_f32_16x16x32_bf16 v[168:171], v[208:211], v[228:231], v[168:171]
    ds_read_b64_tr_b16 v[200:201], v252 offset:32768
    v_mfma_f32_16x16x32_bf16 v[172:175], v[212:215], v[228:231], v[172:175]
    ds_read_b64_tr_b16 v[202:203], v252 offset:33792
    v_mfma_f32_16x16x32_bf16 v[184:187], v[216:219], v[228:231], v[184:187]
    ds_read_b64_tr_b16 v[204:205], v253 offset:32768
    v_mfma_f32_16x16x32_bf16 v[188:191], v[220:223], v[228:231], v[188:191]
    ds_read_b128 v[228:231], v242 offset:41984
    ds_read_b64_tr_b16 v[206:207], v253 offset:33792
    v_mfma_f32_16x16x32_bf16 v[96:99], v[208:211], v[232:235], v[96:99]
    buffer_store_dwordx4 v[12:15], v240, s[40:43], s78 offen offset:1024 sc1
    v_mfma_f32_16x16x32_bf16 v[100:103], v[212:215], v[232:235], v[100:103]
    v_mfma_f32_16x16x32_bf16 v[112:115], v[216:219], v[232:235], v[112:115]
    v_mfma_f32_16x16x32_bf16 v[116:119], v[220:223], v[232:235], v[116:119]
    ds_read_b128 v[232:235], v242 offset:32768
    v_mfma_f32_16x16x32_bf16 v[104:107], v[208:211], v[236:239], v[104:107]
    v_mfma_f32_16x16x32_bf16 v[108:111], v[212:215], v[236:239], v[108:111]
    v_mfma_f32_16x16x32_bf16 v[120:123], v[216:219], v[236:239], v[120:123]
    v_mfma_f32_16x16x32_bf16 v[124:127], v[220:223], v[236:239], v[124:127]
    ds_read_b128 v[236:239], v242 offset:33792
    s_waitcnt lgkmcnt(2)
    v_mfma_f32_16x16x32_bf16 v[128:131], v[192:195], v[224:227], v[128:131]
    ds_read_b64_tr_b16 v[208:209], v245 offset:32768
    ds_read_b64_tr_b16 v[210:211], v245 offset:33792
    v_mfma_f32_16x16x32_bf16 v[132:135], v[196:199], v[224:227], v[132:135]
    ds_read_b64_tr_b16 v[212:213], v246 offset:32768
    ds_read_b64_tr_b16 v[214:215], v246 offset:33792
    v_mfma_f32_16x16x32_bf16 v[144:147], v[200:203], v[224:227], v[144:147]
    ds_read_b64_tr_b16 v[216:217], v247 offset:32768
    ds_read_b64_tr_b16 v[218:219], v247 offset:33792
    v_mfma_f32_16x16x32_bf16 v[148:151], v[204:207], v[224:227], v[148:151]
    ds_read_b64_tr_b16 v[220:221], v248 offset:32768
    ds_read_b64_tr_b16 v[222:223], v248 offset:33792
    v_mfma_f32_16x16x32_bf16 v[136:139], v[192:195], v[228:231], v[136:139]
    v_add_u32 v250, 0x10000, v250
    v_add_u32 v251, 0x10000, v251
    v_mfma_f32_16x16x32_bf16 v[140:143], v[196:199], v[228:231], v[140:143]
    v_add_u32 v252, 0x10000, v252
    v_add_u32 v253, 0x10000, v253
    v_mfma_f32_16x16x32_bf16 v[152:155], v[200:203], v[228:231], v[152:155]
    v_add_u32 v245, 0x10000, v245
    v_add_u32 v246, 0x10000, v246
    v_mfma_f32_16x16x32_bf16 v[156:159], v[204:207], v[228:231], v[156:159]
    v_add_u32 v247, 0x10000, v247
    v_add_u32 v248, 0x10000, v248
    s_waitcnt lgkmcnt(9)
    v_mfma_f32_16x16x32_bf16 v[64:67], v[192:195], v[232:235], v[64:67]
    v_add_u32 v242, 0x10000, v242
    v_mfma_f32_16x16x32_bf16 v[68:71], v[196:199], v[232:235], v[68:71]
    v_mfma_f32_16x16x32_bf16 v[80:83], v[200:203], v[232:235], v[80:83]
    v_mfma_f32_16x16x32_bf16 v[84:87], v[204:207], v[232:235], v[84:87]
    s_waitcnt lgkmcnt(8)
    v_mfma_f32_16x16x32_bf16 v[72:75], v[192:195], v[236:239], v[72:75]
    v_mfma_f32_16x16x32_bf16 v[76:79], v[196:199], v[236:239], v[76:79]
    v_mfma_f32_16x16x32_bf16 v[88:91], v[200:203], v[236:239], v[88:91]
    v_mfma_f32_16x16x32_bf16 v[92:95], v[204:207], v[236:239], v[92:95]
    s_waitcnt lgkmcnt(0)
    s_barrier
    v_mfma_f32_16x16x32_bf16 v[160:163], v[208:211], v[224:227], v[160:163]
    ds_read_b64_tr_b16 v[192:193], v250 offset:0
    s_add_u32 s78, s31, 65536
    v_mfma_f32_16x16x32_bf16 v[164:167], v[212:215], v[224:227], v[164:167]
    ds_read_b64_tr_b16 v[194:195], v250 offset:1024
    v_mfma_f32_16x16x32_bf16 v[176:179], v[216:219], v[224:227], v[176:179]
    ds_read_b64_tr_b16 v[196:197], v251 offset:0
    v_mfma_f32_16x16x32_bf16 v[180:183], v[220:223], v[224:227], v[180:183]
    ds_read_b128 v[224:227], v242 offset:8192
    ds_read_b64_tr_b16 v[198:199], v251 offset:1024
    v_mfma_f32_16x16x32_bf16 v[168:171], v[208:211], v[228:231], v[168:171]
    ds_read_b64_tr_b16 v[200:201], v252 offset:0
    v_mfma_f32_16x16x32_bf16 v[172:175], v[212:215], v[228:231], v[172:175]
    ds_read_b64_tr_b16 v[202:203], v252 offset:1024
    v_mfma_f32_16x16x32_bf16 v[184:187], v[216:219], v[228:231], v[184:187]
    ds_read_b64_tr_b16 v[204:205], v253 offset:0
    v_mfma_f32_16x16x32_bf16 v[188:191], v[220:223], v[228:231], v[188:191]
    ds_read_b128 v[228:231], v242 offset:9216
    ds_read_b64_tr_b16 v[206:207], v253 offset:1024
    v_mfma_f32_16x16x32_bf16 v[96:99], v[208:211], v[232:235], v[96:99]
    buffer_store_dwordx4 v[16:19], v240, s[40:43], s78 offen offset:0 sc1
    v_mfma_f32_16x16x32_bf16 v[100:103], v[212:215], v[232:235], v[100:103]
    v_mfma_f32_16x16x32_bf16 v[112:115], v[216:219], v[232:235], v[112:115]
    v_mfma_f32_16x16x32_bf16 v[116:119], v[220:223], v[232:235], v[116:119]
    ds_read_b128 v[232:235], v242 offset:0
    v_mfma_f32_16x16x32_bf16 v[104:107], v[208:211], v[236:239], v[104:107]
    v_mfma_f32_16x16x32_bf16 v[108:111], v[212:215], v[236:239], v[108:111]
    v_mfma_f32_16x16x32_bf16 v[120:123], v[216:219], v[236:239], v[120:123]
    v_mfma_f32_16x16x32_bf16 v[124:127], v[220:223], v[236:239], v[124:127]
    ds_read_b128 v[236:239], v242 offset:1024
    s_waitcnt lgkmcnt(2)
    v_mfma_f32_16x16x32_bf16 v[128:131], v[192:195], v[224:227], v[128:131]
    ds_read_b64_tr_b16 v[208:209], v245 offset:0
    ds_read_b64_tr_b16 v[210:211], v245 offset:1024
    v_mfma_f32_16x16x32_bf16 v[132:135], v[196:199], v[224:227], v[132:135]
    ds_read_b64_tr_b16 v[212:213], v246 offset:0
    ds_read_b64_tr_b16 v[214:215], v246 offset:1024
    v_mfma_f32_16x16x32_bf16 v[144:147], v[200:203], v[224:227], v[144:147]
    ds_read_b64_tr_b16 v[216:217], v247 offset:0
    ds_read_b64_tr_b16 v[218:219], v247 offset:1024
    v_mfma_f32_16x16x32_bf16 v[148:151], v[204:207], v[224:227], v[148:151]
    ds_read_b64_tr_b16 v[220:221], v248 offset:0
    ds_read_b64_tr_b16 v[222:223], v248 offset:1024
    v_mfma_f32_16x16x32_bf16 v[136:139], v[192:195], v[228:231], v[136:139]
    v_add_u32 v250, 0xfffe0000, v250
    v_add_u32 v251, 0xfffe0000, v251
    v_mfma_f32_16x16x32_bf16 v[140:143], v[196:199], v[228:231], v[140:143]
    v_add_u32 v252, 0xfffe0000, v252
    v_add_u32 v253, 0xfffe0000, v253
    v_mfma_f32_16x16x32_bf16 v[152:155], v[200:203], v[228:231], v[152:155]
    v_add_u32 v245, 0xfffe0000, v245
    v_add_u32 v246, 0xfffe0000, v246
    v_mfma_f32_16x16x32_bf16 v[156:159], v[204:207], v[228:231], v[156:159]
    v_add_u32 v247, 0xfffe0000, v247
    v_add_u32 v248, 0xfffe0000, v248
    s_waitcnt lgkmcnt(9)
    v_mfma_f32_16x16x32_bf16 v[64:67], v[192:195], v[232:235], v[64:67]
    v_add_u32 v242, 0xfffe0000, v242
    v_mfma_f32_16x16x32_bf16 v[68:71], v[196:199], v[232:235], v[68:71]
    v_mfma_f32_16x16x32_bf16 v[80:83], v[200:203], v[232:235], v[80:83]
    v_mfma_f32_16x16x32_bf16 v[84:87], v[204:207], v[232:235], v[84:87]
    s_waitcnt lgkmcnt(8)
    v_mfma_f32_16x16x32_bf16 v[72:75], v[192:195], v[236:239], v[72:75]
    v_mfma_f32_16x16x32_bf16 v[76:79], v[196:199], v[236:239], v[76:79]
    v_mfma_f32_16x16x32_bf16 v[88:91], v[200:203], v[236:239], v[88:91]
    v_mfma_f32_16x16x32_bf16 v[92:95], v[204:207], v[236:239], v[92:95]
    s_waitcnt lgkmcnt(0)
    s_barrier
    v_mfma_f32_16x16x32_bf16 v[160:163], v[208:211], v[224:227], v[160:163]
    ds_read_b64_tr_b16 v[192:193], v250 offset:0
    s_add_u32 s78, s31, 65536
    v_mfma_f32_16x16x32_bf16 v[164:167], v[212:215], v[224:227], v[164:167]
    ds_read_b64_tr_b16 v[194:195], v250 offset:1024
    v_mfma_f32_16x16x32_bf16 v[176:179], v[216:219], v[224:227], v[176:179]
    ds_read_b64_tr_b16 v[196:197], v251 offset:0
    v_mfma_f32_16x16x32_bf16 v[180:183], v[220:223], v[224:227], v[180:183]
    ds_read_b128 v[224:227], v242 offset:8192
    ds_read_b64_tr_b16 v[198:199], v251 offset:1024
    v_mfma_f32_16x16x32_bf16 v[168:171], v[208:211], v[228:231], v[168:171]
    ds_read_b64_tr_b16 v[200:201], v252 offset:0
    v_mfma_f32_16x16x32_bf16 v[172:175], v[212:215], v[228:231], v[172:175]
    ds_read_b64_tr_b16 v[202:203], v252 offset:1024
    v_mfma_f32_16x16x32_bf16 v[184:187], v[216:219], v[228:231], v[184:187]
    ds_read_b64_tr_b16 v[204:205], v253 offset:0
    v_mfma_f32_16x16x32_bf16 v[188:191], v[220:223], v[228:231], v[188:191]
    ds_read_b128 v[228:231], v242 offset:9216
    ds_read_b64_tr_b16 v[206:207], v253 offset:1024
    v_mfma_f32_16x16x32_bf16 v[96:99], v[208:211], v[232:235], v[96:99]
    buffer_store_dwordx4 v[20:23], v240, s[40:43], s78 offen offset:1024 sc1
    v_mfma_f32_16x16x32_bf16 v[100:103], v[212:215], v[232:235], v[100:103]
    v_mfma_f32_16x16x32_bf16 v[112:115], v[216:219], v[232:235], v[112:115]
    v_mfma_f32_16x16x32_bf16 v[116:119], v[220:223], v[232:235], v[116:119]
    ds_read_b128 v[232:235], v242 offset:0
    v_mfma_f32_16x16x32_bf16 v[104:107], v[208:211], v[236:239], v[104:107]
    v_mfma_f32_16x16x32_bf16 v[108:111], v[212:215], v[236:239], v[108:111]
    v_mfma_f32_16x16x32_bf16 v[120:123], v[216:219], v[236:239], v[120:123]
    v_mfma_f32_16x16x32_bf16 v[124:127], v[220:223], v[236:239], v[124:127]
    ds_read_b128 v[236:239], v242 offset:1024
    s_waitcnt lgkmcnt(2)
    v_mfma_f32_16x16x32_bf16 v[128:131], v[192:195], v[224:227], v[128:131]
    ds_read_b64_tr_b16 v[208:209], v245 offset:0
    v_mfma_f32_16x16x32_bf16 v[132:135], v[196:199], v[224:227], v[132:135]
    ds_read_b64_tr_b16 v[210:211], v245 offset:1024
    v_mfma_f32_16x16x32_bf16 v[144:147], v[200:203], v[224:227], v[144:147]
    ds_read_b64_tr_b16 v[212:213], v246 offset:0
    v_mfma_f32_16x16x32_bf16 v[148:151], v[204:207], v[224:227], v[148:151]
    ds_read_b64_tr_b16 v[214:215], v246 offset:1024
    v_mfma_f32_16x16x32_bf16 v[136:139], v[192:195], v[228:231], v[136:139]
    ds_read_b64_tr_b16 v[216:217], v247 offset:0
    v_mfma_f32_16x16x32_bf16 v[140:143], v[196:199], v[228:231], v[140:143]
    ds_read_b64_tr_b16 v[218:219], v247 offset:1024
    v_mfma_f32_16x16x32_bf16 v[152:155], v[200:203], v[228:231], v[152:155]
    ds_read_b64_tr_b16 v[220:221], v248 offset:0
    v_mfma_f32_16x16x32_bf16 v[156:159], v[204:207], v[228:231], v[156:159]
    ds_read_b64_tr_b16 v[222:223], v248 offset:1024
    s_waitcnt lgkmcnt(9)
    v_mfma_f32_16x16x32_bf16 v[64:67], v[192:195], v[232:235], v[64:67]
    v_mfma_f32_16x16x32_bf16 v[68:71], v[196:199], v[232:235], v[68:71]
    v_mfma_f32_16x16x32_bf16 v[80:83], v[200:203], v[232:235], v[80:83]
    v_mfma_f32_16x16x32_bf16 v[84:87], v[204:207], v[232:235], v[84:87]
    s_waitcnt lgkmcnt(8)
    v_mfma_f32_16x16x32_bf16 v[72:75], v[192:195], v[236:239], v[72:75]
    v_mfma_f32_16x16x32_bf16 v[76:79], v[196:199], v[236:239], v[76:79]
    v_mfma_f32_16x16x32_bf16 v[88:91], v[200:203], v[236:239], v[88:91]
    v_mfma_f32_16x16x32_bf16 v[92:95], v[204:207], v[236:239], v[92:95]
    s_waitcnt vmcnt(2) lgkmcnt(0)
    s_barrier
    v_mfma_f32_16x16x32_bf16 v[160:163], v[208:211], v[224:227], v[160:163]
    ds_read_b64_tr_b16 v[192:193], v250 offset:32768
    s_add_u32 s78, s31, 67584
    v_mfma_f32_16x16x32_bf16 v[164:167], v[212:215], v[224:227], v[164:167]
    ds_read_b64_tr_b16 v[194:195], v250 offset:33792
    v_mfma_f32_16x16x32_bf16 v[176:179], v[216:219], v[224:227], v[176:179]
    ds_read_b64_tr_b16 v[196:197], v251 offset:32768
    v_mfma_f32_16x16x32_bf16 v[180:183], v[220:223], v[224:227], v[180:183]
    ds_read_b128 v[224:227], v242 offset:40960
    ds_read_b64_tr_b16 v[198:199], v251 offset:33792
    v_mfma_f32_16x16x32_bf16 v[168:171], v[208:211], v[228:231], v[168:171]
    ds_read_b64_tr_b16 v[200:201], v252 offset:32768
    v_mfma_f32_16x16x32_bf16 v[172:175], v[212:215], v[228:231], v[172:175]
    ds_read_b64_tr_b16 v[202:203], v252 offset:33792
    v_mfma_f32_16x16x32_bf16 v[184:187], v[216:219], v[228:231], v[184:187]
    ds_read_b64_tr_b16 v[204:205], v253 offset:32768
    v_mfma_f32_16x16x32_bf16 v[188:191], v[220:223], v[228:231], v[188:191]
    ds_read_b128 v[228:231], v242 offset:41984
    ds_read_b64_tr_b16 v[206:207], v253 offset:33792
    v_mfma_f32_16x16x32_bf16 v[96:99], v[208:211], v[232:235], v[96:99]
    buffer_store_dwordx4 v[24:27], v240, s[40:43], s78 offen offset:0 sc1
    v_mfma_f32_16x16x32_bf16 v[100:103], v[212:215], v[232:235], v[100:103]
    v_mfma_f32_16x16x32_bf16 v[112:115], v[216:219], v[232:235], v[112:115]
    v_mfma_f32_16x16x32_bf16 v[116:119], v[220:223], v[232:235], v[116:119]
    ds_read_b128 v[232:235], v242 offset:32768
    v_mfma_f32_16x16x32_bf16 v[104:107], v[208:211], v[236:239], v[104:107]
    v_mfma_f32_16x16x32_bf16 v[108:111], v[212:215], v[236:239], v[108:111]
    v_mfma_f32_16x16x32_bf16 v[120:123], v[216:219], v[236:239], v[120:123]
    v_mfma_f32_16x16x32_bf16 v[124:127], v[220:223], v[236:239], v[124:127]
    ds_read_b128 v[236:239], v242 offset:33792
    s_waitcnt lgkmcnt(2)
    v_mfma_f32_16x16x32_bf16 v[128:131], v[192:195], v[224:227], v[128:131]
    ds_read_b64_tr_b16 v[208:209], v245 offset:32768
    ds_read_b64_tr_b16 v[210:211], v245 offset:33792
    v_mfma_f32_16x16x32_bf16 v[132:135], v[196:199], v[224:227], v[132:135]
    ds_read_b64_tr_b16 v[212:213], v246 offset:32768
    ds_read_b64_tr_b16 v[214:215], v246 offset:33792
    v_mfma_f32_16x16x32_bf16 v[144:147], v[200:203], v[224:227], v[144:147]
    ds_read_b64_tr_b16 v[216:217], v247 offset:32768
    ds_read_b64_tr_b16 v[218:219], v247 offset:33792
    v_mfma_f32_16x16x32_bf16 v[148:151], v[204:207], v[224:227], v[148:151]
    ds_read_b64_tr_b16 v[220:221], v248 offset:32768
    ds_read_b64_tr_b16 v[222:223], v248 offset:33792
    v_mfma_f32_16x16x32_bf16 v[136:139], v[192:195], v[228:231], v[136:139]
    v_add_u32 v250, 0x10000, v250
    v_add_u32 v251, 0x10000, v251
    v_mfma_f32_16x16x32_bf16 v[140:143], v[196:199], v[228:231], v[140:143]
    v_add_u32 v252, 0x10000, v252
    v_add_u32 v253, 0x10000, v253
    v_mfma_f32_16x16x32_bf16 v[152:155], v[200:203], v[228:231], v[152:155]
    v_add_u32 v245, 0x10000, v245
    v_add_u32 v246, 0x10000, v246
    v_mfma_f32_16x16x32_bf16 v[156:159], v[204:207], v[228:231], v[156:159]
    v_add_u32 v247, 0x10000, v247
    v_add_u32 v248, 0x10000, v248
    s_waitcnt lgkmcnt(9)
    v_mfma_f32_16x16x32_bf16 v[64:67], v[192:195], v[232:235], v[64:67]
    v_add_u32 v242, 0x10000, v242
    v_mfma_f32_16x16x32_bf16 v[68:71], v[196:199], v[232:235], v[68:71]
    v_mfma_f32_16x16x32_bf16 v[80:83], v[200:203], v[232:235], v[80:83]
    v_mfma_f32_16x16x32_bf16 v[84:87], v[204:207], v[232:235], v[84:87]
    s_waitcnt lgkmcnt(8)
    v_mfma_f32_16x16x32_bf16 v[72:75], v[192:195], v[236:239], v[72:75]
    v_mfma_f32_16x16x32_bf16 v[76:79], v[196:199], v[236:239], v[76:79]
    v_mfma_f32_16x16x32_bf16 v[88:91], v[200:203], v[236:239], v[88:91]
    v_mfma_f32_16x16x32_bf16 v[92:95], v[204:207], v[236:239], v[92:95]
    s_waitcnt lgkmcnt(0)
    s_barrier
    v_mfma_f32_16x16x32_bf16 v[160:163], v[208:211], v[224:227], v[160:163]
    ds_read_b64_tr_b16 v[192:193], v250 offset:0
    s_add_u32 s78, s31, 67584
    v_mfma_f32_16x16x32_bf16 v[164:167], v[212:215], v[224:227], v[164:167]
    ds_read_b64_tr_b16 v[194:195], v250 offset:1024
    v_mfma_f32_16x16x32_bf16 v[176:179], v[216:219], v[224:227], v[176:179]
    ds_read_b64_tr_b16 v[196:197], v251 offset:0
    v_mfma_f32_16x16x32_bf16 v[180:183], v[220:223], v[224:227], v[180:183]
    ds_read_b128 v[224:227], v242 offset:8192
    ds_read_b64_tr_b16 v[198:199], v251 offset:1024
    v_mfma_f32_16x16x32_bf16 v[168:171], v[208:211], v[228:231], v[168:171]
    ds_read_b64_tr_b16 v[200:201], v252 offset:0
    v_mfma_f32_16x16x32_bf16 v[172:175], v[212:215], v[228:231], v[172:175]
    ds_read_b64_tr_b16 v[202:203], v252 offset:1024
    v_mfma_f32_16x16x32_bf16 v[184:187], v[216:219], v[228:231], v[184:187]
    ds_read_b64_tr_b16 v[204:205], v253 offset:0
    v_mfma_f32_16x16x32_bf16 v[188:191], v[220:223], v[228:231], v[188:191]
    ds_read_b128 v[228:231], v242 offset:9216
    ds_read_b64_tr_b16 v[206:207], v253 offset:1024
    v_mfma_f32_16x16x32_bf16 v[96:99], v[208:211], v[232:235], v[96:99]
    buffer_store_dwordx4 v[28:31], v240, s[40:43], s78 offen offset:1024 sc1
    v_mfma_f32_16x16x32_bf16 v[100:103], v[212:215], v[232:235], v[100:103]
    v_mfma_f32_16x16x32_bf16 v[112:115], v[216:219], v[232:235], v[112:115]
    v_mfma_f32_16x16x32_bf16 v[116:119], v[220:223], v[232:235], v[116:119]
    ds_read_b128 v[232:235], v242 offset:0
    v_mfma_f32_16x16x32_bf16 v[104:107], v[208:211], v[236:239], v[104:107]
    v_mfma_f32_16x16x32_bf16 v[108:111], v[212:215], v[236:239], v[108:111]
    v_mfma_f32_16x16x32_bf16 v[120:123], v[216:219], v[236:239], v[120:123]
    v_mfma_f32_16x16x32_bf16 v[124:127], v[220:223], v[236:239], v[124:127]
    ds_read_b128 v[236:239], v242 offset:1024
    s_waitcnt lgkmcnt(2)
    v_mfma_f32_16x16x32_bf16 v[128:131], v[192:195], v[224:227], v[128:131]
    ds_read_b64_tr_b16 v[208:209], v245 offset:0
    v_mfma_f32_16x16x32_bf16 v[132:135], v[196:199], v[224:227], v[132:135]
    ds_read_b64_tr_b16 v[210:211], v245 offset:1024
    v_mfma_f32_16x16x32_bf16 v[144:147], v[200:203], v[224:227], v[144:147]
    ds_read_b64_tr_b16 v[212:213], v246 offset:0
    v_mfma_f32_16x16x32_bf16 v[148:151], v[204:207], v[224:227], v[148:151]
    ds_read_b64_tr_b16 v[214:215], v246 offset:1024
    v_mfma_f32_16x16x32_bf16 v[136:139], v[192:195], v[228:231], v[136:139]
    ds_read_b64_tr_b16 v[216:217], v247 offset:0
    v_mfma_f32_16x16x32_bf16 v[140:143], v[196:199], v[228:231], v[140:143]
    ds_read_b64_tr_b16 v[218:219], v247 offset:1024
    v_mfma_f32_16x16x32_bf16 v[152:155], v[200:203], v[228:231], v[152:155]
    ds_read_b64_tr_b16 v[220:221], v248 offset:0
    v_mfma_f32_16x16x32_bf16 v[156:159], v[204:207], v[228:231], v[156:159]
    ds_read_b64_tr_b16 v[222:223], v248 offset:1024
    s_waitcnt lgkmcnt(9)
    v_mfma_f32_16x16x32_bf16 v[64:67], v[192:195], v[232:235], v[64:67]
    v_mfma_f32_16x16x32_bf16 v[68:71], v[196:199], v[232:235], v[68:71]
    v_mfma_f32_16x16x32_bf16 v[80:83], v[200:203], v[232:235], v[80:83]
    v_mfma_f32_16x16x32_bf16 v[84:87], v[204:207], v[232:235], v[84:87]
    s_waitcnt lgkmcnt(8)
    v_mfma_f32_16x16x32_bf16 v[72:75], v[192:195], v[236:239], v[72:75]
    v_mfma_f32_16x16x32_bf16 v[76:79], v[196:199], v[236:239], v[76:79]
    v_mfma_f32_16x16x32_bf16 v[88:91], v[200:203], v[236:239], v[88:91]
    v_mfma_f32_16x16x32_bf16 v[92:95], v[204:207], v[236:239], v[92:95]
    s_waitcnt lgkmcnt(0)
    s_barrier
    v_mfma_f32_16x16x32_bf16 v[160:163], v[208:211], v[224:227], v[160:163]
    ds_read_b64_tr_b16 v[192:193], v250 offset:32768
    s_add_u32 s78, s31, 131072
    v_mfma_f32_16x16x32_bf16 v[164:167], v[212:215], v[224:227], v[164:167]
    ds_read_b64_tr_b16 v[194:195], v250 offset:33792
    v_mfma_f32_16x16x32_bf16 v[176:179], v[216:219], v[224:227], v[176:179]
    ds_read_b64_tr_b16 v[196:197], v251 offset:32768
    v_mfma_f32_16x16x32_bf16 v[180:183], v[220:223], v[224:227], v[180:183]
    ds_read_b128 v[224:227], v242 offset:40960
    ds_read_b64_tr_b16 v[198:199], v251 offset:33792
    v_mfma_f32_16x16x32_bf16 v[168:171], v[208:211], v[228:231], v[168:171]
    ds_read_b64_tr_b16 v[200:201], v252 offset:32768
    v_mfma_f32_16x16x32_bf16 v[172:175], v[212:215], v[228:231], v[172:175]
    ds_read_b64_tr_b16 v[202:203], v252 offset:33792
    v_mfma_f32_16x16x32_bf16 v[184:187], v[216:219], v[228:231], v[184:187]
    ds_read_b64_tr_b16 v[204:205], v253 offset:32768
    v_mfma_f32_16x16x32_bf16 v[188:191], v[220:223], v[228:231], v[188:191]
    ds_read_b128 v[228:231], v242 offset:41984
    ds_read_b64_tr_b16 v[206:207], v253 offset:33792
    v_mfma_f32_16x16x32_bf16 v[96:99], v[208:211], v[232:235], v[96:99]
    buffer_store_dwordx4 v[32:35], v240, s[40:43], s78 offen offset:0 sc1
    v_mfma_f32_16x16x32_bf16 v[100:103], v[212:215], v[232:235], v[100:103]
    v_mfma_f32_16x16x32_bf16 v[112:115], v[216:219], v[232:235], v[112:115]
    v_mfma_f32_16x16x32_bf16 v[116:119], v[220:223], v[232:235], v[116:119]
    ds_read_b128 v[232:235], v242 offset:32768
    v_mfma_f32_16x16x32_bf16 v[104:107], v[208:211], v[236:239], v[104:107]
    v_mfma_f32_16x16x32_bf16 v[108:111], v[212:215], v[236:239], v[108:111]
    v_mfma_f32_16x16x32_bf16 v[120:123], v[216:219], v[236:239], v[120:123]
    v_mfma_f32_16x16x32_bf16 v[124:127], v[220:223], v[236:239], v[124:127]
    ds_read_b128 v[236:239], v242 offset:33792
    s_waitcnt lgkmcnt(2)
    v_mfma_f32_16x16x32_bf16 v[128:131], v[192:195], v[224:227], v[128:131]
    ds_read_b64_tr_b16 v[208:209], v245 offset:32768
    ds_read_b64_tr_b16 v[210:211], v245 offset:33792
    v_mfma_f32_16x16x32_bf16 v[132:135], v[196:199], v[224:227], v[132:135]
    ds_read_b64_tr_b16 v[212:213], v246 offset:32768
    ds_read_b64_tr_b16 v[214:215], v246 offset:33792
    v_mfma_f32_16x16x32_bf16 v[144:147], v[200:203], v[224:227], v[144:147]
    ds_read_b64_tr_b16 v[216:217], v247 offset:32768
    ds_read_b64_tr_b16 v[218:219], v247 offset:33792
    v_mfma_f32_16x16x32_bf16 v[148:151], v[204:207], v[224:227], v[148:151]
    ds_read_b64_tr_b16 v[220:221], v248 offset:32768
    ds_read_b64_tr_b16 v[222:223], v248 offset:33792
    v_mfma_f32_16x16x32_bf16 v[136:139], v[192:195], v[228:231], v[136:139]
    v_add_u32 v250, 0x10000, v250
    v_add_u32 v251, 0x10000, v251
    v_mfma_f32_16x16x32_bf16 v[140:143], v[196:199], v[228:231], v[140:143]
    v_add_u32 v252, 0x10000, v252
    v_add_u32 v253, 0x10000, v253
    v_mfma_f32_16x16x32_bf16 v[152:155], v[200:203], v[228:231], v[152:155]
    v_add_u32 v245, 0x10000, v245
    v_add_u32 v246, 0x10000, v246
    v_mfma_f32_16x16x32_bf16 v[156:159], v[204:207], v[228:231], v[156:159]
    v_add_u32 v247, 0x10000, v247
    v_add_u32 v248, 0x10000, v248
    s_waitcnt lgkmcnt(9)
    v_mfma_f32_16x16x32_bf16 v[64:67], v[192:195], v[232:235], v[64:67]
    v_add_u32 v242, 0x10000, v242
    v_mfma_f32_16x16x32_bf16 v[68:71], v[196:199], v[232:235], v[68:71]
    v_mfma_f32_16x16x32_bf16 v[80:83], v[200:203], v[232:235], v[80:83]
    v_mfma_f32_16x16x32_bf16 v[84:87], v[204:207], v[232:235], v[84:87]
    s_waitcnt lgkmcnt(8)
    v_mfma_f32_16x16x32_bf16 v[72:75], v[192:195], v[236:239], v[72:75]
    v_mfma_f32_16x16x32_bf16 v[76:79], v[196:199], v[236:239], v[76:79]
    v_mfma_f32_16x16x32_bf16 v[88:91], v[200:203], v[236:239], v[88:91]
    v_mfma_f32_16x16x32_bf16 v[92:95], v[204:207], v[236:239], v[92:95]
    s_waitcnt lgkmcnt(0)
    s_barrier
    v_mfma_f32_16x16x32_bf16 v[160:163], v[208:211], v[224:227], v[160:163]
    ds_read_b64_tr_b16 v[192:193], v250 offset:0
    s_add_u32 s78, s31, 131072
    v_mfma_f32_16x16x32_bf16 v[164:167], v[212:215], v[224:227], v[164:167]
    ds_read_b64_tr_b16 v[194:195], v250 offset:1024
    v_mfma_f32_16x16x32_bf16 v[176:179], v[216:219], v[224:227], v[176:179]
    ds_read_b64_tr_b16 v[196:197], v251 offset:0
    v_mfma_f32_16x16x32_bf16 v[180:183], v[220:223], v[224:227], v[180:183]
    ds_read_b128 v[224:227], v242 offset:8192
    ds_read_b64_tr_b16 v[198:199], v251 offset:1024
    v_mfma_f32_16x16x32_bf16 v[168:171], v[208:211], v[228:231], v[168:171]
    ds_read_b64_tr_b16 v[200:201], v252 offset:0
    v_mfma_f32_16x16x32_bf16 v[172:175], v[212:215], v[228:231], v[172:175]
    ds_read_b64_tr_b16 v[202:203], v252 offset:1024
    v_mfma_f32_16x16x32_bf16 v[184:187], v[216:219], v[228:231], v[184:187]
    ds_read_b64_tr_b16 v[204:205], v253 offset:0
    v_mfma_f32_16x16x32_bf16 v[188:191], v[220:223], v[228:231], v[188:191]
    ds_read_b128 v[228:231], v242 offset:9216
    ds_read_b64_tr_b16 v[206:207], v253 offset:1024
    v_mfma_f32_16x16x32_bf16 v[96:99], v[208:211], v[232:235], v[96:99]
    buffer_store_dwordx4 v[36:39], v240, s[40:43], s78 offen offset:1024 sc1
    v_mfma_f32_16x16x32_bf16 v[100:103], v[212:215], v[232:235], v[100:103]
    v_mfma_f32_16x16x32_bf16 v[112:115], v[216:219], v[232:235], v[112:115]
    v_mfma_f32_16x16x32_bf16 v[116:119], v[220:223], v[232:235], v[116:119]
    ds_read_b128 v[232:235], v242 offset:0
    v_mfma_f32_16x16x32_bf16 v[104:107], v[208:211], v[236:239], v[104:107]
    v_mfma_f32_16x16x32_bf16 v[108:111], v[212:215], v[236:239], v[108:111]
    v_mfma_f32_16x16x32_bf16 v[120:123], v[216:219], v[236:239], v[120:123]
    v_mfma_f32_16x16x32_bf16 v[124:127], v[220:223], v[236:239], v[124:127]
    ds_read_b128 v[236:239], v242 offset:1024
    s_waitcnt lgkmcnt(2)
    v_mfma_f32_16x16x32_bf16 v[128:131], v[192:195], v[224:227], v[128:131]
    ds_read_b64_tr_b16 v[208:209], v245 offset:0
    ds_read_b64_tr_b16 v[210:211], v245 offset:1024
    v_mfma_f32_16x16x32_bf16 v[132:135], v[196:199], v[224:227], v[132:135]
    ds_read_b64_tr_b16 v[212:213], v246 offset:0
    ds_read_b64_tr_b16 v[214:215], v246 offset:1024
    v_mfma_f32_16x16x32_bf16 v[144:147], v[200:203], v[224:227], v[144:147]
    ds_read_b64_tr_b16 v[216:217], v247 offset:0
    ds_read_b64_tr_b16 v[218:219], v247 offset:1024
    v_mfma_f32_16x16x32_bf16 v[148:151], v[204:207], v[224:227], v[148:151]
    ds_read_b64_tr_b16 v[220:221], v248 offset:0
    ds_read_b64_tr_b16 v[222:223], v248 offset:1024
    v_mfma_f32_16x16x32_bf16 v[136:139], v[192:195], v[228:231], v[136:139]
    v_add_u32 v250, 0xfffe0000, v250
    v_add_u32 v251, 0xfffe0000, v251
    v_mfma_f32_16x16x32_bf16 v[140:143], v[196:199], v[228:231], v[140:143]
    v_add_u32 v252, 0xfffe0000, v252
    v_add_u32 v253, 0xfffe0000, v253
    v_mfma_f32_16x16x32_bf16 v[152:155], v[200:203], v[228:231], v[152:155]
    v_add_u32 v245, 0xfffe0000, v245
    v_add_u32 v246, 0xfffe0000, v246
    v_mfma_f32_16x16x32_bf16 v[156:159], v[204:207], v[228:231], v[156:159]
    v_add_u32 v247, 0xfffe0000, v247
    v_add_u32 v248, 0xfffe0000, v248
    s_waitcnt lgkmcnt(9)
    v_mfma_f32_16x16x32_bf16 v[64:67], v[192:195], v[232:235], v[64:67]
    v_add_u32 v242, 0xfffe0000, v242
    v_mfma_f32_16x16x32_bf16 v[68:71], v[196:199], v[232:235], v[68:71]
    v_mfma_f32_16x16x32_bf16 v[80:83], v[200:203], v[232:235], v[80:83]
    v_mfma_f32_16x16x32_bf16 v[84:87], v[204:207], v[232:235], v[84:87]
    s_waitcnt lgkmcnt(8)
    v_mfma_f32_16x16x32_bf16 v[72:75], v[192:195], v[236:239], v[72:75]
    v_mfma_f32_16x16x32_bf16 v[76:79], v[196:199], v[236:239], v[76:79]
    v_mfma_f32_16x16x32_bf16 v[88:91], v[200:203], v[236:239], v[88:91]
    v_mfma_f32_16x16x32_bf16 v[92:95], v[204:207], v[236:239], v[92:95]
    s_waitcnt vmcnt(2) lgkmcnt(0)
    s_barrier
    v_mfma_f32_16x16x32_bf16 v[160:163], v[208:211], v[224:227], v[160:163]
    ds_read_b64_tr_b16 v[192:193], v250 offset:0
    s_add_u32 s78, s31, 133120
    v_mfma_f32_16x16x32_bf16 v[164:167], v[212:215], v[224:227], v[164:167]
    ds_read_b64_tr_b16 v[194:195], v250 offset:1024
    v_mfma_f32_16x16x32_bf16 v[176:179], v[216:219], v[224:227], v[176:179]
    ds_read_b64_tr_b16 v[196:197], v251 offset:0
    v_mfma_f32_16x16x32_bf16 v[180:183], v[220:223], v[224:227], v[180:183]
    ds_read_b128 v[224:227], v242 offset:8192
    ds_read_b64_tr_b16 v[198:199], v251 offset:1024
    v_mfma_f32_16x16x32_bf16 v[168:171], v[208:211], v[228:231], v[168:171]
    ds_read_b64_tr_b16 v[200:201], v252 offset:0
    v_mfma_f32_16x16x32_bf16 v[172:175], v[212:215], v[228:231], v[172:175]
    ds_read_b64_tr_b16 v[202:203], v252 offset:1024
    v_mfma_f32_16x16x32_bf16 v[184:187], v[216:219], v[228:231], v[184:187]
    ds_read_b64_tr_b16 v[204:205], v253 offset:0
    v_mfma_f32_16x16x32_bf16 v[188:191], v[220:223], v[228:231], v[188:191]
    ds_read_b128 v[228:231], v242 offset:9216
    ds_read_b64_tr_b16 v[206:207], v253 offset:1024
    v_mfma_f32_16x16x32_bf16 v[96:99], v[208:211], v[232:235], v[96:99]
    buffer_store_dwordx4 v[40:43], v240, s[40:43], s78 offen offset:0 sc1
    v_mfma_f32_16x16x32_bf16 v[100:103], v[212:215], v[232:235], v[100:103]
    v_mfma_f32_16x16x32_bf16 v[112:115], v[216:219], v[232:235], v[112:115]
    v_mfma_f32_16x16x32_bf16 v[116:119], v[220:223], v[232:235], v[116:119]
    ds_read_b128 v[232:235], v242 offset:0
    v_mfma_f32_16x16x32_bf16 v[104:107], v[208:211], v[236:239], v[104:107]
    v_mfma_f32_16x16x32_bf16 v[108:111], v[212:215], v[236:239], v[108:111]
    v_mfma_f32_16x16x32_bf16 v[120:123], v[216:219], v[236:239], v[120:123]
    v_mfma_f32_16x16x32_bf16 v[124:127], v[220:223], v[236:239], v[124:127]
    ds_read_b128 v[236:239], v242 offset:1024
    s_waitcnt lgkmcnt(2)
    v_mfma_f32_16x16x32_bf16 v[128:131], v[192:195], v[224:227], v[128:131]
    ds_read_b64_tr_b16 v[208:209], v245 offset:0
    v_mfma_f32_16x16x32_bf16 v[132:135], v[196:199], v[224:227], v[132:135]
    ds_read_b64_tr_b16 v[210:211], v245 offset:1024
    v_mfma_f32_16x16x32_bf16 v[144:147], v[200:203], v[224:227], v[144:147]
    ds_read_b64_tr_b16 v[212:213], v246 offset:0
    v_mfma_f32_16x16x32_bf16 v[148:151], v[204:207], v[224:227], v[148:151]
    ds_read_b64_tr_b16 v[214:215], v246 offset:1024
    v_mfma_f32_16x16x32_bf16 v[136:139], v[192:195], v[228:231], v[136:139]
    ds_read_b64_tr_b16 v[216:217], v247 offset:0
    v_mfma_f32_16x16x32_bf16 v[140:143], v[196:199], v[228:231], v[140:143]
    ds_read_b64_tr_b16 v[218:219], v247 offset:1024
    v_mfma_f32_16x16x32_bf16 v[152:155], v[200:203], v[228:231], v[152:155]
    ds_read_b64_tr_b16 v[220:221], v248 offset:0
    v_mfma_f32_16x16x32_bf16 v[156:159], v[204:207], v[228:231], v[156:159]
    ds_read_b64_tr_b16 v[222:223], v248 offset:1024
    s_waitcnt lgkmcnt(9)
    v_mfma_f32_16x16x32_bf16 v[64:67], v[192:195], v[232:235], v[64:67]
    v_mfma_f32_16x16x32_bf16 v[68:71], v[196:199], v[232:235], v[68:71]
    v_mfma_f32_16x16x32_bf16 v[80:83], v[200:203], v[232:235], v[80:83]
    v_mfma_f32_16x16x32_bf16 v[84:87], v[204:207], v[232:235], v[84:87]
    s_waitcnt lgkmcnt(8)
    v_mfma_f32_16x16x32_bf16 v[72:75], v[192:195], v[236:239], v[72:75]
    v_mfma_f32_16x16x32_bf16 v[76:79], v[196:199], v[236:239], v[76:79]
    v_mfma_f32_16x16x32_bf16 v[88:91], v[200:203], v[236:239], v[88:91]
    v_mfma_f32_16x16x32_bf16 v[92:95], v[204:207], v[236:239], v[92:95]
    s_waitcnt lgkmcnt(0)
    s_barrier
    v_mfma_f32_16x16x32_bf16 v[160:163], v[208:211], v[224:227], v[160:163]
    ds_read_b64_tr_b16 v[192:193], v250 offset:32768
    s_add_u32 s78, s31, 133120
    v_mfma_f32_16x16x32_bf16 v[164:167], v[212:215], v[224:227], v[164:167]
    ds_read_b64_tr_b16 v[194:195], v250 offset:33792
    v_mfma_f32_16x16x32_bf16 v[176:179], v[216:219], v[224:227], v[176:179]
    ds_read_b64_tr_b16 v[196:197], v251 offset:32768
    v_mfma_f32_16x16x32_bf16 v[180:183], v[220:223], v[224:227], v[180:183]
    ds_read_b128 v[224:227], v242 offset:40960
    ds_read_b64_tr_b16 v[198:199], v251 offset:33792
    v_mfma_f32_16x16x32_bf16 v[168:171], v[208:211], v[228:231], v[168:171]
    ds_read_b64_tr_b16 v[200:201], v252 offset:32768
    v_mfma_f32_16x16x32_bf16 v[172:175], v[212:215], v[228:231], v[172:175]
    ds_read_b64_tr_b16 v[202:203], v252 offset:33792
    v_mfma_f32_16x16x32_bf16 v[184:187], v[216:219], v[228:231], v[184:187]
    ds_read_b64_tr_b16 v[204:205], v253 offset:32768
    v_mfma_f32_16x16x32_bf16 v[188:191], v[220:223], v[228:231], v[188:191]
    ds_read_b128 v[228:231], v242 offset:41984
    ds_read_b64_tr_b16 v[206:207], v253 offset:33792
    v_mfma_f32_16x16x32_bf16 v[96:99], v[208:211], v[232:235], v[96:99]
    buffer_store_dwordx4 v[44:47], v240, s[40:43], s78 offen offset:1024 sc1
    v_mfma_f32_16x16x32_bf16 v[100:103], v[212:215], v[232:235], v[100:103]
    v_mfma_f32_16x16x32_bf16 v[112:115], v[216:219], v[232:235], v[112:115]
    v_mfma_f32_16x16x32_bf16 v[116:119], v[220:223], v[232:235], v[116:119]
    ds_read_b128 v[232:235], v242 offset:32768
    v_mfma_f32_16x16x32_bf16 v[104:107], v[208:211], v[236:239], v[104:107]
    v_mfma_f32_16x16x32_bf16 v[108:111], v[212:215], v[236:239], v[108:111]
    v_mfma_f32_16x16x32_bf16 v[120:123], v[216:219], v[236:239], v[120:123]
    v_mfma_f32_16x16x32_bf16 v[124:127], v[220:223], v[236:239], v[124:127]
    ds_read_b128 v[236:239], v242 offset:33792
    s_waitcnt lgkmcnt(2)
    v_mfma_f32_16x16x32_bf16 v[128:131], v[192:195], v[224:227], v[128:131]
    ds_read_b64_tr_b16 v[208:209], v245 offset:32768
    ds_read_b64_tr_b16 v[210:211], v245 offset:33792
    v_mfma_f32_16x16x32_bf16 v[132:135], v[196:199], v[224:227], v[132:135]
    ds_read_b64_tr_b16 v[212:213], v246 offset:32768
    ds_read_b64_tr_b16 v[214:215], v246 offset:33792
    v_mfma_f32_16x16x32_bf16 v[144:147], v[200:203], v[224:227], v[144:147]
    ds_read_b64_tr_b16 v[216:217], v247 offset:32768
    ds_read_b64_tr_b16 v[218:219], v247 offset:33792
    v_mfma_f32_16x16x32_bf16 v[148:151], v[204:207], v[224:227], v[148:151]
    ds_read_b64_tr_b16 v[220:221], v248 offset:32768
    ds_read_b64_tr_b16 v[222:223], v248 offset:33792
    v_mfma_f32_16x16x32_bf16 v[136:139], v[192:195], v[228:231], v[136:139]
    v_add_u32 v250, 0x10000, v250
    v_add_u32 v251, 0x10000, v251
    v_mfma_f32_16x16x32_bf16 v[140:143], v[196:199], v[228:231], v[140:143]
    v_add_u32 v252, 0x10000, v252
    v_add_u32 v253, 0x10000, v253
    v_mfma_f32_16x16x32_bf16 v[152:155], v[200:203], v[228:231], v[152:155]
    v_add_u32 v245, 0x10000, v245
    v_add_u32 v246, 0x10000, v246
    v_mfma_f32_16x16x32_bf16 v[156:159], v[204:207], v[228:231], v[156:159]
    v_add_u32 v247, 0x10000, v247
    v_add_u32 v248, 0x10000, v248
    s_waitcnt lgkmcnt(9)
    v_mfma_f32_16x16x32_bf16 v[64:67], v[192:195], v[232:235], v[64:67]
    v_add_u32 v242, 0x10000, v242
    v_mfma_f32_16x16x32_bf16 v[68:71], v[196:199], v[232:235], v[68:71]
    v_mfma_f32_16x16x32_bf16 v[80:83], v[200:203], v[232:235], v[80:83]
    v_mfma_f32_16x16x32_bf16 v[84:87], v[204:207], v[232:235], v[84:87]
    s_waitcnt lgkmcnt(8)
    v_mfma_f32_16x16x32_bf16 v[72:75], v[192:195], v[236:239], v[72:75]
    v_mfma_f32_16x16x32_bf16 v[76:79], v[196:199], v[236:239], v[76:79]
    v_mfma_f32_16x16x32_bf16 v[88:91], v[200:203], v[236:239], v[88:91]
    v_mfma_f32_16x16x32_bf16 v[92:95], v[204:207], v[236:239], v[92:95]
    s_waitcnt lgkmcnt(0)
    s_barrier
    v_mfma_f32_16x16x32_bf16 v[160:163], v[208:211], v[224:227], v[160:163]
    ds_read_b64_tr_b16 v[192:193], v250 offset:0
    s_add_u32 s78, s31, 196608
    v_mfma_f32_16x16x32_bf16 v[164:167], v[212:215], v[224:227], v[164:167]
    ds_read_b64_tr_b16 v[194:195], v250 offset:1024
    v_mfma_f32_16x16x32_bf16 v[176:179], v[216:219], v[224:227], v[176:179]
    ds_read_b64_tr_b16 v[196:197], v251 offset:0
    v_mfma_f32_16x16x32_bf16 v[180:183], v[220:223], v[224:227], v[180:183]
    ds_read_b128 v[224:227], v242 offset:8192
    ds_read_b64_tr_b16 v[198:199], v251 offset:1024
    v_mfma_f32_16x16x32_bf16 v[168:171], v[208:211], v[228:231], v[168:171]
    ds_read_b64_tr_b16 v[200:201], v252 offset:0
    v_mfma_f32_16x16x32_bf16 v[172:175], v[212:215], v[228:231], v[172:175]
    ds_read_b64_tr_b16 v[202:203], v252 offset:1024
    v_mfma_f32_16x16x32_bf16 v[184:187], v[216:219], v[228:231], v[184:187]
    ds_read_b64_tr_b16 v[204:205], v253 offset:0
    v_mfma_f32_16x16x32_bf16 v[188:191], v[220:223], v[228:231], v[188:191]
    ds_read_b128 v[228:231], v242 offset:9216
    ds_read_b64_tr_b16 v[206:207], v253 offset:1024
    v_mfma_f32_16x16x32_bf16 v[96:99], v[208:211], v[232:235], v[96:99]
    buffer_store_dwordx4 v[48:51], v240, s[40:43], s78 offen offset:0 sc1
    v_mfma_f32_16x16x32_bf16 v[100:103], v[212:215], v[232:235], v[100:103]
    v_mfma_f32_16x16x32_bf16 v[112:115], v[216:219], v[232:235], v[112:115]
    v_mfma_f32_16x16x32_bf16 v[116:119], v[220:223], v[232:235], v[116:119]
    ds_read_b128 v[232:235], v242 offset:0
    v_mfma_f32_16x16x32_bf16 v[104:107], v[208:211], v[236:239], v[104:107]
    v_mfma_f32_16x16x32_bf16 v[108:111], v[212:215], v[236:239], v[108:111]
    v_mfma_f32_16x16x32_bf16 v[120:123], v[216:219], v[236:239], v[120:123]
    v_mfma_f32_16x16x32_bf16 v[124:127], v[220:223], v[236:239], v[124:127]
    ds_read_b128 v[236:239], v242 offset:1024
    s_waitcnt lgkmcnt(2)
    v_mfma_f32_16x16x32_bf16 v[128:131], v[192:195], v[224:227], v[128:131]
    ds_read_b64_tr_b16 v[208:209], v245 offset:0
    v_mfma_f32_16x16x32_bf16 v[132:135], v[196:199], v[224:227], v[132:135]
    ds_read_b64_tr_b16 v[210:211], v245 offset:1024
    v_mfma_f32_16x16x32_bf16 v[144:147], v[200:203], v[224:227], v[144:147]
    ds_read_b64_tr_b16 v[212:213], v246 offset:0
    v_mfma_f32_16x16x32_bf16 v[148:151], v[204:207], v[224:227], v[148:151]
    ds_read_b64_tr_b16 v[214:215], v246 offset:1024
    v_mfma_f32_16x16x32_bf16 v[136:139], v[192:195], v[228:231], v[136:139]
    ds_read_b64_tr_b16 v[216:217], v247 offset:0
    v_mfma_f32_16x16x32_bf16 v[140:143], v[196:199], v[228:231], v[140:143]
    ds_read_b64_tr_b16 v[218:219], v247 offset:1024
    v_mfma_f32_16x16x32_bf16 v[152:155], v[200:203], v[228:231], v[152:155]
    ds_read_b64_tr_b16 v[220:221], v248 offset:0
    v_mfma_f32_16x16x32_bf16 v[156:159], v[204:207], v[228:231], v[156:159]
    ds_read_b64_tr_b16 v[222:223], v248 offset:1024
    s_waitcnt lgkmcnt(9)
    v_mfma_f32_16x16x32_bf16 v[64:67], v[192:195], v[232:235], v[64:67]
    v_mfma_f32_16x16x32_bf16 v[68:71], v[196:199], v[232:235], v[68:71]
    v_mfma_f32_16x16x32_bf16 v[80:83], v[200:203], v[232:235], v[80:83]
    v_mfma_f32_16x16x32_bf16 v[84:87], v[204:207], v[232:235], v[84:87]
    s_waitcnt lgkmcnt(8)
    v_mfma_f32_16x16x32_bf16 v[72:75], v[192:195], v[236:239], v[72:75]
    v_mfma_f32_16x16x32_bf16 v[76:79], v[196:199], v[236:239], v[76:79]
    v_mfma_f32_16x16x32_bf16 v[88:91], v[200:203], v[236:239], v[88:91]
    v_mfma_f32_16x16x32_bf16 v[92:95], v[204:207], v[236:239], v[92:95]
    s_waitcnt lgkmcnt(0)
    s_barrier
    v_mfma_f32_16x16x32_bf16 v[160:163], v[208:211], v[224:227], v[160:163]
    ds_read_b64_tr_b16 v[192:193], v250 offset:32768
    s_add_u32 s78, s31, 196608
    v_mfma_f32_16x16x32_bf16 v[164:167], v[212:215], v[224:227], v[164:167]
    ds_read_b64_tr_b16 v[194:195], v250 offset:33792
    v_mfma_f32_16x16x32_bf16 v[176:179], v[216:219], v[224:227], v[176:179]
    ds_read_b64_tr_b16 v[196:197], v251 offset:32768
    v_mfma_f32_16x16x32_bf16 v[180:183], v[220:223], v[224:227], v[180:183]
    ds_read_b128 v[224:227], v242 offset:40960
    ds_read_b64_tr_b16 v[198:199], v251 offset:33792
    v_mfma_f32_16x16x32_bf16 v[168:171], v[208:211], v[228:231], v[168:171]
    ds_read_b64_tr_b16 v[200:201], v252 offset:32768
    v_mfma_f32_16x16x32_bf16 v[172:175], v[212:215], v[228:231], v[172:175]
    ds_read_b64_tr_b16 v[202:203], v252 offset:33792
    v_mfma_f32_16x16x32_bf16 v[184:187], v[216:219], v[228:231], v[184:187]
    ds_read_b64_tr_b16 v[204:205], v253 offset:32768
    v_mfma_f32_16x16x32_bf16 v[188:191], v[220:223], v[228:231], v[188:191]
    ds_read_b128 v[228:231], v242 offset:41984
    ds_read_b64_tr_b16 v[206:207], v253 offset:33792
    v_mfma_f32_16x16x32_bf16 v[96:99], v[208:211], v[232:235], v[96:99]
    buffer_store_dwordx4 v[52:55], v240, s[40:43], s78 offen offset:1024 sc1
    v_mfma_f32_16x16x32_bf16 v[100:103], v[212:215], v[232:235], v[100:103]
    v_mfma_f32_16x16x32_bf16 v[112:115], v[216:219], v[232:235], v[112:115]
    v_mfma_f32_16x16x32_bf16 v[116:119], v[220:223], v[232:235], v[116:119]
    ds_read_b128 v[232:235], v242 offset:32768
    v_mfma_f32_16x16x32_bf16 v[104:107], v[208:211], v[236:239], v[104:107]
    v_mfma_f32_16x16x32_bf16 v[108:111], v[212:215], v[236:239], v[108:111]
    v_mfma_f32_16x16x32_bf16 v[120:123], v[216:219], v[236:239], v[120:123]
    v_mfma_f32_16x16x32_bf16 v[124:127], v[220:223], v[236:239], v[124:127]
    ds_read_b128 v[236:239], v242 offset:33792
    s_waitcnt lgkmcnt(2)
    v_mfma_f32_16x16x32_bf16 v[128:131], v[192:195], v[224:227], v[128:131]
    ds_read_b64_tr_b16 v[208:209], v245 offset:32768
    ds_read_b64_tr_b16 v[210:211], v245 offset:33792
    v_mfma_f32_16x16x32_bf16 v[132:135], v[196:199], v[224:227], v[132:135]
    ds_read_b64_tr_b16 v[212:213], v246 offset:32768
    ds_read_b64_tr_b16 v[214:215], v246 offset:33792
    v_mfma_f32_16x16x32_bf16 v[144:147], v[200:203], v[224:227], v[144:147]
    ds_read_b64_tr_b16 v[216:217], v247 offset:32768
    ds_read_b64_tr_b16 v[218:219], v247 offset:33792
    v_mfma_f32_16x16x32_bf16 v[148:151], v[204:207], v[224:227], v[148:151]
    ds_read_b64_tr_b16 v[220:221], v248 offset:32768
    ds_read_b64_tr_b16 v[222:223], v248 offset:33792
    v_mfma_f32_16x16x32_bf16 v[136:139], v[192:195], v[228:231], v[136:139]
    v_add_u32 v250, 0x10000, v250
    v_add_u32 v251, 0x10000, v251
    v_mfma_f32_16x16x32_bf16 v[140:143], v[196:199], v[228:231], v[140:143]
    v_add_u32 v252, 0x10000, v252
    v_add_u32 v253, 0x10000, v253
    v_mfma_f32_16x16x32_bf16 v[152:155], v[200:203], v[228:231], v[152:155]
    v_add_u32 v245, 0x10000, v245
    v_add_u32 v246, 0x10000, v246
    v_mfma_f32_16x16x32_bf16 v[156:159], v[204:207], v[228:231], v[156:159]
    v_add_u32 v247, 0x10000, v247
    v_add_u32 v248, 0x10000, v248
    s_waitcnt lgkmcnt(9)
    v_mfma_f32_16x16x32_bf16 v[64:67], v[192:195], v[232:235], v[64:67]
    v_add_u32 v242, 0x10000, v242
    v_mfma_f32_16x16x32_bf16 v[68:71], v[196:199], v[232:235], v[68:71]
    v_mfma_f32_16x16x32_bf16 v[80:83], v[200:203], v[232:235], v[80:83]
    v_mfma_f32_16x16x32_bf16 v[84:87], v[204:207], v[232:235], v[84:87]
    s_waitcnt lgkmcnt(8)
    v_mfma_f32_16x16x32_bf16 v[72:75], v[192:195], v[236:239], v[72:75]
    v_mfma_f32_16x16x32_bf16 v[76:79], v[196:199], v[236:239], v[76:79]
    v_mfma_f32_16x16x32_bf16 v[88:91], v[200:203], v[236:239], v[88:91]
    v_mfma_f32_16x16x32_bf16 v[92:95], v[204:207], v[236:239], v[92:95]
    s_waitcnt vmcnt(2) lgkmcnt(0)
    s_barrier
    v_mfma_f32_16x16x32_bf16 v[160:163], v[208:211], v[224:227], v[160:163]
    ds_read_b64_tr_b16 v[192:193], v250 offset:0
    s_add_u32 s78, s31, 198656
    v_mfma_f32_16x16x32_bf16 v[164:167], v[212:215], v[224:227], v[164:167]
    ds_read_b64_tr_b16 v[194:195], v250 offset:1024
    v_mfma_f32_16x16x32_bf16 v[176:179], v[216:219], v[224:227], v[176:179]
    ds_read_b64_tr_b16 v[196:197], v251 offset:0
    v_mfma_f32_16x16x32_bf16 v[180:183], v[220:223], v[224:227], v[180:183]
    ds_read_b128 v[224:227], v242 offset:8192
    ds_read_b64_tr_b16 v[198:199], v251 offset:1024
    v_mfma_f32_16x16x32_bf16 v[168:171], v[208:211], v[228:231], v[168:171]
    ds_read_b64_tr_b16 v[200:201], v252 offset:0
    v_mfma_f32_16x16x32_bf16 v[172:175], v[212:215], v[228:231], v[172:175]
    ds_read_b64_tr_b16 v[202:203], v252 offset:1024
    v_mfma_f32_16x16x32_bf16 v[184:187], v[216:219], v[228:231], v[184:187]
    ds_read_b64_tr_b16 v[204:205], v253 offset:0
    v_mfma_f32_16x16x32_bf16 v[188:191], v[220:223], v[228:231], v[188:191]
    ds_read_b128 v[228:231], v242 offset:9216
    ds_read_b64_tr_b16 v[206:207], v253 offset:1024
    v_mfma_f32_16x16x32_bf16 v[96:99], v[208:211], v[232:235], v[96:99]
    buffer_store_dwordx4 v[56:59], v240, s[40:43], s78 offen offset:0 sc1
    v_mfma_f32_16x16x32_bf16 v[100:103], v[212:215], v[232:235], v[100:103]
    v_mfma_f32_16x16x32_bf16 v[112:115], v[216:219], v[232:235], v[112:115]
    v_mfma_f32_16x16x32_bf16 v[116:119], v[220:223], v[232:235], v[116:119]
    ds_read_b128 v[232:235], v242 offset:0
    v_mfma_f32_16x16x32_bf16 v[104:107], v[208:211], v[236:239], v[104:107]
    v_mfma_f32_16x16x32_bf16 v[108:111], v[212:215], v[236:239], v[108:111]
    v_mfma_f32_16x16x32_bf16 v[120:123], v[216:219], v[236:239], v[120:123]
    v_mfma_f32_16x16x32_bf16 v[124:127], v[220:223], v[236:239], v[124:127]
    ds_read_b128 v[236:239], v242 offset:1024
    s_waitcnt lgkmcnt(2)
    v_mfma_f32_16x16x32_bf16 v[128:131], v[192:195], v[224:227], v[128:131]
    ds_read_b64_tr_b16 v[208:209], v245 offset:0
    ds_read_b64_tr_b16 v[210:211], v245 offset:1024
    v_mfma_f32_16x16x32_bf16 v[132:135], v[196:199], v[224:227], v[132:135]
    ds_read_b64_tr_b16 v[212:213], v246 offset:0
    ds_read_b64_tr_b16 v[214:215], v246 offset:1024
    v_mfma_f32_16x16x32_bf16 v[144:147], v[200:203], v[224:227], v[144:147]
    ds_read_b64_tr_b16 v[216:217], v247 offset:0
    ds_read_b64_tr_b16 v[218:219], v247 offset:1024
    v_mfma_f32_16x16x32_bf16 v[148:151], v[204:207], v[224:227], v[148:151]
    ds_read_b64_tr_b16 v[220:221], v248 offset:0
    ds_read_b64_tr_b16 v[222:223], v248 offset:1024
    v_mfma_f32_16x16x32_bf16 v[136:139], v[192:195], v[228:231], v[136:139]
    v_add_u32 v250, 0xfffe0000, v250
    v_add_u32 v251, 0xfffe0000, v251
    v_mfma_f32_16x16x32_bf16 v[140:143], v[196:199], v[228:231], v[140:143]
    v_add_u32 v252, 0xfffe0000, v252
    v_add_u32 v253, 0xfffe0000, v253
    v_mfma_f32_16x16x32_bf16 v[152:155], v[200:203], v[228:231], v[152:155]
    v_add_u32 v245, 0xfffe0000, v245
    v_add_u32 v246, 0xfffe0000, v246
    v_mfma_f32_16x16x32_bf16 v[156:159], v[204:207], v[228:231], v[156:159]
    v_add_u32 v247, 0xfffe0000, v247
    v_add_u32 v248, 0xfffe0000, v248
    s_waitcnt lgkmcnt(9)
    v_mfma_f32_16x16x32_bf16 v[64:67], v[192:195], v[232:235], v[64:67]
    v_add_u32 v242, 0xfffe0000, v242
    v_mfma_f32_16x16x32_bf16 v[68:71], v[196:199], v[232:235], v[68:71]
    v_mfma_f32_16x16x32_bf16 v[80:83], v[200:203], v[232:235], v[80:83]
    v_mfma_f32_16x16x32_bf16 v[84:87], v[204:207], v[232:235], v[84:87]
    s_waitcnt lgkmcnt(8)
    v_mfma_f32_16x16x32_bf16 v[72:75], v[192:195], v[236:239], v[72:75]
    v_mfma_f32_16x16x32_bf16 v[76:79], v[196:199], v[236:239], v[76:79]
    v_mfma_f32_16x16x32_bf16 v[88:91], v[200:203], v[236:239], v[88:91]
    v_mfma_f32_16x16x32_bf16 v[92:95], v[204:207], v[236:239], v[92:95]
    s_waitcnt lgkmcnt(0)
    s_barrier
    v_mfma_f32_16x16x32_bf16 v[160:163], v[208:211], v[224:227], v[160:163]
    ds_read_b64_tr_b16 v[192:193], v250 offset:0
    s_add_u32 s78, s31, 198656
    v_mfma_f32_16x16x32_bf16 v[164:167], v[212:215], v[224:227], v[164:167]
    ds_read_b64_tr_b16 v[194:195], v250 offset:1024
    v_mfma_f32_16x16x32_bf16 v[176:179], v[216:219], v[224:227], v[176:179]
    ds_read_b64_tr_b16 v[196:197], v251 offset:0
    v_mfma_f32_16x16x32_bf16 v[180:183], v[220:223], v[224:227], v[180:183]
    ds_read_b128 v[224:227], v242 offset:8192
    ds_read_b64_tr_b16 v[198:199], v251 offset:1024
    v_mfma_f32_16x16x32_bf16 v[168:171], v[208:211], v[228:231], v[168:171]
    ds_read_b64_tr_b16 v[200:201], v252 offset:0
    v_mfma_f32_16x16x32_bf16 v[172:175], v[212:215], v[228:231], v[172:175]
    ds_read_b64_tr_b16 v[202:203], v252 offset:1024
    v_mfma_f32_16x16x32_bf16 v[184:187], v[216:219], v[228:231], v[184:187]
    ds_read_b64_tr_b16 v[204:205], v253 offset:0
    v_mfma_f32_16x16x32_bf16 v[188:191], v[220:223], v[228:231], v[188:191]
    ds_read_b128 v[228:231], v242 offset:9216
    ds_read_b64_tr_b16 v[206:207], v253 offset:1024
    v_mfma_f32_16x16x32_bf16 v[96:99], v[208:211], v[232:235], v[96:99]
    buffer_store_dwordx4 v[60:63], v240, s[40:43], s78 offen offset:1024 sc1
    v_mfma_f32_16x16x32_bf16 v[100:103], v[212:215], v[232:235], v[100:103]
    v_mfma_f32_16x16x32_bf16 v[112:115], v[216:219], v[232:235], v[112:115]
    v_mfma_f32_16x16x32_bf16 v[116:119], v[220:223], v[232:235], v[116:119]
    ds_read_b128 v[232:235], v242 offset:0
    v_mfma_f32_16x16x32_bf16 v[104:107], v[208:211], v[236:239], v[104:107]
    v_mfma_f32_16x16x32_bf16 v[108:111], v[212:215], v[236:239], v[108:111]
    v_mfma_f32_16x16x32_bf16 v[120:123], v[216:219], v[236:239], v[120:123]
    v_mfma_f32_16x16x32_bf16 v[124:127], v[220:223], v[236:239], v[124:127]
    ds_read_b128 v[236:239], v242 offset:1024
    s_waitcnt lgkmcnt(2)
    v_mfma_f32_16x16x32_bf16 v[128:131], v[192:195], v[224:227], v[128:131]
    ds_read_b64_tr_b16 v[208:209], v245 offset:0
    v_mfma_f32_16x16x32_bf16 v[132:135], v[196:199], v[224:227], v[132:135]
    ds_read_b64_tr_b16 v[210:211], v245 offset:1024
    v_mfma_f32_16x16x32_bf16 v[144:147], v[200:203], v[224:227], v[144:147]
    ds_read_b64_tr_b16 v[212:213], v246 offset:0
    v_mfma_f32_16x16x32_bf16 v[148:151], v[204:207], v[224:227], v[148:151]
    ds_read_b64_tr_b16 v[214:215], v246 offset:1024
    v_mfma_f32_16x16x32_bf16 v[136:139], v[192:195], v[228:231], v[136:139]
    ds_read_b64_tr_b16 v[216:217], v247 offset:0
    v_mfma_f32_16x16x32_bf16 v[140:143], v[196:199], v[228:231], v[140:143]
    ds_read_b64_tr_b16 v[218:219], v247 offset:1024
    v_mfma_f32_16x16x32_bf16 v[152:155], v[200:203], v[228:231], v[152:155]
    ds_read_b64_tr_b16 v[220:221], v248 offset:0
    v_mfma_f32_16x16x32_bf16 v[156:159], v[204:207], v[228:231], v[156:159]
    ds_read_b64_tr_b16 v[222:223], v248 offset:1024
    s_waitcnt lgkmcnt(9)
    v_mfma_f32_16x16x32_bf16 v[64:67], v[192:195], v[232:235], v[64:67]
    v_mfma_f32_16x16x32_bf16 v[68:71], v[196:199], v[232:235], v[68:71]
    v_mfma_f32_16x16x32_bf16 v[80:83], v[200:203], v[232:235], v[80:83]
    v_mfma_f32_16x16x32_bf16 v[84:87], v[204:207], v[232:235], v[84:87]
    s_waitcnt lgkmcnt(8)
    v_mfma_f32_16x16x32_bf16 v[72:75], v[192:195], v[236:239], v[72:75]
    v_mfma_f32_16x16x32_bf16 v[76:79], v[196:199], v[236:239], v[76:79]
    v_mfma_f32_16x16x32_bf16 v[88:91], v[200:203], v[236:239], v[88:91]
    v_mfma_f32_16x16x32_bf16 v[92:95], v[204:207], v[236:239], v[92:95]
    s_waitcnt lgkmcnt(0)
    s_barrier
    v_mfma_f32_16x16x32_bf16 v[160:163], v[208:211], v[224:227], v[160:163]
    ds_read_b64_tr_b16 v[192:193], v250 offset:32768
    v_mfma_f32_16x16x32_bf16 v[164:167], v[212:215], v[224:227], v[164:167]
    ds_read_b64_tr_b16 v[194:195], v250 offset:33792
    v_mfma_f32_16x16x32_bf16 v[176:179], v[216:219], v[224:227], v[176:179]
    ds_read_b64_tr_b16 v[196:197], v251 offset:32768
    v_mfma_f32_16x16x32_bf16 v[180:183], v[220:223], v[224:227], v[180:183]
    ds_read_b128 v[224:227], v242 offset:40960
    ds_read_b64_tr_b16 v[198:199], v251 offset:33792
    v_mfma_f32_16x16x32_bf16 v[168:171], v[208:211], v[228:231], v[168:171]
    ds_read_b64_tr_b16 v[200:201], v252 offset:32768
    v_mfma_f32_16x16x32_bf16 v[172:175], v[212:215], v[228:231], v[172:175]
    ds_read_b64_tr_b16 v[202:203], v252 offset:33792
    v_mfma_f32_16x16x32_bf16 v[184:187], v[216:219], v[228:231], v[184:187]
    ds_read_b64_tr_b16 v[204:205], v253 offset:32768
    v_mfma_f32_16x16x32_bf16 v[188:191], v[220:223], v[228:231], v[188:191]
    ds_read_b128 v[228:231], v242 offset:41984
    ds_read_b64_tr_b16 v[206:207], v253 offset:33792
    v_mfma_f32_16x16x32_bf16 v[96:99], v[208:211], v[232:235], v[96:99]
    v_mfma_f32_16x16x32_bf16 v[100:103], v[212:215], v[232:235], v[100:103]
    v_mfma_f32_16x16x32_bf16 v[112:115], v[216:219], v[232:235], v[112:115]
    v_mfma_f32_16x16x32_bf16 v[116:119], v[220:223], v[232:235], v[116:119]
    ds_read_b128 v[232:235], v242 offset:32768
    v_mfma_f32_16x16x32_bf16 v[104:107], v[208:211], v[236:239], v[104:107]
    v_mfma_f32_16x16x32_bf16 v[108:111], v[212:215], v[236:239], v[108:111]
    v_mfma_f32_16x16x32_bf16 v[120:123], v[216:219], v[236:239], v[120:123]
    v_mfma_f32_16x16x32_bf16 v[124:127], v[220:223], v[236:239], v[124:127]
    ds_read_b128 v[236:239], v242 offset:33792
    s_waitcnt lgkmcnt(2)
    v_mfma_f32_16x16x32_bf16 v[128:131], v[192:195], v[224:227], v[128:131]
    ds_read_b64_tr_b16 v[208:209], v245 offset:32768
    ds_read_b64_tr_b16 v[210:211], v245 offset:33792
    v_mfma_f32_16x16x32_bf16 v[132:135], v[196:199], v[224:227], v[132:135]
    ds_read_b64_tr_b16 v[212:213], v246 offset:32768
    ds_read_b64_tr_b16 v[214:215], v246 offset:33792
    v_mfma_f32_16x16x32_bf16 v[144:147], v[200:203], v[224:227], v[144:147]
    ds_read_b64_tr_b16 v[216:217], v247 offset:32768
    ds_read_b64_tr_b16 v[218:219], v247 offset:33792
    v_mfma_f32_16x16x32_bf16 v[148:151], v[204:207], v[224:227], v[148:151]
    ds_read_b64_tr_b16 v[220:221], v248 offset:32768
    ds_read_b64_tr_b16 v[222:223], v248 offset:33792
    v_mfma_f32_16x16x32_bf16 v[136:139], v[192:195], v[228:231], v[136:139]
    v_add_u32 v250, 0x10000, v250
    v_add_u32 v251, 0x10000, v251
    v_mfma_f32_16x16x32_bf16 v[140:143], v[196:199], v[228:231], v[140:143]
    v_add_u32 v252, 0x10000, v252
    v_add_u32 v253, 0x10000, v253
    v_mfma_f32_16x16x32_bf16 v[152:155], v[200:203], v[228:231], v[152:155]
    v_add_u32 v245, 0x10000, v245
    v_add_u32 v246, 0x10000, v246
    v_mfma_f32_16x16x32_bf16 v[156:159], v[204:207], v[228:231], v[156:159]
    v_add_u32 v247, 0x10000, v247
    v_add_u32 v248, 0x10000, v248
    s_waitcnt lgkmcnt(9)
    v_mfma_f32_16x16x32_bf16 v[64:67], v[192:195], v[232:235], v[64:67]
    v_add_u32 v242, 0x10000, v242
    v_mfma_f32_16x16x32_bf16 v[68:71], v[196:199], v[232:235], v[68:71]
    v_mfma_f32_16x16x32_bf16 v[80:83], v[200:203], v[232:235], v[80:83]
    v_mfma_f32_16x16x32_bf16 v[84:87], v[204:207], v[232:235], v[84:87]
    s_waitcnt lgkmcnt(8)
    v_mfma_f32_16x16x32_bf16 v[72:75], v[192:195], v[236:239], v[72:75]
    v_mfma_f32_16x16x32_bf16 v[76:79], v[196:199], v[236:239], v[76:79]
    v_mfma_f32_16x16x32_bf16 v[88:91], v[200:203], v[236:239], v[88:91]
    v_mfma_f32_16x16x32_bf16 v[92:95], v[204:207], v[236:239], v[92:95]
    s_waitcnt lgkmcnt(0)
    s_barrier
    v_mfma_f32_16x16x32_bf16 v[160:163], v[208:211], v[224:227], v[160:163]
    ds_read_b64_tr_b16 v[192:193], v250 offset:0
    v_mfma_f32_16x16x32_bf16 v[164:167], v[212:215], v[224:227], v[164:167]
    ds_read_b64_tr_b16 v[194:195], v250 offset:1024
    v_mfma_f32_16x16x32_bf16 v[176:179], v[216:219], v[224:227], v[176:179]
    ds_read_b64_tr_b16 v[196:197], v251 offset:0
    v_mfma_f32_16x16x32_bf16 v[180:183], v[220:223], v[224:227], v[180:183]
    ds_read_b128 v[224:227], v242 offset:8192
    ds_read_b64_tr_b16 v[198:199], v251 offset:1024
    v_mfma_f32_16x16x32_bf16 v[168:171], v[208:211], v[228:231], v[168:171]
    ds_read_b64_tr_b16 v[200:201], v252 offset:0
    v_mfma_f32_16x16x32_bf16 v[172:175], v[212:215], v[228:231], v[172:175]
    ds_read_b64_tr_b16 v[202:203], v252 offset:1024
    v_mfma_f32_16x16x32_bf16 v[184:187], v[216:219], v[228:231], v[184:187]
    ds_read_b64_tr_b16 v[204:205], v253 offset:0
    v_mfma_f32_16x16x32_bf16 v[188:191], v[220:223], v[228:231], v[188:191]
    ds_read_b128 v[228:231], v242 offset:9216
    ds_read_b64_tr_b16 v[206:207], v253 offset:1024
    v_mfma_f32_16x16x32_bf16 v[96:99], v[208:211], v[232:235], v[96:99]
    v_mfma_f32_16x16x32_bf16 v[100:103], v[212:215], v[232:235], v[100:103]
    v_mfma_f32_16x16x32_bf16 v[112:115], v[216:219], v[232:235], v[112:115]
    v_mfma_f32_16x16x32_bf16 v[116:119], v[220:223], v[232:235], v[116:119]
    ds_read_b128 v[232:235], v242 offset:0
    v_mfma_f32_16x16x32_bf16 v[104:107], v[208:211], v[236:239], v[104:107]
    v_mfma_f32_16x16x32_bf16 v[108:111], v[212:215], v[236:239], v[108:111]
    v_mfma_f32_16x16x32_bf16 v[120:123], v[216:219], v[236:239], v[120:123]
    v_mfma_f32_16x16x32_bf16 v[124:127], v[220:223], v[236:239], v[124:127]
    ds_read_b128 v[236:239], v242 offset:1024
    s_waitcnt lgkmcnt(2)
    v_mfma_f32_16x16x32_bf16 v[128:131], v[192:195], v[224:227], v[128:131]
    ds_read_b64_tr_b16 v[208:209], v245 offset:0
    v_mfma_f32_16x16x32_bf16 v[132:135], v[196:199], v[224:227], v[132:135]
    ds_read_b64_tr_b16 v[210:211], v245 offset:1024
    v_mfma_f32_16x16x32_bf16 v[144:147], v[200:203], v[224:227], v[144:147]
    ds_read_b64_tr_b16 v[212:213], v246 offset:0
    v_mfma_f32_16x16x32_bf16 v[148:151], v[204:207], v[224:227], v[148:151]
    ds_read_b64_tr_b16 v[214:215], v246 offset:1024
    v_mfma_f32_16x16x32_bf16 v[136:139], v[192:195], v[228:231], v[136:139]
    ds_read_b64_tr_b16 v[216:217], v247 offset:0
    v_mfma_f32_16x16x32_bf16 v[140:143], v[196:199], v[228:231], v[140:143]
    ds_read_b64_tr_b16 v[218:219], v247 offset:1024
    v_mfma_f32_16x16x32_bf16 v[152:155], v[200:203], v[228:231], v[152:155]
    ds_read_b64_tr_b16 v[220:221], v248 offset:0
    v_mfma_f32_16x16x32_bf16 v[156:159], v[204:207], v[228:231], v[156:159]
    ds_read_b64_tr_b16 v[222:223], v248 offset:1024
    s_waitcnt lgkmcnt(9)
    v_mfma_f32_16x16x32_bf16 v[64:67], v[192:195], v[232:235], v[64:67]
    v_mfma_f32_16x16x32_bf16 v[68:71], v[196:199], v[232:235], v[68:71]
    v_mfma_f32_16x16x32_bf16 v[80:83], v[200:203], v[232:235], v[80:83]
    v_mfma_f32_16x16x32_bf16 v[84:87], v[204:207], v[232:235], v[84:87]
    s_waitcnt lgkmcnt(8)
    v_mfma_f32_16x16x32_bf16 v[72:75], v[192:195], v[236:239], v[72:75]
    v_mfma_f32_16x16x32_bf16 v[76:79], v[196:199], v[236:239], v[76:79]
    v_mfma_f32_16x16x32_bf16 v[88:91], v[200:203], v[236:239], v[88:91]
    v_mfma_f32_16x16x32_bf16 v[92:95], v[204:207], v[236:239], v[92:95]
    s_waitcnt vmcnt(0) lgkmcnt(0)
    s_barrier
    v_mfma_f32_16x16x32_bf16 v[160:163], v[208:211], v[224:227], v[160:163]
    ds_read_b64_tr_b16 v[192:193], v250 offset:32768
    v_mfma_f32_16x16x32_bf16 v[164:167], v[212:215], v[224:227], v[164:167]
    ds_read_b64_tr_b16 v[194:195], v250 offset:33792
    v_mfma_f32_16x16x32_bf16 v[176:179], v[216:219], v[224:227], v[176:179]
    ds_read_b64_tr_b16 v[196:197], v251 offset:32768
    v_mfma_f32_16x16x32_bf16 v[180:183], v[220:223], v[224:227], v[180:183]
    ds_read_b128 v[224:227], v242 offset:40960
    ds_read_b64_tr_b16 v[198:199], v251 offset:33792
    v_mfma_f32_16x16x32_bf16 v[168:171], v[208:211], v[228:231], v[168:171]
    ds_read_b64_tr_b16 v[200:201], v252 offset:32768
    v_mfma_f32_16x16x32_bf16 v[172:175], v[212:215], v[228:231], v[172:175]
    ds_read_b64_tr_b16 v[202:203], v252 offset:33792
    v_mfma_f32_16x16x32_bf16 v[184:187], v[216:219], v[228:231], v[184:187]
    ds_read_b64_tr_b16 v[204:205], v253 offset:32768
    v_mfma_f32_16x16x32_bf16 v[188:191], v[220:223], v[228:231], v[188:191]
    ds_read_b128 v[228:231], v242 offset:41984
    ds_read_b64_tr_b16 v[206:207], v253 offset:33792
    v_mfma_f32_16x16x32_bf16 v[96:99], v[208:211], v[232:235], v[96:99]
    v_mfma_f32_16x16x32_bf16 v[100:103], v[212:215], v[232:235], v[100:103]
    v_mfma_f32_16x16x32_bf16 v[112:115], v[216:219], v[232:235], v[112:115]
    v_mfma_f32_16x16x32_bf16 v[116:119], v[220:223], v[232:235], v[116:119]
    ds_read_b128 v[232:235], v242 offset:32768
    v_mfma_f32_16x16x32_bf16 v[104:107], v[208:211], v[236:239], v[104:107]
    v_mfma_f32_16x16x32_bf16 v[108:111], v[212:215], v[236:239], v[108:111]
    v_mfma_f32_16x16x32_bf16 v[120:123], v[216:219], v[236:239], v[120:123]
    v_mfma_f32_16x16x32_bf16 v[124:127], v[220:223], v[236:239], v[124:127]
    ds_read_b128 v[236:239], v242 offset:33792
    s_waitcnt lgkmcnt(2)
    v_mfma_f32_16x16x32_bf16 v[128:131], v[192:195], v[224:227], v[128:131]
    ds_read_b64_tr_b16 v[208:209], v245 offset:32768
    v_mfma_f32_16x16x32_bf16 v[132:135], v[196:199], v[224:227], v[132:135]
    ds_read_b64_tr_b16 v[210:211], v245 offset:33792
    v_mfma_f32_16x16x32_bf16 v[144:147], v[200:203], v[224:227], v[144:147]
    ds_read_b64_tr_b16 v[212:213], v246 offset:32768
    v_mfma_f32_16x16x32_bf16 v[148:151], v[204:207], v[224:227], v[148:151]
    ds_read_b64_tr_b16 v[214:215], v246 offset:33792
    v_mfma_f32_16x16x32_bf16 v[136:139], v[192:195], v[228:231], v[136:139]
    ds_read_b64_tr_b16 v[216:217], v247 offset:32768
    v_mfma_f32_16x16x32_bf16 v[140:143], v[196:199], v[228:231], v[140:143]
    ds_read_b64_tr_b16 v[218:219], v247 offset:33792
    v_mfma_f32_16x16x32_bf16 v[152:155], v[200:203], v[228:231], v[152:155]
    ds_read_b64_tr_b16 v[220:221], v248 offset:32768
    v_mfma_f32_16x16x32_bf16 v[156:159], v[204:207], v[228:231], v[156:159]
    ds_read_b64_tr_b16 v[222:223], v248 offset:33792
    s_waitcnt lgkmcnt(9)
    v_mfma_f32_16x16x32_bf16 v[64:67], v[192:195], v[232:235], v[64:67]
    v_mfma_f32_16x16x32_bf16 v[68:71], v[196:199], v[232:235], v[68:71]
    v_mfma_f32_16x16x32_bf16 v[80:83], v[200:203], v[232:235], v[80:83]
    v_mfma_f32_16x16x32_bf16 v[84:87], v[204:207], v[232:235], v[84:87]
    s_waitcnt lgkmcnt(8)
    v_mfma_f32_16x16x32_bf16 v[72:75], v[192:195], v[236:239], v[72:75]
    v_mfma_f32_16x16x32_bf16 v[76:79], v[196:199], v[236:239], v[76:79]
    v_mfma_f32_16x16x32_bf16 v[88:91], v[200:203], v[236:239], v[88:91]
    v_mfma_f32_16x16x32_bf16 v[92:95], v[204:207], v[236:239], v[92:95]
    s_waitcnt lgkmcnt(0)
    v_mfma_f32_16x16x32_bf16 v[160:163], v[208:211], v[224:227], v[160:163]
    v_mfma_f32_16x16x32_bf16 v[164:167], v[212:215], v[224:227], v[164:167]
    v_mfma_f32_16x16x32_bf16 v[176:179], v[216:219], v[224:227], v[176:179]
    v_mfma_f32_16x16x32_bf16 v[180:183], v[220:223], v[224:227], v[180:183]
    v_mfma_f32_16x16x32_bf16 v[168:171], v[208:211], v[228:231], v[168:171]
    v_mfma_f32_16x16x32_bf16 v[172:175], v[212:215], v[228:231], v[172:175]
    v_mfma_f32_16x16x32_bf16 v[184:187], v[216:219], v[228:231], v[184:187]
    v_mfma_f32_16x16x32_bf16 v[188:191], v[220:223], v[228:231], v[188:191]
    v_mfma_f32_16x16x32_bf16 v[96:99], v[208:211], v[232:235], v[96:99]
    v_mfma_f32_16x16x32_bf16 v[100:103], v[212:215], v[232:235], v[100:103]
    v_mfma_f32_16x16x32_bf16 v[112:115], v[216:219], v[232:235], v[112:115]
    v_mfma_f32_16x16x32_bf16 v[116:119], v[220:223], v[232:235], v[116:119]
    v_mfma_f32_16x16x32_bf16 v[104:107], v[208:211], v[236:239], v[104:107]
    v_mfma_f32_16x16x32_bf16 v[108:111], v[212:215], v[236:239], v[108:111]
    v_mfma_f32_16x16x32_bf16 v[120:123], v[216:219], v[236:239], v[120:123]
    v_mfma_f32_16x16x32_bf16 v[124:127], v[220:223], v[236:239], v[124:127]
    s_setprio 2
    s_lshl_b32 s78, s76, 13
    s_add_u32 s78, s78, 131072
    v_add_u32 v238, s78, v240
    v_add_u32 v236, 0, v240
    v_cvt_pk_bf16_f32 v208, v160, v161
    v_cvt_pk_bf16_f32 v209, v162, v163
    v_cvt_pk_bf16_f32 v210, v164, v165
    v_cvt_pk_bf16_f32 v211, v166, v167
    v_cvt_pk_bf16_f32 v212, v168, v169
    v_cvt_pk_bf16_f32 v213, v170, v171
    v_cvt_pk_bf16_f32 v214, v172, v173
    v_cvt_pk_bf16_f32 v215, v174, v175
    v_cvt_pk_bf16_f32 v216, v176, v177
    v_cvt_pk_bf16_f32 v217, v178, v179
    v_cvt_pk_bf16_f32 v218, v180, v181
    v_cvt_pk_bf16_f32 v219, v182, v183
    v_cvt_pk_bf16_f32 v220, v184, v185
    v_cvt_pk_bf16_f32 v221, v186, v187
    v_cvt_pk_bf16_f32 v222, v188, v189
    v_cvt_pk_bf16_f32 v223, v190, v191
    s_barrier
    ds_read_b128 v[160:163], v236 offset:0
    ds_read_b128 v[164:167], v236 offset:1024
    ds_read_b128 v[168:171], v236 offset:2048
    ds_read_b128 v[172:175], v236 offset:3072
    ds_read_b128 v[176:179], v236 offset:4096
    ds_read_b128 v[180:183], v236 offset:5120
    ds_read_b128 v[184:187], v236 offset:6144
    ds_read_b128 v[188:191], v236 offset:7168
    v_cvt_pk_bf16_f32 v64, v64, v65
    v_cvt_pk_bf16_f32 v65, v66, v67
    v_cvt_pk_bf16_f32 v66, v68, v69
    v_cvt_pk_bf16_f32 v67, v70, v71
    v_cvt_pk_bf16_f32 v68, v72, v73
    v_cvt_pk_bf16_f32 v69, v74, v75
    v_cvt_pk_bf16_f32 v70, v76, v77
    v_cvt_pk_bf16_f32 v71, v78, v79
    v_cvt_pk_bf16_f32 v72, v80, v81
    v_cvt_pk_bf16_f32 v73, v82, v83
    v_cvt_pk_bf16_f32 v74, v84, v85
    v_cvt_pk_bf16_f32 v75, v86, v87
    v_cvt_pk_bf16_f32 v76, v88, v89
    v_cvt_pk_bf16_f32 v77, v90, v91
    v_cvt_pk_bf16_f32 v78, v92, v93
    v_cvt_pk_bf16_f32 v79, v94, v95
    v_cvt_pk_bf16_f32 v80, v96, v97
    v_cvt_pk_bf16_f32 v81, v98, v99
    v_cvt_pk_bf16_f32 v82, v100, v101
    v_cvt_pk_bf16_f32 v83, v102, v103
    v_cvt_pk_bf16_f32 v84, v104, v105
    v_cvt_pk_bf16_f32 v85, v106, v107
    v_cvt_pk_bf16_f32 v86, v108, v109
    v_cvt_pk_bf16_f32 v87, v110, v111
    v_cvt_pk_bf16_f32 v88, v112, v113
    v_cvt_pk_bf16_f32 v89, v114, v115
    v_cvt_pk_bf16_f32 v90, v116, v117
    v_cvt_pk_bf16_f32 v91, v118, v119
    v_cvt_pk_bf16_f32 v92, v120, v121
    v_cvt_pk_bf16_f32 v93, v122, v123
    v_cvt_pk_bf16_f32 v94, v124, v125
    v_cvt_pk_bf16_f32 v95, v126, v127
    s_waitcnt lgkmcnt(0)
    v_mfma_f32_16x16x32_bf16 v[96:99], v[160:163], v[64:67], 0
    v_cvt_pk_bf16_f32 v192, v128, v129
    v_cvt_pk_bf16_f32 v193, v130, v131
    v_cvt_pk_bf16_f32 v194, v132, v133
    v_mfma_f32_16x16x32_bf16 v[104:107], v[160:163], v[68:71], 0
    ds_read_b128 v[160:163], v236 offset:8192
    v_cvt_pk_bf16_f32 v195, v134, v135
    v_cvt_pk_bf16_f32 v196, v136, v137
    v_mfma_f32_16x16x32_bf16 v[100:103], v[164:167], v[64:67], 0
    v_cvt_pk_bf16_f32 v197, v138, v139
    v_cvt_pk_bf16_f32 v198, v140, v141
    v_cvt_pk_bf16_f32 v199, v142, v143
    v_mfma_f32_16x16x32_bf16 v[108:111], v[164:167], v[68:71], 0
    ds_read_b128 v[164:167], v236 offset:9216
    v_cvt_pk_bf16_f32 v200, v144, v145
    v_cvt_pk_bf16_f32 v201, v146, v147
    v_mfma_f32_16x16x32_bf16 v[96:99], v[168:171], v[72:75], v[96:99]
    v_cvt_pk_bf16_f32 v202, v148, v149
    v_cvt_pk_bf16_f32 v203, v150, v151
    v_cvt_pk_bf16_f32 v204, v152, v153
    v_mfma_f32_16x16x32_bf16 v[104:107], v[168:171], v[76:79], v[104:107]
    ds_read_b128 v[168:171], v236 offset:10240
    v_cvt_pk_bf16_f32 v205, v154, v155
    v_cvt_pk_bf16_f32 v206, v156, v157
    v_mfma_f32_16x16x32_bf16 v[100:103], v[172:175], v[72:75], v[100:103]
    v_cvt_pk_bf16_f32 v207, v158, v159
    ds_write_b128 v238, v[208:211] offset:4096
    ds_write_b128 v238, v[212:215] offset:5120
    v_mfma_f32_16x16x32_bf16 v[108:111], v[172:175], v[76:79], v[108:111]
    ds_read_b128 v[172:175], v236 offset:11264
    ds_write_b128 v238, v[216:219] offset:6144
    ds_write_b128 v238, v[220:223] offset:7168
    v_mfma_f32_16x16x32_bf16 v[96:99], v[176:179], v[80:83], v[96:99]
    ds_write_b128 v238, v[192:195] offset:0
    ds_write_b128 v238, v[196:199] offset:1024
    ds_write_b128 v238, v[200:203] offset:2048
    v_mfma_f32_16x16x32_bf16 v[104:107], v[176:179], v[84:87], v[104:107]
    ds_read_b128 v[176:179], v236 offset:12288
    ds_write_b128 v238, v[204:207] offset:3072
    v_mov_b32 v232, 0x3f803f80
    v_mfma_f32_16x16x32_bf16 v[100:103], v[180:183], v[80:83], v[100:103]
    v_mov_b32 v233, 0x3f803f80
    v_mov_b32 v234, 0x3f803f80
    v_mov_b32 v235, 0x3f803f80
    v_mfma_f32_16x16x32_bf16 v[108:111], v[180:183], v[84:87], v[108:111]
    ds_read_b128 v[180:183], v236 offset:13312
    v_mov_b32 v237, 0xff800000
    v_cmp_gt_i32_e64 s[86:87], 0, v241
    v_mfma_f32_16x16x32_bf16 v[96:99], v[184:187], v[88:91], v[96:99]
    v_cmp_gt_i32_e64 s[88:89], 1, v241
    v_cmp_gt_i32_e64 s[90:91], 2, v241
    v_cmp_gt_i32_e64 s[92:93], 3, v241
    v_mfma_f32_16x16x32_bf16 v[104:107], v[184:187], v[92:95], v[104:107]
    ds_read_b128 v[184:187], v236 offset:14336
    s_mov_b32 s99, 0x40004000
    s_mov_b32 s94, 0
    v_mfma_f32_16x16x32_bf16 v[100:103], v[188:191], v[88:91], v[100:103]
    s_mov_b32 s95, s74
    s_mov_b32 s81, 0
    s_mov_b32 s80, 32768
    v_mfma_f32_16x16x32_bf16 v[108:111], v[188:191], v[92:95], v[108:111]
    ds_read_b128 v[188:191], v236 offset:15360
    s_lshl_b32 s82, s74, 2
    s_add_u32 s82, s82, s76
    v_lshlrev_b32 v242, 13, v240
    s_lshl_b32 s12, s2, 6
    s_add_u32 s12, s12, s76
    s_lshl_b32 s12, s12, 2
    s_add_u32 s12, s12, 4096
    v_add_u32 v239, 4096, v240
    v_add_u32 v236, 32768, v240
    s_cmp_lg_u32 s74, 0
    s_cbranch_scc1 KB_NOZ
    v_mov_b32 v0, 0
    v_mov_b32 v1, 0
    v_mov_b32 v2, 0
    v_mov_b32 v3, 0
    v_mov_b32 v4, 0
    v_mov_b32 v5, 0
    v_mov_b32 v6, 0
    v_mov_b32 v7, 0
    v_mov_b32 v8, 0
    v_mov_b32 v9, 0
    v_mov_b32 v10, 0
    v_mov_b32 v11, 0
    v_mov_b32 v12, 0
    v_mov_b32 v13, 0
    v_mov_b32 v14, 0
    v_mov_b32 v15, 0
    v_mov_b32 v16, 0
    v_mov_b32 v17, 0
    v_mov_b32 v18, 0
    v_mov_b32 v19, 0
    v_mov_b32 v20, 0
    v_mov_b32 v21, 0
    v_mov_b32 v22, 0
    v_mov_b32 v23, 0
    v_mov_b32 v24, 0
    v_mov_b32 v25, 0
    v_mov_b32 v26, 0
    v_mov_b32 v27, 0
    v_mov_b32 v28, 0
    v_mov_b32 v29, 0
    v_mov_b32 v30, 0
    v_mov_b32 v31, 0
    v_mov_b32 v32, 0
    v_mov_b32 v33, 0
    v_mov_b32 v34, 0
    v_mov_b32 v35, 0
    v_mov_b32 v36, 0
    v_mov_b32 v37, 0
    v_mov_b32 v38, 0
    v_mov_b32 v39, 0
    v_mov_b32 v40, 0
    v_mov_b32 v41, 0
    v_mov_b32 v42, 0
    v_mov_b32 v43, 0
    v_mov_b32 v44, 0
    v_mov_b32 v45, 0
    v_mov_b32 v46, 0
    v_mov_b32 v47, 0
    v_mov_b32 v48, 0
    v_mov_b32 v49, 0
    v_mov_b32 v50, 0
    v_mov_b32 v51, 0
    v_mov_b32 v52, 0
    v_mov_b32 v53, 0
    v_mov_b32 v54, 0
    v_mov_b32 v55, 0
    v_mov_b32 v56, 0
    v_mov_b32 v57, 0
    v_mov_b32 v58, 0
    v_mov_b32 v59, 0
    v_mov_b32 v60, 0
    v_mov_b32 v61, 0
    v_mov_b32 v62, 0
    v_mov_b32 v63, 0
    v_mov_b32 v136, 0
    v_mov_b32 v137, 0
    v_mov_b32 v138, 0
    v_mov_b32 v139, 0
    v_mov_b32 v140, 0
    v_mov_b32 v141, 0
    v_mov_b32 v142, 0
    v_mov_b32 v143, 0
    s_cmp_lg_u32 s82, 0
    s_cbranch_scc1 KB_NOZ
    v_cndmask_b32_e64 v96, v96, v237, s[86:87]
    v_cndmask_b32_e64 v97, v97, v237, s[88:89]
    v_cndmask_b32_e64 v98, v98, v237, s[90:91]
    v_cndmask_b32_e64 v99, v99, v237, s[92:93]
    v_cndmask_b32_e64 v108, v108, v237, s[86:87]
    v_cndmask_b32_e64 v109, v109, v237, s[88:89]
    v_cndmask_b32_e64 v110, v110, v237, s[90:91]
    v_cndmask_b32_e64 v111, v111, v237, s[92:93]
    v_mov_b32 v100, v237
    v_mov_b32 v101, v237
    v_mov_b32 v102, v237
    v_mov_b32 v103, v237
KB_NOZ:
    s_nop 4
    v_max3_f32 v224, v96, v97, v98
    v_max3_f32 v224, v224, v99, v100
    v_max3_f32 v224, v224, v101, v102
    v_max_f32 v224, v224, v103
    v_max3_f32 v225, v104, v105, v106
    v_max3_f32 v225, v225, v107, v108
    v_max3_f32 v225, v225, v109, v110
    v_max_f32 v225, v225, v111
    s_nop 0
    s_nop 0
    v_permlane32_swap_b32 v224, v225
    v_max_f32 v224, v224, v225
    v_mov_b32 v225, v224
    s_nop 0
    s_nop 0
    v_permlane16_swap_b32 v224, v225
    v_max_f32 v224, v224, v225
    v_mov_b32 v225, v224
    s_nop 0
    s_nop 0
    v_permlane32_swap_b32 v224, v225
    v_sub_f32 v128, 0xc1600000, v224
    v_sub_f32 v129, 0xc1600000, v224
    v_sub_f32 v130, 0xc1600000, v224
    v_sub_f32 v131, 0xc1600000, v224
    v_sub_f32 v132, 0xc1600000, v225
    v_sub_f32 v133, 0xc1600000, v225
    v_sub_f32 v134, 0xc1600000, v225
    v_sub_f32 v135, 0xc1600000, v225
    v_add_f32 v96, v96, v128
    v_add_f32 v97, v97, v128
    v_add_f32 v98, v98, v128
    v_add_f32 v99, v99, v128
    v_add_f32 v100, v100, v128
    v_add_f32 v101, v101, v128
    v_add_f32 v102, v102, v128
    v_add_f32 v103, v103, v128
    v_add_f32 v104, v104, v132
    v_add_f32 v105, v105, v132
    v_add_f32 v106, v106, v132
    v_add_f32 v107, v107, v132
    v_add_f32 v108, v108, v132
    v_add_f32 v109, v109, v132
    v_add_f32 v110, v110, v132
    v_add_f32 v111, v111, v132
    s_waitcnt lgkmcnt(0)
KB_BLK:
    s_barrier
    s_cmp_eq_u32 s82, 0
    s_cbranch_scc1 KB_FL
    v_mfma_f32_16x16x32_bf16 v[112:115], v[160:163], v[64:67], v[128:131]
    v_exp_f32 v224, v96
    v_exp_f32 v225, v97
    v_mfma_f32_16x16x32_bf16 v[120:123], v[160:163], v[68:71], v[132:135]
    ds_read_b128 v[160:163], v236 offset:0
    v_exp_f32 v226, v98
    v_mfma_f32_16x16x32_bf16 v[116:119], v[164:167], v[64:67], v[128:131]
    v_cvt_pk_bf16_f32 v144, v224, v225
    v_exp_f32 v227, v99
    v_mfma_f32_16x16x32_bf16 v[124:127], v[164:167], v[68:71], v[132:135]
    ds_read_b128 v[164:167], v236 offset:1024
    v_exp_f32 v228, v100
    v_mfma_f32_16x16x32_bf16 v[112:115], v[168:171], v[72:75], v[112:115]
    v_cvt_pk_bf16_f32 v145, v226, v227
    v_exp_f32 v229, v101
    v_mfma_f32_16x16x32_bf16 v[120:123], v[168:171], v[76:79], v[120:123]
    ds_read_b128 v[168:171], v236 offset:2048
    v_exp_f32 v224, v102
    v_mfma_f32_16x16x32_bf16 v[116:119], v[172:175], v[72:75], v[116:119]
    v_cvt_pk_bf16_f32 v146, v228, v229
    v_exp_f32 v225, v103
    v_mfma_f32_16x16x32_bf16 v[124:127], v[172:175], v[76:79], v[124:127]
    ds_read_b128 v[172:175], v236 offset:3072
    v_exp_f32 v226, v104
    v_mfma_f32_16x16x32_bf16 v[112:115], v[176:179], v[80:83], v[112:115]
    v_cvt_pk_bf16_f32 v147, v224, v225
    v_exp_f32 v227, v105
    v_mfma_f32_16x16x32_bf16 v[120:123], v[176:179], v[84:87], v[120:123]
    ds_read_b128 v[176:179], v236 offset:4096
    v_exp_f32 v228, v106
    v_mfma_f32_16x16x32_bf16 v[116:119], v[180:183], v[80:83], v[116:119]
    v_cvt_pk_bf16_f32 v148, v226, v227
    v_exp_f32 v229, v107
    v_mfma_f32_16x16x32_bf16 v[124:127], v[180:183], v[84:87], v[124:127]
    ds_read_b128 v[180:183], v236 offset:5120
    v_exp_f32 v224, v108
    v_mfma_f32_16x16x32_bf16 v[112:115], v[184:187], v[88:91], v[112:115]
    v_cvt_pk_bf16_f32 v149, v228, v229
    v_exp_f32 v225, v109
    v_mfma_f32_16x16x32_bf16 v[120:123], v[184:187], v[92:95], v[120:123]
    ds_read_b128 v[184:187], v236 offset:6144
    v_exp_f32 v226, v110
    v_mfma_f32_16x16x32_bf16 v[116:119], v[188:191], v[88:91], v[116:119]
    v_cvt_pk_bf16_f32 v150, v224, v225
    v_exp_f32 v227, v111
    v_mfma_f32_16x16x32_bf16 v[124:127], v[188:191], v[92:95], v[124:127]
    ds_read_b128 v[188:191], v236 offset:7168
    v_cvt_pk_bf16_f32 v151, v226, v227
    ds_read_b128 v[192:195], v236 offset:16384
    ds_read_b128 v[196:199], v236 offset:17408
    ds_read_b128 v[200:203], v236 offset:18432
    ds_read_b128 v[204:207], v236 offset:19456
    ds_read_b128 v[208:211], v236 offset:20480
    ds_read_b128 v[212:215], v236 offset:21504
    ds_read_b128 v[216:219], v236 offset:22528
    ds_read_b128 v[220:223], v236 offset:23552
    s_cmp_eq_u32 s82, 1
    s_cbranch_scc1 KB_LAST1
    s_waitcnt lgkmcnt(8)
    v_mfma_f32_16x16x32_bf16 v[96:99], v[160:163], v[64:67], v[128:131]
    v_exp_f32 v224, v112
    v_mfma_f32_16x16x32_bf16 v[104:107], v[160:163], v[68:71], v[132:135]
    ds_read_b128 v[160:163], v236 offset:8192
    s_lshr_b32 s79, s82, 1
    v_mfma_f32_16x16x32_bf16 v[100:103], v[164:167], v[64:67], v[128:131]
    v_exp_f32 v225, v113
    v_mfma_f32_16x16x32_bf16 v[108:111], v[164:167], v[68:71], v[132:135]
    ds_read_b128 v[164:167], v236 offset:9216
    v_cvt_pk_bf16_f32 v152, v224, v225
    v_mfma_f32_16x16x32_bf16 v[96:99], v[168:171], v[72:75], v[96:99]
    v_exp_f32 v226, v114
    v_mfma_f32_16x16x32_bf16 v[104:107], v[168:171], v[76:79], v[104:107]
    ds_read_b128 v[168:171], v236 offset:10240
    s_add_u32 s80, s80, 32768
    v_mfma_f32_16x16x32_bf16 v[100:103], v[172:175], v[72:75], v[100:103]
    v_exp_f32 v227, v115
    v_mfma_f32_16x16x32_bf16 v[108:111], v[172:175], v[76:79], v[108:111]
    ds_read_b128 v[172:175], v236 offset:11264
    v_cvt_pk_bf16_f32 v153, v226, v227
    v_mfma_f32_16x16x32_bf16 v[96:99], v[176:179], v[80:83], v[96:99]
    v_exp_f32 v228, v116
    v_mfma_f32_16x16x32_bf16 v[104:107], v[176:179], v[84:87], v[104:107]
    ds_read_b128 v[176:179], v236 offset:12288
    s_and_b32 s80, s80, 131071
    v_mfma_f32_16x16x32_bf16 v[100:103], v[180:183], v[80:83], v[100:103]
    v_exp_f32 v229, v117
    v_mfma_f32_16x16x32_bf16 v[108:111], v[180:183], v[84:87], v[108:111]
    ds_read_b128 v[180:183], v236 offset:13312
    v_cvt_pk_bf16_f32 v154, v228, v229
    v_mfma_f32_16x16x32_bf16 v[96:99], v[184:187], v[88:91], v[96:99]
    v_exp_f32 v224, v118
    v_mfma_f32_16x16x32_bf16 v[104:107], v[184:187], v[92:95], v[104:107]
    ds_read_b128 v[184:187], v236 offset:14336
    v_or3_b32 v230, v152, v153, v154
    v_mfma_f32_16x16x32_bf16 v[100:103], v[188:191], v[88:91], v[100:103]
    v_exp_f32 v225, v119
    v_mfma_f32_16x16x32_bf16 v[108:111], v[188:191], v[92:95], v[108:111]
    ds_read_b128 v[188:191], v236 offset:15360
    v_cvt_pk_bf16_f32 v155, v224, v225
    v_mfma_f32_16x16x32_bf16 v[136:139], v[232:235], v[144:147], 0
    v_exp_f32 v226, v120
    v_mfma_f32_16x16x32_bf16 v[140:143], v[232:235], v[148:151], 0
    s_sub_u32 s79, s79, 2
    s_waitcnt lgkmcnt(8)
    v_mfma_f32_16x16x32_bf16 v[0:3], v[192:195], v[144:147], 0
    v_exp_f32 v227, v121
    v_mfma_f32_16x16x32_bf16 v[8:11], v[192:195], v[148:151], 0
    ds_read_b128 v[192:195], v236 offset:24576
    v_cvt_pk_bf16_f32 v156, v226, v227
    v_mfma_f32_16x16x32_bf16 v[4:7], v[196:199], v[144:147], 0
    v_exp_f32 v228, v122
    v_mfma_f32_16x16x32_bf16 v[12:15], v[196:199], v[148:151], 0
    ds_read_b128 v[196:199], v236 offset:25600
    v_or3_b32 v230, v230, v155, v156
    v_mfma_f32_16x16x32_bf16 v[16:19], v[200:203], v[144:147], 0
    v_exp_f32 v229, v123
    v_mfma_f32_16x16x32_bf16 v[24:27], v[200:203], v[148:151], 0
    ds_read_b128 v[200:203], v236 offset:26624
    v_cvt_pk_bf16_f32 v157, v228, v229
    v_mfma_f32_16x16x32_bf16 v[20:23], v[204:207], v[144:147], 0
    v_exp_f32 v224, v124
    v_mfma_f32_16x16x32_bf16 v[28:31], v[204:207], v[148:151], 0
    ds_read_b128 v[204:207], v236 offset:27648
    v_exp_f32 v225, v125
    v_mfma_f32_16x16x32_bf16 v[32:35], v[208:211], v[144:147], 0
    v_exp_f32 v226, v126
    v_mfma_f32_16x16x32_bf16 v[40:43], v[208:211], v[148:151], 0
    ds_read_b128 v[208:211], v236 offset:28672
    v_cvt_pk_bf16_f32 v158, v224, v225
    v_mfma_f32_16x16x32_bf16 v[36:39], v[212:215], v[144:147], 0
    v_exp_f32 v227, v127
    v_mfma_f32_16x16x32_bf16 v[44:47], v[212:215], v[148:151], 0
    ds_read_b128 v[212:215], v236 offset:29696
    v_or3_b32 v230, v230, v157, v158
    v_mfma_f32_16x16x32_bf16 v[48:51], v[216:219], v[144:147], 0
    v_cvt_pk_bf16_f32 v159, v226, v227
    v_bitop3_b32 v230, v230, s99, v159 bitop3:0xc8
    v_mfma_f32_16x16x32_bf16 v[56:59], v[216:219], v[148:151], 0
    ds_read_b128 v[216:219], v236 offset:30720
    v_cmp_ne_u32 vcc, 0, v230
    v_mfma_f32_16x16x32_bf16 v[52:55], v[220:223], v[144:147], 0
    v_mfma_f32_16x16x32_bf16 v[60:63], v[220:223], v[148:151], 0
    ds_read_b128 v[220:223], v236 offset:31744
    v_add_u32 v236, s80, v240
    s_cbranch_vccnz KB_STUB0
KB_RET0:
    s_cbranch_scc1 KB_TAIL
KB_ULOOP:
    s_cmp_eq_u32 s79, 10
    s_cbranch_scc1 KB_SIG1
KB_SIG1R:
    s_barrier
    s_waitcnt lgkmcnt(8)
    v_mfma_f32_16x16x32_bf16 v[112:115], v[160:163], v[64:67], v[128:131]
    v_exp_f32 v224, v96
    v_mfma_f32_16x16x32_bf16 v[120:123], v[160:163], v[68:71], v[132:135]
    ds_read_b128 v[160:163], v236 offset:0
    v_mfma_f32_16x16x32_bf16 v[116:119], v[164:167], v[64:67], v[128:131]
    v_exp_f32 v225, v97
    v_mfma_f32_16x16x32_bf16 v[124:127], v[164:167], v[68:71], v[132:135]
    ds_read_b128 v[164:167], v236 offset:1024
    v_cvt_pk_bf16_f32 v144, v224, v225
    v_mfma_f32_16x16x32_bf16 v[112:115], v[168:171], v[72:75], v[112:115]
    v_exp_f32 v226, v98
    v_mfma_f32_16x16x32_bf16 v[120:123], v[168:171], v[76:79], v[120:123]
    ds_read_b128 v[168:171], v236 offset:2048
    v_mfma_f32_16x16x32_bf16 v[116:119], v[172:175], v[72:75], v[116:119]
    v_exp_f32 v227, v99
    v_mfma_f32_16x16x32_bf16 v[124:127], v[172:175], v[76:79], v[124:127]
    ds_read_b128 v[172:175], v236 offset:3072
    v_cvt_pk_bf16_f32 v145, v226, v227
    v_mfma_f32_16x16x32_bf16 v[112:115], v[176:179], v[80:83], v[112:115]
    v_exp_f32 v228, v100
    v_mfma_f32_16x16x32_bf16 v[120:123], v[176:179], v[84:87], v[120:123]
    ds_read_b128 v[176:179], v236 offset:4096
    v_mfma_f32_16x16x32_bf16 v[116:119], v[180:183], v[80:83], v[116:119]
    v_exp_f32 v229, v101
    v_mfma_f32_16x16x32_bf16 v[124:127], v[180:183], v[84:87], v[124:127]
    ds_read_b128 v[180:183], v236 offset:5120
    v_cvt_pk_bf16_f32 v146, v228, v229
    v_mfma_f32_16x16x32_bf16 v[112:115], v[184:187], v[88:91], v[112:115]
    v_exp_f32 v224, v102
    v_mfma_f32_16x16x32_bf16 v[120:123], v[184:187], v[92:95], v[120:123]
    ds_read_b128 v[184:187], v236 offset:6144
    v_or3_b32 v230, v144, v145, v146
    v_mfma_f32_16x16x32_bf16 v[116:119], v[188:191], v[88:91], v[116:119]
    v_exp_f32 v225, v103
    v_mfma_f32_16x16x32_bf16 v[124:127], v[188:191], v[92:95], v[124:127]
    ds_read_b128 v[188:191], v236 offset:7168
    v_cvt_pk_bf16_f32 v147, v224, v225
    v_mfma_f32_16x16x32_bf16 v[136:139], v[232:235], v[152:155], v[136:139]
    v_exp_f32 v226, v104
    v_mfma_f32_16x16x32_bf16 v[140:143], v[232:235], v[156:159], v[140:143]
    s_waitcnt lgkmcnt(8)
    v_mfma_f32_16x16x32_bf16 v[0:3], v[192:195], v[152:155], v[0:3]
    v_exp_f32 v227, v105
    v_mfma_f32_16x16x32_bf16 v[8:11], v[192:195], v[156:159], v[8:11]
    ds_read_b128 v[192:195], v236 offset:16384
    v_cvt_pk_bf16_f32 v148, v226, v227
    v_mfma_f32_16x16x32_bf16 v[4:7], v[196:199], v[152:155], v[4:7]
    v_exp_f32 v228, v106
    v_mfma_f32_16x16x32_bf16 v[12:15], v[196:199], v[156:159], v[12:15]
    ds_read_b128 v[196:199], v236 offset:17408
    v_or3_b32 v230, v230, v147, v148
    v_mfma_f32_16x16x32_bf16 v[16:19], v[200:203], v[152:155], v[16:19]
    v_exp_f32 v229, v107
    v_mfma_f32_16x16x32_bf16 v[24:27], v[200:203], v[156:159], v[24:27]
    ds_read_b128 v[200:203], v236 offset:18432
    v_cvt_pk_bf16_f32 v149, v228, v229
    v_mfma_f32_16x16x32_bf16 v[20:23], v[204:207], v[152:155], v[20:23]
    v_exp_f32 v224, v108
    v_mfma_f32_16x16x32_bf16 v[28:31], v[204:207], v[156:159], v[28:31]
    ds_read_b128 v[204:207], v236 offset:19456
    v_exp_f32 v225, v109
    v_mfma_f32_16x16x32_bf16 v[32:35], v[208:211], v[152:155], v[32:35]
    v_exp_f32 v226, v110
    v_mfma_f32_16x16x32_bf16 v[40:43], v[208:211], v[156:159], v[40:43]
    ds_read_b128 v[208:211], v236 offset:20480
    v_cvt_pk_bf16_f32 v150, v224, v225
    v_mfma_f32_16x16x32_bf16 v[36:39], v[212:215], v[152:155], v[36:39]
    v_exp_f32 v227, v111
    v_mfma_f32_16x16x32_bf16 v[44:47], v[212:215], v[156:159], v[44:47]
    ds_read_b128 v[212:215], v236 offset:21504
    v_or3_b32 v230, v230, v149, v150
    v_mfma_f32_16x16x32_bf16 v[48:51], v[216:219], v[152:155], v[48:51]
    v_cvt_pk_bf16_f32 v151, v226, v227
    v_bitop3_b32 v230, v230, s99, v151 bitop3:0xc8
    v_mfma_f32_16x16x32_bf16 v[56:59], v[216:219], v[156:159], v[56:59]
    ds_read_b128 v[216:219], v236 offset:22528
    v_cmp_ne_u32 vcc, 0, v230
    v_mfma_f32_16x16x32_bf16 v[52:55], v[220:223], v[152:155], v[52:55]
    v_mfma_f32_16x16x32_bf16 v[60:63], v[220:223], v[156:159], v[60:63]
    ds_read_b128 v[220:223], v236 offset:23552
    s_cbranch_vccnz KB_STUB1
KB_RET1:
    s_waitcnt lgkmcnt(8)
    v_mfma_f32_16x16x32_bf16 v[96:99], v[160:163], v[64:67], v[128:131]
    v_exp_f32 v224, v112
    v_mfma_f32_16x16x32_bf16 v[104:107], v[160:163], v[68:71], v[132:135]
    ds_read_b128 v[160:163], v236 offset:8192
    s_add_u32 s80, s80, 32768
    v_mfma_f32_16x16x32_bf16 v[100:103], v[164:167], v[64:67], v[128:131]
    v_exp_f32 v225, v113
    v_mfma_f32_16x16x32_bf16 v[108:111], v[164:167], v[68:71], v[132:135]
    ds_read_b128 v[164:167], v236 offset:9216
    v_cvt_pk_bf16_f32 v152, v224, v225
    v_mfma_f32_16x16x32_bf16 v[96:99], v[168:171], v[72:75], v[96:99]
    v_exp_f32 v226, v114
    v_mfma_f32_16x16x32_bf16 v[104:107], v[168:171], v[76:79], v[104:107]
    ds_read_b128 v[168:171], v236 offset:10240
    s_and_b32 s80, s80, 131071
    v_mfma_f32_16x16x32_bf16 v[100:103], v[172:175], v[72:75], v[100:103]
    v_exp_f32 v227, v115
    v_mfma_f32_16x16x32_bf16 v[108:111], v[172:175], v[76:79], v[108:111]
    ds_read_b128 v[172:175], v236 offset:11264
    v_cvt_pk_bf16_f32 v153, v226, v227
    v_mfma_f32_16x16x32_bf16 v[96:99], v[176:179], v[80:83], v[96:99]
    v_exp_f32 v228, v116
    v_mfma_f32_16x16x32_bf16 v[104:107], v[176:179], v[84:87], v[104:107]
    ds_read_b128 v[176:179], v236 offset:12288
    s_sub_u32 s79, s79, 1
    v_mfma_f32_16x16x32_bf16 v[100:103], v[180:183], v[80:83], v[100:103]
    v_exp_f32 v229, v117
    v_mfma_f32_16x16x32_bf16 v[108:111], v[180:183], v[84:87], v[108:111]
    ds_read_b128 v[180:183], v236 offset:13312
    v_cvt_pk_bf16_f32 v154, v228, v229
    v_mfma_f32_16x16x32_bf16 v[96:99], v[184:187], v[88:91], v[96:99]
    v_exp_f32 v224, v118
    v_mfma_f32_16x16x32_bf16 v[104:107], v[184:187], v[92:95], v[104:107]
    ds_read_b128 v[184:187], v236 offset:14336
    v_or3_b32 v230, v152, v153, v154
    v_mfma_f32_16x16x32_bf16 v[100:103], v[188:191], v[88:91], v[100:103]
    v_exp_f32 v225, v119
    v_mfma_f32_16x16x32_bf16 v[108:111], v[188:191], v[92:95], v[108:111]
    ds_read_b128 v[188:191], v236 offset:15360
    v_cvt_pk_bf16_f32 v155, v224, v225
    v_mfma_f32_16x16x32_bf16 v[136:139], v[232:235], v[144:147], v[136:139]
    v_exp_f32 v226, v120
    v_mfma_f32_16x16x32_bf16 v[140:143], v[232:235], v[148:151], v[140:143]
    v_exp_f32 v227, v121
    s_waitcnt lgkmcnt(8)
    v_mfma_f32_16x16x32_bf16 v[0:3], v[192:195], v[144:147], v[0:3]
    v_exp_f32 v228, v122
    v_mfma_f32_16x16x32_bf16 v[8:11], v[192:195], v[148:151], v[8:11]
    ds_read_b128 v[192:195], v236 offset:24576
    v_cvt_pk_bf16_f32 v156, v226, v227
    v_mfma_f32_16x16x32_bf16 v[4:7], v[196:199], v[144:147], v[4:7]
    v_exp_f32 v229, v123
    v_mfma_f32_16x16x32_bf16 v[12:15], v[196:199], v[148:151], v[12:15]
    ds_read_b128 v[196:199], v236 offset:25600
    v_or3_b32 v230, v230, v155, v156
    v_mfma_f32_16x16x32_bf16 v[16:19], v[200:203], v[144:147], v[16:19]
    v_exp_f32 v224, v124
    v_mfma_f32_16x16x32_bf16 v[24:27], v[200:203], v[148:151], v[24:27]
    ds_read_b128 v[200:203], v236 offset:26624
    v_cvt_pk_bf16_f32 v157, v228, v229
    v_mfma_f32_16x16x32_bf16 v[20:23], v[204:207], v[144:147], v[20:23]
    v_exp_f32 v225, v125
    v_mfma_f32_16x16x32_bf16 v[28:31], v[204:207], v[148:151], v[28:31]
    ds_read_b128 v[204:207], v236 offset:27648
    v_cvt_pk_bf16_f32 v158, v224, v225
    v_mfma_f32_16x16x32_bf16 v[32:35], v[208:211], v[144:147], v[32:35]
    v_exp_f32 v226, v126
    v_mfma_f32_16x16x32_bf16 v[40:43], v[208:211], v[148:151], v[40:43]
    ds_read_b128 v[208:211], v236 offset:28672
    v_or3_b32 v230, v230, v157, v158
    v_mfma_f32_16x16x32_bf16 v[36:39], v[212:215], v[144:147], v[36:39]
    v_exp_f32 v227, v127
    v_mfma_f32_16x16x32_bf16 v[44:47], v[212:215], v[148:151], v[44:47]
    ds_read_b128 v[212:215], v236 offset:29696
    v_cvt_pk_bf16_f32 v159, v226, v227
    v_mfma_f32_16x16x32_bf16 v[48:51], v[216:219], v[144:147], v[48:51]
    v_bitop3_b32 v230, v230, s99, v159 bitop3:0xc8
    v_cmp_ne_u32 vcc, 0, v230
    v_mfma_f32_16x16x32_bf16 v[56:59], v[216:219], v[148:151], v[56:59]
    ds_read_b128 v[216:219], v236 offset:30720
    v_mfma_f32_16x16x32_bf16 v[52:55], v[220:223], v[144:147], v[52:55]
    v_mfma_f32_16x16x32_bf16 v[60:63], v[220:223], v[148:151], v[60:63]
    ds_read_b128 v[220:223], v236 offset:31744
    v_add_u32 v236, s80, v240
    s_cbranch_vccnz KB_STUB2
KB_RET2:
    s_cbranch_scc0 KB_ULOOP
KB_TAIL:
    s_bitcmp1_b32 s76, 0
    s_cbranch_scc0 KB_LAST0
    s_barrier
    s_waitcnt lgkmcnt(8)
    v_mfma_f32_16x16x32_bf16 v[112:115], v[160:163], v[64:67], v[128:131]
    v_exp_f32 v224, v96
    v_mfma_f32_16x16x32_bf16 v[120:123], v[160:163], v[68:71], v[132:135]
    ds_read_b128 v[160:163], v236 offset:0
    v_mfma_f32_16x16x32_bf16 v[116:119], v[164:167], v[64:67], v[128:131]
    v_exp_f32 v225, v97
    v_mfma_f32_16x16x32_bf16 v[124:127], v[164:167], v[68:71], v[132:135]
    ds_read_b128 v[164:167], v236 offset:1024
    v_cvt_pk_bf16_f32 v144, v224, v225
    v_mfma_f32_16x16x32_bf16 v[112:115], v[168:171], v[72:75], v[112:115]
    v_exp_f32 v226, v98
    v_mfma_f32_16x16x32_bf16 v[120:123], v[168:171], v[76:79], v[120:123]
    ds_read_b128 v[168:171], v236 offset:2048
    v_mfma_f32_16x16x32_bf16 v[116:119], v[172:175], v[72:75], v[116:119]
    v_exp_f32 v227, v99
    v_mfma_f32_16x16x32_bf16 v[124:127], v[172:175], v[76:79], v[124:127]
    ds_read_b128 v[172:175], v236 offset:3072
    v_cvt_pk_bf16_f32 v145, v226, v227
    v_mfma_f32_16x16x32_bf16 v[112:115], v[176:179], v[80:83], v[112:115]
    v_exp_f32 v228, v100
    v_mfma_f32_16x16x32_bf16 v[120:123], v[176:179], v[84:87], v[120:123]
    ds_read_b128 v[176:179], v236 offset:4096
    v_mfma_f32_16x16x32_bf16 v[116:119], v[180:183], v[80:83], v[116:119]
    v_exp_f32 v229, v101
    v_mfma_f32_16x16x32_bf16 v[124:127], v[180:183], v[84:87], v[124:127]
    ds_read_b128 v[180:183], v236 offset:5120
    v_cvt_pk_bf16_f32 v146, v228, v229
    v_mfma_f32_16x16x32_bf16 v[112:115], v[184:187], v[88:91], v[112:115]
    v_exp_f32 v224, v102
    v_mfma_f32_16x16x32_bf16 v[120:123], v[184:187], v[92:95], v[120:123]
    ds_read_b128 v[184:187], v236 offset:6144
    v_or3_b32 v230, v144, v145, v146
    v_mfma_f32_16x16x32_bf16 v[116:119], v[188:191], v[88:91], v[116:119]
    v_exp_f32 v225, v103
    v_mfma_f32_16x16x32_bf16 v[124:127], v[188:191], v[92:95], v[124:127]
    ds_read_b128 v[188:191], v236 offset:7168
    v_cvt_pk_bf16_f32 v147, v224, v225
    v_mfma_f32_16x16x32_bf16 v[136:139], v[232:235], v[152:155], v[136:139]
    v_exp_f32 v226, v104
    v_mfma_f32_16x16x32_bf16 v[140:143], v[232:235], v[156:159], v[140:143]
    s_waitcnt lgkmcnt(8)
    v_mfma_f32_16x16x32_bf16 v[0:3], v[192:195], v[152:155], v[0:3]
    v_exp_f32 v227, v105
    v_mfma_f32_16x16x32_bf16 v[8:11], v[192:195], v[156:159], v[8:11]
    ds_read_b128 v[192:195], v236 offset:16384
    v_cvt_pk_bf16_f32 v148, v226, v227
    v_mfma_f32_16x16x32_bf16 v[4:7], v[196:199], v[152:155], v[4:7]
    v_exp_f32 v228, v106
    v_mfma_f32_16x16x32_bf16 v[12:15], v[196:199], v[156:159], v[12:15]
    ds_read_b128 v[196:199], v236 offset:17408
    v_or3_b32 v230, v230, v147, v148
    v_mfma_f32_16x16x32_bf16 v[16:19], v[200:203], v[152:155], v[16:19]
    v_exp_f32 v229, v107
    v_mfma_f32_16x16x32_bf16 v[24:27], v[200:203], v[156:159], v[24:27]
    ds_read_b128 v[200:203], v236 offset:18432
    v_cvt_pk_bf16_f32 v149, v228, v229
    v_mfma_f32_16x16x32_bf16 v[20:23], v[204:207], v[152:155], v[20:23]
    v_exp_f32 v224, v108
    v_mfma_f32_16x16x32_bf16 v[28:31], v[204:207], v[156:159], v[28:31]
    ds_read_b128 v[204:207], v236 offset:19456
    v_exp_f32 v225, v109
    v_mfma_f32_16x16x32_bf16 v[32:35], v[208:211], v[152:155], v[32:35]
    v_exp_f32 v226, v110
    v_mfma_f32_16x16x32_bf16 v[40:43], v[208:211], v[156:159], v[40:43]
    ds_read_b128 v[208:211], v236 offset:20480
    v_cvt_pk_bf16_f32 v150, v224, v225
    v_mfma_f32_16x16x32_bf16 v[36:39], v[212:215], v[152:155], v[36:39]
    v_exp_f32 v227, v111
    v_mfma_f32_16x16x32_bf16 v[44:47], v[212:215], v[156:159], v[44:47]
    ds_read_b128 v[212:215], v236 offset:21504
    v_or3_b32 v230, v230, v149, v150
    v_mfma_f32_16x16x32_bf16 v[48:51], v[216:219], v[152:155], v[48:51]
    v_cvt_pk_bf16_f32 v151, v226, v227
    v_bitop3_b32 v230, v230, s99, v151 bitop3:0xc8
    v_mfma_f32_16x16x32_bf16 v[56:59], v[216:219], v[156:159], v[56:59]
    ds_read_b128 v[216:219], v236 offset:22528
    v_cmp_ne_u32 vcc, 0, v230
    v_mfma_f32_16x16x32_bf16 v[52:55], v[220:223], v[152:155], v[52:55]
    v_mfma_f32_16x16x32_bf16 v[60:63], v[220:223], v[156:159], v[60:63]
    ds_read_b128 v[220:223], v236 offset:23552
    s_cbranch_vccnz KB_STUB3
KB_RET3:
KB_LAST1:
    ds_read_b128 v[64:67], v238 offset:0
    ds_read_b128 v[68:71], v238 offset:1024
    ds_read_b128 v[72:75], v238 offset:2048
    ds_read_b128 v[76:79], v238 offset:3072
    ds_read_b128 v[80:83], v238 offset:4096
    ds_read_b128 v[84:87], v238 offset:5120
    ds_read_b128 v[88:91], v238 offset:6144
    ds_read_b128 v[92:95], v238 offset:7168
    v_mfma_f32_16x16x32_bf16 v[136:139], v[232:235], v[144:147], v[136:139]
    v_cndmask_b32_e64 v112, v112, v237, s[86:87]
    v_exp_f32 v224, v112
    v_mfma_f32_16x16x32_bf16 v[140:143], v[232:235], v[148:151], v[140:143]
    v_exp_f32 v228, v120
    s_waitcnt lgkmcnt(8)
    v_mfma_f32_16x16x32_bf16 v[0:3], v[192:195], v[144:147], v[0:3]
    v_cndmask_b32_e64 v113, v113, v237, s[88:89]
    v_exp_f32 v225, v113
    v_mfma_f32_16x16x32_bf16 v[8:11], v[192:195], v[148:151], v[8:11]
    ds_read_b128 v[192:195], v236 offset:24576
    v_exp_f32 v229, v121
    v_mfma_f32_16x16x32_bf16 v[4:7], v[196:199], v[144:147], v[4:7]
    v_cndmask_b32_e64 v114, v114, v237, s[90:91]
    v_exp_f32 v226, v114
    v_mfma_f32_16x16x32_bf16 v[12:15], v[196:199], v[148:151], v[12:15]
    ds_read_b128 v[196:199], v236 offset:25600
    v_cndmask_b32_e64 v115, v115, v237, s[92:93]
    v_cvt_pk_bf16_f32 v244, v224, v225
    v_mfma_f32_16x16x32_bf16 v[16:19], v[200:203], v[144:147], v[16:19]
    v_exp_f32 v227, v115
    v_cndmask_b32_e64 v124, v124, v237, s[86:87]
    v_mfma_f32_16x16x32_bf16 v[24:27], v[200:203], v[148:151], v[24:27]
    ds_read_b128 v[200:203], v236 offset:26624
    v_exp_f32 v224, v122
    v_mfma_f32_16x16x32_bf16 v[20:23], v[204:207], v[144:147], v[20:23]
    v_cvt_pk_bf16_f32 v245, v226, v227
    v_exp_f32 v225, v123
    v_mfma_f32_16x16x32_bf16 v[28:31], v[204:207], v[148:151], v[28:31]
    ds_read_b128 v[204:207], v236 offset:27648
    v_exp_f32 v226, v124
    v_mfma_f32_16x16x32_bf16 v[32:35], v[208:211], v[144:147], v[32:35]
    v_cndmask_b32_e64 v125, v125, v237, s[88:89]
    v_exp_f32 v227, v125
    v_mfma_f32_16x16x32_bf16 v[40:43], v[208:211], v[148:151], v[40:43]
    ds_read_b128 v[208:211], v236 offset:28672
    v_cndmask_b32_e64 v126, v126, v237, s[90:91]
    v_cndmask_b32_e64 v127, v127, v237, s[92:93]
    v_mfma_f32_16x16x32_bf16 v[36:39], v[212:215], v[144:147], v[36:39]
    v_mov_b32 v246, 0
    v_mov_b32 v116, v237
    v_mov_b32 v117, v237
    v_mfma_f32_16x16x32_bf16 v[44:47], v[212:215], v[148:151], v[44:47]
    ds_read_b128 v[212:215], v236 offset:29696
    v_mov_b32 v247, 0
    v_mov_b32 v118, v237
    v_mfma_f32_16x16x32_bf16 v[48:51], v[216:219], v[144:147], v[48:51]
    v_mov_b32 v119, v237
    v_cvt_pk_bf16_f32 v248, v228, v229
    v_or3_b32 v230, v244, v245, v248
    v_mfma_f32_16x16x32_bf16 v[56:59], v[216:219], v[148:151], v[56:59]
    ds_read_b128 v[216:219], v236 offset:30720
    v_exp_f32 v228, v126
    v_mfma_f32_16x16x32_bf16 v[52:55], v[220:223], v[144:147], v[52:55]
    v_cvt_pk_bf16_f32 v249, v224, v225
    v_exp_f32 v229, v127
    v_mfma_f32_16x16x32_bf16 v[60:63], v[220:223], v[148:151], v[60:63]
    ds_read_b128 v[220:223], v236 offset:31744
    v_cvt_pk_bf16_f32 v250, v226, v227
    v_or3_b32 v230, v230, v249, v250
    v_cvt_pk_bf16_f32 v251, v228, v229
    v_bitop3_b32 v230, v230, s99, v251 bitop3:0xc8
    v_cmp_ne_u32 vcc, 0, v230
    s_cbranch_vccnz KB_STUB4
KB_RET4:
    s_branch KB_POST
KB_FL:
    ds_read_b128 v[64:67], v238 offset:0
    ds_read_b128 v[68:71], v238 offset:1024
    ds_read_b128 v[72:75], v238 offset:2048
    ds_read_b128 v[76:79], v238 offset:3072
    ds_read_b128 v[80:83], v238 offset:4096
    ds_read_b128 v[84:87], v238 offset:5120
    ds_read_b128 v[88:91], v238 offset:6144
    ds_read_b128 v[92:95], v238 offset:7168
    ds_read_b128 v[192:195], v236 offset:16384
    ds_read_b128 v[196:199], v236 offset:17408
    ds_read_b128 v[200:203], v236 offset:18432
    ds_read_b128 v[204:207], v236 offset:19456
    ds_read_b128 v[208:211], v236 offset:20480
    ds_read_b128 v[212:215], v236 offset:21504
    ds_read_b128 v[216:219], v236 offset:22528
    ds_read_b128 v[220:223], v236 offset:23552
    v_exp_f32 v224, v96
    v_exp_f32 v225, v97
    v_exp_f32 v226, v98
    v_cvt_pk_bf16_f32 v244, v224, v225
    v_exp_f32 v227, v99
    v_exp_f32 v228, v100
    v_cvt_pk_bf16_f32 v245, v226, v227
    v_exp_f32 v229, v101
    v_exp_f32 v224, v102
    v_cvt_pk_bf16_f32 v246, v228, v229
    v_exp_f32 v225, v103
    v_exp_f32 v226, v104
    v_cvt_pk_bf16_f32 v247, v224, v225
    v_exp_f32 v227, v105
    v_exp_f32 v228, v106
    v_cvt_pk_bf16_f32 v248, v226, v227
    v_exp_f32 v229, v107
    v_exp_f32 v224, v108
    v_cvt_pk_bf16_f32 v249, v228, v229
    v_exp_f32 v225, v109
    v_exp_f32 v226, v110
    v_cvt_pk_bf16_f32 v250, v224, v225
    v_exp_f32 v227, v111
    s_nop 0
    v_cvt_pk_bf16_f32 v251, v226, v227
    s_branch KB_POST
KB_LAST0:
    s_barrier
    ds_read_b128 v[64:67], v238 offset:0
    ds_read_b128 v[68:71], v238 offset:1024
    ds_read_b128 v[72:75], v238 offset:2048
    ds_read_b128 v[76:79], v238 offset:3072
    ds_read_b128 v[80:83], v238 offset:4096
    ds_read_b128 v[84:87], v238 offset:5120
    ds_read_b128 v[88:91], v238 offset:6144
    ds_read_b128 v[92:95], v238 offset:7168
    v_mfma_f32_16x16x32_bf16 v[136:139], v[232:235], v[152:155], v[136:139]
    v_cndmask_b32_e64 v96, v96, v237, s[86:87]
    v_exp_f32 v224, v96
    v_mfma_f32_16x16x32_bf16 v[140:143], v[232:235], v[156:159], v[140:143]
    v_exp_f32 v228, v104
    s_waitcnt lgkmcnt(8)
    v_mfma_f32_16x16x32_bf16 v[0:3], v[192:195], v[152:155], v[0:3]
    v_cndmask_b32_e64 v97, v97, v237, s[88:89]
    v_exp_f32 v225, v97
    v_mfma_f32_16x16x32_bf16 v[8:11], v[192:195], v[156:159], v[8:11]
    ds_read_b128 v[192:195], v236 offset:16384
    v_exp_f32 v229, v105
    v_mfma_f32_16x16x32_bf16 v[4:7], v[196:199], v[152:155], v[4:7]
    v_cndmask_b32_e64 v98, v98, v237, s[90:91]
    v_exp_f32 v226, v98
    v_mfma_f32_16x16x32_bf16 v[12:15], v[196:199], v[156:159], v[12:15]
    ds_read_b128 v[196:199], v236 offset:17408
    v_cndmask_b32_e64 v99, v99, v237, s[92:93]
    v_cvt_pk_bf16_f32 v244, v224, v225
    v_mfma_f32_16x16x32_bf16 v[16:19], v[200:203], v[152:155], v[16:19]
    v_exp_f32 v227, v99
    v_cndmask_b32_e64 v108, v108, v237, s[86:87]
    v_mfma_f32_16x16x32_bf16 v[24:27], v[200:203], v[156:159], v[24:27]
    ds_read_b128 v[200:203], v236 offset:18432
    v_exp_f32 v224, v106
    v_mfma_f32_16x16x32_bf16 v[20:23], v[204:207], v[152:155], v[20:23]
    v_cvt_pk_bf16_f32 v245, v226, v227
    v_exp_f32 v225, v107
    v_mfma_f32_16x16x32_bf16 v[28:31], v[204:207], v[156:159], v[28:31]
    ds_read_b128 v[204:207], v236 offset:19456
    v_exp_f32 v226, v108
    v_mfma_f32_16x16x32_bf16 v[32:35], v[208:211], v[152:155], v[32:35]
    v_cndmask_b32_e64 v109, v109, v237, s[88:89]
    v_exp_f32 v227, v109
    v_mfma_f32_16x16x32_bf16 v[40:43], v[208:211], v[156:159], v[40:43]
    ds_read_b128 v[208:211], v236 offset:20480
    v_cndmask_b32_e64 v110, v110, v237, s[90:91]
    v_cndmask_b32_e64 v111, v111, v237, s[92:93]
    v_mfma_f32_16x16x32_bf16 v[36:39], v[212:215], v[152:155], v[36:39]
    v_mov_b32 v246, 0
    v_mov_b32 v100, v237
    v_mov_b32 v101, v237
    v_mfma_f32_16x16x32_bf16 v[44:47], v[212:215], v[156:159], v[44:47]
    ds_read_b128 v[212:215], v236 offset:21504
    v_mov_b32 v247, 0
    v_mov_b32 v102, v237
    v_mfma_f32_16x16x32_bf16 v[48:51], v[216:219], v[152:155], v[48:51]
    v_mov_b32 v103, v237
    v_cvt_pk_bf16_f32 v248, v228, v229
    v_or3_b32 v230, v244, v245, v248
    v_mfma_f32_16x16x32_bf16 v[56:59], v[216:219], v[156:159], v[56:59]
    ds_read_b128 v[216:219], v236 offset:22528
    v_exp_f32 v228, v110
    v_mfma_f32_16x16x32_bf16 v[52:55], v[220:223], v[152:155], v[52:55]
    v_cvt_pk_bf16_f32 v249, v224, v225
    v_exp_f32 v229, v111
    v_mfma_f32_16x16x32_bf16 v[60:63], v[220:223], v[156:159], v[60:63]
    ds_read_b128 v[220:223], v236 offset:23552
    v_cvt_pk_bf16_f32 v250, v226, v227
    v_or3_b32 v230, v230, v249, v250
    v_cvt_pk_bf16_f32 v251, v228, v229
    v_bitop3_b32 v230, v230, s99, v251 bitop3:0xc8
    v_cmp_ne_u32 vcc, 0, v230
    s_cbranch_vccnz KB_STUB5
KB_RET5:
KB_POST:
    s_lshl_b32 s77, s95, 16
    s_add_u32 s77, s77, 98304
    s_add_u32 s80, s81, s77
    s_and_b32 s80, s80, 131071
    v_add_u32 v236, s80, v240
    s_cmp_ge_u32 s76, 2
    s_cbranch_scc1 KB_NOB
    s_barrier
KB_NOB:
    s_cmp_lg_u32 s94, 0
    s_cbranch_scc1 KB_FINAL
    s_barrier
    ds_read_b128 v[160:163], v236 offset:0
    ds_read_b128 v[164:167], v236 offset:1024
    ds_read_b128 v[168:171], v236 offset:2048
    ds_read_b128 v[172:175], v236 offset:3072
    ds_read_b128 v[176:179], v236 offset:4096
    ds_read_b128 v[180:183], v236 offset:5120
    ds_read_b128 v[184:187], v236 offset:6144
    ds_read_b128 v[188:191], v236 offset:7168
    v_mfma_f32_16x16x32_bf16 v[136:139], v[232:235], v[244:247], v[136:139]
    s_lshl_b32 s77, s95, 1
    s_lshr_b32 s78, s76, 1
    s_add_u32 s77, s77, s78
    s_mul_i32 s77, s77, 745472
    v_mfma_f32_16x16x32_bf16 v[140:143], v[232:235], v[248:251], v[140:143]
    s_lshl_b32 s78, s72, 14
    s_add_u32 s77, s77, s78
    s_and_b32 s78, s76, 1
    s_waitcnt lgkmcnt(8)
    v_mfma_f32_16x16x32_bf16 v[0:3], v[192:195], v[244:247], v[0:3]
    s_lshl_b32 s78, s78, 11
    s_add_u32 s96, s77, s78
    v_rcp_f32 v230, v136
    v_mfma_f32_16x16x32_bf16 v[8:11], v[192:195], v[248:251], v[8:11]
    s_add_u32 s98, s96, 8192
    s_mov_b32 s95, s75
    v_rcp_f32 v231, v140
    v_mfma_f32_16x16x32_bf16 v[4:7], v[196:199], v[244:247], v[4:7]
    s_mov_b32 s94, 1
    s_mov_b32 s81, s80
    s_add_u32 s80, s80, 32768
    s_and_b32 s80, s80, 131071
    v_mfma_f32_16x16x32_bf16 v[12:15], v[196:199], v[248:251], v[12:15]
    s_lshl_b32 s82, s95, 2
    s_add_u32 s82, s82, s76
    v_mul_f32 v0, v0, v230
    v_mul_f32 v1, v1, v230
    v_mfma_f32_16x16x32_bf16 v[16:19], v[200:203], v[244:247], v[16:19]
    v_mul_f32 v2, v2, v230
    v_mul_f32 v3, v3, v230
    v_mul_f32 v4, v4, v230
    v_mul_f32 v5, v5, v230
    v_mfma_f32_16x16x32_bf16 v[24:27], v[200:203], v[248:251], v[24:27]
    v_mul_f32 v6, v6, v230
    v_mul_f32 v7, v7, v230
    v_cvt_pk_bf16_f32 v0, v0, v1
    v_cvt_pk_bf16_f32 v1, v2, v3
    v_mfma_f32_16x16x32_bf16 v[20:23], v[204:207], v[244:247], v[20:23]
    v_cvt_pk_bf16_f32 v2, v4, v5
    v_cvt_pk_bf16_f32 v3, v6, v7
    buffer_store_dwordx4 v[0:3], v240, s[56:59], s96 offen offset:0 sc1
    v_mul_f32 v8, v8, v231
    v_mfma_f32_16x16x32_bf16 v[28:31], v[204:207], v[248:251], v[28:31]
    v_mul_f32 v9, v9, v231
    v_mul_f32 v10, v10, v231
    v_mul_f32 v11, v11, v231
    v_mul_f32 v12, v12, v231
    v_mfma_f32_16x16x32_bf16 v[32:35], v[208:211], v[244:247], v[32:35]
    v_mul_f32 v13, v13, v231
    v_mul_f32 v14, v14, v231
    v_mul_f32 v15, v15, v231
    v_cvt_pk_bf16_f32 v8, v8, v9
    v_mfma_f32_16x16x32_bf16 v[40:43], v[208:211], v[248:251], v[40:43]
    v_cvt_pk_bf16_f32 v9, v10, v11
    v_cvt_pk_bf16_f32 v10, v12, v13
    v_cvt_pk_bf16_f32 v11, v14, v15
    buffer_store_dwordx4 v[8:11], v240, s[56:59], s96 offen offset:1024 sc1
    v_mfma_f32_16x16x32_bf16 v[36:39], v[212:215], v[244:247], v[36:39]
    v_mul_f32 v16, v16, v230
    v_mul_f32 v17, v17, v230
    v_mul_f32 v18, v18, v230
    v_mul_f32 v19, v19, v230
    v_mfma_f32_16x16x32_bf16 v[44:47], v[212:215], v[248:251], v[44:47]
    v_mul_f32 v20, v20, v230
    v_mul_f32 v21, v21, v230
    v_mul_f32 v22, v22, v230
    v_mul_f32 v23, v23, v230
    v_mfma_f32_16x16x32_bf16 v[48:51], v[216:219], v[244:247], v[48:51]
    v_cvt_pk_bf16_f32 v16, v16, v17
    v_cvt_pk_bf16_f32 v17, v18, v19
    v_cvt_pk_bf16_f32 v18, v20, v21
    v_cvt_pk_bf16_f32 v19, v22, v23
    v_mfma_f32_16x16x32_bf16 v[56:59], v[216:219], v[248:251], v[56:59]
    buffer_store_dwordx4 v[16:19], v239, s[56:59], s96 offen offset:0 sc1
    v_mul_f32 v24, v24, v231
    v_mul_f32 v25, v25, v231
    v_mul_f32 v26, v26, v231
    v_mfma_f32_16x16x32_bf16 v[52:55], v[220:223], v[244:247], v[52:55]
    v_mul_f32 v27, v27, v231
    v_mul_f32 v28, v28, v231
    v_mul_f32 v29, v29, v231
    v_mul_f32 v30, v30, v231
    v_mfma_f32_16x16x32_bf16 v[60:63], v[220:223], v[248:251], v[60:63]
    v_mul_f32 v31, v31, v231
    v_cvt_pk_bf16_f32 v24, v24, v25
    v_cvt_pk_bf16_f32 v25, v26, v27
    s_waitcnt lgkmcnt(0)
    v_mfma_f32_16x16x32_bf16 v[96:99], v[160:163], v[64:67], 0
    v_cvt_pk_bf16_f32 v26, v28, v29
    v_cvt_pk_bf16_f32 v27, v30, v31
    buffer_store_dwordx4 v[24:27], v239, s[56:59], s96 offen offset:1024 sc1
    v_mul_f32 v32, v32, v230
    v_mfma_f32_16x16x32_bf16 v[104:107], v[160:163], v[68:71], 0
    ds_read_b128 v[160:163], v236 offset:8192
    v_mul_f32 v33, v33, v230
    v_mul_f32 v34, v34, v230
    v_mul_f32 v35, v35, v230
    v_mfma_f32_16x16x32_bf16 v[100:103], v[164:167], v[64:67], 0
    v_mul_f32 v36, v36, v230
    v_mul_f32 v37, v37, v230
    v_mul_f32 v38, v38, v230
    v_mul_f32 v39, v39, v230
    v_mfma_f32_16x16x32_bf16 v[108:111], v[164:167], v[68:71], 0
    ds_read_b128 v[164:167], v236 offset:9216
    v_cvt_pk_bf16_f32 v32, v32, v33
    v_cvt_pk_bf16_f32 v33, v34, v35
    v_cvt_pk_bf16_f32 v34, v36, v37
    v_mfma_f32_16x16x32_bf16 v[96:99], v[168:171], v[72:75], v[96:99]
    v_cvt_pk_bf16_f32 v35, v38, v39
    buffer_store_dwordx4 v[32:35], v240, s[56:59], s98 offen offset:0 sc1
    v_mul_f32 v40, v40, v231
    v_mul_f32 v41, v41, v231
    v_mfma_f32_16x16x32_bf16 v[104:107], v[168:171], v[76:79], v[104:107]
    ds_read_b128 v[168:171], v236 offset:10240
    v_mul_f32 v42, v42, v231
    v_mul_f32 v43, v43, v231
    v_mul_f32 v44, v44, v231
    v_mfma_f32_16x16x32_bf16 v[100:103], v[172:175], v[72:75], v[100:103]
    v_mul_f32 v45, v45, v231
    v_mul_f32 v46, v46, v231
    v_mul_f32 v47, v47, v231
    v_cvt_pk_bf16_f32 v40, v40, v41
    v_mfma_f32_16x16x32_bf16 v[108:111], v[172:175], v[76:79], v[108:111]
    ds_read_b128 v[172:175], v236 offset:11264
    v_cvt_pk_bf16_f32 v41, v42, v43
    v_cvt_pk_bf16_f32 v42, v44, v45
    v_cvt_pk_bf16_f32 v43, v46, v47
    v_mfma_f32_16x16x32_bf16 v[96:99], v[176:179], v[80:83], v[96:99]
    buffer_store_dwordx4 v[40:43], v240, s[56:59], s98 offen offset:1024 sc1
    v_mul_f32 v48, v48, v230
    v_mul_f32 v49, v49, v230
    v_mul_f32 v50, v50, v230
    v_mfma_f32_16x16x32_bf16 v[104:107], v[176:179], v[84:87], v[104:107]
    ds_read_b128 v[176:179], v236 offset:12288
    v_mul_f32 v51, v51, v230
    v_mul_f32 v52, v52, v230
    v_mul_f32 v53, v53, v230
    v_mfma_f32_16x16x32_bf16 v[100:103], v[180:183], v[80:83], v[100:103]
    v_mul_f32 v54, v54, v230
    v_mul_f32 v55, v55, v230
    v_cvt_pk_bf16_f32 v48, v48, v49
    v_cvt_pk_bf16_f32 v49, v50, v51
    v_mfma_f32_16x16x32_bf16 v[108:111], v[180:183], v[84:87], v[108:111]
    ds_read_b128 v[180:183], v236 offset:13312
    v_cvt_pk_bf16_f32 v50, v52, v53
    v_cvt_pk_bf16_f32 v51, v54, v55
    buffer_store_dwordx4 v[48:51], v239, s[56:59], s98 offen offset:0 sc1
    v_mfma_f32_16x16x32_bf16 v[96:99], v[184:187], v[88:91], v[96:99]
    v_mfma_f32_16x16x32_bf16 v[104:107], v[184:187], v[92:95], v[104:107]
    ds_read_b128 v[184:187], v236 offset:14336
    v_mfma_f32_16x16x32_bf16 v[100:103], v[188:191], v[88:91], v[100:103]
    v_mfma_f32_16x16x32_bf16 v[108:111], v[188:191], v[92:95], v[108:111]
    ds_read_b128 v[188:191], v236 offset:15360
    v_mul_f32 v56, v56, v231
    v_mul_f32 v57, v57, v231
    v_mul_f32 v58, v58, v231
    v_mul_f32 v59, v59, v231
    v_mul_f32 v60, v60, v231
    v_mul_f32 v61, v61, v231
    v_mul_f32 v62, v62, v231
    v_mul_f32 v63, v63, v231
    v_cvt_pk_bf16_f32 v56, v56, v57
    v_cvt_pk_bf16_f32 v57, v58, v59
    v_cvt_pk_bf16_f32 v58, v60, v61
    v_cvt_pk_bf16_f32 v59, v62, v63
    buffer_store_dwordx4 v[56:59], v239, s[56:59], s98 offen offset:1024 sc1
    v_add_u32 v236, s80, v240
    v_max3_f32 v224, v96, v97, v98
    v_max3_f32 v224, v224, v99, v100
    v_max3_f32 v224, v224, v101, v102
    v_max_f32 v224, v224, v103
    v_max3_f32 v225, v104, v105, v106
    v_max3_f32 v225, v225, v107, v108
    v_max3_f32 v225, v225, v109, v110
    v_max_f32 v225, v225, v111
    s_nop 0
    s_nop 0
    v_permlane32_swap_b32 v224, v225
    v_max_f32 v224, v224, v225
    v_mov_b32 v225, v224
    s_nop 0
    s_nop 0
    v_permlane16_swap_b32 v224, v225
    v_max_f32 v224, v224, v225
    v_mov_b32 v225, v224
    s_nop 0
    s_nop 0
    v_permlane32_swap_b32 v224, v225
    v_sub_f32 v128, 0xc1600000, v224
    v_sub_f32 v129, 0xc1600000, v224
    v_sub_f32 v130, 0xc1600000, v224
    v_sub_f32 v131, 0xc1600000, v224
    v_sub_f32 v132, 0xc1600000, v225
    v_sub_f32 v133, 0xc1600000, v225
    v_sub_f32 v134, 0xc1600000, v225
    v_sub_f32 v135, 0xc1600000, v225
    v_add_f32 v96, v96, v128
    v_add_f32 v97, v97, v128
    v_add_f32 v98, v98, v128
    v_add_f32 v99, v99, v128
    v_add_f32 v100, v100, v128
    v_add_f32 v101, v101, v128
    v_add_f32 v102, v102, v128
    v_add_f32 v103, v103, v128
    v_add_f32 v104, v104, v132
    v_add_f32 v105, v105, v132
    v_add_f32 v106, v106, v132
    v_add_f32 v107, v107, v132
    v_add_f32 v108, v108, v132
    v_add_f32 v109, v109, v132
    v_add_f32 v110, v110, v132
    v_add_f32 v111, v111, v132
    s_waitcnt lgkmcnt(0)
    s_branch KB_BLK
KB_FINAL:
    v_mfma_f32_16x16x32_bf16 v[136:139], v[232:235], v[244:247], v[136:139]
    s_lshl_b32 s77, s95, 1
    s_lshr_b32 s78, s76, 1
    s_add_u32 s77, s77, s78
    s_mul_i32 s77, s77, 745472
    s_lshl_b32 s78, s72, 14
    s_add_u32 s77, s77, s78
    v_mfma_f32_16x16x32_bf16 v[140:143], v[232:235], v[248:251], v[140:143]
    s_and_b32 s78, s76, 1
    s_lshl_b32 s78, s78, 11
    s_add_u32 s96, s77, s78
    s_add_u32 s98, s96, 8192
    s_waitcnt lgkmcnt(0)
    v_mfma_f32_16x16x32_bf16 v[0:3], v[192:195], v[244:247], v[0:3]
    v_rcp_f32 v230, v136
    v_mfma_f32_16x16x32_bf16 v[8:11], v[192:195], v[248:251], v[8:11]
    v_rcp_f32 v231, v140
    v_mfma_f32_16x16x32_bf16 v[4:7], v[196:199], v[244:247], v[4:7]
    v_mfma_f32_16x16x32_bf16 v[12:15], v[196:199], v[248:251], v[12:15]
    v_mfma_f32_16x16x32_bf16 v[16:19], v[200:203], v[244:247], v[16:19]
    v_mfma_f32_16x16x32_bf16 v[24:27], v[200:203], v[248:251], v[24:27]
    v_mfma_f32_16x16x32_bf16 v[20:23], v[204:207], v[244:247], v[20:23]
    v_mul_f32 v0, v0, v230
    v_mul_f32 v1, v1, v230
    v_mul_f32 v2, v2, v230
    v_mul_f32 v3, v3, v230
    v_mul_f32 v4, v4, v230
    v_mul_f32 v5, v5, v230
    v_mfma_f32_16x16x32_bf16 v[28:31], v[204:207], v[248:251], v[28:31]
    v_mul_f32 v6, v6, v230
    v_mul_f32 v7, v7, v230
    v_cvt_pk_bf16_f32 v0, v0, v1
    v_cvt_pk_bf16_f32 v1, v2, v3
    v_cvt_pk_bf16_f32 v2, v4, v5
    v_cvt_pk_bf16_f32 v3, v6, v7
    v_mfma_f32_16x16x32_bf16 v[32:35], v[208:211], v[244:247], v[32:35]
    buffer_store_dwordx4 v[0:3], v240, s[56:59], s96 offen offset:0 sc1
    v_mul_f32 v8, v8, v231
    v_mul_f32 v9, v9, v231
    v_mul_f32 v10, v10, v231
    v_mul_f32 v11, v11, v231
    v_mul_f32 v12, v12, v231
    v_mfma_f32_16x16x32_bf16 v[40:43], v[208:211], v[248:251], v[40:43]
    v_mul_f32 v13, v13, v231
    v_mul_f32 v14, v14, v231
    v_mul_f32 v15, v15, v231
    v_cvt_pk_bf16_f32 v8, v8, v9
    v_cvt_pk_bf16_f32 v9, v10, v11
    v_cvt_pk_bf16_f32 v10, v12, v13
    v_mfma_f32_16x16x32_bf16 v[36:39], v[212:215], v[244:247], v[36:39]
    v_cvt_pk_bf16_f32 v11, v14, v15
    buffer_store_dwordx4 v[8:11], v240, s[56:59], s96 offen offset:1024 sc1
    v_mul_f32 v16, v16, v230
    v_mul_f32 v17, v17, v230
    v_mul_f32 v18, v18, v230
    v_mul_f32 v19, v19, v230
    v_mfma_f32_16x16x32_bf16 v[44:47], v[212:215], v[248:251], v[44:47]
    v_mul_f32 v20, v20, v230
    v_mul_f32 v21, v21, v230
    v_mul_f32 v22, v22, v230
    v_mul_f32 v23, v23, v230
    v_cvt_pk_bf16_f32 v16, v16, v17
    v_cvt_pk_bf16_f32 v17, v18, v19
    v_mfma_f32_16x16x32_bf16 v[48:51], v[216:219], v[244:247], v[48:51]
    v_cvt_pk_bf16_f32 v18, v20, v21
    v_cvt_pk_bf16_f32 v19, v22, v23
    buffer_store_dwordx4 v[16:19], v239, s[56:59], s96 offen offset:0 sc1
    v_mul_f32 v24, v24, v231
    v_mul_f32 v25, v25, v231
    v_mul_f32 v26, v26, v231
    v_mfma_f32_16x16x32_bf16 v[56:59], v[216:219], v[248:251], v[56:59]
    v_mul_f32 v27, v27, v231
    v_mul_f32 v28, v28, v231
    v_mul_f32 v29, v29, v231
    v_mul_f32 v30, v30, v231
    v_mul_f32 v31, v31, v231
    v_cvt_pk_bf16_f32 v24, v24, v25
    v_mfma_f32_16x16x32_bf16 v[52:55], v[220:223], v[244:247], v[52:55]
    v_cvt_pk_bf16_f32 v25, v26, v27
    v_cvt_pk_bf16_f32 v26, v28, v29
    v_cvt_pk_bf16_f32 v27, v30, v31
    buffer_store_dwordx4 v[24:27], v239, s[56:59], s96 offen offset:1024 sc1
    v_mul_f32 v32, v32, v230
    v_mul_f32 v33, v33, v230
    v_mfma_f32_16x16x32_bf16 v[60:63], v[220:223], v[248:251], v[60:63]
    v_mul_f32 v34, v34, v230
    v_mul_f32 v35, v35, v230
    v_mul_f32 v36, v36, v230
    v_mul_f32 v37, v37, v230
    v_mul_f32 v38, v38, v230
    v_mul_f32 v39, v39, v230
    v_cvt_pk_bf16_f32 v32, v32, v33
    v_cvt_pk_bf16_f32 v33, v34, v35
    v_cvt_pk_bf16_f32 v34, v36, v37
    v_cvt_pk_bf16_f32 v35, v38, v39
    buffer_store_dwordx4 v[32:35], v240, s[56:59], s98 offen offset:0 sc1
    v_mul_f32 v40, v40, v231
    v_mul_f32 v41, v41, v231
    v_mul_f32 v42, v42, v231
    v_mul_f32 v43, v43, v231
    v_mul_f32 v44, v44, v231
    v_mul_f32 v45, v45, v231
    v_mul_f32 v46, v46, v231
    v_mul_f32 v47, v47, v231
    v_cvt_pk_bf16_f32 v40, v40, v41
    v_cvt_pk_bf16_f32 v41, v42, v43
    v_cvt_pk_bf16_f32 v42, v44, v45
    v_cvt_pk_bf16_f32 v43, v46, v47
    buffer_store_dwordx4 v[40:43], v240, s[56:59], s98 offen offset:1024 sc1
    v_mul_f32 v48, v48, v230
    v_mul_f32 v49, v49, v230
    v_mul_f32 v50, v50, v230
    v_mul_f32 v51, v51, v230
    v_mul_f32 v52, v52, v230
    v_mul_f32 v53, v53, v230
    v_mul_f32 v54, v54, v230
    v_mul_f32 v55, v55, v230
    v_cvt_pk_bf16_f32 v48, v48, v49
    v_cvt_pk_bf16_f32 v49, v50, v51
    v_cvt_pk_bf16_f32 v50, v52, v53
    v_cvt_pk_bf16_f32 v51, v54, v55
    buffer_store_dwordx4 v[48:51], v239, s[56:59], s98 offen offset:0 sc1
    v_mul_f32 v56, v56, v231
    v_mul_f32 v57, v57, v231
    v_mul_f32 v58, v58, v231
    v_mul_f32 v59, v59, v231
    v_mul_f32 v60, v60, v231
    v_mul_f32 v61, v61, v231
    v_mul_f32 v62, v62, v231
    v_mul_f32 v63, v63, v231
    v_cvt_pk_bf16_f32 v56, v56, v57
    v_cvt_pk_bf16_f32 v57, v58, v59
    v_cvt_pk_bf16_f32 v58, v60, v61
    v_cvt_pk_bf16_f32 v59, v62, v63
    buffer_store_dwordx4 v[56:59], v239, s[56:59], s98 offen offset:1024 sc1
    s_add_u32 s36, s28, 62914560
    s_addc_u32 s37, s29, 0
    s_mov_b32 s38, 7454720
    s_mov_b32 s39, 0x20000
    s_bfe_u32 s77, s2, 0x10001
    s_lshl_b32 s77, s77, 3
    s_add_u32 s77, s77, s73
    s_bitcmp0_b32 s2, 0
    s_cselect_b32 s78, 16, 0
    s_add_u32 s77, s77, s78
    s_and_b32 s78, s2, 4
    s_bfe_u32 s79, s2, 0x20003
    s_add_u32 s78, s78, s79
    s_lshr_b32 s16, s77, 1
    s_sub_u32 s35, 15, s16
    s_min_u32 s35, s35, s16
    s_lshl_b32 s35, s35, 2
    s_add_u32 s35, s35, s76
    s_lshl_b32 s35, s35, 8
    s_and_b32 s79, s77, 1
    s_add_u32 s35, s35, s79
    s_lshl_b32 s35, s35, 3
    s_add_u32 s35, s35, 4096
    s_cmp_ge_u32 s16, 8
    s_cselect_b32 s34, 2, 1
    s_mul_i32 s15, s76, 163840
    s_mul_i32 s78, s78, 931840
    s_add_u32 s15, s15, s78
    s_and_b32 s16, s2, 7
    s_mul_i32 s33, s16, 20480
    s_add_u32 s33, s33, s15
    s_mul_i32 s14, s77, 745472
    s_lshl_b32 s78, s76, 17
    s_add_u32 s14, s14, s78
    s_lshl_b32 s32, s16, 14
    s_add_u32 s32, s32, s14
    s_lshl_b32 s13, 1, s16
    v_cmp_gt_u32 vcc, 0x80, v240
    v_lshlrev_b32 v232, 4, v240
    s_nop 0
    v_cndmask_b32 v232, 0x40000000, v232, vcc
    buffer_load_dwordx2 v[230:231], v232, s[52:55], s35 offen sc1
    v_add_u32 v239, 4096, v240
    buffer_load_dwordx4 v[96:99], v240, s[36:39], s33 offen offset:0 sc1
    buffer_load_dwordx4 v[100:103], v240, s[36:39], s33 offen offset:1024 sc1
    buffer_load_dwordx4 v[104:107], v240, s[36:39], s33 offen offset:2048 sc1
    buffer_load_dwordx4 v[108:111], v240, s[36:39], s33 offen offset:3072 sc1
    buffer_load_dwordx4 v[112:115], v239, s[36:39], s33 offen sc1
    s_add_u32 s33, s33, 5120
    buffer_load_dwordx4 v[168:171], v240, s[36:39], s33 offen offset:0 sc1
    buffer_load_dwordx4 v[172:175], v240, s[36:39], s33 offen offset:1024 sc1
    buffer_load_dwordx4 v[176:179], v240, s[36:39], s33 offen offset:2048 sc1
    buffer_load_dwordx4 v[180:183], v240, s[36:39], s33 offen offset:3072 sc1
    buffer_load_dwordx4 v[184:187], v239, s[36:39], s33 offen sc1
    s_add_u32 s33, s33, 5120
    buffer_load_dwordx4 v[132:135], v240, s[36:39], s33 offen offset:0 sc1
    buffer_load_dwordx4 v[136:139], v240, s[36:39], s33 offen offset:1024 sc1
    buffer_load_dwordx4 v[140:143], v240, s[36:39], s33 offen offset:2048 sc1
    buffer_load_dwordx4 v[144:147], v240, s[36:39], s33 offen offset:3072 sc1
    buffer_load_dwordx4 v[148:151], v239, s[36:39], s33 offen sc1
    s_add_u32 s33, s33, 5120
    buffer_load_dwordx4 v[204:207], v240, s[36:39], s33 offen offset:0 sc1
    buffer_load_dwordx4 v[208:211], v240, s[36:39], s33 offen offset:1024 sc1
    buffer_load_dwordx4 v[212:215], v240, s[36:39], s33 offen offset:2048 sc1
    buffer_load_dwordx4 v[216:219], v240, s[36:39], s33 offen offset:3072 sc1
    buffer_load_dwordx4 v[220:223], v239, s[36:39], s33 offen sc1
    s_add_u32 s33, s33, 5120
    v_add_u32 v224, 0, v240
    v_add_u32 v225, 1024, v240
    v_add_u32 v226, 2048, v240
    v_add_u32 v227, 3072, v240
    s_mul_i32 s77, s76, 20480
    s_add_u32 s77, s77, 81920
    v_add_u32 v229, s77, v240
    v_mov_b32 v243, 2
    s_waitcnt vmcnt(21)
    buffer_store_dword v243, v242, s[52:55], s12 offen sc1
    s_setprio 0
    v_mov_b32 v0, 0
    v_mov_b32 v1, 0
    v_mov_b32 v2, 0
    v_mov_b32 v3, 0
    v_mov_b32 v4, 0
    v_mov_b32 v5, 0
    v_mov_b32 v6, 0
    v_mov_b32 v7, 0
    v_mov_b32 v8, 0
    v_mov_b32 v9, 0
    v_mov_b32 v10, 0
    v_mov_b32 v11, 0
    v_mov_b32 v12, 0
    v_mov_b32 v13, 0
    v_mov_b32 v14, 0
    v_mov_b32 v15, 0
    v_mov_b32 v16, 0
    v_mov_b32 v17, 0
    v_mov_b32 v18, 0
    v_mov_b32 v19, 0
    v_mov_b32 v20, 0
    v_mov_b32 v21, 0
    v_mov_b32 v22, 0
    v_mov_b32 v23, 0
    v_mov_b32 v24, 0
    v_mov_b32 v25, 0
    v_mov_b32 v26, 0
    v_mov_b32 v27, 0
    v_mov_b32 v28, 0
    v_mov_b32 v29, 0
    v_mov_b32 v30, 0
    v_mov_b32 v31, 0
    v_mov_b32 v32, 0
    v_mov_b32 v33, 0
    v_mov_b32 v34, 0
    v_mov_b32 v35, 0
    v_mov_b32 v36, 0
    v_mov_b32 v37, 0
    v_mov_b32 v38, 0
    v_mov_b32 v39, 0
    v_mov_b32 v40, 0
    v_mov_b32 v41, 0
    v_mov_b32 v42, 0
    v_mov_b32 v43, 0
    v_mov_b32 v44, 0
    v_mov_b32 v45, 0
    v_mov_b32 v46, 0
    v_mov_b32 v47, 0
    v_mov_b32 v48, 0
    v_mov_b32 v49, 0
    v_mov_b32 v50, 0
    v_mov_b32 v51, 0
    v_mov_b32 v52, 0
    v_mov_b32 v53, 0
    v_mov_b32 v54, 0
    v_mov_b32 v55, 0
    v_mov_b32 v56, 0
    v_mov_b32 v57, 0
    v_mov_b32 v58, 0
    v_mov_b32 v59, 0
    v_mov_b32 v60, 0
    v_mov_b32 v61, 0
    v_mov_b32 v62, 0
    v_mov_b32 v63, 0
    v_mov_b32 v64, 0
    v_mov_b32 v65, 0
    v_mov_b32 v66, 0
    v_mov_b32 v67, 0
    v_mov_b32 v68, 0
    v_mov_b32 v69, 0
    v_mov_b32 v70, 0
    v_mov_b32 v71, 0
    v_mov_b32 v72, 0
    v_mov_b32 v73, 0
    v_mov_b32 v74, 0
    v_mov_b32 v75, 0
    v_mov_b32 v76, 0
    v_mov_b32 v77, 0
    v_mov_b32 v78, 0
    v_mov_b32 v79, 0
    s_waitcnt vmcnt(21)
    v_min_u32 v230, v230, v231
    v_cmp_le_u32 vcc, s34, v230
    s_and_b32 s77, vcc_lo, s13
    s_cbranch_scc1 KB_XP_OK
    s_mov_b32 s30, 100000
KB_XP_SPIN:
    s_sleep 6
    buffer_load_dwordx2 v[230:231], v232, s[52:55], s35 offen sc1
    s_waitcnt vmcnt(0)
    v_min_u32 v230, v230, v231
    v_cmp_le_u32 vcc, s34, v230
    s_and_b32 s77, vcc_lo, s13
    s_cbranch_scc1 KB_XP_OK
    s_sub_u32 s30, s30, 1
    s_cbranch_scc0 KB_XP_SPIN
    s_mov_b32 s77, s13
KB_XP_OK:
    s_xor_b32 s13, s13, 0xff
    buffer_load_dwordx4 v[80:83], v224, s[56:59], s32 offen sc1
    buffer_load_dwordx4 v[84:87], v225, s[56:59], s32 offen sc1
    buffer_load_dwordx4 v[88:91], v226, s[56:59], s32 offen sc1
    buffer_load_dwordx4 v[92:95], v227, s[56:59], s32 offen sc1
    s_add_u32 s32, s32, 4096
    buffer_load_dwordx2 v[230:231], v232, s[52:55], s35 offen sc1
    buffer_load_dwordx4 v[152:155], v224, s[56:59], s32 offen sc1
    buffer_load_dwordx4 v[156:159], v225, s[56:59], s32 offen sc1
    buffer_load_dwordx4 v[160:163], v226, s[56:59], s32 offen sc1
    buffer_load_dwordx4 v[164:167], v227, s[56:59], s32 offen sc1
    s_add_u32 s32, s32, 4096
    buffer_load_dwordx4 v[116:119], v224, s[56:59], s32 offen sc1
    buffer_load_dwordx4 v[120:123], v225, s[56:59], s32 offen sc1
    buffer_load_dwordx4 v[124:127], v226, s[56:59], s32 offen sc1
    buffer_load_dwordx4 v[128:131], v227, s[56:59], s32 offen sc1
    s_add_u32 s32, s32, 4096
    buffer_load_dwordx4 v[188:191], v224, s[56:59], s32 offen sc1
    buffer_load_dwordx4 v[192:195], v225, s[56:59], s32 offen sc1
    buffer_load_dwordx4 v[196:199], v226, s[56:59], s32 offen sc1
    buffer_load_dwordx4 v[200:203], v227, s[56:59], s32 offen sc1
    s_add_u32 s32, s32, 4096
    s_waitcnt vmcnt(12)
    v_min_u32 v230, v230, v231
    v_cmp_le_u32 vcc, s34, v230
    s_and_b32 s77, vcc_lo, s13
    s_cbranch_scc1 KB_XR_OK
    s_mov_b32 s30, 100000
KB_XR_SPIN:
    s_sleep 6
    buffer_load_dwordx2 v[230:231], v232, s[52:55], s35 offen sc1
    s_waitcnt vmcnt(0)
    v_min_u32 v230, v230, v231
    v_cmp_le_u32 vcc, s34, v230
    s_and_b32 s77, vcc_lo, s13
    s_cbranch_scc1 KB_XR_OK
    s_sub_u32 s30, s30, 1
    s_cbranch_scc0 KB_XR_SPIN
    s_mov_b32 s77, s13
KB_XR_OK:
    s_ff1_i32_b32 s16, s77
    s_bitset0_b32 s13, s16
    s_lshl_b32 s32, s16, 14
    s_add_u32 s32, s32, s14
    s_mul_i32 s33, s16, 20480
    s_add_u32 s33, s33, s15
    s_waitcnt vmcnt(13)
    v_mfma_f32_16x16x32_bf16 v[0:3], v[96:99], v[80:83], v[0:3]
    v_mfma_f32_16x16x32_bf16 v[20:23], v[96:99], v[84:87], v[20:23]
    v_mfma_f32_16x16x32_bf16 v[40:43], v[96:99], v[88:91], v[40:43]
    v_mfma_f32_16x16x32_bf16 v[60:63], v[96:99], v[92:95], v[60:63]
    buffer_load_dwordx4 v[96:99], v240, s[36:39], s33 offen offset:0 sc1
    v_mfma_f32_16x16x32_bf16 v[4:7], v[100:103], v[80:83], v[4:7]
    v_mfma_f32_16x16x32_bf16 v[24:27], v[100:103], v[84:87], v[24:27]
    v_mfma_f32_16x16x32_bf16 v[44:47], v[100:103], v[88:91], v[44:47]
    v_mfma_f32_16x16x32_bf16 v[64:67], v[100:103], v[92:95], v[64:67]
    buffer_load_dwordx4 v[100:103], v240, s[36:39], s33 offen offset:1024 sc1
    v_mfma_f32_16x16x32_bf16 v[8:11], v[104:107], v[80:83], v[8:11]
    v_mfma_f32_16x16x32_bf16 v[28:31], v[104:107], v[84:87], v[28:31]
    v_mfma_f32_16x16x32_bf16 v[48:51], v[104:107], v[88:91], v[48:51]
    v_mfma_f32_16x16x32_bf16 v[68:71], v[104:107], v[92:95], v[68:71]
    buffer_load_dwordx4 v[104:107], v240, s[36:39], s33 offen offset:2048 sc1
    v_mfma_f32_16x16x32_bf16 v[12:15], v[108:111], v[80:83], v[12:15]
    v_mfma_f32_16x16x32_bf16 v[32:35], v[108:111], v[84:87], v[32:35]
    v_mfma_f32_16x16x32_bf16 v[52:55], v[108:111], v[88:91], v[52:55]
    v_mfma_f32_16x16x32_bf16 v[72:75], v[108:111], v[92:95], v[72:75]
    buffer_load_dwordx4 v[108:111], v240, s[36:39], s33 offen offset:3072 sc1
    v_mfma_f32_16x16x32_bf16 v[16:19], v[112:115], v[80:83], v[16:19]
    v_mfma_f32_16x16x32_bf16 v[36:39], v[112:115], v[84:87], v[36:39]
    v_mfma_f32_16x16x32_bf16 v[56:59], v[112:115], v[88:91], v[56:59]
    v_mfma_f32_16x16x32_bf16 v[76:79], v[112:115], v[92:95], v[76:79]
    buffer_load_dwordx4 v[112:115], v239, s[36:39], s33 offen sc1
    buffer_load_dwordx4 v[80:83], v224, s[56:59], s32 offen sc1
    buffer_load_dwordx4 v[84:87], v225, s[56:59], s32 offen sc1
    buffer_load_dwordx4 v[88:91], v226, s[56:59], s32 offen sc1
    buffer_load_dwordx4 v[92:95], v227, s[56:59], s32 offen sc1
    s_add_u32 s32, s32, 4096
    s_add_u32 s33, s33, 5120
    buffer_load_dwordx2 v[230:231], v232, s[52:55], s35 offen sc1
    s_waitcnt vmcnt(18)
    v_mfma_f32_16x16x32_bf16 v[0:3], v[168:171], v[152:155], v[0:3]
    v_mfma_f32_16x16x32_bf16 v[20:23], v[168:171], v[156:159], v[20:23]
    v_mfma_f32_16x16x32_bf16 v[40:43], v[168:171], v[160:163], v[40:43]
    v_mfma_f32_16x16x32_bf16 v[60:63], v[168:171], v[164:167], v[60:63]
    buffer_load_dwordx4 v[168:171], v240, s[36:39], s33 offen offset:0 sc1
    v_mfma_f32_16x16x32_bf16 v[4:7], v[172:175], v[152:155], v[4:7]
    v_mfma_f32_16x16x32_bf16 v[24:27], v[172:175], v[156:159], v[24:27]
    v_mfma_f32_16x16x32_bf16 v[44:47], v[172:175], v[160:163], v[44:47]
    v_mfma_f32_16x16x32_bf16 v[64:67], v[172:175], v[164:167], v[64:67]
    buffer_load_dwordx4 v[172:175], v240, s[36:39], s33 offen offset:1024 sc1
    v_mfma_f32_16x16x32_bf16 v[8:11], v[176:179], v[152:155], v[8:11]
    v_mfma_f32_16x16x32_bf16 v[28:31], v[176:179], v[156:159], v[28:31]
    v_mfma_f32_16x16x32_bf16 v[48:51], v[176:179], v[160:163], v[48:51]
    v_mfma_f32_16x16x32_bf16 v[68:71], v[176:179], v[164:167], v[68:71]
    buffer_load_dwordx4 v[176:179], v240, s[36:39], s33 offen offset:2048 sc1
    v_mfma_f32_16x16x32_bf16 v[12:15], v[180:183], v[152:155], v[12:15]
    v_mfma_f32_16x16x32_bf16 v[32:35], v[180:183], v[156:159], v[32:35]
    v_mfma_f32_16x16x32_bf16 v[52:55], v[180:183], v[160:163], v[52:55]
    v_mfma_f32_16x16x32_bf16 v[72:75], v[180:183], v[164:167], v[72:75]
    buffer_load_dwordx4 v[180:183], v240, s[36:39], s33 offen offset:3072 sc1
    v_mfma_f32_16x16x32_bf16 v[16:19], v[184:187], v[152:155], v[16:19]
    v_mfma_f32_16x16x32_bf16 v[36:39], v[184:187], v[156:159], v[36:39]
    v_mfma_f32_16x16x32_bf16 v[56:59], v[184:187], v[160:163], v[56:59]
    v_mfma_f32_16x16x32_bf16 v[76:79], v[184:187], v[164:167], v[76:79]
    buffer_load_dwordx4 v[184:187], v239, s[36:39], s33 offen sc1
    buffer_load_dwordx4 v[152:155], v224, s[56:59], s32 offen sc1
    buffer_load_dwordx4 v[156:159], v225, s[56:59], s32 offen sc1
    buffer_load_dwordx4 v[160:163], v226, s[56:59], s32 offen sc1
    buffer_load_dwordx4 v[164:167], v227, s[56:59], s32 offen sc1
    s_add_u32 s32, s32, 4096
    s_add_u32 s33, s33, 5120
    s_waitcnt vmcnt(23)
    v_mfma_f32_16x16x32_bf16 v[0:3], v[132:135], v[116:119], v[0:3]
    v_mfma_f32_16x16x32_bf16 v[20:23], v[132:135], v[120:123], v[20:23]
    v_mfma_f32_16x16x32_bf16 v[40:43], v[132:135], v[124:127], v[40:43]
    v_mfma_f32_16x16x32_bf16 v[60:63], v[132:135], v[128:131], v[60:63]
    buffer_load_dwordx4 v[132:135], v240, s[36:39], s33 offen offset:0 sc1
    v_mfma_f32_16x16x32_bf16 v[4:7], v[136:139], v[116:119], v[4:7]
    v_mfma_f32_16x16x32_bf16 v[24:27], v[136:139], v[120:123], v[24:27]
    v_mfma_f32_16x16x32_bf16 v[44:47], v[136:139], v[124:127], v[44:47]
    v_mfma_f32_16x16x32_bf16 v[64:67], v[136:139], v[128:131], v[64:67]
    buffer_load_dwordx4 v[136:139], v240, s[36:39], s33 offen offset:1024 sc1
    v_mfma_f32_16x16x32_bf16 v[8:11], v[140:143], v[116:119], v[8:11]
    v_mfma_f32_16x16x32_bf16 v[28:31], v[140:143], v[120:123], v[28:31]
    v_mfma_f32_16x16x32_bf16 v[48:51], v[140:143], v[124:127], v[48:51]
    v_mfma_f32_16x16x32_bf16 v[68:71], v[140:143], v[128:131], v[68:71]
    buffer_load_dwordx4 v[140:143], v240, s[36:39], s33 offen offset:2048 sc1
    v_mfma_f32_16x16x32_bf16 v[12:15], v[144:147], v[116:119], v[12:15]
    v_mfma_f32_16x16x32_bf16 v[32:35], v[144:147], v[120:123], v[32:35]
    v_mfma_f32_16x16x32_bf16 v[52:55], v[144:147], v[124:127], v[52:55]
    v_mfma_f32_16x16x32_bf16 v[72:75], v[144:147], v[128:131], v[72:75]
    buffer_load_dwordx4 v[144:147], v240, s[36:39], s33 offen offset:3072 sc1
    v_mfma_f32_16x16x32_bf16 v[16:19], v[148:151], v[116:119], v[16:19]
    v_mfma_f32_16x16x32_bf16 v[36:39], v[148:151], v[120:123], v[36:39]
    v_mfma_f32_16x16x32_bf16 v[56:59], v[148:151], v[124:127], v[56:59]
    v_mfma_f32_16x16x32_bf16 v[76:79], v[148:151], v[128:131], v[76:79]
    buffer_load_dwordx4 v[148:151], v239, s[36:39], s33 offen sc1
    buffer_load_dwordx4 v[116:119], v224, s[56:59], s32 offen sc1
    buffer_load_dwordx4 v[120:123], v225, s[56:59], s32 offen sc1
    buffer_load_dwordx4 v[124:127], v226, s[56:59], s32 offen sc1
    buffer_load_dwordx4 v[128:131], v227, s[56:59], s32 offen sc1
    s_add_u32 s32, s32, 4096
    s_add_u32 s33, s33, 5120
    s_waitcnt vmcnt(28)
    v_mfma_f32_16x16x32_bf16 v[0:3], v[204:207], v[188:191], v[0:3]
    v_mfma_f32_16x16x32_bf16 v[20:23], v[204:207], v[192:195], v[20:23]
    v_mfma_f32_16x16x32_bf16 v[40:43], v[204:207], v[196:199], v[40:43]
    v_mfma_f32_16x16x32_bf16 v[60:63], v[204:207], v[200:203], v[60:63]
    buffer_load_dwordx4 v[204:207], v240, s[36:39], s33 offen offset:0 sc1
    v_mfma_f32_16x16x32_bf16 v[4:7], v[208:211], v[188:191], v[4:7]
    v_mfma_f32_16x16x32_bf16 v[24:27], v[208:211], v[192:195], v[24:27]
    v_mfma_f32_16x16x32_bf16 v[44:47], v[208:211], v[196:199], v[44:47]
    v_mfma_f32_16x16x32_bf16 v[64:67], v[208:211], v[200:203], v[64:67]
    buffer_load_dwordx4 v[208:211], v240, s[36:39], s33 offen offset:1024 sc1
    v_mfma_f32_16x16x32_bf16 v[8:11], v[212:215], v[188:191], v[8:11]
    v_mfma_f32_16x16x32_bf16 v[28:31], v[212:215], v[192:195], v[28:31]
    v_mfma_f32_16x16x32_bf16 v[48:51], v[212:215], v[196:199], v[48:51]
    v_mfma_f32_16x16x32_bf16 v[68:71], v[212:215], v[200:203], v[68:71]
    buffer_load_dwordx4 v[212:215], v240, s[36:39], s33 offen offset:2048 sc1
    v_mfma_f32_16x16x32_bf16 v[12:15], v[216:219], v[188:191], v[12:15]
    v_mfma_f32_16x16x32_bf16 v[32:35], v[216:219], v[192:195], v[32:35]
    v_mfma_f32_16x16x32_bf16 v[52:55], v[216:219], v[196:199], v[52:55]
    v_mfma_f32_16x16x32_bf16 v[72:75], v[216:219], v[200:203], v[72:75]
    buffer_load_dwordx4 v[216:219], v240, s[36:39], s33 offen offset:3072 sc1
    v_mfma_f32_16x16x32_bf16 v[16:19], v[220:223], v[188:191], v[16:19]
    v_mfma_f32_16x16x32_bf16 v[36:39], v[220:223], v[192:195], v[36:39]
    v_mfma_f32_16x16x32_bf16 v[56:59], v[220:223], v[196:199], v[56:59]
    v_mfma_f32_16x16x32_bf16 v[76:79], v[220:223], v[200:203], v[76:79]
    buffer_load_dwordx4 v[220:223], v239, s[36:39], s33 offen sc1
    buffer_load_dwordx4 v[188:191], v224, s[56:59], s32 offen sc1
    buffer_load_dwordx4 v[192:195], v225, s[56:59], s32 offen sc1
    buffer_load_dwordx4 v[196:199], v226, s[56:59], s32 offen sc1
    buffer_load_dwordx4 v[200:203], v227, s[56:59], s32 offen sc1
    s_add_u32 s32, s32, 4096
    s_add_u32 s33, s33, 5120
    s_mov_b32 s79, 5
KB_XLOOP:
    s_waitcnt vmcnt(27)
    v_min_u32 v230, v230, v231
    v_cmp_le_u32 vcc, s34, v230
    s_and_b32 s77, vcc_lo, s13
    s_cbranch_scc1 KB_XS_OK
    s_mov_b32 s30, 100000
KB_XS_SPIN:
    s_sleep 6
    buffer_load_dwordx2 v[230:231], v232, s[52:55], s35 offen sc1
    s_waitcnt vmcnt(0)
    v_min_u32 v230, v230, v231
    v_cmp_le_u32 vcc, s34, v230
    s_and_b32 s77, vcc_lo, s13
    s_cbranch_scc1 KB_XS_OK
    s_sub_u32 s30, s30, 1
    s_cbranch_scc0 KB_XS_SPIN
    s_mov_b32 s77, s13
KB_XS_OK:
    s_ff1_i32_b32 s16, s77
    s_bitset0_b32 s13, s16
    s_lshl_b32 s32, s16, 14
    s_add_u32 s32, s32, s14
    s_mul_i32 s33, s16, 20480
    s_add_u32 s33, s33, s15
    s_waitcnt vmcnt(28)
    v_mfma_f32_16x16x32_bf16 v[0:3], v[96:99], v[80:83], v[0:3]
    v_mfma_f32_16x16x32_bf16 v[20:23], v[96:99], v[84:87], v[20:23]
    v_mfma_f32_16x16x32_bf16 v[40:43], v[96:99], v[88:91], v[40:43]
    v_mfma_f32_16x16x32_bf16 v[60:63], v[96:99], v[92:95], v[60:63]
    buffer_load_dwordx4 v[96:99], v240, s[36:39], s33 offen offset:0 sc1
    v_mfma_f32_16x16x32_bf16 v[4:7], v[100:103], v[80:83], v[4:7]
    v_mfma_f32_16x16x32_bf16 v[24:27], v[100:103], v[84:87], v[24:27]
    v_mfma_f32_16x16x32_bf16 v[44:47], v[100:103], v[88:91], v[44:47]
    v_mfma_f32_16x16x32_bf16 v[64:67], v[100:103], v[92:95], v[64:67]
    buffer_load_dwordx4 v[100:103], v240, s[36:39], s33 offen offset:1024 sc1
    v_mfma_f32_16x16x32_bf16 v[8:11], v[104:107], v[80:83], v[8:11]
    v_mfma_f32_16x16x32_bf16 v[28:31], v[104:107], v[84:87], v[28:31]
    v_mfma_f32_16x16x32_bf16 v[48:51], v[104:107], v[88:91], v[48:51]
    v_mfma_f32_16x16x32_bf16 v[68:71], v[104:107], v[92:95], v[68:71]
    buffer_load_dwordx4 v[104:107], v240, s[36:39], s33 offen offset:2048 sc1
    v_mfma_f32_16x16x32_bf16 v[12:15], v[108:111], v[80:83], v[12:15]
    v_mfma_f32_16x16x32_bf16 v[32:35], v[108:111], v[84:87], v[32:35]
    v_mfma_f32_16x16x32_bf16 v[52:55], v[108:111], v[88:91], v[52:55]
    v_mfma_f32_16x16x32_bf16 v[72:75], v[108:111], v[92:95], v[72:75]
    buffer_load_dwordx4 v[108:111], v240, s[36:39], s33 offen offset:3072 sc1
    v_mfma_f32_16x16x32_bf16 v[16:19], v[112:115], v[80:83], v[16:19]
    v_mfma_f32_16x16x32_bf16 v[36:39], v[112:115], v[84:87], v[36:39]
    v_mfma_f32_16x16x32_bf16 v[56:59], v[112:115], v[88:91], v[56:59]
    v_mfma_f32_16x16x32_bf16 v[76:79], v[112:115], v[92:95], v[76:79]
    buffer_load_dwordx4 v[112:115], v239, s[36:39], s33 offen sc1
    buffer_load_dwordx4 v[80:83], v224, s[56:59], s32 offen sc1
    buffer_load_dwordx4 v[84:87], v225, s[56:59], s32 offen sc1
    buffer_load_dwordx4 v[88:91], v226, s[56:59], s32 offen sc1
    buffer_load_dwordx4 v[92:95], v227, s[56:59], s32 offen sc1
    s_add_u32 s32, s32, 4096
    s_add_u32 s33, s33, 5120
    buffer_load_dwordx2 v[230:231], v232, s[52:55], s35 offen sc1
    s_waitcnt vmcnt(28)
    v_mfma_f32_16x16x32_bf16 v[0:3], v[168:171], v[152:155], v[0:3]
    v_mfma_f32_16x16x32_bf16 v[20:23], v[168:171], v[156:159], v[20:23]
    v_mfma_f32_16x16x32_bf16 v[40:43], v[168:171], v[160:163], v[40:43]
    v_mfma_f32_16x16x32_bf16 v[60:63], v[168:171], v[164:167], v[60:63]
    buffer_load_dwordx4 v[168:171], v240, s[36:39], s33 offen offset:0 sc1
    v_mfma_f32_16x16x32_bf16 v[4:7], v[172:175], v[152:155], v[4:7]
    v_mfma_f32_16x16x32_bf16 v[24:27], v[172:175], v[156:159], v[24:27]
    v_mfma_f32_16x16x32_bf16 v[44:47], v[172:175], v[160:163], v[44:47]
    v_mfma_f32_16x16x32_bf16 v[64:67], v[172:175], v[164:167], v[64:67]
    buffer_load_dwordx4 v[172:175], v240, s[36:39], s33 offen offset:1024 sc1
    v_mfma_f32_16x16x32_bf16 v[8:11], v[176:179], v[152:155], v[8:11]
    v_mfma_f32_16x16x32_bf16 v[28:31], v[176:179], v[156:159], v[28:31]
    v_mfma_f32_16x16x32_bf16 v[48:51], v[176:179], v[160:163], v[48:51]
    v_mfma_f32_16x16x32_bf16 v[68:71], v[176:179], v[164:167], v[68:71]
    buffer_load_dwordx4 v[176:179], v240, s[36:39], s33 offen offset:2048 sc1
    v_mfma_f32_16x16x32_bf16 v[12:15], v[180:183], v[152:155], v[12:15]
    v_mfma_f32_16x16x32_bf16 v[32:35], v[180:183], v[156:159], v[32:35]
    v_mfma_f32_16x16x32_bf16 v[52:55], v[180:183], v[160:163], v[52:55]
    v_mfma_f32_16x16x32_bf16 v[72:75], v[180:183], v[164:167], v[72:75]
    buffer_load_dwordx4 v[180:183], v240, s[36:39], s33 offen offset:3072 sc1
    v_mfma_f32_16x16x32_bf16 v[16:19], v[184:187], v[152:155], v[16:19]
    v_mfma_f32_16x16x32_bf16 v[36:39], v[184:187], v[156:159], v[36:39]
    v_mfma_f32_16x16x32_bf16 v[56:59], v[184:187], v[160:163], v[56:59]
    v_mfma_f32_16x16x32_bf16 v[76:79], v[184:187], v[164:167], v[76:79]
    buffer_load_dwordx4 v[184:187], v239, s[36:39], s33 offen sc1
    buffer_load_dwordx4 v[152:155], v224, s[56:59], s32 offen sc1
    buffer_load_dwordx4 v[156:159], v225, s[56:59], s32 offen sc1
    buffer_load_dwordx4 v[160:163], v226, s[56:59], s32 offen sc1
    buffer_load_dwordx4 v[164:167], v227, s[56:59], s32 offen sc1
    s_add_u32 s32, s32, 4096
    s_add_u32 s33, s33, 5120
    s_waitcnt vmcnt(28)
    v_mfma_f32_16x16x32_bf16 v[0:3], v[132:135], v[116:119], v[0:3]
    v_mfma_f32_16x16x32_bf16 v[20:23], v[132:135], v[120:123], v[20:23]
    v_mfma_f32_16x16x32_bf16 v[40:43], v[132:135], v[124:127], v[40:43]
    v_mfma_f32_16x16x32_bf16 v[60:63], v[132:135], v[128:131], v[60:63]
    buffer_load_dwordx4 v[132:135], v240, s[36:39], s33 offen offset:0 sc1
    v_mfma_f32_16x16x32_bf16 v[4:7], v[136:139], v[116:119], v[4:7]
    v_mfma_f32_16x16x32_bf16 v[24:27], v[136:139], v[120:123], v[24:27]
    v_mfma_f32_16x16x32_bf16 v[44:47], v[136:139], v[124:127], v[44:47]
    v_mfma_f32_16x16x32_bf16 v[64:67], v[136:139], v[128:131], v[64:67]
    buffer_load_dwordx4 v[136:139], v240, s[36:39], s33 offen offset:1024 sc1
    v_mfma_f32_16x16x32_bf16 v[8:11], v[140:143], v[116:119], v[8:11]
    v_mfma_f32_16x16x32_bf16 v[28:31], v[140:143], v[120:123], v[28:31]
    v_mfma_f32_16x16x32_bf16 v[48:51], v[140:143], v[124:127], v[48:51]
    v_mfma_f32_16x16x32_bf16 v[68:71], v[140:143], v[128:131], v[68:71]
    buffer_load_dwordx4 v[140:143], v240, s[36:39], s33 offen offset:2048 sc1
    v_mfma_f32_16x16x32_bf16 v[12:15], v[144:147], v[116:119], v[12:15]
    v_mfma_f32_16x16x32_bf16 v[32:35], v[144:147], v[120:123], v[32:35]
    v_mfma_f32_16x16x32_bf16 v[52:55], v[144:147], v[124:127], v[52:55]
    v_mfma_f32_16x16x32_bf16 v[72:75], v[144:147], v[128:131], v[72:75]
    buffer_load_dwordx4 v[144:147], v240, s[36:39], s33 offen offset:3072 sc1
    v_mfma_f32_16x16x32_bf16 v[16:19], v[148:151], v[116:119], v[16:19]
    v_mfma_f32_16x16x32_bf16 v[36:39], v[148:151], v[120:123], v[36:39]
    v_mfma_f32_16x16x32_bf16 v[56:59], v[148:151], v[124:127], v[56:59]
    v_mfma_f32_16x16x32_bf16 v[76:79], v[148:151], v[128:131], v[76:79]
    buffer_load_dwordx4 v[148:151], v239, s[36:39], s33 offen sc1
    buffer_load_dwordx4 v[116:119], v224, s[56:59], s32 offen sc1
    buffer_load_dwordx4 v[120:123], v225, s[56:59], s32 offen sc1
    buffer_load_dwordx4 v[124:127], v226, s[56:59], s32 offen sc1
    buffer_load_dwordx4 v[128:131], v227, s[56:59], s32 offen sc1
    s_add_u32 s32, s32, 4096
    s_add_u32 s33, s33, 5120
    s_waitcnt vmcnt(28)
    v_mfma_f32_16x16x32_bf16 v[0:3], v[204:207], v[188:191], v[0:3]
    v_mfma_f32_16x16x32_bf16 v[20:23], v[204:207], v[192:195], v[20:23]
    v_mfma_f32_16x16x32_bf16 v[40:43], v[204:207], v[196:199], v[40:43]
    v_mfma_f32_16x16x32_bf16 v[60:63], v[204:207], v[200:203], v[60:63]
    buffer_load_dwordx4 v[204:207], v240, s[36:39], s33 offen offset:0 sc1
    v_mfma_f32_16x16x32_bf16 v[4:7], v[208:211], v[188:191], v[4:7]
    v_mfma_f32_16x16x32_bf16 v[24:27], v[208:211], v[192:195], v[24:27]
    v_mfma_f32_16x16x32_bf16 v[44:47], v[208:211], v[196:199], v[44:47]
    v_mfma_f32_16x16x32_bf16 v[64:67], v[208:211], v[200:203], v[64:67]
    buffer_load_dwordx4 v[208:211], v240, s[36:39], s33 offen offset:1024 sc1
    v_mfma_f32_16x16x32_bf16 v[8:11], v[212:215], v[188:191], v[8:11]
    v_mfma_f32_16x16x32_bf16 v[28:31], v[212:215], v[192:195], v[28:31]
    v_mfma_f32_16x16x32_bf16 v[48:51], v[212:215], v[196:199], v[48:51]
    v_mfma_f32_16x16x32_bf16 v[68:71], v[212:215], v[200:203], v[68:71]
    buffer_load_dwordx4 v[212:215], v240, s[36:39], s33 offen offset:2048 sc1
    v_mfma_f32_16x16x32_bf16 v[12:15], v[216:219], v[188:191], v[12:15]
    v_mfma_f32_16x16x32_bf16 v[32:35], v[216:219], v[192:195], v[32:35]
    v_mfma_f32_16x16x32_bf16 v[52:55], v[216:219], v[196:199], v[52:55]
    v_mfma_f32_16x16x32_bf16 v[72:75], v[216:219], v[200:203], v[72:75]
    buffer_load_dwordx4 v[216:219], v240, s[36:39], s33 offen offset:3072 sc1
    v_mfma_f32_16x16x32_bf16 v[16:19], v[220:223], v[188:191], v[16:19]
    v_mfma_f32_16x16x32_bf16 v[36:39], v[220:223], v[192:195], v[36:39]
    v_mfma_f32_16x16x32_bf16 v[56:59], v[220:223], v[196:199], v[56:59]
    v_mfma_f32_16x16x32_bf16 v[76:79], v[220:223], v[200:203], v[76:79]
    buffer_load_dwordx4 v[220:223], v239, s[36:39], s33 offen sc1
    buffer_load_dwordx4 v[188:191], v224, s[56:59], s32 offen sc1
    buffer_load_dwordx4 v[192:195], v225, s[56:59], s32 offen sc1
    buffer_load_dwordx4 v[196:199], v226, s[56:59], s32 offen sc1
    buffer_load_dwordx4 v[200:203], v227, s[56:59], s32 offen sc1
    s_add_u32 s32, s32, 4096
    s_add_u32 s33, s33, 5120
    s_cmp_lg_u32 s79, 3
    s_cbranch_scc1 KB_XNB
    s_barrier
KB_XNB:
    s_sub_u32 s79, s79, 1
    s_cbranch_scc0 KB_XLOOP
    s_barrier
    s_waitcnt vmcnt(28)
    v_mfma_f32_16x16x32_bf16 v[0:3], v[96:99], v[80:83], v[0:3]
    v_mfma_f32_16x16x32_bf16 v[20:23], v[96:99], v[84:87], v[20:23]
    v_mfma_f32_16x16x32_bf16 v[40:43], v[96:99], v[88:91], v[40:43]
    v_mfma_f32_16x16x32_bf16 v[60:63], v[96:99], v[92:95], v[60:63]
    v_mfma_f32_16x16x32_bf16 v[4:7], v[100:103], v[80:83], v[4:7]
    v_mfma_f32_16x16x32_bf16 v[24:27], v[100:103], v[84:87], v[24:27]
    v_mfma_f32_16x16x32_bf16 v[44:47], v[100:103], v[88:91], v[44:47]
    v_mfma_f32_16x16x32_bf16 v[64:67], v[100:103], v[92:95], v[64:67]
    v_mfma_f32_16x16x32_bf16 v[8:11], v[104:107], v[80:83], v[8:11]
    v_mfma_f32_16x16x32_bf16 v[28:31], v[104:107], v[84:87], v[28:31]
    v_mfma_f32_16x16x32_bf16 v[48:51], v[104:107], v[88:91], v[48:51]
    v_mfma_f32_16x16x32_bf16 v[68:71], v[104:107], v[92:95], v[68:71]
    v_mfma_f32_16x16x32_bf16 v[12:15], v[108:111], v[80:83], v[12:15]
    v_mfma_f32_16x16x32_bf16 v[32:35], v[108:111], v[84:87], v[32:35]
    v_mfma_f32_16x16x32_bf16 v[52:55], v[108:111], v[88:91], v[52:55]
    v_mfma_f32_16x16x32_bf16 v[72:75], v[108:111], v[92:95], v[72:75]
    v_mfma_f32_16x16x32_bf16 v[16:19], v[112:115], v[80:83], v[16:19]
    v_mfma_f32_16x16x32_bf16 v[36:39], v[112:115], v[84:87], v[36:39]
    v_mfma_f32_16x16x32_bf16 v[56:59], v[112:115], v[88:91], v[56:59]
    v_mfma_f32_16x16x32_bf16 v[76:79], v[112:115], v[92:95], v[76:79]
    s_waitcnt vmcnt(18)
    v_mfma_f32_16x16x32_bf16 v[0:3], v[168:171], v[152:155], v[0:3]
    v_mfma_f32_16x16x32_bf16 v[20:23], v[168:171], v[156:159], v[20:23]
    v_mfma_f32_16x16x32_bf16 v[40:43], v[168:171], v[160:163], v[40:43]
    v_mfma_f32_16x16x32_bf16 v[60:63], v[168:171], v[164:167], v[60:63]
    v_mfma_f32_16x16x32_bf16 v[4:7], v[172:175], v[152:155], v[4:7]
    v_mfma_f32_16x16x32_bf16 v[24:27], v[172:175], v[156:159], v[24:27]
    v_mfma_f32_16x16x32_bf16 v[44:47], v[172:175], v[160:163], v[44:47]
    v_mfma_f32_16x16x32_bf16 v[64:67], v[172:175], v[164:167], v[64:67]
    v_mfma_f32_16x16x32_bf16 v[8:11], v[176:179], v[152:155], v[8:11]
    v_mfma_f32_16x16x32_bf16 v[28:31], v[176:179], v[156:159], v[28:31]
    v_mfma_f32_16x16x32_bf16 v[48:51], v[176:179], v[160:163], v[48:51]
    v_mfma_f32_16x16x32_bf16 v[68:71], v[176:179], v[164:167], v[68:71]
    v_mfma_f32_16x16x32_bf16 v[12:15], v[180:183], v[152:155], v[12:15]
    v_mfma_f32_16x16x32_bf16 v[32:35], v[180:183], v[156:159], v[32:35]
    v_mfma_f32_16x16x32_bf16 v[52:55], v[180:183], v[160:163], v[52:55]
    v_mfma_f32_16x16x32_bf16 v[72:75], v[180:183], v[164:167], v[72:75]
    v_mfma_f32_16x16x32_bf16 v[16:19], v[184:187], v[152:155], v[16:19]
    v_mfma_f32_16x16x32_bf16 v[36:39], v[184:187], v[156:159], v[36:39]
    v_mfma_f32_16x16x32_bf16 v[56:59], v[184:187], v[160:163], v[56:59]
    v_mfma_f32_16x16x32_bf16 v[76:79], v[184:187], v[164:167], v[76:79]
    s_waitcnt vmcnt(9)
    v_mfma_f32_16x16x32_bf16 v[0:3], v[132:135], v[116:119], v[0:3]
    v_mfma_f32_16x16x32_bf16 v[20:23], v[132:135], v[120:123], v[20:23]
    v_mfma_f32_16x16x32_bf16 v[40:43], v[132:135], v[124:127], v[40:43]
    v_mfma_f32_16x16x32_bf16 v[60:63], v[132:135], v[128:131], v[60:63]
    v_mfma_f32_16x16x32_bf16 v[4:7], v[136:139], v[116:119], v[4:7]
    v_mfma_f32_16x16x32_bf16 v[24:27], v[136:139], v[120:123], v[24:27]
    v_mfma_f32_16x16x32_bf16 v[44:47], v[136:139], v[124:127], v[44:47]
    v_mfma_f32_16x16x32_bf16 v[64:67], v[136:139], v[128:131], v[64:67]
    v_mfma_f32_16x16x32_bf16 v[8:11], v[140:143], v[116:119], v[8:11]
    v_mfma_f32_16x16x32_bf16 v[28:31], v[140:143], v[120:123], v[28:31]
    v_mfma_f32_16x16x32_bf16 v[48:51], v[140:143], v[124:127], v[48:51]
    v_mfma_f32_16x16x32_bf16 v[68:71], v[140:143], v[128:131], v[68:71]
    v_mfma_f32_16x16x32_bf16 v[12:15], v[144:147], v[116:119], v[12:15]
    v_mfma_f32_16x16x32_bf16 v[32:35], v[144:147], v[120:123], v[32:35]
    v_mfma_f32_16x16x32_bf16 v[52:55], v[144:147], v[124:127], v[52:55]
    v_mfma_f32_16x16x32_bf16 v[72:75], v[144:147], v[128:131], v[72:75]
    v_mfma_f32_16x16x32_bf16 v[16:19], v[148:151], v[116:119], v[16:19]
    v_mfma_f32_16x16x32_bf16 v[36:39], v[148:151], v[120:123], v[36:39]
    v_mfma_f32_16x16x32_bf16 v[56:59], v[148:151], v[124:127], v[56:59]
    v_mfma_f32_16x16x32_bf16 v[76:79], v[148:151], v[128:131], v[76:79]
    s_waitcnt vmcnt(0)
    v_mfma_f32_16x16x32_bf16 v[0:3], v[204:207], v[188:191], v[0:3]
    v_mfma_f32_16x16x32_bf16 v[20:23], v[204:207], v[192:195], v[20:23]
    v_mfma_f32_16x16x32_bf16 v[40:43], v[204:207], v[196:199], v[40:43]
    v_mfma_f32_16x16x32_bf16 v[60:63], v[204:207], v[200:203], v[60:63]
    v_mfma_f32_16x16x32_bf16 v[4:7], v[208:211], v[188:191], v[4:7]
    v_mfma_f32_16x16x32_bf16 v[24:27], v[208:211], v[192:195], v[24:27]
    v_mfma_f32_16x16x32_bf16 v[44:47], v[208:211], v[196:199], v[44:47]
    v_mfma_f32_16x16x32_bf16 v[64:67], v[208:211], v[200:203], v[64:67]
    v_mfma_f32_16x16x32_bf16 v[8:11], v[212:215], v[188:191], v[8:11]
    ds_write_b128 v229, v[0:3] offset:0
    ds_write_b128 v229, v[20:23] offset:5120
    v_mfma_f32_16x16x32_bf16 v[28:31], v[212:215], v[192:195], v[28:31]
    ds_write_b128 v229, v[40:43] offset:10240
    ds_write_b128 v229, v[60:63] offset:15360
    v_mfma_f32_16x16x32_bf16 v[48:51], v[212:215], v[196:199], v[48:51]
    ds_write_b128 v229, v[4:7] offset:1024
    ds_write_b128 v229, v[24:27] offset:6144
    v_mfma_f32_16x16x32_bf16 v[68:71], v[212:215], v[200:203], v[68:71]
    ds_write_b128 v229, v[44:47] offset:11264
    ds_write_b128 v229, v[64:67] offset:16384
    v_mfma_f32_16x16x32_bf16 v[12:15], v[216:219], v[188:191], v[12:15]
    ds_write_b128 v229, v[8:11] offset:2048
    ds_write_b128 v229, v[28:31] offset:7168
    v_mfma_f32_16x16x32_bf16 v[32:35], v[216:219], v[192:195], v[32:35]
    ds_write_b128 v229, v[48:51] offset:12288
    v_mfma_f32_16x16x32_bf16 v[52:55], v[216:219], v[196:199], v[52:55]
    ds_write_b128 v229, v[68:71] offset:17408
    v_mfma_f32_16x16x32_bf16 v[72:75], v[216:219], v[200:203], v[72:75]
    v_mfma_f32_16x16x32_bf16 v[16:19], v[220:223], v[188:191], v[16:19]
    ds_write_b128 v229, v[12:15] offset:3072
    v_mfma_f32_16x16x32_bf16 v[36:39], v[220:223], v[192:195], v[36:39]
    v_mfma_f32_16x16x32_bf16 v[56:59], v[220:223], v[196:199], v[56:59]
    ds_write_b128 v229, v[32:35] offset:8192
    v_mfma_f32_16x16x32_bf16 v[76:79], v[220:223], v[200:203], v[76:79]
    ds_write_b128 v229, v[52:55] offset:13312
    s_nop 0
    ds_write_b128 v229, v[72:75] offset:18432
    ds_write_b128 v229, v[16:19] offset:4096
    s_nop 0
    ds_write_b128 v229, v[36:39] offset:9216
    ds_write_b128 v229, v[56:59] offset:14336
    s_nop 0
    ds_write_b128 v229, v[76:79] offset:19456
    s_waitcnt lgkmcnt(0)
    s_barrier
    s_endpgm
KB_STUB0:
    s_call_b64 s[84:85], KB_FIX10
    s_branch KB_RET0
KB_STUB1:
    s_call_b64 s[84:85], KB_FIX00
    s_branch KB_RET1
KB_STUB2:
    s_call_b64 s[84:85], KB_FIX10
    s_branch KB_RET2
KB_STUB3:
    s_call_b64 s[84:85], KB_FIX00
    s_branch KB_RET3
KB_STUB4:
    s_call_b64 s[84:85], KB_FIX11
    s_branch KB_RET4
KB_STUB5:
    s_call_b64 s[84:85], KB_FIX01
    s_branch KB_RET5
KB_FIX00:
    s_nop 7
    v_max3_f32 v224, v96, v97, v98
    v_max3_f32 v224, v224, v99, v100
    v_max3_f32 v224, v224, v101, v102
    v_max_f32 v224, v224, v103
    v_max3_f32 v225, v104, v105, v106
    v_max3_f32 v225, v225, v107, v108
    v_max3_f32 v225, v225, v109, v110
    v_max_f32 v225, v225, v111
    s_nop 0
    s_nop 0
    v_permlane32_swap_b32 v224, v225
    v_max_f32 v224, v224, v225
    v_mov_b32 v225, v224
    s_nop 0
    s_nop 0
    v_permlane16_swap_b32 v224, v225
    v_max_f32 v224, v224, v225
    v_mov_b32 v225, v224
    s_nop 0
    s_nop 0
    v_permlane32_swap_b32 v224, v225
    v_add_f32 v224, 0x41600000, v224
    v_max_f32 v224, 0, v224
    v_exp_f32_e64 v226, -v224
    v_add_f32 v225, 0x41600000, v225
    v_max_f32 v225, 0, v225
    v_exp_f32_e64 v227, -v225
    v_sub_f32 v96, v96, v224
    v_sub_f32 v112, v112, v224
    v_sub_f32 v97, v97, v224
    v_sub_f32 v113, v113, v224
    v_sub_f32 v98, v98, v224
    v_sub_f32 v114, v114, v224
    v_sub_f32 v99, v99, v224
    v_sub_f32 v115, v115, v224
    v_sub_f32 v100, v100, v224
    v_sub_f32 v116, v116, v224
    v_sub_f32 v101, v101, v224
    v_sub_f32 v117, v117, v224
    v_sub_f32 v102, v102, v224
    v_sub_f32 v118, v118, v224
    v_sub_f32 v103, v103, v224
    v_sub_f32 v119, v119, v224
    v_sub_f32 v104, v104, v225
    v_sub_f32 v120, v120, v225
    v_sub_f32 v105, v105, v225
    v_sub_f32 v121, v121, v225
    v_sub_f32 v106, v106, v225
    v_sub_f32 v122, v122, v225
    v_sub_f32 v107, v107, v225
    v_sub_f32 v123, v123, v225
    v_sub_f32 v108, v108, v225
    v_sub_f32 v124, v124, v225
    v_sub_f32 v109, v109, v225
    v_sub_f32 v125, v125, v225
    v_sub_f32 v110, v110, v225
    v_sub_f32 v126, v126, v225
    v_sub_f32 v111, v111, v225
    v_sub_f32 v127, v127, v225
    v_sub_f32 v128, v128, v224
    v_mul_f32 v136, v136, v226
    v_sub_f32 v129, v129, v224
    v_mul_f32 v137, v137, v226
    v_sub_f32 v130, v130, v224
    v_mul_f32 v138, v138, v226
    v_sub_f32 v131, v131, v224
    v_mul_f32 v139, v139, v226
    v_sub_f32 v132, v132, v225
    v_mul_f32 v140, v140, v227
    v_sub_f32 v133, v133, v225
    v_mul_f32 v141, v141, v227
    v_sub_f32 v134, v134, v225
    v_mul_f32 v142, v142, v227
    v_sub_f32 v135, v135, v225
    v_mul_f32 v143, v143, v227
    v_mul_f32 v0, v0, v226
    v_mul_f32 v1, v1, v226
    v_mul_f32 v2, v2, v226
    v_mul_f32 v3, v3, v226
    v_mul_f32 v4, v4, v226
    v_mul_f32 v5, v5, v226
    v_mul_f32 v6, v6, v226
    v_mul_f32 v7, v7, v226
    v_mul_f32 v8, v8, v227
    v_mul_f32 v9, v9, v227
    v_mul_f32 v10, v10, v227
    v_mul_f32 v11, v11, v227
    v_mul_f32 v12, v12, v227
    v_mul_f32 v13, v13, v227
    v_mul_f32 v14, v14, v227
    v_mul_f32 v15, v15, v227
    v_mul_f32 v16, v16, v226
    v_mul_f32 v17, v17, v226
    v_mul_f32 v18, v18, v226
    v_mul_f32 v19, v19, v226
    v_mul_f32 v20, v20, v226
    v_mul_f32 v21, v21, v226
    v_mul_f32 v22, v22, v226
    v_mul_f32 v23, v23, v226
    v_mul_f32 v24, v24, v227
    v_mul_f32 v25, v25, v227
    v_mul_f32 v26, v26, v227
    v_mul_f32 v27, v27, v227
    v_mul_f32 v28, v28, v227
    v_mul_f32 v29, v29, v227
    v_mul_f32 v30, v30, v227
    v_mul_f32 v31, v31, v227
    v_mul_f32 v32, v32, v226
    v_mul_f32 v33, v33, v226
    v_mul_f32 v34, v34, v226
    v_mul_f32 v35, v35, v226
    v_mul_f32 v36, v36, v226
    v_mul_f32 v37, v37, v226
    v_mul_f32 v38, v38, v226
    v_mul_f32 v39, v39, v226
    v_mul_f32 v40, v40, v227
    v_mul_f32 v41, v41, v227
    v_mul_f32 v42, v42, v227
    v_mul_f32 v43, v43, v227
    v_mul_f32 v44, v44, v227
    v_mul_f32 v45, v45, v227
    v_mul_f32 v46, v46, v227
    v_mul_f32 v47, v47, v227
    v_mul_f32 v48, v48, v226
    v_mul_f32 v49, v49, v226
    v_mul_f32 v50, v50, v226
    v_mul_f32 v51, v51, v226
    v_mul_f32 v52, v52, v226
    v_mul_f32 v53, v53, v226
    v_mul_f32 v54, v54, v226
    v_mul_f32 v55, v55, v226
    v_mul_f32 v56, v56, v227
    v_mul_f32 v57, v57, v227
    v_mul_f32 v58, v58, v227
    v_mul_f32 v59, v59, v227
    v_mul_f32 v60, v60, v227
    v_mul_f32 v61, v61, v227
    v_mul_f32 v62, v62, v227
    v_mul_f32 v63, v63, v227
    v_exp_f32 v224, v96
    v_exp_f32 v225, v97
    v_exp_f32 v226, v98
    v_cvt_pk_bf16_f32 v144, v224, v225
    v_exp_f32 v227, v99
    v_exp_f32 v228, v100
    v_cvt_pk_bf16_f32 v145, v226, v227
    v_exp_f32 v229, v101
    v_exp_f32 v224, v102
    v_cvt_pk_bf16_f32 v146, v228, v229
    v_exp_f32 v225, v103
    v_exp_f32 v226, v104
    v_cvt_pk_bf16_f32 v147, v224, v225
    v_exp_f32 v227, v105
    v_exp_f32 v228, v106
    v_cvt_pk_bf16_f32 v148, v226, v227
    v_exp_f32 v229, v107
    v_exp_f32 v224, v108
    v_cvt_pk_bf16_f32 v149, v228, v229
    v_exp_f32 v225, v109
    v_exp_f32 v226, v110
    v_cvt_pk_bf16_f32 v150, v224, v225
    v_exp_f32 v227, v111
    s_nop 0
    v_cvt_pk_bf16_f32 v151, v226, v227
    s_nop 1
    s_setpc_b64 s[84:85]
KB_FIX01:
    s_nop 7
    v_max3_f32 v224, v96, v97, v98
    v_max3_f32 v224, v224, v99, v100
    v_max3_f32 v224, v224, v101, v102
    v_max_f32 v224, v224, v103
    v_max3_f32 v225, v104, v105, v106
    v_max3_f32 v225, v225, v107, v108
    v_max3_f32 v225, v225, v109, v110
    v_max_f32 v225, v225, v111
    s_nop 0
    s_nop 0
    v_permlane32_swap_b32 v224, v225
    v_max_f32 v224, v224, v225
    v_mov_b32 v225, v224
    s_nop 0
    s_nop 0
    v_permlane16_swap_b32 v224, v225
    v_max_f32 v224, v224, v225
    v_mov_b32 v225, v224
    s_nop 0
    s_nop 0
    v_permlane32_swap_b32 v224, v225
    v_add_f32 v224, 0x41600000, v224
    v_max_f32 v224, 0, v224
    v_exp_f32_e64 v226, -v224
    v_add_f32 v225, 0x41600000, v225
    v_max_f32 v225, 0, v225
    v_exp_f32_e64 v227, -v225
    v_sub_f32 v96, v96, v224
    v_sub_f32 v112, v112, v224
    v_sub_f32 v97, v97, v224
    v_sub_f32 v113, v113, v224
    v_sub_f32 v98, v98, v224
    v_sub_f32 v114, v114, v224
    v_sub_f32 v99, v99, v224
    v_sub_f32 v115, v115, v224
    v_sub_f32 v100, v100, v224
    v_sub_f32 v116, v116, v224
    v_sub_f32 v101, v101, v224
    v_sub_f32 v117, v117, v224
    v_sub_f32 v102, v102, v224
    v_sub_f32 v118, v118, v224
    v_sub_f32 v103, v103, v224
    v_sub_f32 v119, v119, v224
    v_sub_f32 v104, v104, v225
    v_sub_f32 v120, v120, v225
    v_sub_f32 v105, v105, v225
    v_sub_f32 v121, v121, v225
    v_sub_f32 v106, v106, v225
    v_sub_f32 v122, v122, v225
    v_sub_f32 v107, v107, v225
    v_sub_f32 v123, v123, v225
    v_sub_f32 v108, v108, v225
    v_sub_f32 v124, v124, v225
    v_sub_f32 v109, v109, v225
    v_sub_f32 v125, v125, v225
    v_sub_f32 v110, v110, v225
    v_sub_f32 v126, v126, v225
    v_sub_f32 v111, v111, v225
    v_sub_f32 v127, v127, v225
    v_sub_f32 v128, v128, v224
    v_mul_f32 v136, v136, v226
    v_sub_f32 v129, v129, v224
    v_mul_f32 v137, v137, v226
    v_sub_f32 v130, v130, v224
    v_mul_f32 v138, v138, v226
    v_sub_f32 v131, v131, v224
    v_mul_f32 v139, v139, v226
    v_sub_f32 v132, v132, v225
    v_mul_f32 v140, v140, v227
    v_sub_f32 v133, v133, v225
    v_mul_f32 v141, v141, v227
    v_sub_f32 v134, v134, v225
    v_mul_f32 v142, v142, v227
    v_sub_f32 v135, v135, v225
    v_mul_f32 v143, v143, v227
    v_mul_f32 v0, v0, v226
    v_mul_f32 v1, v1, v226
    v_mul_f32 v2, v2, v226
    v_mul_f32 v3, v3, v226
    v_mul_f32 v4, v4, v226
    v_mul_f32 v5, v5, v226
    v_mul_f32 v6, v6, v226
    v_mul_f32 v7, v7, v226
    v_mul_f32 v8, v8, v227
    v_mul_f32 v9, v9, v227
    v_mul_f32 v10, v10, v227
    v_mul_f32 v11, v11, v227
    v_mul_f32 v12, v12, v227
    v_mul_f32 v13, v13, v227
    v_mul_f32 v14, v14, v227
    v_mul_f32 v15, v15, v227
    v_mul_f32 v16, v16, v226
    v_mul_f32 v17, v17, v226
    v_mul_f32 v18, v18, v226
    v_mul_f32 v19, v19, v226
    v_mul_f32 v20, v20, v226
    v_mul_f32 v21, v21, v226
    v_mul_f32 v22, v22, v226
    v_mul_f32 v23, v23, v226
    v_mul_f32 v24, v24, v227
    v_mul_f32 v25, v25, v227
    v_mul_f32 v26, v26, v227
    v_mul_f32 v27, v27, v227
    v_mul_f32 v28, v28, v227
    v_mul_f32 v29, v29, v227
    v_mul_f32 v30, v30, v227
    v_mul_f32 v31, v31, v227
    v_mul_f32 v32, v32, v226
    v_mul_f32 v33, v33, v226
    v_mul_f32 v34, v34, v226
    v_mul_f32 v35, v35, v226
    v_mul_f32 v36, v36, v226
    v_mul_f32 v37, v37, v226
    v_mul_f32 v38, v38, v226
    v_mul_f32 v39, v39, v226
    v_mul_f32 v40, v40, v227
    v_mul_f32 v41, v41, v227
    v_mul_f32 v42, v42, v227
    v_mul_f32 v43, v43, v227
    v_mul_f32 v44, v44, v227
    v_mul_f32 v45, v45, v227
    v_mul_f32 v46, v46, v227
    v_mul_f32 v47, v47, v227
    v_mul_f32 v48, v48, v226
    v_mul_f32 v49, v49, v226
    v_mul_f32 v50, v50, v226
    v_mul_f32 v51, v51, v226
    v_mul_f32 v52, v52, v226
    v_mul_f32 v53, v53, v226
    v_mul_f32 v54, v54, v226
    v_mul_f32 v55, v55, v226
    v_mul_f32 v56, v56, v227
    v_mul_f32 v57, v57, v227
    v_mul_f32 v58, v58, v227
    v_mul_f32 v59, v59, v227
    v_mul_f32 v60, v60, v227
    v_mul_f32 v61, v61, v227
    v_mul_f32 v62, v62, v227
    v_mul_f32 v63, v63, v227
    v_exp_f32 v224, v96
    v_exp_f32 v225, v97
    v_exp_f32 v226, v98
    v_cvt_pk_bf16_f32 v244, v224, v225
    v_exp_f32 v227, v99
    v_exp_f32 v228, v100
    v_cvt_pk_bf16_f32 v245, v226, v227
    v_exp_f32 v229, v101
    v_exp_f32 v224, v102
    v_cvt_pk_bf16_f32 v246, v228, v229
    v_exp_f32 v225, v103
    v_exp_f32 v226, v104
    v_cvt_pk_bf16_f32 v247, v224, v225
    v_exp_f32 v227, v105
    v_exp_f32 v228, v106
    v_cvt_pk_bf16_f32 v248, v226, v227
    v_exp_f32 v229, v107
    v_exp_f32 v224, v108
    v_cvt_pk_bf16_f32 v249, v228, v229
    v_exp_f32 v225, v109
    v_exp_f32 v226, v110
    v_cvt_pk_bf16_f32 v250, v224, v225
    v_exp_f32 v227, v111
    s_nop 0
    v_cvt_pk_bf16_f32 v251, v226, v227
    s_nop 1
    s_setpc_b64 s[84:85]
KB_FIX10:
    s_nop 7
    v_max3_f32 v224, v112, v113, v114
    v_max3_f32 v224, v224, v115, v116
    v_max3_f32 v224, v224, v117, v118
    v_max_f32 v224, v224, v119
    v_max3_f32 v225, v120, v121, v122
    v_max3_f32 v225, v225, v123, v124
    v_max3_f32 v225, v225, v125, v126
    v_max_f32 v225, v225, v127
    s_nop 0
    s_nop 0
    v_permlane32_swap_b32 v224, v225
    v_max_f32 v224, v224, v225
    v_mov_b32 v225, v224
    s_nop 0
    s_nop 0
    v_permlane16_swap_b32 v224, v225
    v_max_f32 v224, v224, v225
    v_mov_b32 v225, v224
    s_nop 0
    s_nop 0
    v_permlane32_swap_b32 v224, v225
    v_add_f32 v224, 0x41600000, v224
    v_max_f32 v224, 0, v224
    v_exp_f32_e64 v226, -v224
    v_add_f32 v225, 0x41600000, v225
    v_max_f32 v225, 0, v225
    v_exp_f32_e64 v227, -v225
    v_sub_f32 v112, v112, v224
    v_sub_f32 v96, v96, v224
    v_sub_f32 v113, v113, v224
    v_sub_f32 v97, v97, v224
    v_sub_f32 v114, v114, v224
    v_sub_f32 v98, v98, v224
    v_sub_f32 v115, v115, v224
    v_sub_f32 v99, v99, v224
    v_sub_f32 v116, v116, v224
    v_sub_f32 v100, v100, v224
    v_sub_f32 v117, v117, v224
    v_sub_f32 v101, v101, v224
    v_sub_f32 v118, v118, v224
    v_sub_f32 v102, v102, v224
    v_sub_f32 v119, v119, v224
    v_sub_f32 v103, v103, v224
    v_sub_f32 v120, v120, v225
    v_sub_f32 v104, v104, v225
    v_sub_f32 v121, v121, v225
    v_sub_f32 v105, v105, v225
    v_sub_f32 v122, v122, v225
    v_sub_f32 v106, v106, v225
    v_sub_f32 v123, v123, v225
    v_sub_f32 v107, v107, v225
    v_sub_f32 v124, v124, v225
    v_sub_f32 v108, v108, v225
    v_sub_f32 v125, v125, v225
    v_sub_f32 v109, v109, v225
    v_sub_f32 v126, v126, v225
    v_sub_f32 v110, v110, v225
    v_sub_f32 v127, v127, v225
    v_sub_f32 v111, v111, v225
    v_sub_f32 v128, v128, v224
    v_mul_f32 v136, v136, v226
    v_sub_f32 v129, v129, v224
    v_mul_f32 v137, v137, v226
    v_sub_f32 v130, v130, v224
    v_mul_f32 v138, v138, v226
    v_sub_f32 v131, v131, v224
    v_mul_f32 v139, v139, v226
    v_sub_f32 v132, v132, v225
    v_mul_f32 v140, v140, v227
    v_sub_f32 v133, v133, v225
    v_mul_f32 v141, v141, v227
    v_sub_f32 v134, v134, v225
    v_mul_f32 v142, v142, v227
    v_sub_f32 v135, v135, v225
    v_mul_f32 v143, v143, v227
    v_mul_f32 v0, v0, v226
    v_mul_f32 v1, v1, v226
    v_mul_f32 v2, v2, v226
    v_mul_f32 v3, v3, v226
    v_mul_f32 v4, v4, v226
    v_mul_f32 v5, v5, v226
    v_mul_f32 v6, v6, v226
    v_mul_f32 v7, v7, v226
    v_mul_f32 v8, v8, v227
    v_mul_f32 v9, v9, v227
    v_mul_f32 v10, v10, v227
    v_mul_f32 v11, v11, v227
    v_mul_f32 v12, v12, v227
    v_mul_f32 v13, v13, v227
    v_mul_f32 v14, v14, v227
    v_mul_f32 v15, v15, v227
    v_mul_f32 v16, v16, v226
    v_mul_f32 v17, v17, v226
    v_mul_f32 v18, v18, v226
    v_mul_f32 v19, v19, v226
    v_mul_f32 v20, v20, v226
    v_mul_f32 v21, v21, v226
    v_mul_f32 v22, v22, v226
    v_mul_f32 v23, v23, v226
    v_mul_f32 v24, v24, v227
    v_mul_f32 v25, v25, v227
    v_mul_f32 v26, v26, v227
    v_mul_f32 v27, v27, v227
    v_mul_f32 v28, v28, v227
    v_mul_f32 v29, v29, v227
    v_mul_f32 v30, v30, v227
    v_mul_f32 v31, v31, v227
    v_mul_f32 v32, v32, v226
    v_mul_f32 v33, v33, v226
    v_mul_f32 v34, v34, v226
    v_mul_f32 v35, v35, v226
    v_mul_f32 v36, v36, v226
    v_mul_f32 v37, v37, v226
    v_mul_f32 v38, v38, v226
    v_mul_f32 v39, v39, v226
    v_mul_f32 v40, v40, v227
    v_mul_f32 v41, v41, v227
    v_mul_f32 v42, v42, v227
    v_mul_f32 v43, v43, v227
    v_mul_f32 v44, v44, v227
    v_mul_f32 v45, v45, v227
    v_mul_f32 v46, v46, v227
    v_mul_f32 v47, v47, v227
    v_mul_f32 v48, v48, v226
    v_mul_f32 v49, v49, v226
    v_mul_f32 v50, v50, v226
    v_mul_f32 v51, v51, v226
    v_mul_f32 v52, v52, v226
    v_mul_f32 v53, v53, v226
    v_mul_f32 v54, v54, v226
    v_mul_f32 v55, v55, v226
    v_mul_f32 v56, v56, v227
    v_mul_f32 v57, v57, v227
    v_mul_f32 v58, v58, v227
    v_mul_f32 v59, v59, v227
    v_mul_f32 v60, v60, v227
    v_mul_f32 v61, v61, v227
    v_mul_f32 v62, v62, v227
    v_mul_f32 v63, v63, v227
    v_exp_f32 v224, v112
    v_exp_f32 v225, v113
    v_exp_f32 v226, v114
    v_cvt_pk_bf16_f32 v152, v224, v225
    v_exp_f32 v227, v115
    v_exp_f32 v228, v116
    v_cvt_pk_bf16_f32 v153, v226, v227
    v_exp_f32 v229, v117
    v_exp_f32 v224, v118
    v_cvt_pk_bf16_f32 v154, v228, v229
    v_exp_f32 v225, v119
    v_exp_f32 v226, v120
    v_cvt_pk_bf16_f32 v155, v224, v225
    v_exp_f32 v227, v121
    v_exp_f32 v228, v122
    v_cvt_pk_bf16_f32 v156, v226, v227
    v_exp_f32 v229, v123
    v_exp_f32 v224, v124
    v_cvt_pk_bf16_f32 v157, v228, v229
    v_exp_f32 v225, v125
    v_exp_f32 v226, v126
    v_cvt_pk_bf16_f32 v158, v224, v225
    v_exp_f32 v227, v127
    s_nop 0
    v_cvt_pk_bf16_f32 v159, v226, v227
    s_nop 1
    s_setpc_b64 s[84:85]
KB_FIX11:
    s_nop 7
    v_max3_f32 v224, v112, v113, v114
    v_max3_f32 v224, v224, v115, v116
    v_max3_f32 v224, v224, v117, v118
    v_max_f32 v224, v224, v119
    v_max3_f32 v225, v120, v121, v122
    v_max3_f32 v225, v225, v123, v124
    v_max3_f32 v225, v225, v125, v126
    v_max_f32 v225, v225, v127
    s_nop 0
    s_nop 0
    v_permlane32_swap_b32 v224, v225
    v_max_f32 v224, v224, v225
    v_mov_b32 v225, v224
    s_nop 0
    s_nop 0
    v_permlane16_swap_b32 v224, v225
    v_max_f32 v224, v224, v225
    v_mov_b32 v225, v224
    s_nop 0
    s_nop 0
    v_permlane32_swap_b32 v224, v225
    v_add_f32 v224, 0x41600000, v224
    v_max_f32 v224, 0, v224
    v_exp_f32_e64 v226, -v224
    v_add_f32 v225, 0x41600000, v225
    v_max_f32 v225, 0, v225
    v_exp_f32_e64 v227, -v225
    v_sub_f32 v112, v112, v224
    v_sub_f32 v96, v96, v224
    v_sub_f32 v113, v113, v224
    v_sub_f32 v97, v97, v224
    v_sub_f32 v114, v114, v224
    v_sub_f32 v98, v98, v224
    v_sub_f32 v115, v115, v224
    v_sub_f32 v99, v99, v224
    v_sub_f32 v116, v116, v224
    v_sub_f32 v100, v100, v224
    v_sub_f32 v117, v117, v224
    v_sub_f32 v101, v101, v224
    v_sub_f32 v118, v118, v224
    v_sub_f32 v102, v102, v224
    v_sub_f32 v119, v119, v224
    v_sub_f32 v103, v103, v224
    v_sub_f32 v120, v120, v225
    v_sub_f32 v104, v104, v225
    v_sub_f32 v121, v121, v225
    v_sub_f32 v105, v105, v225
    v_sub_f32 v122, v122, v225
    v_sub_f32 v106, v106, v225
    v_sub_f32 v123, v123, v225
    v_sub_f32 v107, v107, v225
    v_sub_f32 v124, v124, v225
    v_sub_f32 v108, v108, v225
    v_sub_f32 v125, v125, v225
    v_sub_f32 v109, v109, v225
    v_sub_f32 v126, v126, v225
    v_sub_f32 v110, v110, v225
    v_sub_f32 v127, v127, v225
    v_sub_f32 v111, v111, v225
    v_sub_f32 v128, v128, v224
    v_mul_f32 v136, v136, v226
    v_sub_f32 v129, v129, v224
    v_mul_f32 v137, v137, v226
    v_sub_f32 v130, v130, v224
    v_mul_f32 v138, v138, v226
    v_sub_f32 v131, v131, v224
    v_mul_f32 v139, v139, v226
    v_sub_f32 v132, v132, v225
    v_mul_f32 v140, v140, v227
    v_sub_f32 v133, v133, v225
    v_mul_f32 v141, v141, v227
    v_sub_f32 v134, v134, v225
    v_mul_f32 v142, v142, v227
    v_sub_f32 v135, v135, v225
    v_mul_f32 v143, v143, v227
    v_mul_f32 v0, v0, v226
    v_mul_f32 v1, v1, v226
    v_mul_f32 v2, v2, v226
    v_mul_f32 v3, v3, v226
    v_mul_f32 v4, v4, v226
    v_mul_f32 v5, v5, v226
    v_mul_f32 v6, v6, v226
    v_mul_f32 v7, v7, v226
    v_mul_f32 v8, v8, v227
    v_mul_f32 v9, v9, v227
    v_mul_f32 v10, v10, v227
    v_mul_f32 v11, v11, v227
    v_mul_f32 v12, v12, v227
    v_mul_f32 v13, v13, v227
    v_mul_f32 v14, v14, v227
    v_mul_f32 v15, v15, v227
    v_mul_f32 v16, v16, v226
    v_mul_f32 v17, v17, v226
    v_mul_f32 v18, v18, v226
    v_mul_f32 v19, v19, v226
    v_mul_f32 v20, v20, v226
    v_mul_f32 v21, v21, v226
    v_mul_f32 v22, v22, v226
    v_mul_f32 v23, v23, v226
    v_mul_f32 v24, v24, v227
    v_mul_f32 v25, v25, v227
    v_mul_f32 v26, v26, v227
    v_mul_f32 v27, v27, v227
    v_mul_f32 v28, v28, v227
    v_mul_f32 v29, v29, v227
    v_mul_f32 v30, v30, v227
    v_mul_f32 v31, v31, v227
    v_mul_f32 v32, v32, v226
    v_mul_f32 v33, v33, v226
    v_mul_f32 v34, v34, v226
    v_mul_f32 v35, v35, v226
    v_mul_f32 v36, v36, v226
    v_mul_f32 v37, v37, v226
    v_mul_f32 v38, v38, v226
    v_mul_f32 v39, v39, v226
    v_mul_f32 v40, v40, v227
    v_mul_f32 v41, v41, v227
    v_mul_f32 v42, v42, v227
    v_mul_f32 v43, v43, v227
    v_mul_f32 v44, v44, v227
    v_mul_f32 v45, v45, v227
    v_mul_f32 v46, v46, v227
    v_mul_f32 v47, v47, v227
    v_mul_f32 v48, v48, v226
    v_mul_f32 v49, v49, v226
    v_mul_f32 v50, v50, v226
    v_mul_f32 v51, v51, v226
    v_mul_f32 v52, v52, v226
    v_mul_f32 v53, v53, v226
    v_mul_f32 v54, v54, v226
    v_mul_f32 v55, v55, v226
    v_mul_f32 v56, v56, v227
    v_mul_f32 v57, v57, v227
    v_mul_f32 v58, v58, v227
    v_mul_f32 v59, v59, v227
    v_mul_f32 v60, v60, v227
    v_mul_f32 v61, v61, v227
    v_mul_f32 v62, v62, v227
    v_mul_f32 v63, v63, v227
    v_exp_f32 v224, v112
    v_exp_f32 v225, v113
    v_exp_f32 v226, v114
    v_cvt_pk_bf16_f32 v244, v224, v225
    v_exp_f32 v227, v115
    v_exp_f32 v228, v116
    v_cvt_pk_bf16_f32 v245, v226, v227
    v_exp_f32 v229, v117
    v_exp_f32 v224, v118
    v_cvt_pk_bf16_f32 v246, v228, v229
    v_exp_f32 v225, v119
    v_exp_f32 v226, v120
    v_cvt_pk_bf16_f32 v247, v224, v225
    v_exp_f32 v227, v121
    v_exp_f32 v228, v122
    v_cvt_pk_bf16_f32 v248, v226, v227
    v_exp_f32 v229, v123
    v_exp_f32 v224, v124
    v_cvt_pk_bf16_f32 v249, v228, v229
    v_exp_f32 v225, v125
    v_exp_f32 v226, v126
    v_cvt_pk_bf16_f32 v250, v224, v225
    v_exp_f32 v227, v127
    s_nop 0
    v_cvt_pk_bf16_f32 v251, v226, v227
    s_nop 1
    s_setpc_b64 s[84:85]
KB_SIG1:
    v_mov_b32 v243, s94
    s_waitcnt vmcnt(0)
    buffer_store_dword v243, v242, s[52:55], s12 offen sc1
    s_branch KB_SIG1R
KB_XK:
    s_waitcnt lgkmcnt(6)
    v_mfma_f32_16x16x32_bf16 v[0:3], v[224:227], v[192:195], 0
    ds_read_b128 v[208:211], v245 offset:8192
    s_add_u32 m0, s83, 114688
    v_mfma_f32_16x16x32_bf16 v[8:11], v[224:227], v[196:199], 0
    ds_read_b128 v[212:215], v245 offset:10240
    s_add_u32 s89, s88, 31744
    v_mfma_f32_16x16x32_bf16 v[32:35], v[224:227], v[200:203], 0
    ds_read_b128 v[216:219], v245 offset:12288
    v_mfma_f32_16x16x32_bf16 v[40:43], v[224:227], v[204:207], 0
    ds_read_b128 v[220:223], v245 offset:14336
    buffer_load_dwordx4 v244, s[36:39], s88 offen nt lds
    s_waitcnt lgkmcnt(8)
    v_mfma_f32_16x16x32_bf16 v[4:7], v[228:231], v[192:195], 0
    v_xor_b32 v245, 64, v245
    v_mfma_f32_16x16x32_bf16 v[12:15], v[228:231], v[196:199], 0
    buffer_load_dwordx4 v244, s[36:39], s89 offen offset:1024 nt lds
    v_mfma_f32_16x16x32_bf16 v[36:39], v[228:231], v[200:203], 0
    v_mfma_f32_16x16x32_bf16 v[44:47], v[228:231], v[204:207], 0
    s_add_u32 s88, s88, 262144
    s_waitcnt lgkmcnt(6)
    v_mfma_f32_16x16x32_bf16 v[16:19], v[232:235], v[192:195], 0
    s_add_u32 m0, s81, 131072
    v_mfma_f32_16x16x32_bf16 v[24:27], v[232:235], v[196:199], 0
    v_mfma_f32_16x16x32_bf16 v[48:51], v[232:235], v[200:203], 0
    s_nop 0
    v_mfma_f32_16x16x32_bf16 v[56:59], v[232:235], v[204:207], 0
    s_waitcnt lgkmcnt(4)
    v_mfma_f32_16x16x32_bf16 v[20:23], v[236:239], v[192:195], 0
    buffer_load_dwordx4 v243, s[32:35], s86 offen lds
    v_mfma_f32_16x16x32_bf16 v[28:31], v[236:239], v[196:199], 0
    v_mfma_f32_16x16x32_bf16 v[52:55], v[236:239], v[200:203], 0
    buffer_load_dwordx4 v183, s[32:35], s86 offen offset:1024 lds
    v_mfma_f32_16x16x32_bf16 v[60:63], v[236:239], v[204:207], 0
    s_waitcnt vmcnt(16) lgkmcnt(0)
    s_barrier
    v_mfma_f32_16x16x32_bf16 v[64:67], v[224:227], v[208:211], 0
    ds_read_b128 v[192:195], v245 offset:0
    s_add_u32 m0, s81, 131072
    s_add_u32 s87, s86, 14336
    buffer_load_dwordx4 v243, s[32:35], s87 offen offset:2048 lds
    buffer_load_dwordx4 v183, s[32:35], s87 offen offset:3072 lds
    v_mfma_f32_16x16x32_bf16 v[72:75], v[224:227], v[212:215], 0
    ds_read_b128 v[196:199], v245 offset:2048
    s_add_u32 s86, s86, 128
    s_add_u32 m0, s83, 32768
    s_add_u32 s89, s88, 31744
    v_mfma_f32_16x16x32_bf16 v[96:99], v[224:227], v[216:219], 0
    ds_read_b128 v[200:203], v245 offset:4096
    buffer_load_dwordx4 v244, s[36:39], s88 offen nt lds
    buffer_load_dwordx4 v244, s[36:39], s89 offen offset:1024 nt lds
    s_add_u32 s88, s88, 262144
    v_mfma_f32_16x16x32_bf16 v[104:107], v[224:227], v[220:223], 0
    ds_read_b64_tr_b16 v[224:225], v246 offset:16384
    ds_read_b64_tr_b16 v[226:227], v246 offset:17408
    ds_read_b128 v[204:207], v245 offset:6144
    s_waitcnt vmcnt(17)
    v_lshlrev_b32 v140, 16, v128
    v_and_b32 v141, 0xffff0000, v128
    v_mfma_f32_16x16x32_bf16 v[68:71], v[228:231], v[208:211], 0
    v_lshlrev_b32 v142, 16, v129
    v_and_b32 v143, 0xffff0000, v129
    v_lshlrev_b32 v144, 16, v130
    v_mfma_f32_16x16x32_bf16 v[76:79], v[228:231], v[212:215], 0
    v_and_b32 v145, 0xffff0000, v130
    v_lshlrev_b32 v146, 16, v131
    v_and_b32 v147, 0xffff0000, v131
    v_mfma_f32_16x16x32_bf16 v[100:103], v[228:231], v[216:219], 0
    v_lshlrev_b32 v148, 16, v132
    v_and_b32 v149, 0xffff0000, v132
    v_lshlrev_b32 v150, 16, v133
    v_mfma_f32_16x16x32_bf16 v[108:111], v[228:231], v[220:223], 0
    ds_read_b64_tr_b16 v[228:229], v247 offset:16384
    ds_read_b64_tr_b16 v[230:231], v247 offset:17408
    v_and_b32 v151, 0xffff0000, v133
    v_lshlrev_b32 v152, 16, v134
    v_and_b32 v153, 0xffff0000, v134
    v_mfma_f32_16x16x32_bf16 v[80:83], v[232:235], v[208:211], 0
    v_lshlrev_b32 v154, 16, v135
    v_and_b32 v155, 0xffff0000, v135
    v_lshlrev_b32 v156, 16, v136
    v_and_b32 v157, 0xffff0000, v136
    v_mfma_f32_16x16x32_bf16 v[88:91], v[232:235], v[212:215], 0
    v_lshlrev_b32 v158, 16, v137
    v_and_b32 v159, 0xffff0000, v137
    v_lshlrev_b32 v160, 16, v138
    v_mfma_f32_16x16x32_bf16 v[112:115], v[232:235], v[216:219], 0
    v_and_b32 v161, 0xffff0000, v138
    v_lshlrev_b32 v162, 16, v139
    v_and_b32 v163, 0xffff0000, v139
    v_mfma_f32_16x16x32_bf16 v[120:123], v[232:235], v[220:223], 0
    ds_read_b64_tr_b16 v[232:233], v248 offset:16384
    ds_read_b64_tr_b16 v[234:235], v248 offset:17408
    v_add_f32 v164, v140, v141
    v_add_f32 v165, v142, v143
    v_add_f32 v164, v164, v144
    v_mfma_f32_16x16x32_bf16 v[84:87], v[236:239], v[208:211], 0
    v_add_f32 v165, v165, v145
    v_add_f32 v164, v164, v146
    v_add_f32 v165, v165, v147
    v_mfma_f32_16x16x32_bf16 v[92:95], v[236:239], v[212:215], 0
    v_add_f32 v164, v164, v148
    v_add_f32 v165, v165, v149
    v_add_f32 v164, v164, v150
    v_mfma_f32_16x16x32_bf16 v[116:119], v[236:239], v[216:219], 0
    v_add_f32 v165, v165, v151
    v_add_f32 v164, v164, v152
    v_add_f32 v165, v165, v153
    v_mfma_f32_16x16x32_bf16 v[124:127], v[236:239], v[220:223], 0
    ds_read_b64_tr_b16 v[236:237], v249 offset:16384
    ds_read_b64_tr_b16 v[238:239], v249 offset:17408
    v_add_f32 v164, v164, v154
    v_add_f32 v165, v165, v155
    v_add_f32 v164, v164, v156
    s_waitcnt lgkmcnt(6)
    v_mfma_f32_16x16x32_bf16 v[0:3], v[224:227], v[192:195], v[0:3]
    ds_read_b128 v[208:211], v245 offset:8192
    v_add_f32 v165, v165, v157
    v_add_f32 v164, v164, v158
    v_add_f32 v165, v165, v159
    v_mfma_f32_16x16x32_bf16 v[8:11], v[224:227], v[196:199], v[8:11]
    ds_read_b128 v[212:215], v245 offset:10240
    v_add_f32 v164, v164, v160
    v_add_f32 v165, v165, v161
    v_mfma_f32_16x16x32_bf16 v[32:35], v[224:227], v[200:203], v[32:35]
    ds_read_b128 v[216:219], v245 offset:12288
    v_add_f32 v164, v164, v162
    v_add_f32 v165, v165, v163
    v_add_f32 v164, v164, v165
    v_mfma_f32_16x16x32_bf16 v[40:43], v[224:227], v[204:207], v[40:43]
    ds_read_b128 v[220:223], v245 offset:14336
    s_nop 1
    v_add_f32_dpp v164, v164, v164 quad_perm:[1,0,3,2] row_mask:0xf bank_mask:0xf
    s_waitcnt lgkmcnt(8)
    v_mfma_f32_16x16x32_bf16 v[4:7], v[228:231], v[192:195], v[4:7]
    v_xor_b32 v245, 64, v245
    s_nop 1
    v_add_f32_dpp v164, v164, v164 quad_perm:[2,3,0,1] row_mask:0xf bank_mask:0xf
    s_nop 1
    v_mfma_f32_16x16x32_bf16 v[12:15], v[228:231], v[196:199], v[12:15]
    v_add_u32 v245, 0x10000, v245
    v_add_f32_dpp v164, v164, v164 row_ror:8 row_mask:0xf bank_mask:0xf
    v_mov_b32 v169, v164
    v_mfma_f32_16x16x32_bf16 v[36:39], v[228:231], v[200:203], v[36:39]
    v_xor_b32 v246, 0x10000, v246
    s_nop 1
    v_permlane16_swap_b32 v164, v169
    v_add_f32 v164, v164, v169
    v_mfma_f32_16x16x32_bf16 v[44:47], v[228:231], v[204:207], v[44:47]
    v_xor_b32 v247, 0x10000, v247
    v_mov_b32 v169, v164
    s_nop 1
    s_waitcnt lgkmcnt(6)
    v_mfma_f32_16x16x32_bf16 v[16:19], v[232:235], v[192:195], v[16:19]
    v_xor_b32 v248, 0x10000, v248
    v_permlane32_swap_b32 v164, v169
    v_add_f32 v164, v164, v169
    v_mul_f32 v171, 0x3acccccd, v164
    v_mfma_f32_16x16x32_bf16 v[24:27], v[232:235], v[196:199], v[24:27]
    v_xor_b32 v249, 0x10000, v249
    v_sub_f32 v174, v140, v171
    v_mul_f32 v166, v174, v174
    v_mfma_f32_16x16x32_bf16 v[48:51], v[232:235], v[200:203], v[48:51]
    v_sub_f32 v175, v141, v171
    v_mul_f32 v167, v175, v175
    v_sub_f32 v176, v142, v171
    v_mfma_f32_16x16x32_bf16 v[56:59], v[232:235], v[204:207], v[56:59]
    v_fmac_f32 v166, v176, v176
    v_sub_f32 v177, v143, v171
    s_waitcnt lgkmcnt(4)
    v_mfma_f32_16x16x32_bf16 v[20:23], v[236:239], v[192:195], v[20:23]
    v_fmac_f32 v167, v177, v177
    v_sub_f32 v174, v144, v171
    v_fmac_f32 v166, v174, v174
    v_mfma_f32_16x16x32_bf16 v[28:31], v[236:239], v[196:199], v[28:31]
    v_sub_f32 v175, v145, v171
    v_fmac_f32 v167, v175, v175
    v_mfma_f32_16x16x32_bf16 v[52:55], v[236:239], v[200:203], v[52:55]
    v_sub_f32 v176, v146, v171
    v_fmac_f32 v166, v176, v176
    v_sub_f32 v177, v147, v171
    v_mfma_f32_16x16x32_bf16 v[60:63], v[236:239], v[204:207], v[60:63]
    v_fmac_f32 v167, v177, v177
    v_sub_f32 v174, v148, v171
    s_waitcnt vmcnt(8) lgkmcnt(0)
    s_barrier
    v_mfma_f32_16x16x32_bf16 v[64:67], v[224:227], v[208:211], v[64:67]
    ds_read_b128 v[192:195], v245 offset:0
    s_lshl_b32 s77, s2, 12
    buffer_store_dword v186, v185, s[60:63], s77 offen sc1
    s_add_u32 m0, s83, 49152
    s_add_u32 s89, s88, 31744
    v_mfma_f32_16x16x32_bf16 v[72:75], v[224:227], v[212:215], v[72:75]
    ds_read_b128 v[196:199], v245 offset:2048
    buffer_load_dwordx4 v244, s[36:39], s88 offen nt lds
    buffer_load_dwordx4 v244, s[36:39], s89 offen offset:1024 nt lds
    s_add_u32 s88, s88, 262144
    v_mfma_f32_16x16x32_bf16 v[96:99], v[224:227], v[216:219], v[96:99]
    ds_read_b128 v[200:203], v245 offset:4096
    s_add_u32 m0, s81, 0
    s_nop 0
    buffer_load_dwordx4 v243, s[32:35], s86 offen lds
    v_mfma_f32_16x16x32_bf16 v[104:107], v[224:227], v[220:223], v[104:107]
    ds_read_b64_tr_b16 v[224:225], v246 offset:0
    ds_read_b64_tr_b16 v[226:227], v246 offset:1024
    ds_read_b128 v[204:207], v245 offset:6144
    buffer_load_dwordx4 v183, s[32:35], s86 offen offset:1024 lds
    v_fmac_f32 v166, v174, v174
    v_sub_f32 v175, v149, v171
    v_mfma_f32_16x16x32_bf16 v[68:71], v[228:231], v[208:211], v[68:71]
    v_fmac_f32 v167, v175, v175
    v_sub_f32 v176, v150, v171
    v_fmac_f32 v166, v176, v176
    v_mfma_f32_16x16x32_bf16 v[76:79], v[228:231], v[212:215], v[76:79]
    v_sub_f32 v177, v151, v171
    v_fmac_f32 v167, v177, v177
    v_sub_f32 v174, v152, v171
    v_fmac_f32 v166, v174, v174
    v_mfma_f32_16x16x32_bf16 v[100:103], v[228:231], v[216:219], v[100:103]
    v_sub_f32 v175, v153, v171
    v_fmac_f32 v167, v175, v175
    v_sub_f32 v176, v154, v171
    v_mfma_f32_16x16x32_bf16 v[108:111], v[228:231], v[220:223], v[108:111]
    ds_read_b64_tr_b16 v[228:229], v247 offset:0
    ds_read_b64_tr_b16 v[230:231], v247 offset:1024
    v_fmac_f32 v166, v176, v176
    v_sub_f32 v177, v155, v171
    v_fmac_f32 v167, v177, v177
    v_mfma_f32_16x16x32_bf16 v[80:83], v[232:235], v[208:211], v[80:83]
    v_sub_f32 v174, v156, v171
    v_mul_f32 v168, v174, v174
    v_sub_f32 v175, v157, v171
    v_mfma_f32_16x16x32_bf16 v[88:91], v[232:235], v[212:215], v[88:91]
    v_fmac_f32 v168, v175, v175
    v_sub_f32 v176, v158, v171
    v_fmac_f32 v168, v176, v176
    v_mfma_f32_16x16x32_bf16 v[112:115], v[232:235], v[216:219], v[112:115]
    v_sub_f32 v177, v159, v171
    v_fmac_f32 v168, v177, v177
    v_sub_f32 v174, v160, v171
    v_fmac_f32 v168, v174, v174
    v_mfma_f32_16x16x32_bf16 v[120:123], v[232:235], v[220:223], v[120:123]
    ds_read_b64_tr_b16 v[232:233], v248 offset:0
    ds_read_b64_tr_b16 v[234:235], v248 offset:1024
    v_sub_f32 v175, v161, v171
    v_fmac_f32 v168, v175, v175
    v_sub_f32 v176, v162, v171
    v_mfma_f32_16x16x32_bf16 v[84:87], v[236:239], v[208:211], v[84:87]
    v_fmac_f32 v168, v176, v176
    v_sub_f32 v177, v163, v171
    v_fmac_f32 v168, v177, v177
    v_mfma_f32_16x16x32_bf16 v[92:95], v[236:239], v[212:215], v[92:95]
    v_add_f32 v166, v166, v167
    v_fmac_f32 v166, v168, v182
    s_nop 1
    v_mfma_f32_16x16x32_bf16 v[116:119], v[236:239], v[216:219], v[116:119]
    v_add_f32_dpp v166, v166, v166 quad_perm:[1,0,3,2] row_mask:0xf bank_mask:0xf
    s_nop 1
    v_add_f32_dpp v166, v166, v166 quad_perm:[2,3,0,1] row_mask:0xf bank_mask:0xf
    v_mfma_f32_16x16x32_bf16 v[124:127], v[236:239], v[220:223], v[124:127]
    ds_read_b64_tr_b16 v[236:237], v249 offset:0
    ds_read_b64_tr_b16 v[238:239], v249 offset:1024
    s_nop 1
    v_add_f32_dpp v166, v166, v166 row_ror:8 row_mask:0xf bank_mask:0xf
    v_mov_b32 v169, v166
    s_waitcnt lgkmcnt(6)
    v_mfma_f32_16x16x32_bf16 v[0:3], v[224:227], v[192:195], v[0:3]
    ds_read_b128 v[208:211], v245 offset:8192
    s_nop 1
    v_permlane16_swap_b32 v166, v169
    v_add_f32 v166, v166, v169
    v_mfma_f32_16x16x32_bf16 v[8:11], v[224:227], v[196:199], v[8:11]
    ds_read_b128 v[212:215], v245 offset:10240
    v_mov_b32 v169, v166
    s_nop 1
    v_mfma_f32_16x16x32_bf16 v[32:35], v[224:227], v[200:203], v[32:35]
    ds_read_b128 v[216:219], v245 offset:12288
    v_permlane32_swap_b32 v166, v169
    v_add_f32 v166, v166, v169
    v_mul_f32 v166, 0x3acccccd, v166
    v_mfma_f32_16x16x32_bf16 v[40:43], v[224:227], v[204:207], v[40:43]
    ds_read_b128 v[220:223], v245 offset:14336
    v_cvt_pk_bf16_f32 v172, v171, v171
    v_and_b32 v172, 0xffff0000, v172
    s_waitcnt lgkmcnt(8)
    v_mfma_f32_16x16x32_bf16 v[4:7], v[228:231], v[192:195], v[4:7]
    v_xor_b32 v245, 64, v245
    v_cvt_pk_bf16_f32 v166, v166, v166
    v_and_b32 v166, 0xffff0000, v166
    v_add_f32 v166, 0x3727c5ac, v166
    v_mfma_f32_16x16x32_bf16 v[12:15], v[228:231], v[196:199], v[12:15]
    v_cvt_pk_bf16_f32 v166, v166, v166
    v_and_b32 v166, 0xffff0000, v166
    v_mfma_f32_16x16x32_bf16 v[36:39], v[228:231], v[200:203], v[36:39]
    v_sqrt_f32 v166, v166
    s_nop 0
    v_cvt_pk_bf16_f32 v166, v166, v166
    v_mfma_f32_16x16x32_bf16 v[44:47], v[228:231], v[204:207], v[44:47]
    v_and_b32 v166, 0xffff0000, v166
    v_rcp_f32 v173, v166
    s_waitcnt lgkmcnt(6)
    v_mfma_f32_16x16x32_bf16 v[16:19], v[232:235], v[192:195], v[16:19]
    v_sub_f32 v140, v140, v172
    v_sub_f32 v141, v141, v172
    v_cvt_pk_bf16_f32 v170, v140, v141
    v_mfma_f32_16x16x32_bf16 v[24:27], v[232:235], v[196:199], v[24:27]
    v_lshlrev_b32 v140, 16, v170
    v_and_b32 v141, 0xffff0000, v170
    v_mfma_f32_16x16x32_bf16 v[48:51], v[232:235], v[200:203], v[48:51]
    v_mul_f32 v140, v140, v173
    v_mul_f32 v141, v141, v173
    v_cvt_pk_bf16_f32 v128, v140, v141
    v_mfma_f32_16x16x32_bf16 v[56:59], v[232:235], v[204:207], v[56:59]
    v_sub_f32 v142, v142, v172
    v_sub_f32 v143, v143, v172
    s_waitcnt lgkmcnt(4)
    v_mfma_f32_16x16x32_bf16 v[20:23], v[236:239], v[192:195], v[20:23]
    v_cvt_pk_bf16_f32 v170, v142, v143
    v_lshlrev_b32 v142, 16, v170
    v_and_b32 v143, 0xffff0000, v170
    v_mfma_f32_16x16x32_bf16 v[28:31], v[236:239], v[196:199], v[28:31]
    v_mul_f32 v142, v142, v173
    v_mul_f32 v143, v143, v173
    v_mfma_f32_16x16x32_bf16 v[52:55], v[236:239], v[200:203], v[52:55]
    v_cvt_pk_bf16_f32 v129, v142, v143
    v_sub_f32 v144, v144, v172
    v_sub_f32 v145, v145, v172
    v_mfma_f32_16x16x32_bf16 v[60:63], v[236:239], v[204:207], v[60:63]
    v_cvt_pk_bf16_f32 v170, v144, v145
    v_lshlrev_b32 v144, 16, v170
    s_waitcnt vmcnt(11) lgkmcnt(0)
    s_barrier
    v_mfma_f32_16x16x32_bf16 v[64:67], v[224:227], v[208:211], v[64:67]
    ds_read_b128 v[192:195], v245 offset:0
    s_add_u32 m0, s81, 0
    s_add_u32 s87, s86, 14336
    buffer_load_dwordx4 v243, s[32:35], s87 offen offset:2048 lds
    buffer_load_dwordx4 v183, s[32:35], s87 offen offset:3072 lds
    v_mfma_f32_16x16x32_bf16 v[72:75], v[224:227], v[212:215], v[72:75]
    ds_read_b128 v[196:199], v245 offset:2048
    s_add_u32 s86, s86, 128
    s_add_u32 m0, s83, 98304
    s_add_u32 s89, s88, 31744
    v_mfma_f32_16x16x32_bf16 v[96:99], v[224:227], v[216:219], v[96:99]
    ds_read_b128 v[200:203], v245 offset:4096
    buffer_load_dwordx4 v244, s[36:39], s88 offen nt lds
    buffer_load_dwordx4 v244, s[36:39], s89 offen offset:1024 nt lds
    s_add_u32 s88, s88, 262144
    v_mfma_f32_16x16x32_bf16 v[104:107], v[224:227], v[220:223], v[104:107]
    ds_read_b64_tr_b16 v[224:225], v246 offset:16384
    ds_read_b64_tr_b16 v[226:227], v246 offset:17408
    ds_read_b128 v[204:207], v245 offset:6144
    v_and_b32 v145, 0xffff0000, v170
    v_mul_f32 v144, v144, v173
    v_mul_f32 v145, v145, v173
    v_mfma_f32_16x16x32_bf16 v[68:71], v[228:231], v[208:211], v[68:71]
    v_cvt_pk_bf16_f32 v130, v144, v145
    v_sub_f32 v146, v146, v172
    v_sub_f32 v147, v147, v172
    v_mfma_f32_16x16x32_bf16 v[76:79], v[228:231], v[212:215], v[76:79]
    v_cvt_pk_bf16_f32 v170, v146, v147
    v_lshlrev_b32 v146, 16, v170
    v_and_b32 v147, 0xffff0000, v170
    v_mfma_f32_16x16x32_bf16 v[100:103], v[228:231], v[216:219], v[100:103]
    v_mul_f32 v146, v146, v173
    v_mul_f32 v147, v147, v173
    v_cvt_pk_bf16_f32 v131, v146, v147
    v_mfma_f32_16x16x32_bf16 v[108:111], v[228:231], v[220:223], v[108:111]
    ds_read_b64_tr_b16 v[228:229], v247 offset:16384
    ds_read_b64_tr_b16 v[230:231], v247 offset:17408
    v_sub_f32 v148, v148, v172
    v_sub_f32 v149, v149, v172
    v_cvt_pk_bf16_f32 v170, v148, v149
    v_mfma_f32_16x16x32_bf16 v[80:83], v[232:235], v[208:211], v[80:83]
    v_lshlrev_b32 v148, 16, v170
    v_and_b32 v149, 0xffff0000, v170
    v_mul_f32 v148, v148, v173
    v_mul_f32 v149, v149, v173
    v_mfma_f32_16x16x32_bf16 v[88:91], v[232:235], v[212:215], v[88:91]
    v_cvt_pk_bf16_f32 v132, v148, v149
    v_sub_f32 v150, v150, v172
    v_sub_f32 v151, v151, v172
    v_mfma_f32_16x16x32_bf16 v[112:115], v[232:235], v[216:219], v[112:115]
    v_cvt_pk_bf16_f32 v170, v150, v151
    v_lshlrev_b32 v150, 16, v170
    v_and_b32 v151, 0xffff0000, v170
    v_mfma_f32_16x16x32_bf16 v[120:123], v[232:235], v[220:223], v[120:123]
    ds_read_b64_tr_b16 v[232:233], v248 offset:16384
    ds_read_b64_tr_b16 v[234:235], v248 offset:17408
    v_mul_f32 v150, v150, v173
    v_mul_f32 v151, v151, v173
    v_cvt_pk_bf16_f32 v133, v150, v151
    v_mfma_f32_16x16x32_bf16 v[84:87], v[236:239], v[208:211], v[84:87]
    v_sub_f32 v152, v152, v172
    v_sub_f32 v153, v153, v172
    v_cvt_pk_bf16_f32 v170, v152, v153
    v_mfma_f32_16x16x32_bf16 v[92:95], v[236:239], v[212:215], v[92:95]
    v_lshlrev_b32 v152, 16, v170
    v_and_b32 v153, 0xffff0000, v170
    v_mul_f32 v152, v152, v173
    v_mfma_f32_16x16x32_bf16 v[116:119], v[236:239], v[216:219], v[116:119]
    v_mul_f32 v153, v153, v173
    v_cvt_pk_bf16_f32 v134, v152, v153
    v_sub_f32 v154, v154, v172
    v_mfma_f32_16x16x32_bf16 v[124:127], v[236:239], v[220:223], v[124:127]
    ds_read_b64_tr_b16 v[236:237], v249 offset:16384
    ds_read_b64_tr_b16 v[238:239], v249 offset:17408
    v_sub_f32 v155, v155, v172
    v_cvt_pk_bf16_f32 v170, v154, v155
    v_lshlrev_b32 v154, 16, v170
    s_waitcnt lgkmcnt(6)
    v_mfma_f32_16x16x32_bf16 v[0:3], v[224:227], v[192:195], v[0:3]
    ds_read_b128 v[208:211], v245 offset:8192
    v_and_b32 v155, 0xffff0000, v170
    v_mul_f32 v154, v154, v173
    v_mul_f32 v155, v155, v173
    v_mfma_f32_16x16x32_bf16 v[8:11], v[224:227], v[196:199], v[8:11]
    ds_read_b128 v[212:215], v245 offset:10240
    v_cvt_pk_bf16_f32 v135, v154, v155
    v_sub_f32 v156, v156, v172
    v_mfma_f32_16x16x32_bf16 v[32:35], v[224:227], v[200:203], v[32:35]
    ds_read_b128 v[216:219], v245 offset:12288
    v_sub_f32 v157, v157, v172
    v_cvt_pk_bf16_f32 v170, v156, v157
    v_lshlrev_b32 v156, 16, v170
    v_mfma_f32_16x16x32_bf16 v[40:43], v[224:227], v[204:207], v[40:43]
    ds_read_b128 v[220:223], v245 offset:14336
    v_and_b32 v157, 0xffff0000, v170
    v_mul_f32 v156, v156, v173
    s_waitcnt lgkmcnt(8)
    v_mfma_f32_16x16x32_bf16 v[4:7], v[228:231], v[192:195], v[4:7]
    v_xor_b32 v245, 64, v245
    v_mul_f32 v157, v157, v173
    v_cvt_pk_bf16_f32 v136, v156, v157
    v_sub_f32 v158, v158, v172
    v_mfma_f32_16x16x32_bf16 v[12:15], v[228:231], v[196:199], v[12:15]
    v_add_u32 v245, 0x10000, v245
    v_sub_f32 v159, v159, v172
    v_cvt_pk_bf16_f32 v170, v158, v159
    v_mfma_f32_16x16x32_bf16 v[36:39], v[228:231], v[200:203], v[36:39]
    v_xor_b32 v246, 0x10000, v246
    v_lshlrev_b32 v158, 16, v170
    v_and_b32 v159, 0xffff0000, v170
    v_mul_f32 v158, v158, v173
    v_mfma_f32_16x16x32_bf16 v[44:47], v[228:231], v[204:207], v[44:47]
    v_xor_b32 v247, 0x10000, v247
    v_mul_f32 v159, v159, v173
    v_cvt_pk_bf16_f32 v137, v158, v159
    s_waitcnt lgkmcnt(6)
    v_mfma_f32_16x16x32_bf16 v[16:19], v[232:235], v[192:195], v[16:19]
    v_xor_b32 v248, 0x10000, v248
    v_sub_f32 v160, v160, v172
    v_sub_f32 v161, v161, v172
    v_mfma_f32_16x16x32_bf16 v[24:27], v[232:235], v[196:199], v[24:27]
    v_xor_b32 v249, 0x10000, v249
    v_cvt_pk_bf16_f32 v170, v160, v161
    v_lshlrev_b32 v160, 16, v170
    v_and_b32 v161, 0xffff0000, v170
    v_mfma_f32_16x16x32_bf16 v[48:51], v[232:235], v[200:203], v[48:51]
    v_mul_f32 v160, v160, v173
    v_mul_f32 v161, v161, v173
    v_mfma_f32_16x16x32_bf16 v[56:59], v[232:235], v[204:207], v[56:59]
    v_cvt_pk_bf16_f32 v138, v160, v161
    v_sub_f32 v162, v162, v172
    v_sub_f32 v163, v163, v172
    s_waitcnt lgkmcnt(4)
    v_mfma_f32_16x16x32_bf16 v[20:23], v[236:239], v[192:195], v[20:23]
    v_cvt_pk_bf16_f32 v170, v162, v163
    v_lshlrev_b32 v162, 16, v170
    v_mfma_f32_16x16x32_bf16 v[28:31], v[236:239], v[196:199], v[28:31]
    v_and_b32 v163, 0xffff0000, v170
    v_mul_f32 v162, v162, v173
    v_mul_f32 v163, v163, v173
    v_mfma_f32_16x16x32_bf16 v[52:55], v[236:239], v[200:203], v[52:55]
    v_cvt_pk_bf16_f32 v139, v162, v163
    buffer_store_dwordx4 v[128:131], v180, s[44:47], 0 offen sc1
    v_mfma_f32_16x16x32_bf16 v[60:63], v[236:239], v[204:207], v[60:63]
    buffer_store_dwordx4 v[132:135], v180, s[44:47], s92 offen sc1
    buffer_store_dwordx4 v[136:139], v181, s[44:47], s93 offen sc1
    s_waitcnt vmcnt(12) lgkmcnt(0)
    s_barrier
    v_mfma_f32_16x16x32_bf16 v[64:67], v[224:227], v[208:211], v[64:67]
    ds_read_b128 v[192:195], v245 offset:0
    s_add_u32 m0, s83, 114688
    v_mfma_f32_16x16x32_bf16 v[72:75], v[224:227], v[212:215], v[72:75]
    ds_read_b128 v[196:199], v245 offset:2048
    s_add_u32 s89, s88, 31744
    v_mfma_f32_16x16x32_bf16 v[96:99], v[224:227], v[216:219], v[96:99]
    ds_read_b128 v[200:203], v245 offset:4096
    v_mfma_f32_16x16x32_bf16 v[104:107], v[224:227], v[220:223], v[104:107]
    ds_read_b64_tr_b16 v[224:225], v246 offset:0
    ds_read_b64_tr_b16 v[226:227], v246 offset:1024
    ds_read_b128 v[204:207], v245 offset:6144
    buffer_load_dwordx4 v244, s[36:39], s88 offen nt lds
    v_mfma_f32_16x16x32_bf16 v[68:71], v[228:231], v[208:211], v[68:71]
    v_mfma_f32_16x16x32_bf16 v[76:79], v[228:231], v[212:215], v[76:79]
    buffer_load_dwordx4 v244, s[36:39], s89 offen offset:1024 nt lds
    v_mfma_f32_16x16x32_bf16 v[100:103], v[228:231], v[216:219], v[100:103]
    v_mfma_f32_16x16x32_bf16 v[108:111], v[228:231], v[220:223], v[108:111]
    ds_read_b64_tr_b16 v[228:229], v247 offset:0
    ds_read_b64_tr_b16 v[230:231], v247 offset:1024
    s_add_u32 s88, s88, 262144
    v_mfma_f32_16x16x32_bf16 v[80:83], v[232:235], v[208:211], v[80:83]
    s_add_u32 m0, s81, 65536
    v_mfma_f32_16x16x32_bf16 v[88:91], v[232:235], v[212:215], v[88:91]
    v_mfma_f32_16x16x32_bf16 v[112:115], v[232:235], v[216:219], v[112:115]
    s_nop 0
    v_mfma_f32_16x16x32_bf16 v[120:123], v[232:235], v[220:223], v[120:123]
    ds_read_b64_tr_b16 v[232:233], v248 offset:0
    ds_read_b64_tr_b16 v[234:235], v248 offset:1024
    v_mfma_f32_16x16x32_bf16 v[84:87], v[236:239], v[208:211], v[84:87]
    buffer_load_dwordx4 v243, s[32:35], s86 offen lds
    v_mfma_f32_16x16x32_bf16 v[92:95], v[236:239], v[212:215], v[92:95]
    v_mfma_f32_16x16x32_bf16 v[116:119], v[236:239], v[216:219], v[116:119]
    buffer_load_dwordx4 v183, s[32:35], s86 offen offset:1024 lds
    v_mfma_f32_16x16x32_bf16 v[124:127], v[236:239], v[220:223], v[124:127]
    ds_read_b64_tr_b16 v[236:237], v249 offset:0
    ds_read_b64_tr_b16 v[238:239], v249 offset:1024
    s_waitcnt lgkmcnt(6)
    v_mfma_f32_16x16x32_bf16 v[0:3], v[224:227], v[192:195], v[0:3]
    ds_read_b128 v[208:211], v245 offset:8192
    v_mfma_f32_16x16x32_bf16 v[8:11], v[224:227], v[196:199], v[8:11]
    ds_read_b128 v[212:215], v245 offset:10240
    v_mfma_f32_16x16x32_bf16 v[32:35], v[224:227], v[200:203], v[32:35]
    ds_read_b128 v[216:219], v245 offset:12288
    v_mfma_f32_16x16x32_bf16 v[40:43], v[224:227], v[204:207], v[40:43]
    ds_read_b128 v[220:223], v245 offset:14336
    s_waitcnt lgkmcnt(8)
    v_mfma_f32_16x16x32_bf16 v[4:7], v[228:231], v[192:195], v[4:7]
    v_xor_b32 v245, 64, v245
    v_mfma_f32_16x16x32_bf16 v[12:15], v[228:231], v[196:199], v[12:15]
    v_mfma_f32_16x16x32_bf16 v[36:39], v[228:231], v[200:203], v[36:39]
    v_mfma_f32_16x16x32_bf16 v[44:47], v[228:231], v[204:207], v[44:47]
    s_waitcnt lgkmcnt(6)
    v_mfma_f32_16x16x32_bf16 v[16:19], v[232:235], v[192:195], v[16:19]
    v_mfma_f32_16x16x32_bf16 v[24:27], v[232:235], v[196:199], v[24:27]
    v_mfma_f32_16x16x32_bf16 v[48:51], v[232:235], v[200:203], v[48:51]
    v_mfma_f32_16x16x32_bf16 v[56:59], v[232:235], v[204:207], v[56:59]
    s_waitcnt lgkmcnt(4)
    v_mfma_f32_16x16x32_bf16 v[20:23], v[236:239], v[192:195], v[20:23]
    v_mfma_f32_16x16x32_bf16 v[28:31], v[236:239], v[196:199], v[28:31]
    v_mfma_f32_16x16x32_bf16 v[52:55], v[236:239], v[200:203], v[52:55]
    v_mfma_f32_16x16x32_bf16 v[60:63], v[236:239], v[204:207], v[60:63]
    s_waitcnt vmcnt(13) lgkmcnt(0)
    s_barrier
    v_mfma_f32_16x16x32_bf16 v[64:67], v[224:227], v[208:211], v[64:67]
    ds_read_b128 v[192:195], v245 offset:0
    s_add_u32 m0, s81, 65536
    v_mfma_f32_16x16x32_bf16 v[72:75], v[224:227], v[212:215], v[72:75]
    ds_read_b128 v[196:199], v245 offset:2048
    s_add_u32 s87, s86, 14336
    v_mfma_f32_16x16x32_bf16 v[96:99], v[224:227], v[216:219], v[96:99]
    ds_read_b128 v[200:203], v245 offset:4096
    v_mfma_f32_16x16x32_bf16 v[104:107], v[224:227], v[220:223], v[104:107]
    ds_read_b64_tr_b16 v[224:225], v246 offset:16384
    ds_read_b64_tr_b16 v[226:227], v246 offset:17408
    ds_read_b128 v[204:207], v245 offset:6144
    buffer_load_dwordx4 v243, s[32:35], s87 offen offset:2048 lds
    v_mfma_f32_16x16x32_bf16 v[68:71], v[228:231], v[208:211], v[68:71]
    buffer_load_dwordx4 v183, s[32:35], s87 offen offset:3072 lds
    v_mfma_f32_16x16x32_bf16 v[76:79], v[228:231], v[212:215], v[76:79]
    v_mfma_f32_16x16x32_bf16 v[100:103], v[228:231], v[216:219], v[100:103]
    s_add_u32 s86, s86, 128
    v_mfma_f32_16x16x32_bf16 v[108:111], v[228:231], v[220:223], v[108:111]
    ds_read_b64_tr_b16 v[228:229], v247 offset:16384
    ds_read_b64_tr_b16 v[230:231], v247 offset:17408
    v_mfma_f32_16x16x32_bf16 v[80:83], v[232:235], v[208:211], v[80:83]
    s_add_u32 m0, s83, 32768
    v_mfma_f32_16x16x32_bf16 v[88:91], v[232:235], v[212:215], v[88:91]
    s_add_u32 s89, s88, 31744
    v_mfma_f32_16x16x32_bf16 v[112:115], v[232:235], v[216:219], v[112:115]
    v_mfma_f32_16x16x32_bf16 v[120:123], v[232:235], v[220:223], v[120:123]
    ds_read_b64_tr_b16 v[232:233], v248 offset:16384
    ds_read_b64_tr_b16 v[234:235], v248 offset:17408
    buffer_load_dwordx4 v244, s[36:39], s88 offen nt lds
    v_mfma_f32_16x16x32_bf16 v[84:87], v[236:239], v[208:211], v[84:87]
    buffer_load_dwordx4 v244, s[36:39], s89 offen offset:1024 nt lds
    v_mfma_f32_16x16x32_bf16 v[92:95], v[236:239], v[212:215], v[92:95]
    v_mfma_f32_16x16x32_bf16 v[116:119], v[236:239], v[216:219], v[116:119]
    s_add_u32 s88, s88, 262144
    v_mfma_f32_16x16x32_bf16 v[124:127], v[236:239], v[220:223], v[124:127]
    ds_read_b64_tr_b16 v[236:237], v249 offset:16384
    ds_read_b64_tr_b16 v[238:239], v249 offset:17408
    s_waitcnt lgkmcnt(6)
    v_mfma_f32_16x16x32_bf16 v[0:3], v[224:227], v[192:195], v[0:3]
    ds_read_b128 v[208:211], v245 offset:8192
    s_cmp_eq_u32 s76, 0
    v_mfma_f32_16x16x32_bf16 v[8:11], v[224:227], v[196:199], v[8:11]
    ds_read_b128 v[212:215], v245 offset:10240
    v_mfma_f32_16x16x32_bf16 v[32:35], v[224:227], v[200:203], v[32:35]
    ds_read_b128 v[216:219], v245 offset:12288
    v_mfma_f32_16x16x32_bf16 v[40:43], v[224:227], v[204:207], v[40:43]
    ds_read_b128 v[220:223], v245 offset:14336
    s_waitcnt lgkmcnt(8)
    v_mfma_f32_16x16x32_bf16 v[4:7], v[228:231], v[192:195], v[4:7]
    v_xor_b32 v245, 64, v245
    v_mfma_f32_16x16x32_bf16 v[12:15], v[228:231], v[196:199], v[12:15]
    v_add_u32 v245, 0xfffe0000, v245
    s_cselect_b32 s78, s101, 0x40000000
    v_mfma_f32_16x16x32_bf16 v[36:39], v[228:231], v[200:203], v[36:39]
    v_xor_b32 v246, 0x10000, v246
    v_mfma_f32_16x16x32_bf16 v[44:47], v[228:231], v[204:207], v[44:47]
    v_xor_b32 v247, 0x10000, v247
    s_waitcnt lgkmcnt(6)
    v_mfma_f32_16x16x32_bf16 v[16:19], v[232:235], v[192:195], v[16:19]
    v_xor_b32 v248, 0x10000, v248
    v_mfma_f32_16x16x32_bf16 v[24:27], v[232:235], v[196:199], v[24:27]
    v_xor_b32 v249, 0x10000, v249
    v_mfma_f32_16x16x32_bf16 v[48:51], v[232:235], v[200:203], v[48:51]
    buffer_load_dword v254, v184, s[48:51], s78 offen
    v_mfma_f32_16x16x32_bf16 v[56:59], v[232:235], v[204:207], v[56:59]
    s_waitcnt lgkmcnt(4)
    v_mfma_f32_16x16x32_bf16 v[20:23], v[236:239], v[192:195], v[20:23]
    v_mfma_f32_16x16x32_bf16 v[28:31], v[236:239], v[196:199], v[28:31]
    v_mfma_f32_16x16x32_bf16 v[52:55], v[236:239], v[200:203], v[52:55]
    v_mfma_f32_16x16x32_bf16 v[60:63], v[236:239], v[204:207], v[60:63]
    s_waitcnt vmcnt(12) lgkmcnt(0)
    s_barrier
    v_mfma_f32_16x16x32_bf16 v[64:67], v[224:227], v[208:211], v[64:67]
    ds_read_b128 v[192:195], v245 offset:0
    s_add_u32 m0, s83, 49152
    v_mfma_f32_16x16x32_bf16 v[72:75], v[224:227], v[212:215], v[72:75]
    ds_read_b128 v[196:199], v245 offset:2048
    s_add_u32 s89, s88, 31744
    v_mfma_f32_16x16x32_bf16 v[96:99], v[224:227], v[216:219], v[96:99]
    ds_read_b128 v[200:203], v245 offset:4096
    v_mfma_f32_16x16x32_bf16 v[104:107], v[224:227], v[220:223], v[104:107]
    ds_read_b64_tr_b16 v[224:225], v246 offset:0
    ds_read_b64_tr_b16 v[226:227], v246 offset:1024
    ds_read_b128 v[204:207], v245 offset:6144
    buffer_load_dwordx4 v244, s[36:39], s88 offen nt lds
    v_mfma_f32_16x16x32_bf16 v[68:71], v[228:231], v[208:211], v[68:71]
    v_mfma_f32_16x16x32_bf16 v[76:79], v[228:231], v[212:215], v[76:79]
    buffer_load_dwordx4 v244, s[36:39], s89 offen offset:1024 nt lds
    v_mfma_f32_16x16x32_bf16 v[100:103], v[228:231], v[216:219], v[100:103]
    v_mfma_f32_16x16x32_bf16 v[108:111], v[228:231], v[220:223], v[108:111]
    ds_read_b64_tr_b16 v[228:229], v247 offset:0
    ds_read_b64_tr_b16 v[230:231], v247 offset:1024
    s_add_u32 s88, s88, 262144
    v_mfma_f32_16x16x32_bf16 v[80:83], v[232:235], v[208:211], v[80:83]
    s_add_u32 m0, s81, 131072
    v_mfma_f32_16x16x32_bf16 v[88:91], v[232:235], v[212:215], v[88:91]
    v_mfma_f32_16x16x32_bf16 v[112:115], v[232:235], v[216:219], v[112:115]
    s_nop 0
    v_mfma_f32_16x16x32_bf16 v[120:123], v[232:235], v[220:223], v[120:123]
    ds_read_b64_tr_b16 v[232:233], v248 offset:0
    ds_read_b64_tr_b16 v[234:235], v248 offset:1024
    v_mfma_f32_16x16x32_bf16 v[84:87], v[236:239], v[208:211], v[84:87]
    buffer_load_dwordx4 v243, s[32:35], s86 offen lds
    v_mfma_f32_16x16x32_bf16 v[92:95], v[236:239], v[212:215], v[92:95]
    v_mfma_f32_16x16x32_bf16 v[116:119], v[236:239], v[216:219], v[116:119]
    buffer_load_dwordx4 v183, s[32:35], s86 offen offset:1024 lds
    v_mfma_f32_16x16x32_bf16 v[124:127], v[236:239], v[220:223], v[124:127]
    ds_read_b64_tr_b16 v[236:237], v249 offset:0
    ds_read_b64_tr_b16 v[238:239], v249 offset:1024
    s_waitcnt lgkmcnt(6)
    v_mfma_f32_16x16x32_bf16 v[0:3], v[224:227], v[192:195], v[0:3]
    ds_read_b128 v[208:211], v245 offset:8192
    v_mfma_f32_16x16x32_bf16 v[8:11], v[224:227], v[196:199], v[8:11]
    ds_read_b128 v[212:215], v245 offset:10240
    v_mfma_f32_16x16x32_bf16 v[32:35], v[224:227], v[200:203], v[32:35]
    ds_read_b128 v[216:219], v245 offset:12288
    v_mfma_f32_16x16x32_bf16 v[40:43], v[224:227], v[204:207], v[40:43]
    ds_read_b128 v[220:223], v245 offset:14336
    s_waitcnt lgkmcnt(8)
    v_mfma_f32_16x16x32_bf16 v[4:7], v[228:231], v[192:195], v[4:7]
    v_xor_b32 v245, 64, v245
    v_mfma_f32_16x16x32_bf16 v[12:15], v[228:231], v[196:199], v[12:15]
    v_mfma_f32_16x16x32_bf16 v[36:39], v[228:231], v[200:203], v[36:39]
    v_mfma_f32_16x16x32_bf16 v[44:47], v[228:231], v[204:207], v[44:47]
    s_waitcnt lgkmcnt(6)
    v_mfma_f32_16x16x32_bf16 v[16:19], v[232:235], v[192:195], v[16:19]
    v_mfma_f32_16x16x32_bf16 v[24:27], v[232:235], v[196:199], v[24:27]
    v_mfma_f32_16x16x32_bf16 v[48:51], v[232:235], v[200:203], v[48:51]
    v_mfma_f32_16x16x32_bf16 v[56:59], v[232:235], v[204:207], v[56:59]
    s_waitcnt lgkmcnt(4)
    v_mfma_f32_16x16x32_bf16 v[20:23], v[236:239], v[192:195], v[20:23]
    v_mfma_f32_16x16x32_bf16 v[28:31], v[236:239], v[196:199], v[28:31]
    v_mfma_f32_16x16x32_bf16 v[52:55], v[236:239], v[200:203], v[52:55]
    v_mfma_f32_16x16x32_bf16 v[60:63], v[236:239], v[204:207], v[60:63]
    s_waitcnt vmcnt(11) lgkmcnt(0)
    s_barrier
    v_mfma_f32_16x16x32_bf16 v[64:67], v[224:227], v[208:211], v[64:67]
    ds_read_b128 v[192:195], v245 offset:0
    s_add_u32 m0, s81, 131072
    v_mfma_f32_16x16x32_bf16 v[72:75], v[224:227], v[212:215], v[72:75]
    ds_read_b128 v[196:199], v245 offset:2048
    s_add_u32 s87, s86, 14336
    v_mfma_f32_16x16x32_bf16 v[96:99], v[224:227], v[216:219], v[96:99]
    ds_read_b128 v[200:203], v245 offset:4096
    v_mfma_f32_16x16x32_bf16 v[104:107], v[224:227], v[220:223], v[104:107]
    ds_read_b64_tr_b16 v[224:225], v246 offset:16384
    ds_read_b64_tr_b16 v[226:227], v246 offset:17408
    ds_read_b128 v[204:207], v245 offset:6144
    buffer_load_dwordx4 v243, s[32:35], s87 offen offset:2048 lds
    v_mfma_f32_16x16x32_bf16 v[68:71], v[228:231], v[208:211], v[68:71]
    buffer_load_dwordx4 v183, s[32:35], s87 offen offset:3072 lds
    v_mfma_f32_16x16x32_bf16 v[76:79], v[228:231], v[212:215], v[76:79]
    v_mfma_f32_16x16x32_bf16 v[100:103], v[228:231], v[216:219], v[100:103]
    s_add_u32 s86, s86, 128
    v_mfma_f32_16x16x32_bf16 v[108:111], v[228:231], v[220:223], v[108:111]
    ds_read_b64_tr_b16 v[228:229], v247 offset:16384
    ds_read_b64_tr_b16 v[230:231], v247 offset:17408
    v_mfma_f32_16x16x32_bf16 v[80:83], v[232:235], v[208:211], v[80:83]
    s_add_u32 m0, s83, 98304
    v_mfma_f32_16x16x32_bf16 v[88:91], v[232:235], v[212:215], v[88:91]
    s_add_u32 s89, s88, 31744
    v_mfma_f32_16x16x32_bf16 v[112:115], v[232:235], v[216:219], v[112:115]
    v_mfma_f32_16x16x32_bf16 v[120:123], v[232:235], v[220:223], v[120:123]
    ds_read_b64_tr_b16 v[232:233], v248 offset:16384
    ds_read_b64_tr_b16 v[234:235], v248 offset:17408
    buffer_load_dwordx4 v244, s[36:39], s88 offen nt lds
    v_mfma_f32_16x16x32_bf16 v[84:87], v[236:239], v[208:211], v[84:87]
    buffer_load_dwordx4 v244, s[36:39], s89 offen offset:1024 nt lds
    v_mfma_f32_16x16x32_bf16 v[92:95], v[236:239], v[212:215], v[92:95]
    v_mfma_f32_16x16x32_bf16 v[116:119], v[236:239], v[216:219], v[116:119]
    s_add_u32 s88, s88, 262144
    v_mfma_f32_16x16x32_bf16 v[124:127], v[236:239], v[220:223], v[124:127]
    ds_read_b64_tr_b16 v[236:237], v249 offset:16384
    ds_read_b64_tr_b16 v[238:239], v249 offset:17408
    s_waitcnt lgkmcnt(6)
    v_mfma_f32_16x16x32_bf16 v[0:3], v[224:227], v[192:195], v[0:3]
    ds_read_b128 v[208:211], v245 offset:8192
    s_cmp_eq_u32 s76, 3
    v_mfma_f32_16x16x32_bf16 v[8:11], v[224:227], v[196:199], v[8:11]
    ds_read_b128 v[212:215], v245 offset:10240
    v_mfma_f32_16x16x32_bf16 v[32:35], v[224:227], v[200:203], v[32:35]
    ds_read_b128 v[216:219], v245 offset:12288
    v_mfma_f32_16x16x32_bf16 v[40:43], v[224:227], v[204:207], v[40:43]
    ds_read_b128 v[220:223], v245 offset:14336
    s_waitcnt lgkmcnt(8)
    v_mfma_f32_16x16x32_bf16 v[4:7], v[228:231], v[192:195], v[4:7]
    v_xor_b32 v245, 64, v245
    s_cselect_b32 s78, s101, 0x40000000
    v_mfma_f32_16x16x32_bf16 v[12:15], v[228:231], v[196:199], v[12:15]
    v_add_u32 v245, 0x10000, v245
    v_mfma_f32_16x16x32_bf16 v[36:39], v[228:231], v[200:203], v[36:39]
    v_xor_b32 v246, 0x10000, v246
    v_mfma_f32_16x16x32_bf16 v[44:47], v[228:231], v[204:207], v[44:47]
    v_xor_b32 v247, 0x10000, v247
    s_waitcnt lgkmcnt(6)
    v_mfma_f32_16x16x32_bf16 v[16:19], v[232:235], v[192:195], v[16:19]
    v_xor_b32 v248, 0x10000, v248
    buffer_load_dword v254, v184, s[48:51], s78 offen
    v_mfma_f32_16x16x32_bf16 v[24:27], v[232:235], v[196:199], v[24:27]
    v_xor_b32 v249, 0x10000, v249
    v_mfma_f32_16x16x32_bf16 v[48:51], v[232:235], v[200:203], v[48:51]
    v_mfma_f32_16x16x32_bf16 v[56:59], v[232:235], v[204:207], v[56:59]
    s_waitcnt lgkmcnt(4)
    v_mfma_f32_16x16x32_bf16 v[20:23], v[236:239], v[192:195], v[20:23]
    s_add_u32 s101, s101, s30
    v_mfma_f32_16x16x32_bf16 v[28:31], v[236:239], v[196:199], v[28:31]
    v_mfma_f32_16x16x32_bf16 v[52:55], v[236:239], v[200:203], v[52:55]
    v_mfma_f32_16x16x32_bf16 v[60:63], v[236:239], v[204:207], v[60:63]
    s_waitcnt vmcnt(10) lgkmcnt(0)
    s_barrier
    v_mfma_f32_16x16x32_bf16 v[64:67], v[224:227], v[208:211], v[64:67]
    ds_read_b128 v[192:195], v245 offset:0
    s_add_u32 m0, s83, 114688
    v_mfma_f32_16x16x32_bf16 v[72:75], v[224:227], v[212:215], v[72:75]
    ds_read_b128 v[196:199], v245 offset:2048
    s_add_u32 s89, s88, 31744
    v_mfma_f32_16x16x32_bf16 v[96:99], v[224:227], v[216:219], v[96:99]
    ds_read_b128 v[200:203], v245 offset:4096
    v_mfma_f32_16x16x32_bf16 v[104:107], v[224:227], v[220:223], v[104:107]
    ds_read_b64_tr_b16 v[224:225], v246 offset:0
    ds_read_b64_tr_b16 v[226:227], v246 offset:1024
    ds_read_b128 v[204:207], v245 offset:6144
    buffer_load_dwordx4 v244, s[36:39], s88 offen nt lds
    v_mfma_f32_16x16x32_bf16 v[68:71], v[228:231], v[208:211], v[68:71]
    v_mfma_f32_16x16x32_bf16 v[76:79], v[228:231], v[212:215], v[76:79]
    buffer_load_dwordx4 v244, s[36:39], s89 offen offset:1024 nt lds
    v_mfma_f32_16x16x32_bf16 v[100:103], v[228:231], v[216:219], v[100:103]
    v_mfma_f32_16x16x32_bf16 v[108:111], v[228:231], v[220:223], v[108:111]
    ds_read_b64_tr_b16 v[228:229], v247 offset:0
    ds_read_b64_tr_b16 v[230:231], v247 offset:1024
    s_add_u32 s88, s88, 262144
    v_mfma_f32_16x16x32_bf16 v[80:83], v[232:235], v[208:211], v[80:83]
    s_add_u32 m0, s81, 0
    v_mfma_f32_16x16x32_bf16 v[88:91], v[232:235], v[212:215], v[88:91]
    v_mfma_f32_16x16x32_bf16 v[112:115], v[232:235], v[216:219], v[112:115]
    s_nop 0
    v_mfma_f32_16x16x32_bf16 v[120:123], v[232:235], v[220:223], v[120:123]
    ds_read_b64_tr_b16 v[232:233], v248 offset:0
    ds_read_b64_tr_b16 v[234:235], v248 offset:1024
    v_mfma_f32_16x16x32_bf16 v[84:87], v[236:239], v[208:211], v[84:87]
    buffer_load_dwordx4 v243, s[32:35], s86 offen lds
    v_mfma_f32_16x16x32_bf16 v[92:95], v[236:239], v[212:215], v[92:95]
    v_mfma_f32_16x16x32_bf16 v[116:119], v[236:239], v[216:219], v[116:119]
    buffer_load_dwordx4 v183, s[32:35], s86 offen offset:1024 lds
    v_mfma_f32_16x16x32_bf16 v[124:127], v[236:239], v[220:223], v[124:127]
    ds_read_b64_tr_b16 v[236:237], v249 offset:0
    ds_read_b64_tr_b16 v[238:239], v249 offset:1024
    s_waitcnt lgkmcnt(6)
    v_mfma_f32_16x16x32_bf16 v[0:3], v[224:227], v[192:195], v[0:3]
    ds_read_b128 v[208:211], v245 offset:8192
    v_mfma_f32_16x16x32_bf16 v[8:11], v[224:227], v[196:199], v[8:11]
    ds_read_b128 v[212:215], v245 offset:10240
    v_mfma_f32_16x16x32_bf16 v[32:35], v[224:227], v[200:203], v[32:35]
    ds_read_b128 v[216:219], v245 offset:12288
    v_mfma_f32_16x16x32_bf16 v[40:43], v[224:227], v[204:207], v[40:43]
    ds_read_b128 v[220:223], v245 offset:14336
    s_waitcnt lgkmcnt(8)
    v_mfma_f32_16x16x32_bf16 v[4:7], v[228:231], v[192:195], v[4:7]
    v_xor_b32 v245, 64, v245
    v_mfma_f32_16x16x32_bf16 v[12:15], v[228:231], v[196:199], v[12:15]
    v_mfma_f32_16x16x32_bf16 v[36:39], v[228:231], v[200:203], v[36:39]
    v_mfma_f32_16x16x32_bf16 v[44:47], v[228:231], v[204:207], v[44:47]
    s_waitcnt lgkmcnt(6)
    v_mfma_f32_16x16x32_bf16 v[16:19], v[232:235], v[192:195], v[16:19]
    v_mfma_f32_16x16x32_bf16 v[24:27], v[232:235], v[196:199], v[24:27]
    v_mfma_f32_16x16x32_bf16 v[48:51], v[232:235], v[200:203], v[48:51]
    v_mfma_f32_16x16x32_bf16 v[56:59], v[232:235], v[204:207], v[56:59]
    s_waitcnt lgkmcnt(4)
    v_mfma_f32_16x16x32_bf16 v[20:23], v[236:239], v[192:195], v[20:23]
    v_mfma_f32_16x16x32_bf16 v[28:31], v[236:239], v[196:199], v[28:31]
    v_mfma_f32_16x16x32_bf16 v[52:55], v[236:239], v[200:203], v[52:55]
    v_mfma_f32_16x16x32_bf16 v[60:63], v[236:239], v[204:207], v[60:63]
    s_waitcnt vmcnt(11) lgkmcnt(0)
    s_barrier
    v_mfma_f32_16x16x32_bf16 v[64:67], v[224:227], v[208:211], v[64:67]
    ds_read_b128 v[192:195], v245 offset:0
    s_add_u32 m0, s81, 0
    v_mfma_f32_16x16x32_bf16 v[72:75], v[224:227], v[212:215], v[72:75]
    ds_read_b128 v[196:199], v245 offset:2048
    s_add_u32 s87, s86, 14336
    v_mfma_f32_16x16x32_bf16 v[96:99], v[224:227], v[216:219], v[96:99]
    ds_read_b128 v[200:203], v245 offset:4096
    v_mfma_f32_16x16x32_bf16 v[104:107], v[224:227], v[220:223], v[104:107]
    ds_read_b64_tr_b16 v[224:225], v246 offset:16384
    ds_read_b64_tr_b16 v[226:227], v246 offset:17408
    ds_read_b128 v[204:207], v245 offset:6144
    buffer_load_dwordx4 v243, s[32:35], s87 offen offset:2048 lds
    v_mfma_f32_16x16x32_bf16 v[68:71], v[228:231], v[208:211], v[68:71]
    buffer_load_dwordx4 v183, s[32:35], s87 offen offset:3072 lds
    v_mfma_f32_16x16x32_bf16 v[76:79], v[228:231], v[212:215], v[76:79]
    v_mfma_f32_16x16x32_bf16 v[100:103], v[228:231], v[216:219], v[100:103]
    s_add_u32 s86, s86, 128
    v_mfma_f32_16x16x32_bf16 v[108:111], v[228:231], v[220:223], v[108:111]
    ds_read_b64_tr_b16 v[228:229], v247 offset:16384
    ds_read_b64_tr_b16 v[230:231], v247 offset:17408
    v_mfma_f32_16x16x32_bf16 v[80:83], v[232:235], v[208:211], v[80:83]
    s_add_u32 m0, s83, 32768
    v_mfma_f32_16x16x32_bf16 v[88:91], v[232:235], v[212:215], v[88:91]
    s_add_u32 s89, s88, 31744
    v_mfma_f32_16x16x32_bf16 v[112:115], v[232:235], v[216:219], v[112:115]
    v_mfma_f32_16x16x32_bf16 v[120:123], v[232:235], v[220:223], v[120:123]
    ds_read_b64_tr_b16 v[232:233], v248 offset:16384
    ds_read_b64_tr_b16 v[234:235], v248 offset:17408
    buffer_load_dwordx4 v244, s[36:39], s88 offen nt lds
    v_mfma_f32_16x16x32_bf16 v[84:87], v[236:239], v[208:211], v[84:87]
    buffer_load_dwordx4 v244, s[36:39], s89 offen offset:1024 nt lds
    v_mfma_f32_16x16x32_bf16 v[92:95], v[236:239], v[212:215], v[92:95]
    v_mfma_f32_16x16x32_bf16 v[116:119], v[236:239], v[216:219], v[116:119]
    s_add_u32 s88, s88, 262144
    v_mfma_f32_16x16x32_bf16 v[124:127], v[236:239], v[220:223], v[124:127]
    ds_read_b64_tr_b16 v[236:237], v249 offset:16384
    ds_read_b64_tr_b16 v[238:239], v249 offset:17408
    s_waitcnt lgkmcnt(6)
    v_mfma_f32_16x16x32_bf16 v[0:3], v[224:227], v[192:195], v[0:3]
    ds_read_b128 v[208:211], v245 offset:8192
    s_cmp_eq_u32 s76, 1
    v_mfma_f32_16x16x32_bf16 v[8:11], v[224:227], v[196:199], v[8:11]
    ds_read_b128 v[212:215], v245 offset:10240
    v_mfma_f32_16x16x32_bf16 v[32:35], v[224:227], v[200:203], v[32:35]
    ds_read_b128 v[216:219], v245 offset:12288
    v_mfma_f32_16x16x32_bf16 v[40:43], v[224:227], v[204:207], v[40:43]
    ds_read_b128 v[220:223], v245 offset:14336
    s_waitcnt lgkmcnt(8)
    v_mfma_f32_16x16x32_bf16 v[4:7], v[228:231], v[192:195], v[4:7]
    v_xor_b32 v245, 64, v245
    v_mfma_f32_16x16x32_bf16 v[12:15], v[228:231], v[196:199], v[12:15]
    v_add_u32 v245, 0x10000, v245
    s_cselect_b32 s78, s101, 0x40000000
    v_mfma_f32_16x16x32_bf16 v[36:39], v[228:231], v[200:203], v[36:39]
    v_xor_b32 v246, 0x10000, v246
    v_mfma_f32_16x16x32_bf16 v[44:47], v[228:231], v[204:207], v[44:47]
    v_xor_b32 v247, 0x10000, v247
    s_waitcnt lgkmcnt(6)
    v_mfma_f32_16x16x32_bf16 v[16:19], v[232:235], v[192:195], v[16:19]
    v_xor_b32 v248, 0x10000, v248
    v_mfma_f32_16x16x32_bf16 v[24:27], v[232:235], v[196:199], v[24:27]
    v_xor_b32 v249, 0x10000, v249
    v_mfma_f32_16x16x32_bf16 v[48:51], v[232:235], v[200:203], v[48:51]
    buffer_load_dword v254, v184, s[48:51], s78 offen
    v_mfma_f32_16x16x32_bf16 v[56:59], v[232:235], v[204:207], v[56:59]
    s_waitcnt lgkmcnt(4)
    v_mfma_f32_16x16x32_bf16 v[20:23], v[236:239], v[192:195], v[20:23]
    v_mfma_f32_16x16x32_bf16 v[28:31], v[236:239], v[196:199], v[28:31]
    v_mfma_f32_16x16x32_bf16 v[52:55], v[236:239], v[200:203], v[52:55]
    v_mfma_f32_16x16x32_bf16 v[60:63], v[236:239], v[204:207], v[60:63]
    s_waitcnt vmcnt(10) lgkmcnt(0)
    s_barrier
    v_mfma_f32_16x16x32_bf16 v[64:67], v[224:227], v[208:211], v[64:67]
    ds_read_b128 v[192:195], v245 offset:0
    s_add_u32 m0, s83, 49152
    v_mfma_f32_16x16x32_bf16 v[72:75], v[224:227], v[212:215], v[72:75]
    ds_read_b128 v[196:199], v245 offset:2048
    s_add_u32 s89, s88, 31744
    v_mfma_f32_16x16x32_bf16 v[96:99], v[224:227], v[216:219], v[96:99]
    ds_read_b128 v[200:203], v245 offset:4096
    v_mfma_f32_16x16x32_bf16 v[104:107], v[224:227], v[220:223], v[104:107]
    ds_read_b64_tr_b16 v[224:225], v246 offset:0
    ds_read_b64_tr_b16 v[226:227], v246 offset:1024
    ds_read_b128 v[204:207], v245 offset:6144
    buffer_load_dwordx4 v244, s[36:39], s88 offen nt lds
    v_mfma_f32_16x16x32_bf16 v[68:71], v[228:231], v[208:211], v[68:71]
    v_mfma_f32_16x16x32_bf16 v[76:79], v[228:231], v[212:215], v[76:79]
    buffer_load_dwordx4 v244, s[36:39], s89 offen offset:1024 nt lds
    v_mfma_f32_16x16x32_bf16 v[100:103], v[228:231], v[216:219], v[100:103]
    v_mfma_f32_16x16x32_bf16 v[108:111], v[228:231], v[220:223], v[108:111]
    ds_read_b64_tr_b16 v[228:229], v247 offset:0
    ds_read_b64_tr_b16 v[230:231], v247 offset:1024
    s_add_u32 s88, s88, 262144
    v_mfma_f32_16x16x32_bf16 v[80:83], v[232:235], v[208:211], v[80:83]
    s_add_u32 m0, s81, 65536
    v_mfma_f32_16x16x32_bf16 v[88:91], v[232:235], v[212:215], v[88:91]
    v_mfma_f32_16x16x32_bf16 v[112:115], v[232:235], v[216:219], v[112:115]
    s_nop 0
    v_mfma_f32_16x16x32_bf16 v[120:123], v[232:235], v[220:223], v[120:123]
    ds_read_b64_tr_b16 v[232:233], v248 offset:0
    ds_read_b64_tr_b16 v[234:235], v248 offset:1024
    v_mfma_f32_16x16x32_bf16 v[84:87], v[236:239], v[208:211], v[84:87]
    buffer_load_dwordx4 v243, s[32:35], s86 offen lds
    v_mfma_f32_16x16x32_bf16 v[92:95], v[236:239], v[212:215], v[92:95]
    v_mfma_f32_16x16x32_bf16 v[116:119], v[236:239], v[216:219], v[116:119]
    buffer_load_dwordx4 v183, s[32:35], s86 offen offset:1024 lds
    v_mfma_f32_16x16x32_bf16 v[124:127], v[236:239], v[220:223], v[124:127]
    ds_read_b64_tr_b16 v[236:237], v249 offset:0
    ds_read_b64_tr_b16 v[238:239], v249 offset:1024
    s_waitcnt lgkmcnt(6)
    v_mfma_f32_16x16x32_bf16 v[0:3], v[224:227], v[192:195], v[0:3]
    ds_read_b128 v[208:211], v245 offset:8192
    v_mfma_f32_16x16x32_bf16 v[8:11], v[224:227], v[196:199], v[8:11]
    ds_read_b128 v[212:215], v245 offset:10240
    v_mfma_f32_16x16x32_bf16 v[32:35], v[224:227], v[200:203], v[32:35]
    ds_read_b128 v[216:219], v245 offset:12288
    v_mfma_f32_16x16x32_bf16 v[40:43], v[224:227], v[204:207], v[40:43]
    ds_read_b128 v[220:223], v245 offset:14336
    s_waitcnt lgkmcnt(8)
    v_mfma_f32_16x16x32_bf16 v[4:7], v[228:231], v[192:195], v[4:7]
    v_xor_b32 v245, 64, v245
    v_mfma_f32_16x16x32_bf16 v[12:15], v[228:231], v[196:199], v[12:15]
    v_mfma_f32_16x16x32_bf16 v[36:39], v[228:231], v[200:203], v[36:39]
    v_mfma_f32_16x16x32_bf16 v[44:47], v[228:231], v[204:207], v[44:47]
    s_waitcnt lgkmcnt(6)
    v_mfma_f32_16x16x32_bf16 v[16:19], v[232:235], v[192:195], v[16:19]
    v_mfma_f32_16x16x32_bf16 v[24:27], v[232:235], v[196:199], v[24:27]
    v_mfma_f32_16x16x32_bf16 v[48:51], v[232:235], v[200:203], v[48:51]
    v_mfma_f32_16x16x32_bf16 v[56:59], v[232:235], v[204:207], v[56:59]
    s_waitcnt lgkmcnt(4)
    v_mfma_f32_16x16x32_bf16 v[20:23], v[236:239], v[192:195], v[20:23]
    v_mfma_f32_16x16x32_bf16 v[28:31], v[236:239], v[196:199], v[28:31]
    v_mfma_f32_16x16x32_bf16 v[52:55], v[236:239], v[200:203], v[52:55]
    v_mfma_f32_16x16x32_bf16 v[60:63], v[236:239], v[204:207], v[60:63]
    s_waitcnt vmcnt(11) lgkmcnt(0)
    s_barrier
    v_mfma_f32_16x16x32_bf16 v[64:67], v[224:227], v[208:211], v[64:67]
    ds_read_b128 v[192:195], v245 offset:0
    s_add_u32 m0, s81, 65536
    v_mfma_f32_16x16x32_bf16 v[72:75], v[224:227], v[212:215], v[72:75]
    ds_read_b128 v[196:199], v245 offset:2048
    s_add_u32 s87, s86, 14336
    v_mfma_f32_16x16x32_bf16 v[96:99], v[224:227], v[216:219], v[96:99]
    ds_read_b128 v[200:203], v245 offset:4096
    v_mfma_f32_16x16x32_bf16 v[104:107], v[224:227], v[220:223], v[104:107]
    ds_read_b64_tr_b16 v[224:225], v246 offset:16384
    ds_read_b64_tr_b16 v[226:227], v246 offset:17408
    ds_read_b128 v[204:207], v245 offset:6144
    buffer_load_dwordx4 v243, s[32:35], s87 offen offset:2048 lds
    v_mfma_f32_16x16x32_bf16 v[68:71], v[228:231], v[208:211], v[68:71]
    buffer_load_dwordx4 v183, s[32:35], s87 offen offset:3072 lds
    v_mfma_f32_16x16x32_bf16 v[76:79], v[228:231], v[212:215], v[76:79]
    v_mfma_f32_16x16x32_bf16 v[100:103], v[228:231], v[216:219], v[100:103]
    s_add_u32 s86, s86, 128
    v_mfma_f32_16x16x32_bf16 v[108:111], v[228:231], v[220:223], v[108:111]
    ds_read_b64_tr_b16 v[228:229], v247 offset:16384
    ds_read_b64_tr_b16 v[230:231], v247 offset:17408
    v_mfma_f32_16x16x32_bf16 v[80:83], v[232:235], v[208:211], v[80:83]
    s_add_u32 m0, s83, 98304
    v_mfma_f32_16x16x32_bf16 v[88:91], v[232:235], v[212:215], v[88:91]
    s_add_u32 s89, s88, 31744
    v_mfma_f32_16x16x32_bf16 v[112:115], v[232:235], v[216:219], v[112:115]
    v_mfma_f32_16x16x32_bf16 v[120:123], v[232:235], v[220:223], v[120:123]
    ds_read_b64_tr_b16 v[232:233], v248 offset:16384
    ds_read_b64_tr_b16 v[234:235], v248 offset:17408
    buffer_load_dwordx4 v244, s[36:39], s88 offen nt lds
    v_mfma_f32_16x16x32_bf16 v[84:87], v[236:239], v[208:211], v[84:87]
    buffer_load_dwordx4 v244, s[36:39], s89 offen offset:1024 nt lds
    v_mfma_f32_16x16x32_bf16 v[92:95], v[236:239], v[212:215], v[92:95]
    v_mfma_f32_16x16x32_bf16 v[116:119], v[236:239], v[216:219], v[116:119]
    s_add_u32 s88, s88, 262144
    v_mfma_f32_16x16x32_bf16 v[124:127], v[236:239], v[220:223], v[124:127]
    ds_read_b64_tr_b16 v[236:237], v249 offset:16384
    ds_read_b64_tr_b16 v[238:239], v249 offset:17408
    s_waitcnt lgkmcnt(6)
    v_mfma_f32_16x16x32_bf16 v[0:3], v[224:227], v[192:195], v[0:3]
    ds_read_b128 v[208:211], v245 offset:8192
    s_cmp_ge_u32 s76, 2
    v_mfma_f32_16x16x32_bf16 v[8:11], v[224:227], v[196:199], v[8:11]
    ds_read_b128 v[212:215], v245 offset:10240
    v_mfma_f32_16x16x32_bf16 v[32:35], v[224:227], v[200:203], v[32:35]
    ds_read_b128 v[216:219], v245 offset:12288
    v_mfma_f32_16x16x32_bf16 v[40:43], v[224:227], v[204:207], v[40:43]
    ds_read_b128 v[220:223], v245 offset:14336
    s_waitcnt lgkmcnt(8)
    v_mfma_f32_16x16x32_bf16 v[4:7], v[228:231], v[192:195], v[4:7]
    v_xor_b32 v245, 64, v245
    v_mfma_f32_16x16x32_bf16 v[12:15], v[228:231], v[196:199], v[12:15]
    v_add_u32 v245, 0xfffe0000, v245
    s_cselect_b32 s78, s101, 0x40000000
    v_mfma_f32_16x16x32_bf16 v[36:39], v[228:231], v[200:203], v[36:39]
    v_xor_b32 v246, 0x10000, v246
    v_mfma_f32_16x16x32_bf16 v[44:47], v[228:231], v[204:207], v[44:47]
    v_xor_b32 v247, 0x10000, v247
    s_waitcnt lgkmcnt(6)
    v_mfma_f32_16x16x32_bf16 v[16:19], v[232:235], v[192:195], v[16:19]
    v_xor_b32 v248, 0x10000, v248
    v_mfma_f32_16x16x32_bf16 v[24:27], v[232:235], v[196:199], v[24:27]
    v_xor_b32 v249, 0x10000, v249
    v_mfma_f32_16x16x32_bf16 v[48:51], v[232:235], v[200:203], v[48:51]
    buffer_load_dword v254, v184, s[48:51], s78 offen
    v_mfma_f32_16x16x32_bf16 v[56:59], v[232:235], v[204:207], v[56:59]
    s_waitcnt lgkmcnt(4)
    v_mfma_f32_16x16x32_bf16 v[20:23], v[236:239], v[192:195], v[20:23]
    v_mfma_f32_16x16x32_bf16 v[28:31], v[236:239], v[196:199], v[28:31]
    v_mfma_f32_16x16x32_bf16 v[52:55], v[236:239], v[200:203], v[52:55]
    v_mfma_f32_16x16x32_bf16 v[60:63], v[236:239], v[204:207], v[60:63]
    s_waitcnt vmcnt(10) lgkmcnt(0)
    s_barrier
    v_mfma_f32_16x16x32_bf16 v[64:67], v[224:227], v[208:211], v[64:67]
    ds_read_b128 v[192:195], v245 offset:0
    s_add_u32 m0, s83, 114688
    v_mfma_f32_16x16x32_bf16 v[72:75], v[224:227], v[212:215], v[72:75]
    ds_read_b128 v[196:199], v245 offset:2048
    v_mfma_f32_16x16x32_bf16 v[96:99], v[224:227], v[216:219], v[96:99]
    ds_read_b128 v[200:203], v245 offset:4096
    v_mfma_f32_16x16x32_bf16 v[104:107], v[224:227], v[220:223], v[104:107]
    ds_read_b64_tr_b16 v[224:225], v246 offset:0
    ds_read_b64_tr_b16 v[226:227], v246 offset:1024
    ds_read_b128 v[204:207], v245 offset:6144
    s_add_u32 s89, s88, 31744
    v_mfma_f32_16x16x32_bf16 v[68:71], v[228:231], v[208:211], v[68:71]
    v_mfma_f32_16x16x32_bf16 v[76:79], v[228:231], v[212:215], v[76:79]
    v_mfma_f32_16x16x32_bf16 v[100:103], v[228:231], v[216:219], v[100:103]
    buffer_load_dwordx4 v244, s[36:39], s88 offen nt lds
    v_mfma_f32_16x16x32_bf16 v[108:111], v[228:231], v[220:223], v[108:111]
    ds_read_b64_tr_b16 v[228:229], v247 offset:0
    ds_read_b64_tr_b16 v[230:231], v247 offset:1024
    v_mfma_f32_16x16x32_bf16 v[80:83], v[232:235], v[208:211], v[80:83]
    v_mfma_f32_16x16x32_bf16 v[88:91], v[232:235], v[212:215], v[88:91]
    buffer_load_dwordx4 v244, s[36:39], s89 offen offset:1024 nt lds
    v_mfma_f32_16x16x32_bf16 v[112:115], v[232:235], v[216:219], v[112:115]
    v_mfma_f32_16x16x32_bf16 v[120:123], v[232:235], v[220:223], v[120:123]
    ds_read_b64_tr_b16 v[232:233], v248 offset:0
    ds_read_b64_tr_b16 v[234:235], v248 offset:1024
    v_mfma_f32_16x16x32_bf16 v[84:87], v[236:239], v[208:211], v[84:87]
    s_add_u32 s88, s88, 262144
    v_mfma_f32_16x16x32_bf16 v[92:95], v[236:239], v[212:215], v[92:95]
    v_mfma_f32_16x16x32_bf16 v[116:119], v[236:239], v[216:219], v[116:119]
    v_mfma_f32_16x16x32_bf16 v[124:127], v[236:239], v[220:223], v[124:127]
    ds_read_b64_tr_b16 v[236:237], v249 offset:0
    ds_read_b64_tr_b16 v[238:239], v249 offset:1024
    s_waitcnt lgkmcnt(6)
    v_mfma_f32_16x16x32_bf16 v[0:3], v[224:227], v[192:195], v[0:3]
    ds_read_b128 v[208:211], v245 offset:8192
    v_mfma_f32_16x16x32_bf16 v[8:11], v[224:227], v[196:199], v[8:11]
    ds_read_b128 v[212:215], v245 offset:10240
    v_mfma_f32_16x16x32_bf16 v[32:35], v[224:227], v[200:203], v[32:35]
    ds_read_b128 v[216:219], v245 offset:12288
    v_mfma_f32_16x16x32_bf16 v[40:43], v[224:227], v[204:207], v[40:43]
    ds_read_b128 v[220:223], v245 offset:14336
    s_waitcnt lgkmcnt(8)
    v_mfma_f32_16x16x32_bf16 v[4:7], v[228:231], v[192:195], v[4:7]
    v_xor_b32 v245, 64, v245
    v_mfma_f32_16x16x32_bf16 v[12:15], v[228:231], v[196:199], v[12:15]
    v_mfma_f32_16x16x32_bf16 v[36:39], v[228:231], v[200:203], v[36:39]
    v_mfma_f32_16x16x32_bf16 v[44:47], v[228:231], v[204:207], v[44:47]
    s_waitcnt lgkmcnt(6)
    v_mfma_f32_16x16x32_bf16 v[16:19], v[232:235], v[192:195], v[16:19]
    v_mfma_f32_16x16x32_bf16 v[24:27], v[232:235], v[196:199], v[24:27]
    v_mfma_f32_16x16x32_bf16 v[48:51], v[232:235], v[200:203], v[48:51]
    v_mfma_f32_16x16x32_bf16 v[56:59], v[232:235], v[204:207], v[56:59]
    s_waitcnt lgkmcnt(4)
    v_mfma_f32_16x16x32_bf16 v[20:23], v[236:239], v[192:195], v[20:23]
    v_mfma_f32_16x16x32_bf16 v[28:31], v[236:239], v[196:199], v[28:31]
    v_mfma_f32_16x16x32_bf16 v[52:55], v[236:239], v[200:203], v[52:55]
    v_mfma_f32_16x16x32_bf16 v[60:63], v[236:239], v[204:207], v[60:63]
    s_waitcnt vmcnt(9) lgkmcnt(0)
    s_barrier
    v_mfma_f32_16x16x32_bf16 v[64:67], v[224:227], v[208:211], v[64:67]
    ds_read_b128 v[192:195], v245 offset:0
    v_mfma_f32_16x16x32_bf16 v[72:75], v[224:227], v[212:215], v[72:75]
    ds_read_b128 v[196:199], v245 offset:2048
    v_mfma_f32_16x16x32_bf16 v[96:99], v[224:227], v[216:219], v[96:99]
    ds_read_b128 v[200:203], v245 offset:4096
    v_mfma_f32_16x16x32_bf16 v[104:107], v[224:227], v[220:223], v[104:107]
    ds_read_b64_tr_b16 v[224:225], v246 offset:16384
    ds_read_b64_tr_b16 v[226:227], v246 offset:17408
    ds_read_b128 v[204:207], v245 offset:6144
    v_mfma_f32_16x16x32_bf16 v[68:71], v[228:231], v[208:211], v[68:71]
    v_mfma_f32_16x16x32_bf16 v[76:79], v[228:231], v[212:215], v[76:79]
    v_mfma_f32_16x16x32_bf16 v[100:103], v[228:231], v[216:219], v[100:103]
    v_mfma_f32_16x16x32_bf16 v[108:111], v[228:231], v[220:223], v[108:111]
    ds_read_b64_tr_b16 v[228:229], v247 offset:16384
    ds_read_b64_tr_b16 v[230:231], v247 offset:17408
    v_mfma_f32_16x16x32_bf16 v[80:83], v[232:235], v[208:211], v[80:83]
    v_mfma_f32_16x16x32_bf16 v[88:91], v[232:235], v[212:215], v[88:91]
    v_mfma_f32_16x16x32_bf16 v[112:115], v[232:235], v[216:219], v[112:115]
    v_mfma_f32_16x16x32_bf16 v[120:123], v[232:235], v[220:223], v[120:123]
    ds_read_b64_tr_b16 v[232:233], v248 offset:16384
    ds_read_b64_tr_b16 v[234:235], v248 offset:17408
    v_mfma_f32_16x16x32_bf16 v[84:87], v[236:239], v[208:211], v[84:87]
    v_mfma_f32_16x16x32_bf16 v[92:95], v[236:239], v[212:215], v[92:95]
    v_mfma_f32_16x16x32_bf16 v[116:119], v[236:239], v[216:219], v[116:119]
    v_mfma_f32_16x16x32_bf16 v[124:127], v[236:239], v[220:223], v[124:127]
    ds_read_b64_tr_b16 v[236:237], v249 offset:16384
    ds_read_b64_tr_b16 v[238:239], v249 offset:17408
    s_waitcnt lgkmcnt(6)
    v_mfma_f32_16x16x32_bf16 v[0:3], v[224:227], v[192:195], v[0:3]
    ds_read_b128 v[208:211], v245 offset:8192
    v_mfma_f32_16x16x32_bf16 v[8:11], v[224:227], v[196:199], v[8:11]
    ds_read_b128 v[212:215], v245 offset:10240
    v_mfma_f32_16x16x32_bf16 v[32:35], v[224:227], v[200:203], v[32:35]
    ds_read_b128 v[216:219], v245 offset:12288
    v_mfma_f32_16x16x32_bf16 v[40:43], v[224:227], v[204:207], v[40:43]
    ds_read_b128 v[220:223], v245 offset:14336
    s_waitcnt lgkmcnt(8)
    v_mfma_f32_16x16x32_bf16 v[4:7], v[228:231], v[192:195], v[4:7]
    v_xor_b32 v245, 64, v245
    v_mfma_f32_16x16x32_bf16 v[12:15], v[228:231], v[196:199], v[12:15]
    v_add_u32 v245, 0x10000, v245
    v_mfma_f32_16x16x32_bf16 v[36:39], v[228:231], v[200:203], v[36:39]
    v_xor_b32 v246, 0x10000, v246
    v_mfma_f32_16x16x32_bf16 v[44:47], v[228:231], v[204:207], v[44:47]
    v_xor_b32 v247, 0x10000, v247
    s_waitcnt lgkmcnt(6)
    v_mfma_f32_16x16x32_bf16 v[16:19], v[232:235], v[192:195], v[16:19]
    v_xor_b32 v248, 0x10000, v248
    v_mfma_f32_16x16x32_bf16 v[24:27], v[232:235], v[196:199], v[24:27]
    v_xor_b32 v249, 0x10000, v249
    v_mfma_f32_16x16x32_bf16 v[48:51], v[232:235], v[200:203], v[48:51]
    v_mfma_f32_16x16x32_bf16 v[56:59], v[232:235], v[204:207], v[56:59]
    s_waitcnt lgkmcnt(4)
    v_mfma_f32_16x16x32_bf16 v[20:23], v[236:239], v[192:195], v[20:23]
    v_mfma_f32_16x16x32_bf16 v[28:31], v[236:239], v[196:199], v[28:31]
    v_mfma_f32_16x16x32_bf16 v[52:55], v[236:239], v[200:203], v[52:55]
    v_mfma_f32_16x16x32_bf16 v[60:63], v[236:239], v[204:207], v[60:63]
    s_waitcnt vmcnt(3) lgkmcnt(0)
    s_barrier
    v_mfma_f32_16x16x32_bf16 v[64:67], v[224:227], v[208:211], v[64:67]
    ds_read_b128 v[192:195], v245 offset:0
    v_mfma_f32_16x16x32_bf16 v[72:75], v[224:227], v[212:215], v[72:75]
    ds_read_b128 v[196:199], v245 offset:2048
    v_mfma_f32_16x16x32_bf16 v[96:99], v[224:227], v[216:219], v[96:99]
    ds_read_b128 v[200:203], v245 offset:4096
    v_mfma_f32_16x16x32_bf16 v[104:107], v[224:227], v[220:223], v[104:107]
    ds_read_b64_tr_b16 v[224:225], v246 offset:0
    ds_read_b64_tr_b16 v[226:227], v246 offset:1024
    ds_read_b128 v[204:207], v245 offset:6144
    v_mfma_f32_16x16x32_bf16 v[68:71], v[228:231], v[208:211], v[68:71]
    v_mfma_f32_16x16x32_bf16 v[76:79], v[228:231], v[212:215], v[76:79]
    v_mfma_f32_16x16x32_bf16 v[100:103], v[228:231], v[216:219], v[100:103]
    v_mfma_f32_16x16x32_bf16 v[108:111], v[228:231], v[220:223], v[108:111]
    ds_read_b64_tr_b16 v[228:229], v247 offset:0
    ds_read_b64_tr_b16 v[230:231], v247 offset:1024
    v_mfma_f32_16x16x32_bf16 v[80:83], v[232:235], v[208:211], v[80:83]
    v_mfma_f32_16x16x32_bf16 v[88:91], v[232:235], v[212:215], v[88:91]
    v_mfma_f32_16x16x32_bf16 v[112:115], v[232:235], v[216:219], v[112:115]
    v_mfma_f32_16x16x32_bf16 v[120:123], v[232:235], v[220:223], v[120:123]
    ds_read_b64_tr_b16 v[232:233], v248 offset:0
    ds_read_b64_tr_b16 v[234:235], v248 offset:1024
    v_mfma_f32_16x16x32_bf16 v[84:87], v[236:239], v[208:211], v[84:87]
    v_mfma_f32_16x16x32_bf16 v[92:95], v[236:239], v[212:215], v[92:95]
    v_mfma_f32_16x16x32_bf16 v[116:119], v[236:239], v[216:219], v[116:119]
    v_mfma_f32_16x16x32_bf16 v[124:127], v[236:239], v[220:223], v[124:127]
    ds_read_b64_tr_b16 v[236:237], v249 offset:0
    ds_read_b64_tr_b16 v[238:239], v249 offset:1024
    s_waitcnt lgkmcnt(6)
    v_mfma_f32_16x16x32_bf16 v[0:3], v[224:227], v[192:195], v[0:3]
    ds_read_b128 v[208:211], v245 offset:8192
    v_mfma_f32_16x16x32_bf16 v[8:11], v[224:227], v[196:199], v[8:11]
    ds_read_b128 v[212:215], v245 offset:10240
    v_mfma_f32_16x16x32_bf16 v[32:35], v[224:227], v[200:203], v[32:35]
    ds_read_b128 v[216:219], v245 offset:12288
    v_mfma_f32_16x16x32_bf16 v[40:43], v[224:227], v[204:207], v[40:43]
    ds_read_b128 v[220:223], v245 offset:14336
    s_waitcnt lgkmcnt(8)
    v_mfma_f32_16x16x32_bf16 v[4:7], v[228:231], v[192:195], v[4:7]
    v_xor_b32 v245, 64, v245
    v_mfma_f32_16x16x32_bf16 v[12:15], v[228:231], v[196:199], v[12:15]
    v_mfma_f32_16x16x32_bf16 v[36:39], v[228:231], v[200:203], v[36:39]
    v_mfma_f32_16x16x32_bf16 v[44:47], v[228:231], v[204:207], v[44:47]
    s_waitcnt lgkmcnt(6)
    v_mfma_f32_16x16x32_bf16 v[16:19], v[232:235], v[192:195], v[16:19]
    v_mfma_f32_16x16x32_bf16 v[24:27], v[232:235], v[196:199], v[24:27]
    v_mfma_f32_16x16x32_bf16 v[48:51], v[232:235], v[200:203], v[48:51]
    v_mfma_f32_16x16x32_bf16 v[56:59], v[232:235], v[204:207], v[56:59]
    s_waitcnt lgkmcnt(4)
    v_mfma_f32_16x16x32_bf16 v[20:23], v[236:239], v[192:195], v[20:23]
    v_mfma_f32_16x16x32_bf16 v[28:31], v[236:239], v[196:199], v[28:31]
    v_mfma_f32_16x16x32_bf16 v[52:55], v[236:239], v[200:203], v[52:55]
    v_mfma_f32_16x16x32_bf16 v[60:63], v[236:239], v[204:207], v[60:63]
    s_waitcnt vmcnt(0) lgkmcnt(0)
    s_barrier
    v_mfma_f32_16x16x32_bf16 v[64:67], v[224:227], v[208:211], v[64:67]
    ds_read_b128 v[192:195], v245 offset:0
    v_mfma_f32_16x16x32_bf16 v[72:75], v[224:227], v[212:215], v[72:75]
    ds_read_b128 v[196:199], v245 offset:2048
    v_mfma_f32_16x16x32_bf16 v[96:99], v[224:227], v[216:219], v[96:99]
    ds_read_b128 v[200:203], v245 offset:4096
    v_mfma_f32_16x16x32_bf16 v[104:107], v[224:227], v[220:223], v[104:107]
    ds_read_b64_tr_b16 v[224:225], v246 offset:16384
    ds_read_b64_tr_b16 v[226:227], v246 offset:17408
    ds_read_b128 v[204:207], v245 offset:6144
    v_mfma_f32_16x16x32_bf16 v[68:71], v[228:231], v[208:211], v[68:71]
    v_mfma_f32_16x16x32_bf16 v[76:79], v[228:231], v[212:215], v[76:79]
    v_mfma_f32_16x16x32_bf16 v[100:103], v[228:231], v[216:219], v[100:103]
    v_mfma_f32_16x16x32_bf16 v[108:111], v[228:231], v[220:223], v[108:111]
    ds_read_b64_tr_b16 v[228:229], v247 offset:16384
    ds_read_b64_tr_b16 v[230:231], v247 offset:17408
    v_mfma_f32_16x16x32_bf16 v[80:83], v[232:235], v[208:211], v[80:83]
    v_mfma_f32_16x16x32_bf16 v[88:91], v[232:235], v[212:215], v[88:91]
    v_mfma_f32_16x16x32_bf16 v[112:115], v[232:235], v[216:219], v[112:115]
    v_mfma_f32_16x16x32_bf16 v[120:123], v[232:235], v[220:223], v[120:123]
    ds_read_b64_tr_b16 v[232:233], v248 offset:16384
    ds_read_b64_tr_b16 v[234:235], v248 offset:17408
    v_mfma_f32_16x16x32_bf16 v[84:87], v[236:239], v[208:211], v[84:87]
    v_mfma_f32_16x16x32_bf16 v[92:95], v[236:239], v[212:215], v[92:95]
    v_mfma_f32_16x16x32_bf16 v[116:119], v[236:239], v[216:219], v[116:119]
    v_mfma_f32_16x16x32_bf16 v[124:127], v[236:239], v[220:223], v[124:127]
    ds_read_b64_tr_b16 v[236:237], v249 offset:16384
    ds_read_b64_tr_b16 v[238:239], v249 offset:17408
    s_waitcnt lgkmcnt(6)
    v_mfma_f32_16x16x32_bf16 v[0:3], v[224:227], v[192:195], v[0:3]
    ds_read_b128 v[208:211], v245 offset:8192
    v_mfma_f32_16x16x32_bf16 v[8:11], v[224:227], v[196:199], v[8:11]
    ds_read_b128 v[212:215], v245 offset:10240
    v_mfma_f32_16x16x32_bf16 v[32:35], v[224:227], v[200:203], v[32:35]
    ds_read_b128 v[216:219], v245 offset:12288
    v_mfma_f32_16x16x32_bf16 v[40:43], v[224:227], v[204:207], v[40:43]
    ds_read_b128 v[220:223], v245 offset:14336
    s_waitcnt lgkmcnt(8)
    v_mfma_f32_16x16x32_bf16 v[4:7], v[228:231], v[192:195], v[4:7]
    v_xor_b32 v245, 128, v250
    v_mfma_f32_16x16x32_bf16 v[12:15], v[228:231], v[196:199], v[12:15]
    v_xor_b32 v246, 128, v251
    v_mfma_f32_16x16x32_bf16 v[36:39], v[228:231], v[200:203], v[36:39]
    v_xor_b32 v247, 128, v252
    v_mfma_f32_16x16x32_bf16 v[44:47], v[228:231], v[204:207], v[44:47]
    v_xor_b32 v248, 128, v253
    s_waitcnt lgkmcnt(6)
    v_mfma_f32_16x16x32_bf16 v[16:19], v[232:235], v[192:195], v[16:19]
    v_mfma_f32_16x16x32_bf16 v[24:27], v[232:235], v[196:199], v[24:27]
    v_mfma_f32_16x16x32_bf16 v[48:51], v[232:235], v[200:203], v[48:51]
    v_mfma_f32_16x16x32_bf16 v[56:59], v[232:235], v[204:207], v[56:59]
    s_waitcnt lgkmcnt(4)
    v_mfma_f32_16x16x32_bf16 v[20:23], v[236:239], v[192:195], v[20:23]
    v_mfma_f32_16x16x32_bf16 v[28:31], v[236:239], v[196:199], v[28:31]
    v_mfma_f32_16x16x32_bf16 v[52:55], v[236:239], v[200:203], v[52:55]
    v_mfma_f32_16x16x32_bf16 v[60:63], v[236:239], v[204:207], v[60:63]
    s_waitcnt lgkmcnt(0)
    s_barrier
    v_mfma_f32_16x16x32_bf16 v[64:67], v[224:227], v[208:211], v[64:67]
    ds_read_b64_tr_b16 v[192:193], v250 offset:0
    v_pk_mul_f32 v[0:1], v[0:1], s[90:91]
    v_pk_mul_f32 v[2:3], v[2:3], s[90:91]
    v_pk_mul_f32 v[4:5], v[4:5], s[90:91]
    v_pk_mul_f32 v[6:7], v[6:7], s[90:91]
    v_mfma_f32_16x16x32_bf16 v[72:75], v[224:227], v[212:215], v[72:75]
    ds_read_b64_tr_b16 v[194:195], v250 offset:1024
    v_pk_mul_f32 v[8:9], v[8:9], s[90:91]
    v_pk_mul_f32 v[10:11], v[10:11], s[90:91]
    v_pk_mul_f32 v[12:13], v[12:13], s[90:91]
    v_pk_mul_f32 v[14:15], v[14:15], s[90:91]
    v_mfma_f32_16x16x32_bf16 v[96:99], v[224:227], v[216:219], v[96:99]
    ds_read_b64_tr_b16 v[196:197], v251 offset:0
    v_cvt_pk_bf16_f32 v0, v0, v1
    v_cvt_pk_bf16_f32 v1, v2, v3
    v_cvt_pk_bf16_f32 v2, v4, v5
    v_cvt_pk_bf16_f32 v3, v6, v7
    v_mfma_f32_16x16x32_bf16 v[104:107], v[224:227], v[220:223], v[104:107]
    ds_read_b128 v[224:227], v242 offset:8192
    ds_read_b64_tr_b16 v[198:199], v251 offset:1024
    v_cvt_pk_bf16_f32 v4, v8, v9
    v_cvt_pk_bf16_f32 v5, v10, v11
    v_cvt_pk_bf16_f32 v6, v12, v13
    v_cvt_pk_bf16_f32 v7, v14, v15
    v_mfma_f32_16x16x32_bf16 v[68:71], v[228:231], v[208:211], v[68:71]
    ds_read_b64_tr_b16 v[200:201], v252 offset:0
    v_pk_mul_f32 v[16:17], v[16:17], s[90:91]
    v_pk_mul_f32 v[18:19], v[18:19], s[90:91]
    v_pk_mul_f32 v[20:21], v[20:21], s[90:91]
    v_pk_mul_f32 v[22:23], v[22:23], s[90:91]
    v_mfma_f32_16x16x32_bf16 v[76:79], v[228:231], v[212:215], v[76:79]
    ds_read_b64_tr_b16 v[202:203], v252 offset:1024
    v_pk_mul_f32 v[24:25], v[24:25], s[90:91]
    v_pk_mul_f32 v[26:27], v[26:27], s[90:91]
    v_pk_mul_f32 v[28:29], v[28:29], s[90:91]
    v_pk_mul_f32 v[30:31], v[30:31], s[90:91]
    v_mfma_f32_16x16x32_bf16 v[100:103], v[228:231], v[216:219], v[100:103]
    ds_read_b64_tr_b16 v[204:205], v253 offset:0
    v_cvt_pk_bf16_f32 v8, v16, v17
    v_cvt_pk_bf16_f32 v9, v18, v19
    v_cvt_pk_bf16_f32 v10, v20, v21
    v_cvt_pk_bf16_f32 v11, v22, v23
    v_mfma_f32_16x16x32_bf16 v[108:111], v[228:231], v[220:223], v[108:111]
    ds_read_b128 v[228:231], v242 offset:9216
    ds_read_b64_tr_b16 v[206:207], v253 offset:1024
    v_cvt_pk_bf16_f32 v12, v24, v25
    v_cvt_pk_bf16_f32 v13, v26, v27
    v_cvt_pk_bf16_f32 v14, v28, v29
    v_cvt_pk_bf16_f32 v15, v30, v31
    v_mfma_f32_16x16x32_bf16 v[80:83], v[232:235], v[208:211], v[80:83]
    v_pk_mul_f32 v[32:33], v[32:33], s[90:91]
    v_pk_mul_f32 v[34:35], v[34:35], s[90:91]
    v_pk_mul_f32 v[36:37], v[36:37], s[90:91]
    v_pk_mul_f32 v[38:39], v[38:39], s[90:91]
    v_mfma_f32_16x16x32_bf16 v[88:91], v[232:235], v[212:215], v[88:91]
    v_pk_mul_f32 v[40:41], v[40:41], s[90:91]
    v_pk_mul_f32 v[42:43], v[42:43], s[90:91]
    v_pk_mul_f32 v[44:45], v[44:45], s[90:91]
    v_pk_mul_f32 v[46:47], v[46:47], s[90:91]
    v_mfma_f32_16x16x32_bf16 v[112:115], v[232:235], v[216:219], v[112:115]
    v_cvt_pk_bf16_f32 v16, v32, v33
    v_cvt_pk_bf16_f32 v17, v34, v35
    v_cvt_pk_bf16_f32 v18, v36, v37
    v_cvt_pk_bf16_f32 v19, v38, v39
    v_mfma_f32_16x16x32_bf16 v[120:123], v[232:235], v[220:223], v[120:123]
    ds_read_b128 v[232:235], v242 offset:0
    v_cvt_pk_bf16_f32 v20, v40, v41
    v_cvt_pk_bf16_f32 v21, v42, v43
    v_cvt_pk_bf16_f32 v22, v44, v45
    v_cvt_pk_bf16_f32 v23, v46, v47
    v_mfma_f32_16x16x32_bf16 v[84:87], v[236:239], v[208:211], v[84:87]
    v_pk_mul_f32 v[48:49], v[48:49], s[90:91]
    v_pk_mul_f32 v[50:51], v[50:51], s[90:91]
    v_pk_mul_f32 v[52:53], v[52:53], s[90:91]
    v_pk_mul_f32 v[54:55], v[54:55], s[90:91]
    v_mfma_f32_16x16x32_bf16 v[92:95], v[236:239], v[212:215], v[92:95]
    v_pk_mul_f32 v[56:57], v[56:57], s[90:91]
    v_pk_mul_f32 v[58:59], v[58:59], s[90:91]
    v_pk_mul_f32 v[60:61], v[60:61], s[90:91]
    v_pk_mul_f32 v[62:63], v[62:63], s[90:91]
    v_mfma_f32_16x16x32_bf16 v[116:119], v[236:239], v[216:219], v[116:119]
    v_cvt_pk_bf16_f32 v24, v48, v49
    v_cvt_pk_bf16_f32 v25, v50, v51
    v_cvt_pk_bf16_f32 v26, v52, v53
    v_cvt_pk_bf16_f32 v27, v54, v55
    v_mfma_f32_16x16x32_bf16 v[124:127], v[236:239], v[220:223], v[124:127]
    ds_read_b128 v[236:239], v242 offset:1024
    v_cvt_pk_bf16_f32 v28, v56, v57
    v_cvt_pk_bf16_f32 v29, v58, v59
    v_cvt_pk_bf16_f32 v30, v60, v61
    v_cvt_pk_bf16_f32 v31, v62, v63
    s_branch KB_XT2
KB_Y:
    s_mov_b32 s40, s28
    s_mov_b32 s41, s29
    s_mov_b32 s42, 33554432
    s_mov_b32 s43, 0x20000
    s_add_u32 s44, s28, 33554432
    s_addc_u32 s45, s29, 0
    s_mov_b32 s46, 2621440
    s_mov_b32 s47, 0x20000
    s_add_u32 s56, s28, 37748736
    s_addc_u32 s57, s29, 0
    s_mov_b32 s58, 23855104
    s_mov_b32 s59, 0x20000
    s_mov_b32 s48, s12
    s_mov_b32 s49, s13
    s_mov_b32 s50, 5242880
    s_mov_b32 s51, 0x20000
    s_mov_b32 s52, s14
    s_mov_b32 s53, s15
    s_mov_b32 s54, 2211840
    s_mov_b32 s55, 0x20000
    s_mov_b32 s60, s22
    s_mov_b32 s61, s23
    s_mov_b32 s62, 256
    s_mov_b32 s63, 0x20000
    s_add_u32 s4, s28, 71303168
    s_addc_u32 s5, s29, 0
    s_mov_b32 s6, 69632
    s_mov_b32 s7, 0x20000
    s_mov_b32 s68, s16
    s_mov_b32 s69, s17
    s_mov_b32 s70, 3456
    s_mov_b32 s71, 0x20000
    v_subrev_u32 v252, 256, v0
    v_lshlrev_b32 v252, 17, v252
    s_mov_b32 s74, s73
    s_sub_u32 s75, 15, s73
    s_lshl_b32 s31, s72, 19
    s_lshl_b32 s77, s73, 13
    s_add_u32 s31, s31, s77
    s_and_b32 s78, s3, 1
    s_lshl_b32 s79, s78, 12
    s_add_u32 s31, s31, s79
    s_add_u32 s31, s31, 262144
    s_bitcmp1_b32 s3, 1
    s_cselect_b32 s79, 0, 16777216
    s_cselect_b32 s90, 0x3e0293ee, 1.0
    s_cselect_b32 s77, 8192, 0
    s_mov_b32 s91, s90
    s_add_u32 s77, s77, 32768
    s_add_u32 s31, s31, s79
    v_bfe_u32 v200, v193, 2, 2
    v_bfe_u32 v201, v193, 1, 3
    v_xor_b32 v201, v201, v194
    v_lshlrev_b32 v201, 4, v201
    v_and_b32 v202, 15, v193
    v_lshl_add_u32 v245, v202, 7, v201
    v_add_u32 v245, 16384, v245
    v_lshl_add_u32 v201, v194, 3, v200
    v_and_b32 v203, 3, v193
    v_lshlrev_b32 v203, 3, v203
    v_and_b32 v202, 1, v194
    v_lshl_add_u32 v204, v200, 1, v202
    v_lshl_add_u32 v205, v201, 8, v203
    v_lshl_add_u32 v205, v204, 5, v205
    s_lshl_b32 s78, s78, 7
    v_xor_b32 v246, s78, v205
    v_add_u32 v246, s77, v246
    v_xor_b32 v247, 32, v246
    v_xor_b32 v248, 64, v246
    v_xor_b32 v249, 96, v246
    v_lshl_add_u32 v250, v201, 7, v203
    v_lshrrev_b32 v200, 1, v200
    v_lshl_add_u32 v200, v202, 1, v200
    v_lshl_add_u32 v250, v200, 5, v250
    v_add_u32 v250, 139264, v250
    v_xor_b32 v251, 32, v250
    s_lshl_b32 s78, s76, 11
    s_add_u32 s78, s78, 147456
    v_bfe_u32 v200, v193, 2, 2
    v_sub_u32 v200, 0, v200
    v_xor_b32 v200, v200, v194
    v_and_b32 v200, 3, v200
    v_and_b32 v202, 15, v193
    v_lshlrev_b32 v202, 6, v202
    v_lshl_add_u32 v202, v200, 4, v202
    v_add_u32 v242, s78, v202
    s_mov_b32 s97, 0x3fb8aa3b
    v_bfe_u32 v195, v193, 4, 1
    v_and_b32 v196, 1, v192
    v_lshl_add_u32 v195, v196, 1, v195
    v_lshlrev_b32 v195, 1, v195
    v_and_b32 v196, 7, v193
    v_xor_b32 v195, v195, v196
    v_lshlrev_b32 v195, 4, v195
    v_lshrrev_b32 v196, 3, v193
    s_movk_i32 s77, 3456
    v_mul_lo_u32 v241, v196, s77
    v_add_u32 v241, v241, v195
    s_mul_i32 s99, s76, 27648
    s_lshl_b32 s77, s72, 7
    s_add_u32 s99, s99, s77
    s_cmp_ge_u32 s72, 27
    s_cselect_b32 s99, 0x40000000, s99
    s_lshl_b32 s77, s74, 2
    s_add_u32 s77, s77, s76
    s_mul_i32 s100, s77, 40960
    s_lshl_b32 s77, s75, 2
    s_add_u32 s77, s77, s76
    s_mul_i32 s101, s77, 40960
    s_lshl_b32 s94, s76, 10
    s_add_u32 s94, s94, 8192
    s_lshl_b32 s77, s2, 2
    s_add_u32 s77, s77, s76
    s_mul_i32 s78, s77, 52429
    s_lshr_b32 s78, s78, 18
    s_mul_i32 s79, s78, 5
    s_sub_u32 s77, s77, s79
    s_and_b32 s79, s78, 127
    s_mul_i32 s26, s79, 40960
    s_lshl_b32 s79, s77, 8
    s_add_u32 s26, s26, s79
    s_mul_i32 s27, s78, 5120
    s_lshl_b32 s79, s77, 13
    s_add_u32 s27, s27, s79
    s_cmp_ge_u32 s78, 182
    s_cselect_b32 s27, 0x40000000, s27
    s_add_u32 s27, s27, s77
    s_mov_b32 s66, 2211840
    s_cmp_lt_u32 s78, 128
    s_cselect_b32 s64, s18, s20
    s_cselect_b32 s65, s19, s21
    s_cselect_b32 s66, 5242880, s66
    s_mov_b32 s67, 0x20000
    s_cmp_eq_u32 s76, 0
    s_cselect_b32 s14, 0xff, 0
    s_cselect_b32 s15, -1, 0
    s_cselect_b32 s22, 0, 0x40000000
    s_add_u32 m0, s83, 49152
    s_add_u32 s89, s88, 31744
    buffer_load_dwordx4 v244, s[36:39], s88 offen nt lds
    buffer_load_dwordx4 v244, s[36:39], s89 offen offset:1024 nt lds
    s_add_u32 s88, s88, 262144
    s_add_u32 m0, s81, 65536
    s_add_u32 s87, s86, 14336
    buffer_load_dwordx4 v243, s[32:35], s86 offen lds
    buffer_load_dwordx4 v183, s[32:35], s86 offen offset:1024 lds
    buffer_load_dwordx4 v243, s[32:35], s87 offen offset:2048 lds
    buffer_load_dwordx4 v183, s[32:35], s87 offen offset:3072 lds
    s_add_u32 s86, s86, 128
    s_add_u32 m0, s83, 98304
    s_add_u32 s89, s88, 31744
    buffer_load_dwordx4 v244, s[36:39], s88 offen nt lds
    buffer_load_dwordx4 v244, s[36:39], s89 offen offset:1024 nt lds
    s_add_u32 s88, s88, 262144
    s_setprio 1
    s_waitcnt vmcnt(8)
    s_barrier
    ds_read_b128 v[192:195], v245 offset:0
    ds_read_b128 v[196:199], v245 offset:2048
    ds_read_b128 v[200:203], v245 offset:4096
    ds_read_b128 v[204:207], v245 offset:6144
    ds_read_b64_tr_b16 v[224:225], v246 offset:0
    ds_read_b64_tr_b16 v[226:227], v246 offset:1024
    ds_read_b64_tr_b16 v[228:229], v247 offset:0
    ds_read_b64_tr_b16 v[230:231], v247 offset:1024
    ds_read_b64_tr_b16 v[232:233], v248 offset:0
    ds_read_b64_tr_b16 v[234:235], v248 offset:1024
    ds_read_b64_tr_b16 v[236:237], v249 offset:0
    ds_read_b64_tr_b16 v[238:239], v249 offset:1024
    s_bitcmp1_b32 s3, 1
    s_cbranch_scc1 KB_YK
    s_waitcnt lgkmcnt(6)
    v_mfma_f32_16x16x32_bf16 v[0:3], v[192:195], v[224:227], 0
    ds_read_b128 v[208:211], v245 offset:8192
    s_add_u32 m0, s83, 114688
    v_mfma_f32_16x16x32_bf16 v[4:7], v[196:199], v[224:227], 0
    ds_read_b128 v[212:215], v245 offset:10240
    s_add_u32 s89, s88, 31744
    v_mfma_f32_16x16x32_bf16 v[32:35], v[200:203], v[224:227], 0
    ds_read_b128 v[216:219], v245 offset:12288
    v_mfma_f32_16x16x32_bf16 v[36:39], v[204:207], v[224:227], 0
    ds_read_b128 v[220:223], v245 offset:14336
    buffer_load_dwordx4 v244, s[36:39], s88 offen nt lds
    s_waitcnt lgkmcnt(8)
    v_mfma_f32_16x16x32_bf16 v[8:11], v[192:195], v[228:231], 0
    v_xor_b32 v245, 64, v245
    v_mfma_f32_16x16x32_bf16 v[12:15], v[196:199], v[228:231], 0
    buffer_load_dwordx4 v244, s[36:39], s89 offen offset:1024 nt lds
    v_mfma_f32_16x16x32_bf16 v[40:43], v[200:203], v[228:231], 0
    v_mfma_f32_16x16x32_bf16 v[44:47], v[204:207], v[228:231], 0
    s_add_u32 s88, s88, 262144
    s_waitcnt lgkmcnt(6)
    v_mfma_f32_16x16x32_bf16 v[16:19], v[192:195], v[232:235], 0
    s_add_u32 m0, s81, 131072
    v_mfma_f32_16x16x32_bf16 v[20:23], v[196:199], v[232:235], 0
    v_mfma_f32_16x16x32_bf16 v[48:51], v[200:203], v[232:235], 0
    s_nop 0
    v_mfma_f32_16x16x32_bf16 v[52:55], v[204:207], v[232:235], 0
    s_waitcnt lgkmcnt(4)
    v_mfma_f32_16x16x32_bf16 v[24:27], v[192:195], v[236:239], 0
    buffer_load_dwordx4 v243, s[32:35], s86 offen lds
    v_mfma_f32_16x16x32_bf16 v[28:31], v[196:199], v[236:239], 0
    v_mfma_f32_16x16x32_bf16 v[56:59], v[200:203], v[236:239], 0
    buffer_load_dwordx4 v183, s[32:35], s86 offen offset:1024 lds
    v_mfma_f32_16x16x32_bf16 v[60:63], v[204:207], v[236:239], 0
    s_waitcnt vmcnt(10) lgkmcnt(0)
    s_barrier
    v_mfma_f32_16x16x32_bf16 v[64:67], v[208:211], v[224:227], 0
    ds_read_b128 v[192:195], v245 offset:0
    s_add_u32 m0, s81, 131072
    v_mfma_f32_16x16x32_bf16 v[68:71], v[212:215], v[224:227], 0
    ds_read_b128 v[196:199], v245 offset:2048
    s_add_u32 s87, s86, 14336
    v_mfma_f32_16x16x32_bf16 v[96:99], v[216:219], v[224:227], 0
    ds_read_b128 v[200:203], v245 offset:4096
    v_mfma_f32_16x16x32_bf16 v[100:103], v[220:223], v[224:227], 0
    ds_read_b64_tr_b16 v[224:225], v246 offset:16384
    ds_read_b64_tr_b16 v[226:227], v246 offset:17408
    ds_read_b128 v[204:207], v245 offset:6144
    buffer_load_dwordx4 v243, s[32:35], s87 offen offset:2048 lds
    v_mfma_f32_16x16x32_bf16 v[72:75], v[208:211], v[228:231], 0
    buffer_load_dwordx4 v183, s[32:35], s87 offen offset:3072 lds
    v_mfma_f32_16x16x32_bf16 v[76:79], v[212:215], v[228:231], 0
    v_mfma_f32_16x16x32_bf16 v[104:107], v[216:219], v[228:231], 0
    s_add_u32 s86, s86, 128
    v_mfma_f32_16x16x32_bf16 v[108:111], v[220:223], v[228:231], 0
    ds_read_b64_tr_b16 v[228:229], v247 offset:16384
    ds_read_b64_tr_b16 v[230:231], v247 offset:17408
    v_mfma_f32_16x16x32_bf16 v[80:83], v[208:211], v[232:235], 0
    s_add_u32 m0, s83, 32768
    v_mfma_f32_16x16x32_bf16 v[84:87], v[212:215], v[232:235], 0
    s_add_u32 s89, s88, 31744
    v_mfma_f32_16x16x32_bf16 v[112:115], v[216:219], v[232:235], 0
    v_mfma_f32_16x16x32_bf16 v[116:119], v[220:223], v[232:235], 0
    ds_read_b64_tr_b16 v[232:233], v248 offset:16384
    ds_read_b64_tr_b16 v[234:235], v248 offset:17408
    buffer_load_dwordx4 v244, s[36:39], s88 offen nt lds
    v_mfma_f32_16x16x32_bf16 v[88:91], v[208:211], v[236:239], 0
    buffer_load_dwordx4 v244, s[36:39], s89 offen offset:1024 nt lds
    v_mfma_f32_16x16x32_bf16 v[92:95], v[212:215], v[236:239], 0
    v_mfma_f32_16x16x32_bf16 v[120:123], v[216:219], v[236:239], 0
    s_add_u32 s88, s88, 262144
    v_mfma_f32_16x16x32_bf16 v[124:127], v[220:223], v[236:239], 0
    ds_read_b64_tr_b16 v[236:237], v249 offset:16384
    ds_read_b64_tr_b16 v[238:239], v249 offset:17408
    s_waitcnt lgkmcnt(6)
    v_mfma_f32_16x16x32_bf16 v[0:3], v[192:195], v[224:227], v[0:3]
    ds_read_b128 v[208:211], v245 offset:8192
    v_mfma_f32_16x16x32_bf16 v[4:7], v[196:199], v[224:227], v[4:7]
    ds_read_b128 v[212:215], v245 offset:10240
    v_mfma_f32_16x16x32_bf16 v[32:35], v[200:203], v[224:227], v[32:35]
    ds_read_b128 v[216:219], v245 offset:12288
    v_mfma_f32_16x16x32_bf16 v[36:39], v[204:207], v[224:227], v[36:39]
    ds_read_b128 v[220:223], v245 offset:14336
    s_waitcnt lgkmcnt(8)
    v_mfma_f32_16x16x32_bf16 v[8:11], v[192:195], v[228:231], v[8:11]
    v_xor_b32 v245, 64, v245
    v_mfma_f32_16x16x32_bf16 v[12:15], v[196:199], v[228:231], v[12:15]
    v_add_u32 v245, 0x10000, v245
    v_mfma_f32_16x16x32_bf16 v[40:43], v[200:203], v[228:231], v[40:43]
    v_xor_b32 v246, 0x10000, v246
    v_mfma_f32_16x16x32_bf16 v[44:47], v[204:207], v[228:231], v[44:47]
    v_xor_b32 v247, 0x10000, v247
    s_waitcnt lgkmcnt(6)
    v_mfma_f32_16x16x32_bf16 v[16:19], v[192:195], v[232:235], v[16:19]
    v_xor_b32 v248, 0x10000, v248
    v_mfma_f32_16x16x32_bf16 v[20:23], v[196:199], v[232:235], v[20:23]
    v_xor_b32 v249, 0x10000, v249
    v_mfma_f32_16x16x32_bf16 v[48:51], v[200:203], v[232:235], v[48:51]
    v_mfma_f32_16x16x32_bf16 v[52:55], v[204:207], v[232:235], v[52:55]
    s_waitcnt lgkmcnt(4)
    v_mfma_f32_16x16x32_bf16 v[24:27], v[192:195], v[236:239], v[24:27]
    v_mfma_f32_16x16x32_bf16 v[28:31], v[196:199], v[236:239], v[28:31]
    v_mfma_f32_16x16x32_bf16 v[56:59], v[200:203], v[236:239], v[56:59]
    v_mfma_f32_16x16x32_bf16 v[60:63], v[204:207], v[236:239], v[60:63]
    s_waitcnt vmcnt(8) lgkmcnt(0)
    s_barrier
    v_mfma_f32_16x16x32_bf16 v[64:67], v[208:211], v[224:227], v[64:67]
    ds_read_b128 v[192:195], v245 offset:0
    s_add_u32 m0, s83, 49152
    v_mfma_f32_16x16x32_bf16 v[68:71], v[212:215], v[224:227], v[68:71]
    ds_read_b128 v[196:199], v245 offset:2048
    s_add_u32 s89, s88, 31744
    v_mfma_f32_16x16x32_bf16 v[96:99], v[216:219], v[224:227], v[96:99]
    ds_read_b128 v[200:203], v245 offset:4096
    v_mfma_f32_16x16x32_bf16 v[100:103], v[220:223], v[224:227], v[100:103]
    ds_read_b64_tr_b16 v[224:225], v246 offset:0
    ds_read_b64_tr_b16 v[226:227], v246 offset:1024
    ds_read_b128 v[204:207], v245 offset:6144
    buffer_load_dwordx4 v244, s[36:39], s88 offen nt lds
    v_mfma_f32_16x16x32_bf16 v[72:75], v[208:211], v[228:231], v[72:75]
    v_mfma_f32_16x16x32_bf16 v[76:79], v[212:215], v[228:231], v[76:79]
    buffer_load_dwordx4 v244, s[36:39], s89 offen offset:1024 nt lds
    v_mfma_f32_16x16x32_bf16 v[104:107], v[216:219], v[228:231], v[104:107]
    v_mfma_f32_16x16x32_bf16 v[108:111], v[220:223], v[228:231], v[108:111]
    ds_read_b64_tr_b16 v[228:229], v247 offset:0
    ds_read_b64_tr_b16 v[230:231], v247 offset:1024
    s_add_u32 s88, s88, 262144
    v_mfma_f32_16x16x32_bf16 v[80:83], v[208:211], v[232:235], v[80:83]
    s_add_u32 m0, s81, 0
    v_mfma_f32_16x16x32_bf16 v[84:87], v[212:215], v[232:235], v[84:87]
    v_mfma_f32_16x16x32_bf16 v[112:115], v[216:219], v[232:235], v[112:115]
    s_nop 0
    v_mfma_f32_16x16x32_bf16 v[116:119], v[220:223], v[232:235], v[116:119]
    ds_read_b64_tr_b16 v[232:233], v248 offset:0
    ds_read_b64_tr_b16 v[234:235], v248 offset:1024
    v_mfma_f32_16x16x32_bf16 v[88:91], v[208:211], v[236:239], v[88:91]
    buffer_load_dwordx4 v243, s[32:35], s86 offen lds
    v_mfma_f32_16x16x32_bf16 v[92:95], v[212:215], v[236:239], v[92:95]
    v_mfma_f32_16x16x32_bf16 v[120:123], v[216:219], v[236:239], v[120:123]
    buffer_load_dwordx4 v183, s[32:35], s86 offen offset:1024 lds
    v_mfma_f32_16x16x32_bf16 v[124:127], v[220:223], v[236:239], v[124:127]
    ds_read_b64_tr_b16 v[236:237], v249 offset:0
    ds_read_b64_tr_b16 v[238:239], v249 offset:1024
    s_waitcnt lgkmcnt(6)
    v_mfma_f32_16x16x32_bf16 v[0:3], v[192:195], v[224:227], v[0:3]
    ds_read_b128 v[208:211], v245 offset:8192
    v_mfma_f32_16x16x32_bf16 v[4:7], v[196:199], v[224:227], v[4:7]
    ds_read_b128 v[212:215], v245 offset:10240
    v_mfma_f32_16x16x32_bf16 v[32:35], v[200:203], v[224:227], v[32:35]
    ds_read_b128 v[216:219], v245 offset:12288
    v_mfma_f32_16x16x32_bf16 v[36:39], v[204:207], v[224:227], v[36:39]
    ds_read_b128 v[220:223], v245 offset:14336
    s_waitcnt lgkmcnt(8)
    v_mfma_f32_16x16x32_bf16 v[8:11], v[192:195], v[228:231], v[8:11]
    v_xor_b32 v245, 64, v245
    v_mfma_f32_16x16x32_bf16 v[12:15], v[196:199], v[228:231], v[12:15]
    v_mfma_f32_16x16x32_bf16 v[40:43], v[200:203], v[228:231], v[40:43]
    v_mfma_f32_16x16x32_bf16 v[44:47], v[204:207], v[228:231], v[44:47]
    s_waitcnt lgkmcnt(6)
    v_mfma_f32_16x16x32_bf16 v[16:19], v[192:195], v[232:235], v[16:19]
    v_mfma_f32_16x16x32_bf16 v[20:23], v[196:199], v[232:235], v[20:23]
    v_mfma_f32_16x16x32_bf16 v[48:51], v[200:203], v[232:235], v[48:51]
    v_mfma_f32_16x16x32_bf16 v[52:55], v[204:207], v[232:235], v[52:55]
    s_waitcnt lgkmcnt(4)
    v_mfma_f32_16x16x32_bf16 v[24:27], v[192:195], v[236:239], v[24:27]
    v_mfma_f32_16x16x32_bf16 v[28:31], v[196:199], v[236:239], v[28:31]
    v_mfma_f32_16x16x32_bf16 v[56:59], v[200:203], v[236:239], v[56:59]
    v_mfma_f32_16x16x32_bf16 v[60:63], v[204:207], v[236:239], v[60:63]
    s_waitcnt vmcnt(10) lgkmcnt(0)
    s_barrier
    v_mfma_f32_16x16x32_bf16 v[64:67], v[208:211], v[224:227], v[64:67]
    ds_read_b128 v[192:195], v245 offset:0
    s_add_u32 m0, s81, 0
    v_mfma_f32_16x16x32_bf16 v[68:71], v[212:215], v[224:227], v[68:71]
    ds_read_b128 v[196:199], v245 offset:2048
    s_add_u32 s87, s86, 14336
    v_mfma_f32_16x16x32_bf16 v[96:99], v[216:219], v[224:227], v[96:99]
    ds_read_b128 v[200:203], v245 offset:4096
    v_mfma_f32_16x16x32_bf16 v[100:103], v[220:223], v[224:227], v[100:103]
    ds_read_b64_tr_b16 v[224:225], v246 offset:16384
    ds_read_b64_tr_b16 v[226:227], v246 offset:17408
    ds_read_b128 v[204:207], v245 offset:6144
    buffer_load_dwordx4 v243, s[32:35], s87 offen offset:2048 lds
    v_mfma_f32_16x16x32_bf16 v[72:75], v[208:211], v[228:231], v[72:75]
    buffer_load_dwordx4 v183, s[32:35], s87 offen offset:3072 lds
    v_mfma_f32_16x16x32_bf16 v[76:79], v[212:215], v[228:231], v[76:79]
    v_mfma_f32_16x16x32_bf16 v[104:107], v[216:219], v[228:231], v[104:107]
    s_add_u32 s86, s86, 128
    v_mfma_f32_16x16x32_bf16 v[108:111], v[220:223], v[228:231], v[108:111]
    ds_read_b64_tr_b16 v[228:229], v247 offset:16384
    ds_read_b64_tr_b16 v[230:231], v247 offset:17408
    v_mfma_f32_16x16x32_bf16 v[80:83], v[208:211], v[232:235], v[80:83]
    s_add_u32 m0, s83, 98304
    v_mfma_f32_16x16x32_bf16 v[84:87], v[212:215], v[232:235], v[84:87]
    s_add_u32 s89, s88, 31744
    v_mfma_f32_16x16x32_bf16 v[112:115], v[216:219], v[232:235], v[112:115]
    v_mfma_f32_16x16x32_bf16 v[116:119], v[220:223], v[232:235], v[116:119]
    ds_read_b64_tr_b16 v[232:233], v248 offset:16384
    ds_read_b64_tr_b16 v[234:235], v248 offset:17408
    buffer_load_dwordx4 v244, s[36:39], s88 offen nt lds
    v_mfma_f32_16x16x32_bf16 v[88:91], v[208:211], v[236:239], v[88:91]
    buffer_load_dwordx4 v244, s[36:39], s89 offen offset:1024 nt lds
    v_mfma_f32_16x16x32_bf16 v[92:95], v[212:215], v[236:239], v[92:95]
    v_mfma_f32_16x16x32_bf16 v[120:123], v[216:219], v[236:239], v[120:123]
    s_add_u32 s88, s88, 262144
    v_mfma_f32_16x16x32_bf16 v[124:127], v[220:223], v[236:239], v[124:127]
    ds_read_b64_tr_b16 v[236:237], v249 offset:16384
    ds_read_b64_tr_b16 v[238:239], v249 offset:17408
    s_waitcnt lgkmcnt(6)
    v_mfma_f32_16x16x32_bf16 v[0:3], v[192:195], v[224:227], v[0:3]
    ds_read_b128 v[208:211], v245 offset:8192
    v_mfma_f32_16x16x32_bf16 v[4:7], v[196:199], v[224:227], v[4:7]
    ds_read_b128 v[212:215], v245 offset:10240
    v_mfma_f32_16x16x32_bf16 v[32:35], v[200:203], v[224:227], v[32:35]
    ds_read_b128 v[216:219], v245 offset:12288
    v_mfma_f32_16x16x32_bf16 v[36:39], v[204:207], v[224:227], v[36:39]
    ds_read_b128 v[220:223], v245 offset:14336
    s_waitcnt lgkmcnt(8)
    v_mfma_f32_16x16x32_bf16 v[8:11], v[192:195], v[228:231], v[8:11]
    v_xor_b32 v245, 64, v245
    v_mfma_f32_16x16x32_bf16 v[12:15], v[196:199], v[228:231], v[12:15]
    v_add_u32 v245, 0x10000, v245
    v_mfma_f32_16x16x32_bf16 v[40:43], v[200:203], v[228:231], v[40:43]
    v_xor_b32 v246, 0x10000, v246
    v_mfma_f32_16x16x32_bf16 v[44:47], v[204:207], v[228:231], v[44:47]
    v_xor_b32 v247, 0x10000, v247
    s_waitcnt lgkmcnt(6)
    v_mfma_f32_16x16x32_bf16 v[16:19], v[192:195], v[232:235], v[16:19]
    v_xor_b32 v248, 0x10000, v248
    v_mfma_f32_16x16x32_bf16 v[20:23], v[196:199], v[232:235], v[20:23]
    v_xor_b32 v249, 0x10000, v249
    v_mfma_f32_16x16x32_bf16 v[48:51], v[200:203], v[232:235], v[48:51]
    v_mfma_f32_16x16x32_bf16 v[52:55], v[204:207], v[232:235], v[52:55]
    s_waitcnt lgkmcnt(4)
    v_mfma_f32_16x16x32_bf16 v[24:27], v[192:195], v[236:239], v[24:27]
    v_mfma_f32_16x16x32_bf16 v[28:31], v[196:199], v[236:239], v[28:31]
    v_mfma_f32_16x16x32_bf16 v[56:59], v[200:203], v[236:239], v[56:59]
    v_mfma_f32_16x16x32_bf16 v[60:63], v[204:207], v[236:239], v[60:63]
    s_waitcnt vmcnt(8) lgkmcnt(0)
    s_barrier
    v_mfma_f32_16x16x32_bf16 v[64:67], v[208:211], v[224:227], v[64:67]
    ds_read_b128 v[192:195], v245 offset:0
    s_add_u32 m0, s83, 114688
    v_mfma_f32_16x16x32_bf16 v[68:71], v[212:215], v[224:227], v[68:71]
    ds_read_b128 v[196:199], v245 offset:2048
    s_add_u32 s89, s88, 31744
    v_mfma_f32_16x16x32_bf16 v[96:99], v[216:219], v[224:227], v[96:99]
    ds_read_b128 v[200:203], v245 offset:4096
    v_mfma_f32_16x16x32_bf16 v[100:103], v[220:223], v[224:227], v[100:103]
    ds_read_b64_tr_b16 v[224:225], v246 offset:0
    ds_read_b64_tr_b16 v[226:227], v246 offset:1024
    ds_read_b128 v[204:207], v245 offset:6144
    buffer_load_dwordx4 v244, s[36:39], s88 offen nt lds
    v_mfma_f32_16x16x32_bf16 v[72:75], v[208:211], v[228:231], v[72:75]
    v_mfma_f32_16x16x32_bf16 v[76:79], v[212:215], v[228:231], v[76:79]
    buffer_load_dwordx4 v244, s[36:39], s89 offen offset:1024 nt lds
    v_mfma_f32_16x16x32_bf16 v[104:107], v[216:219], v[228:231], v[104:107]
    v_mfma_f32_16x16x32_bf16 v[108:111], v[220:223], v[228:231], v[108:111]
    ds_read_b64_tr_b16 v[228:229], v247 offset:0
    ds_read_b64_tr_b16 v[230:231], v247 offset:1024
    s_add_u32 s88, s88, 262144
    v_mfma_f32_16x16x32_bf16 v[80:83], v[208:211], v[232:235], v[80:83]
    s_add_u32 m0, s81, 65536
    v_mfma_f32_16x16x32_bf16 v[84:87], v[212:215], v[232:235], v[84:87]
    v_mfma_f32_16x16x32_bf16 v[112:115], v[216:219], v[232:235], v[112:115]
    s_nop 0
    v_mfma_f32_16x16x32_bf16 v[116:119], v[220:223], v[232:235], v[116:119]
    ds_read_b64_tr_b16 v[232:233], v248 offset:0
    ds_read_b64_tr_b16 v[234:235], v248 offset:1024
    v_mfma_f32_16x16x32_bf16 v[88:91], v[208:211], v[236:239], v[88:91]
    buffer_load_dwordx4 v243, s[32:35], s86 offen lds
    v_mfma_f32_16x16x32_bf16 v[92:95], v[212:215], v[236:239], v[92:95]
    v_mfma_f32_16x16x32_bf16 v[120:123], v[216:219], v[236:239], v[120:123]
    buffer_load_dwordx4 v183, s[32:35], s86 offen offset:1024 lds
    v_mfma_f32_16x16x32_bf16 v[124:127], v[220:223], v[236:239], v[124:127]
    ds_read_b64_tr_b16 v[236:237], v249 offset:0
    ds_read_b64_tr_b16 v[238:239], v249 offset:1024
    s_waitcnt lgkmcnt(6)
    v_mfma_f32_16x16x32_bf16 v[0:3], v[192:195], v[224:227], v[0:3]
    ds_read_b128 v[208:211], v245 offset:8192
    v_mfma_f32_16x16x32_bf16 v[4:7], v[196:199], v[224:227], v[4:7]
    ds_read_b128 v[212:215], v245 offset:10240
    v_mfma_f32_16x16x32_bf16 v[32:35], v[200:203], v[224:227], v[32:35]
    ds_read_b128 v[216:219], v245 offset:12288
    v_mfma_f32_16x16x32_bf16 v[36:39], v[204:207], v[224:227], v[36:39]
    ds_read_b128 v[220:223], v245 offset:14336
    s_waitcnt lgkmcnt(8)
    v_mfma_f32_16x16x32_bf16 v[8:11], v[192:195], v[228:231], v[8:11]
    v_xor_b32 v245, 64, v245
    v_mfma_f32_16x16x32_bf16 v[12:15], v[196:199], v[228:231], v[12:15]
    v_mfma_f32_16x16x32_bf16 v[40:43], v[200:203], v[228:231], v[40:43]
    v_mfma_f32_16x16x32_bf16 v[44:47], v[204:207], v[228:231], v[44:47]
    s_waitcnt lgkmcnt(6)
    v_mfma_f32_16x16x32_bf16 v[16:19], v[192:195], v[232:235], v[16:19]
    v_mfma_f32_16x16x32_bf16 v[20:23], v[196:199], v[232:235], v[20:23]
    v_mfma_f32_16x16x32_bf16 v[48:51], v[200:203], v[232:235], v[48:51]
    v_mfma_f32_16x16x32_bf16 v[52:55], v[204:207], v[232:235], v[52:55]
    s_waitcnt lgkmcnt(4)
    v_mfma_f32_16x16x32_bf16 v[24:27], v[192:195], v[236:239], v[24:27]
    v_mfma_f32_16x16x32_bf16 v[28:31], v[196:199], v[236:239], v[28:31]
    v_mfma_f32_16x16x32_bf16 v[56:59], v[200:203], v[236:239], v[56:59]
    v_mfma_f32_16x16x32_bf16 v[60:63], v[204:207], v[236:239], v[60:63]
    s_waitcnt vmcnt(10) lgkmcnt(0)
    s_barrier
    v_mfma_f32_16x16x32_bf16 v[64:67], v[208:211], v[224:227], v[64:67]
    ds_read_b128 v[192:195], v245 offset:0
    s_add_u32 m0, s81, 65536
    v_mfma_f32_16x16x32_bf16 v[68:71], v[212:215], v[224:227], v[68:71]
    ds_read_b128 v[196:199], v245 offset:2048
    s_add_u32 s87, s86, 14336
    v_mfma_f32_16x16x32_bf16 v[96:99], v[216:219], v[224:227], v[96:99]
    ds_read_b128 v[200:203], v245 offset:4096
    v_mfma_f32_16x16x32_bf16 v[100:103], v[220:223], v[224:227], v[100:103]
    ds_read_b64_tr_b16 v[224:225], v246 offset:16384
    ds_read_b64_tr_b16 v[226:227], v246 offset:17408
    ds_read_b128 v[204:207], v245 offset:6144
    buffer_load_dwordx4 v243, s[32:35], s87 offen offset:2048 lds
    v_mfma_f32_16x16x32_bf16 v[72:75], v[208:211], v[228:231], v[72:75]
    buffer_load_dwordx4 v183, s[32:35], s87 offen offset:3072 lds
    v_mfma_f32_16x16x32_bf16 v[76:79], v[212:215], v[228:231], v[76:79]
    v_mfma_f32_16x16x32_bf16 v[104:107], v[216:219], v[228:231], v[104:107]
    s_add_u32 s86, s86, 128
    v_mfma_f32_16x16x32_bf16 v[108:111], v[220:223], v[228:231], v[108:111]
    ds_read_b64_tr_b16 v[228:229], v247 offset:16384
    ds_read_b64_tr_b16 v[230:231], v247 offset:17408
    v_mfma_f32_16x16x32_bf16 v[80:83], v[208:211], v[232:235], v[80:83]
    s_add_u32 m0, s83, 32768
    v_mfma_f32_16x16x32_bf16 v[84:87], v[212:215], v[232:235], v[84:87]
    s_add_u32 s89, s88, 31744
    v_mfma_f32_16x16x32_bf16 v[112:115], v[216:219], v[232:235], v[112:115]
    v_mfma_f32_16x16x32_bf16 v[116:119], v[220:223], v[232:235], v[116:119]
    ds_read_b64_tr_b16 v[232:233], v248 offset:16384
    ds_read_b64_tr_b16 v[234:235], v248 offset:17408
    buffer_load_dwordx4 v244, s[36:39], s88 offen nt lds
    v_mfma_f32_16x16x32_bf16 v[88:91], v[208:211], v[236:239], v[88:91]
    buffer_load_dwordx4 v244, s[36:39], s89 offen offset:1024 nt lds
    v_mfma_f32_16x16x32_bf16 v[92:95], v[212:215], v[236:239], v[92:95]
    v_mfma_f32_16x16x32_bf16 v[120:123], v[216:219], v[236:239], v[120:123]
    s_add_u32 s88, s88, 262144
    v_mfma_f32_16x16x32_bf16 v[124:127], v[220:223], v[236:239], v[124:127]
    ds_read_b64_tr_b16 v[236:237], v249 offset:16384
    ds_read_b64_tr_b16 v[238:239], v249 offset:17408
    s_waitcnt lgkmcnt(6)
    v_mfma_f32_16x16x32_bf16 v[0:3], v[192:195], v[224:227], v[0:3]
    ds_read_b128 v[208:211], v245 offset:8192
    v_mfma_f32_16x16x32_bf16 v[4:7], v[196:199], v[224:227], v[4:7]
    ds_read_b128 v[212:215], v245 offset:10240
    v_mfma_f32_16x16x32_bf16 v[32:35], v[200:203], v[224:227], v[32:35]
    ds_read_b128 v[216:219], v245 offset:12288
    v_mfma_f32_16x16x32_bf16 v[36:39], v[204:207], v[224:227], v[36:39]
    ds_read_b128 v[220:223], v245 offset:14336
    s_waitcnt lgkmcnt(8)
    v_mfma_f32_16x16x32_bf16 v[8:11], v[192:195], v[228:231], v[8:11]
    v_xor_b32 v245, 64, v245
    v_mfma_f32_16x16x32_bf16 v[12:15], v[196:199], v[228:231], v[12:15]
    v_add_u32 v245, 0xfffe0000, v245
    v_mfma_f32_16x16x32_bf16 v[40:43], v[200:203], v[228:231], v[40:43]
    v_xor_b32 v246, 0x10000, v246
    v_mfma_f32_16x16x32_bf16 v[44:47], v[204:207], v[228:231], v[44:47]
    v_xor_b32 v247, 0x10000, v247
    s_waitcnt lgkmcnt(6)
    v_mfma_f32_16x16x32_bf16 v[16:19], v[192:195], v[232:235], v[16:19]
    v_xor_b32 v248, 0x10000, v248
    v_mfma_f32_16x16x32_bf16 v[20:23], v[196:199], v[232:235], v[20:23]
    v_xor_b32 v249, 0x10000, v249
    v_mfma_f32_16x16x32_bf16 v[48:51], v[200:203], v[232:235], v[48:51]
    v_mfma_f32_16x16x32_bf16 v[52:55], v[204:207], v[232:235], v[52:55]
    s_waitcnt lgkmcnt(4)
    v_mfma_f32_16x16x32_bf16 v[24:27], v[192:195], v[236:239], v[24:27]
    v_mfma_f32_16x16x32_bf16 v[28:31], v[196:199], v[236:239], v[28:31]
    v_mfma_f32_16x16x32_bf16 v[56:59], v[200:203], v[236:239], v[56:59]
    v_mfma_f32_16x16x32_bf16 v[60:63], v[204:207], v[236:239], v[60:63]
    s_waitcnt vmcnt(8) lgkmcnt(0)
    s_barrier
    v_mfma_f32_16x16x32_bf16 v[64:67], v[208:211], v[224:227], v[64:67]
    ds_read_b128 v[192:195], v245 offset:0
    s_add_u32 m0, s83, 49152
    v_mfma_f32_16x16x32_bf16 v[68:71], v[212:215], v[224:227], v[68:71]
    ds_read_b128 v[196:199], v245 offset:2048
    s_add_u32 s89, s88, 31744
    v_mfma_f32_16x16x32_bf16 v[96:99], v[216:219], v[224:227], v[96:99]
    ds_read_b128 v[200:203], v245 offset:4096
    v_mfma_f32_16x16x32_bf16 v[100:103], v[220:223], v[224:227], v[100:103]
    ds_read_b64_tr_b16 v[224:225], v246 offset:0
    ds_read_b64_tr_b16 v[226:227], v246 offset:1024
    ds_read_b128 v[204:207], v245 offset:6144
    buffer_load_dwordx4 v244, s[36:39], s88 offen nt lds
    v_mfma_f32_16x16x32_bf16 v[72:75], v[208:211], v[228:231], v[72:75]
    v_mfma_f32_16x16x32_bf16 v[76:79], v[212:215], v[228:231], v[76:79]
    buffer_load_dwordx4 v244, s[36:39], s89 offen offset:1024 nt lds
    v_mfma_f32_16x16x32_bf16 v[104:107], v[216:219], v[228:231], v[104:107]
    v_mfma_f32_16x16x32_bf16 v[108:111], v[220:223], v[228:231], v[108:111]
    ds_read_b64_tr_b16 v[228:229], v247 offset:0
    ds_read_b64_tr_b16 v[230:231], v247 offset:1024
    s_add_u32 s88, s88, 262144
    v_mfma_f32_16x16x32_bf16 v[80:83], v[208:211], v[232:235], v[80:83]
    s_add_u32 m0, s81, 131072
    v_mfma_f32_16x16x32_bf16 v[84:87], v[212:215], v[232:235], v[84:87]
    v_mfma_f32_16x16x32_bf16 v[112:115], v[216:219], v[232:235], v[112:115]
    s_nop 0
    v_mfma_f32_16x16x32_bf16 v[116:119], v[220:223], v[232:235], v[116:119]
    ds_read_b64_tr_b16 v[232:233], v248 offset:0
    ds_read_b64_tr_b16 v[234:235], v248 offset:1024
    v_mfma_f32_16x16x32_bf16 v[88:91], v[208:211], v[236:239], v[88:91]
    buffer_load_dwordx4 v243, s[32:35], s86 offen lds
    v_mfma_f32_16x16x32_bf16 v[92:95], v[212:215], v[236:239], v[92:95]
    v_mfma_f32_16x16x32_bf16 v[120:123], v[216:219], v[236:239], v[120:123]
    buffer_load_dwordx4 v183, s[32:35], s86 offen offset:1024 lds
    v_mfma_f32_16x16x32_bf16 v[124:127], v[220:223], v[236:239], v[124:127]
    ds_read_b64_tr_b16 v[236:237], v249 offset:0
    ds_read_b64_tr_b16 v[238:239], v249 offset:1024
    s_waitcnt lgkmcnt(6)
    v_mfma_f32_16x16x32_bf16 v[0:3], v[192:195], v[224:227], v[0:3]
    ds_read_b128 v[208:211], v245 offset:8192
    s_min_u32 s13, s72, 26
    v_mfma_f32_16x16x32_bf16 v[4:7], v[196:199], v[224:227], v[4:7]
    ds_read_b128 v[212:215], v245 offset:10240
    v_mfma_f32_16x16x32_bf16 v[32:35], v[200:203], v[224:227], v[32:35]
    ds_read_b128 v[216:219], v245 offset:12288
    s_lshl_b32 s13, s13, 7
    v_mfma_f32_16x16x32_bf16 v[36:39], v[204:207], v[224:227], v[36:39]
    ds_read_b128 v[220:223], v245 offset:14336
    s_waitcnt lgkmcnt(8)
    v_mfma_f32_16x16x32_bf16 v[8:11], v[192:195], v[228:231], v[8:11]
    v_xor_b32 v245, 64, v245
    v_lshrrev_b32 v168, 8, v240
    v_mfma_f32_16x16x32_bf16 v[12:15], v[196:199], v[228:231], v[12:15]
    v_mfma_f32_16x16x32_bf16 v[40:43], v[200:203], v[228:231], v[40:43]
    v_lshlrev_b32 v168, 3, v168
    v_mfma_f32_16x16x32_bf16 v[44:47], v[204:207], v[228:231], v[44:47]
    s_waitcnt lgkmcnt(6)
    v_mfma_f32_16x16x32_bf16 v[16:19], v[192:195], v[232:235], v[16:19]
    buffer_load_dwordx2 v[160:161], v168, s[68:71], s13 offen offset:0
    v_mfma_f32_16x16x32_bf16 v[20:23], v[196:199], v[232:235], v[20:23]
    v_mfma_f32_16x16x32_bf16 v[48:51], v[200:203], v[232:235], v[48:51]
    buffer_load_dwordx2 v[162:163], v168, s[68:71], s13 offen offset:32
    v_mfma_f32_16x16x32_bf16 v[52:55], v[204:207], v[232:235], v[52:55]
    s_waitcnt lgkmcnt(4)
    v_mfma_f32_16x16x32_bf16 v[24:27], v[192:195], v[236:239], v[24:27]
    buffer_load_dwordx2 v[164:165], v168, s[68:71], s13 offen offset:64
    v_mfma_f32_16x16x32_bf16 v[28:31], v[196:199], v[236:239], v[28:31]
    v_mfma_f32_16x16x32_bf16 v[56:59], v[200:203], v[236:239], v[56:59]
    buffer_load_dwordx2 v[166:167], v168, s[68:71], s13 offen offset:96
    v_mfma_f32_16x16x32_bf16 v[60:63], v[204:207], v[236:239], v[60:63]
    s_waitcnt vmcnt(14) lgkmcnt(0)
    s_barrier
    v_mfma_f32_16x16x32_bf16 v[64:67], v[208:211], v[224:227], v[64:67]
    ds_read_b128 v[192:195], v245 offset:0
    s_add_u32 m0, s81, 131072
    v_mfma_f32_16x16x32_bf16 v[68:71], v[212:215], v[224:227], v[68:71]
    ds_read_b128 v[196:199], v245 offset:2048
    s_add_u32 s87, s86, 14336
    v_mfma_f32_16x16x32_bf16 v[96:99], v[216:219], v[224:227], v[96:99]
    ds_read_b128 v[200:203], v245 offset:4096
    v_mfma_f32_16x16x32_bf16 v[100:103], v[220:223], v[224:227], v[100:103]
    ds_read_b64_tr_b16 v[224:225], v246 offset:16384
    ds_read_b64_tr_b16 v[226:227], v246 offset:17408
    ds_read_b128 v[204:207], v245 offset:6144
    buffer_load_dwordx4 v243, s[32:35], s87 offen offset:2048 lds
    v_mfma_f32_16x16x32_bf16 v[72:75], v[208:211], v[228:231], v[72:75]
    buffer_load_dwordx4 v183, s[32:35], s87 offen offset:3072 lds
    v_mfma_f32_16x16x32_bf16 v[76:79], v[212:215], v[228:231], v[76:79]
    v_mfma_f32_16x16x32_bf16 v[104:107], v[216:219], v[228:231], v[104:107]
    s_add_u32 s86, s86, 128
    v_mfma_f32_16x16x32_bf16 v[108:111], v[220:223], v[228:231], v[108:111]
    ds_read_b64_tr_b16 v[228:229], v247 offset:16384
    ds_read_b64_tr_b16 v[230:231], v247 offset:17408
    v_mfma_f32_16x16x32_bf16 v[80:83], v[208:211], v[232:235], v[80:83]
    s_add_u32 m0, s83, 98304
    v_mfma_f32_16x16x32_bf16 v[84:87], v[212:215], v[232:235], v[84:87]
    s_add_u32 s89, s88, 31744
    v_mfma_f32_16x16x32_bf16 v[112:115], v[216:219], v[232:235], v[112:115]
    v_mfma_f32_16x16x32_bf16 v[116:119], v[220:223], v[232:235], v[116:119]
    ds_read_b64_tr_b16 v[232:233], v248 offset:16384
    ds_read_b64_tr_b16 v[234:235], v248 offset:17408
    buffer_load_dwordx4 v244, s[36:39], s88 offen nt lds
    v_mfma_f32_16x16x32_bf16 v[88:91], v[208:211], v[236:239], v[88:91]
    buffer_load_dwordx4 v244, s[36:39], s89 offen offset:1024 nt lds
    v_mfma_f32_16x16x32_bf16 v[92:95], v[212:215], v[236:239], v[92:95]
    v_mfma_f32_16x16x32_bf16 v[120:123], v[216:219], v[236:239], v[120:123]
    s_add_u32 s88, s88, 262144
    v_mfma_f32_16x16x32_bf16 v[124:127], v[220:223], v[236:239], v[124:127]
    ds_read_b64_tr_b16 v[236:237], v249 offset:16384
    ds_read_b64_tr_b16 v[238:239], v249 offset:17408
    s_waitcnt lgkmcnt(6)
    v_mfma_f32_16x16x32_bf16 v[0:3], v[192:195], v[224:227], v[0:3]
    ds_read_b128 v[208:211], v245 offset:8192
    v_mfma_f32_16x16x32_bf16 v[4:7], v[196:199], v[224:227], v[4:7]
    ds_read_b128 v[212:215], v245 offset:10240
    v_mfma_f32_16x16x32_bf16 v[32:35], v[200:203], v[224:227], v[32:35]
    ds_read_b128 v[216:219], v245 offset:12288
    v_mfma_f32_16x16x32_bf16 v[36:39], v[204:207], v[224:227], v[36:39]
    ds_read_b128 v[220:223], v245 offset:14336
    s_waitcnt lgkmcnt(8)
    v_mfma_f32_16x16x32_bf16 v[8:11], v[192:195], v[228:231], v[8:11]
    v_xor_b32 v245, 64, v245
    v_mfma_f32_16x16x32_bf16 v[12:15], v[196:199], v[228:231], v[12:15]
    v_add_u32 v245, 0x10000, v245
    v_mfma_f32_16x16x32_bf16 v[40:43], v[200:203], v[228:231], v[40:43]
    v_xor_b32 v246, 0x10000, v246
    v_mfma_f32_16x16x32_bf16 v[44:47], v[204:207], v[228:231], v[44:47]
    v_xor_b32 v247, 0x10000, v247
    s_waitcnt lgkmcnt(6)
    v_mfma_f32_16x16x32_bf16 v[16:19], v[192:195], v[232:235], v[16:19]
    v_xor_b32 v248, 0x10000, v248
    v_mfma_f32_16x16x32_bf16 v[20:23], v[196:199], v[232:235], v[20:23]
    v_xor_b32 v249, 0x10000, v249
    v_mfma_f32_16x16x32_bf16 v[48:51], v[200:203], v[232:235], v[48:51]
    v_mfma_f32_16x16x32_bf16 v[52:55], v[204:207], v[232:235], v[52:55]
    s_waitcnt lgkmcnt(4)
    v_mfma_f32_16x16x32_bf16 v[24:27], v[192:195], v[236:239], v[24:27]
    v_mfma_f32_16x16x32_bf16 v[28:31], v[196:199], v[236:239], v[28:31]
    v_mfma_f32_16x16x32_bf16 v[56:59], v[200:203], v[236:239], v[56:59]
    v_mfma_f32_16x16x32_bf16 v[60:63], v[204:207], v[236:239], v[60:63]
    s_waitcnt vmcnt(12) lgkmcnt(0)
    s_barrier
    v_mfma_f32_16x16x32_bf16 v[64:67], v[208:211], v[224:227], v[64:67]
    buffer_load_dword v254, off, s[60:63], s22 sc1
    s_add_u32 m0, s83, 114688
    v_mfma_f32_16x16x32_bf16 v[68:71], v[212:215], v[224:227], v[68:71]
    ds_read_b128 v[192:195], v245 offset:0
    s_add_u32 s89, s88, 31744
    v_mfma_f32_16x16x32_bf16 v[96:99], v[216:219], v[224:227], v[96:99]
    ds_read_b128 v[196:199], v245 offset:2048
    v_mfma_f32_16x16x32_bf16 v[100:103], v[220:223], v[224:227], v[100:103]
    ds_read_b64_tr_b16 v[224:225], v246 offset:0
    ds_read_b64_tr_b16 v[226:227], v246 offset:1024
    ds_read_b128 v[200:203], v245 offset:4096
    buffer_load_dwordx4 v244, s[36:39], s88 offen nt lds
    v_mfma_f32_16x16x32_bf16 v[72:75], v[208:211], v[228:231], v[72:75]
    ds_read_b128 v[204:207], v245 offset:6144
    v_mfma_f32_16x16x32_bf16 v[76:79], v[212:215], v[228:231], v[76:79]
    buffer_load_dwordx4 v244, s[36:39], s89 offen offset:1024 nt lds
    v_mfma_f32_16x16x32_bf16 v[104:107], v[216:219], v[228:231], v[104:107]
    v_mfma_f32_16x16x32_bf16 v[108:111], v[220:223], v[228:231], v[108:111]
    ds_read_b64_tr_b16 v[228:229], v247 offset:0
    ds_read_b64_tr_b16 v[230:231], v247 offset:1024
    s_add_u32 s88, s88, 262144
    v_mfma_f32_16x16x32_bf16 v[80:83], v[208:211], v[232:235], v[80:83]
    s_add_u32 m0, s81, 0
    v_mfma_f32_16x16x32_bf16 v[84:87], v[212:215], v[232:235], v[84:87]
    v_mfma_f32_16x16x32_bf16 v[112:115], v[216:219], v[232:235], v[112:115]
    s_nop 0
    v_mfma_f32_16x16x32_bf16 v[116:119], v[220:223], v[232:235], v[116:119]
    ds_read_b64_tr_b16 v[232:233], v248 offset:0
    ds_read_b64_tr_b16 v[234:235], v248 offset:1024
    v_mfma_f32_16x16x32_bf16 v[88:91], v[208:211], v[236:239], v[88:91]
    buffer_load_dwordx4 v243, s[32:35], s86 offen lds
    v_mfma_f32_16x16x32_bf16 v[92:95], v[212:215], v[236:239], v[92:95]
    v_mfma_f32_16x16x32_bf16 v[120:123], v[216:219], v[236:239], v[120:123]
    buffer_load_dwordx4 v183, s[32:35], s86 offen offset:1024 lds
    v_mfma_f32_16x16x32_bf16 v[124:127], v[220:223], v[236:239], v[124:127]
    ds_read_b64_tr_b16 v[236:237], v249 offset:0
    ds_read_b64_tr_b16 v[238:239], v249 offset:1024
    s_waitcnt lgkmcnt(6)
    v_mfma_f32_16x16x32_bf16 v[0:3], v[192:195], v[224:227], v[0:3]
    ds_read_b128 v[208:211], v245 offset:8192
    v_mfma_f32_16x16x32_bf16 v[4:7], v[196:199], v[224:227], v[4:7]
    ds_read_b128 v[212:215], v245 offset:10240
    v_mfma_f32_16x16x32_bf16 v[32:35], v[200:203], v[224:227], v[32:35]
    ds_read_b128 v[216:219], v245 offset:12288
    v_mfma_f32_16x16x32_bf16 v[36:39], v[204:207], v[224:227], v[36:39]
    ds_read_b128 v[220:223], v245 offset:14336
    s_waitcnt lgkmcnt(8)
    v_mfma_f32_16x16x32_bf16 v[8:11], v[192:195], v[228:231], v[8:11]
    v_xor_b32 v245, 64, v245
    v_mfma_f32_16x16x32_bf16 v[12:15], v[196:199], v[228:231], v[12:15]
    v_mfma_f32_16x16x32_bf16 v[40:43], v[200:203], v[228:231], v[40:43]
    v_mfma_f32_16x16x32_bf16 v[44:47], v[204:207], v[228:231], v[44:47]
    s_waitcnt lgkmcnt(6)
    v_mfma_f32_16x16x32_bf16 v[16:19], v[192:195], v[232:235], v[16:19]
    v_mfma_f32_16x16x32_bf16 v[20:23], v[196:199], v[232:235], v[20:23]
    v_mfma_f32_16x16x32_bf16 v[48:51], v[200:203], v[232:235], v[48:51]
    v_mfma_f32_16x16x32_bf16 v[52:55], v[204:207], v[232:235], v[52:55]
    s_waitcnt lgkmcnt(4)
    v_mfma_f32_16x16x32_bf16 v[24:27], v[192:195], v[236:239], v[24:27]
    v_mfma_f32_16x16x32_bf16 v[28:31], v[196:199], v[236:239], v[28:31]
    v_mfma_f32_16x16x32_bf16 v[56:59], v[200:203], v[236:239], v[56:59]
    v_mfma_f32_16x16x32_bf16 v[60:63], v[204:207], v[236:239], v[60:63]
    s_waitcnt vmcnt(4) lgkmcnt(0)
    v_cmp_gt_u32 vcc, 1, v254
    s_and_b32 s30, vcc_lo, s15
    s_cbranch_scc0 KB_E9V_OK
    s_mov_b32 s23, 100000
KB_E9V_SPIN:
    s_sleep 10
    buffer_load_dword v254, off, s[60:63], s22 sc1
    s_waitcnt vmcnt(0)
    v_cmp_gt_u32 vcc, 1, v254
    s_and_b32 s30, vcc_lo, s15
    s_cbranch_scc0 KB_E9V_OK
    s_sub_u32 s23, s23, 1
    s_cbranch_scc0 KB_E9V_SPIN
KB_E9V_OK:
    s_barrier
    v_mfma_f32_16x16x32_bf16 v[64:67], v[208:211], v[224:227], v[64:67]
    ds_read_b128 v[192:195], v245 offset:0
    s_lshr_b32 s77, s2, 4
    s_sub_u32 s78, 15, s77
    v_mfma_f32_16x16x32_bf16 v[68:71], v[212:215], v[224:227], v[68:71]
    ds_read_b128 v[196:199], v245 offset:2048
    s_min_u32 s78, s78, s77
    v_mfma_f32_16x16x32_bf16 v[96:99], v[216:219], v[224:227], v[96:99]
    ds_read_b128 v[200:203], v245 offset:4096
    s_lshl_b32 s78, s78, 1
    s_lshr_b32 s77, s77, 3
    v_mfma_f32_16x16x32_bf16 v[100:103], v[220:223], v[224:227], v[100:103]
    ds_read_b64_tr_b16 v[224:225], v246 offset:16384
    ds_read_b64_tr_b16 v[226:227], v246 offset:17408
    ds_read_b128 v[204:207], v245 offset:6144
    s_add_u32 s78, s78, s77
    v_mfma_f32_16x16x32_bf16 v[72:75], v[208:211], v[228:231], v[72:75]
    s_lshl_b32 s78, s78, 4
    s_and_b32 s77, s2, 15
    v_mfma_f32_16x16x32_bf16 v[76:79], v[212:215], v[228:231], v[76:79]
    s_add_u32 s78, s78, s77
    v_mfma_f32_16x16x32_bf16 v[104:107], v[216:219], v[228:231], v[104:107]
    s_lshl_b32 s78, s78, 8
    s_add_u32 s78, s78, 4116
    v_mfma_f32_16x16x32_bf16 v[108:111], v[220:223], v[228:231], v[108:111]
    ds_read_b64_tr_b16 v[228:229], v247 offset:16384
    ds_read_b64_tr_b16 v[230:231], v247 offset:17408
    v_mov_b32 v253, 1
    v_mfma_f32_16x16x32_bf16 v[80:83], v[208:211], v[232:235], v[80:83]
    buffer_store_dword v253, v252, s[4:7], s78 offen sc1
    v_mfma_f32_16x16x32_bf16 v[84:87], v[212:215], v[232:235], v[84:87]
    s_add_u32 m0, s81, 0
    s_add_u32 s87, s86, 14336
    v_mfma_f32_16x16x32_bf16 v[112:115], v[216:219], v[232:235], v[112:115]
    buffer_load_dwordx4 v243, s[32:35], s87 offen offset:2048 lds
    v_mfma_f32_16x16x32_bf16 v[116:119], v[220:223], v[232:235], v[116:119]
    ds_read_b64_tr_b16 v[232:233], v248 offset:16384
    ds_read_b64_tr_b16 v[234:235], v248 offset:17408
    buffer_load_dwordx4 v183, s[32:35], s87 offen offset:3072 lds
    s_add_u32 s86, s86, 128
    v_mfma_f32_16x16x32_bf16 v[88:91], v[208:211], v[236:239], v[88:91]
    s_add_u32 m0, s83, 32768
    v_mfma_f32_16x16x32_bf16 v[92:95], v[212:215], v[236:239], v[92:95]
    s_add_u32 s89, s88, 31744
    buffer_load_dwordx4 v244, s[36:39], s88 offen nt lds
    v_mfma_f32_16x16x32_bf16 v[120:123], v[216:219], v[236:239], v[120:123]
    buffer_load_dwordx4 v244, s[36:39], s89 offen offset:1024 nt lds
    v_mfma_f32_16x16x32_bf16 v[124:127], v[220:223], v[236:239], v[124:127]
    ds_read_b64_tr_b16 v[236:237], v249 offset:16384
    ds_read_b64_tr_b16 v[238:239], v249 offset:17408
    s_add_u32 s88, s88, 262144
    s_waitcnt lgkmcnt(6)
    v_mfma_f32_16x16x32_bf16 v[0:3], v[192:195], v[224:227], v[0:3]
    ds_read_b128 v[208:211], v245 offset:8192
    v_mfma_f32_16x16x32_bf16 v[4:7], v[196:199], v[224:227], v[4:7]
    ds_read_b128 v[212:215], v245 offset:10240
    v_mfma_f32_16x16x32_bf16 v[32:35], v[200:203], v[224:227], v[32:35]
    ds_read_b128 v[216:219], v245 offset:12288
    v_mfma_f32_16x16x32_bf16 v[36:39], v[204:207], v[224:227], v[36:39]
    ds_read_b128 v[220:223], v245 offset:14336
    s_waitcnt lgkmcnt(8)
    v_mfma_f32_16x16x32_bf16 v[8:11], v[192:195], v[228:231], v[8:11]
    v_xor_b32 v245, 64, v245
    v_mfma_f32_16x16x32_bf16 v[12:15], v[196:199], v[228:231], v[12:15]
    v_add_u32 v245, 0x10000, v245
    v_mfma_f32_16x16x32_bf16 v[40:43], v[200:203], v[228:231], v[40:43]
    v_xor_b32 v246, 0x10000, v246
    v_mfma_f32_16x16x32_bf16 v[44:47], v[204:207], v[228:231], v[44:47]
    v_xor_b32 v247, 0x10000, v247
    s_waitcnt lgkmcnt(6)
    v_mfma_f32_16x16x32_bf16 v[16:19], v[192:195], v[232:235], v[16:19]
    v_xor_b32 v248, 0x10000, v248
    v_mfma_f32_16x16x32_bf16 v[20:23], v[196:199], v[232:235], v[20:23]
    v_xor_b32 v249, 0x10000, v249
    v_mfma_f32_16x16x32_bf16 v[48:51], v[200:203], v[232:235], v[48:51]
    v_mfma_f32_16x16x32_bf16 v[52:55], v[204:207], v[232:235], v[52:55]
    s_waitcnt lgkmcnt(4)
    v_mfma_f32_16x16x32_bf16 v[24:27], v[192:195], v[236:239], v[24:27]
    v_mfma_f32_16x16x32_bf16 v[28:31], v[196:199], v[236:239], v[28:31]
    v_mfma_f32_16x16x32_bf16 v[56:59], v[200:203], v[236:239], v[56:59]
    v_mfma_f32_16x16x32_bf16 v[60:63], v[204:207], v[236:239], v[60:63]
    s_waitcnt vmcnt(10) lgkmcnt(0)
    s_barrier
    v_mfma_f32_16x16x32_bf16 v[64:67], v[208:211], v[224:227], v[64:67]
    ds_read_b128 v[192:195], v245 offset:0
    s_add_u32 m0, s83, 49152
    v_mfma_f32_16x16x32_bf16 v[68:71], v[212:215], v[224:227], v[68:71]
    ds_read_b128 v[196:199], v245 offset:2048
    s_add_u32 s89, s88, 31744
    v_mfma_f32_16x16x32_bf16 v[96:99], v[216:219], v[224:227], v[96:99]
    ds_read_b128 v[200:203], v245 offset:4096
    v_mfma_f32_16x16x32_bf16 v[100:103], v[220:223], v[224:227], v[100:103]
    ds_read_b64_tr_b16 v[224:225], v246 offset:0
    ds_read_b64_tr_b16 v[226:227], v246 offset:1024
    ds_read_b128 v[204:207], v245 offset:6144
    buffer_load_dwordx4 v244, s[36:39], s88 offen nt lds
    v_mfma_f32_16x16x32_bf16 v[72:75], v[208:211], v[228:231], v[72:75]
    v_mfma_f32_16x16x32_bf16 v[76:79], v[212:215], v[228:231], v[76:79]
    buffer_load_dwordx4 v244, s[36:39], s89 offen offset:1024 nt lds
    v_mfma_f32_16x16x32_bf16 v[104:107], v[216:219], v[228:231], v[104:107]
    v_mfma_f32_16x16x32_bf16 v[108:111], v[220:223], v[228:231], v[108:111]
    ds_read_b64_tr_b16 v[228:229], v247 offset:0
    ds_read_b64_tr_b16 v[230:231], v247 offset:1024
    s_add_u32 s88, s88, 262144
    v_mfma_f32_16x16x32_bf16 v[80:83], v[208:211], v[232:235], v[80:83]
    s_add_u32 m0, s81, 65536
    v_mfma_f32_16x16x32_bf16 v[84:87], v[212:215], v[232:235], v[84:87]
    v_mfma_f32_16x16x32_bf16 v[112:115], v[216:219], v[232:235], v[112:115]
    s_nop 0
    v_mfma_f32_16x16x32_bf16 v[116:119], v[220:223], v[232:235], v[116:119]
    ds_read_b64_tr_b16 v[232:233], v248 offset:0
    ds_read_b64_tr_b16 v[234:235], v248 offset:1024
    v_mfma_f32_16x16x32_bf16 v[88:91], v[208:211], v[236:239], v[88:91]
    buffer_load_dwordx4 v243, s[32:35], s86 offen lds
    v_mfma_f32_16x16x32_bf16 v[92:95], v[212:215], v[236:239], v[92:95]
    v_mfma_f32_16x16x32_bf16 v[120:123], v[216:219], v[236:239], v[120:123]
    buffer_load_dwordx4 v183, s[32:35], s86 offen offset:1024 lds
    v_mfma_f32_16x16x32_bf16 v[124:127], v[220:223], v[236:239], v[124:127]
    ds_read_b64_tr_b16 v[236:237], v249 offset:0
    ds_read_b64_tr_b16 v[238:239], v249 offset:1024
    s_waitcnt lgkmcnt(6)
    v_mfma_f32_16x16x32_bf16 v[0:3], v[192:195], v[224:227], v[0:3]
    ds_read_b128 v[208:211], v245 offset:8192
    v_mfma_f32_16x16x32_bf16 v[4:7], v[196:199], v[224:227], v[4:7]
    ds_read_b128 v[212:215], v245 offset:10240
    v_mfma_f32_16x16x32_bf16 v[32:35], v[200:203], v[224:227], v[32:35]
    ds_read_b128 v[216:219], v245 offset:12288
    v_mfma_f32_16x16x32_bf16 v[36:39], v[204:207], v[224:227], v[36:39]
    ds_read_b128 v[220:223], v245 offset:14336
    s_waitcnt lgkmcnt(8)
    v_mfma_f32_16x16x32_bf16 v[8:11], v[192:195], v[228:231], v[8:11]
    v_xor_b32 v245, 64, v245
    v_mfma_f32_16x16x32_bf16 v[12:15], v[196:199], v[228:231], v[12:15]
    v_mfma_f32_16x16x32_bf16 v[40:43], v[200:203], v[228:231], v[40:43]
    v_mfma_f32_16x16x32_bf16 v[44:47], v[204:207], v[228:231], v[44:47]
    s_waitcnt lgkmcnt(6)
    v_mfma_f32_16x16x32_bf16 v[16:19], v[192:195], v[232:235], v[16:19]
    v_mfma_f32_16x16x32_bf16 v[20:23], v[196:199], v[232:235], v[20:23]
    v_mfma_f32_16x16x32_bf16 v[48:51], v[200:203], v[232:235], v[48:51]
    v_mfma_f32_16x16x32_bf16 v[52:55], v[204:207], v[232:235], v[52:55]
    s_waitcnt lgkmcnt(4)
    v_mfma_f32_16x16x32_bf16 v[24:27], v[192:195], v[236:239], v[24:27]
    v_mfma_f32_16x16x32_bf16 v[28:31], v[196:199], v[236:239], v[28:31]
    v_mfma_f32_16x16x32_bf16 v[56:59], v[200:203], v[236:239], v[56:59]
    v_mfma_f32_16x16x32_bf16 v[60:63], v[204:207], v[236:239], v[60:63]
    s_waitcnt vmcnt(11) lgkmcnt(0)
    s_barrier
    v_mfma_f32_16x16x32_bf16 v[64:67], v[208:211], v[224:227], v[64:67]
    ds_read_b128 v[192:195], v245 offset:0
    s_add_u32 m0, s81, 65536
    v_mfma_f32_16x16x32_bf16 v[68:71], v[212:215], v[224:227], v[68:71]
    ds_read_b128 v[196:199], v245 offset:2048
    s_add_u32 s87, s86, 14336
    v_mfma_f32_16x16x32_bf16 v[96:99], v[216:219], v[224:227], v[96:99]
    ds_read_b128 v[200:203], v245 offset:4096
    v_mfma_f32_16x16x32_bf16 v[100:103], v[220:223], v[224:227], v[100:103]
    ds_read_b64_tr_b16 v[224:225], v246 offset:16384
    ds_read_b64_tr_b16 v[226:227], v246 offset:17408
    ds_read_b128 v[204:207], v245 offset:6144
    buffer_load_dwordx4 v243, s[32:35], s87 offen offset:2048 lds
    v_mfma_f32_16x16x32_bf16 v[72:75], v[208:211], v[228:231], v[72:75]
    buffer_load_dwordx4 v183, s[32:35], s87 offen offset:3072 lds
    v_mfma_f32_16x16x32_bf16 v[76:79], v[212:215], v[228:231], v[76:79]
    v_mfma_f32_16x16x32_bf16 v[104:107], v[216:219], v[228:231], v[104:107]
    s_add_u32 s86, s86, 128
    v_mfma_f32_16x16x32_bf16 v[108:111], v[220:223], v[228:231], v[108:111]
    ds_read_b64_tr_b16 v[228:229], v247 offset:16384
    ds_read_b64_tr_b16 v[230:231], v247 offset:17408
    v_mfma_f32_16x16x32_bf16 v[80:83], v[208:211], v[232:235], v[80:83]
    s_add_u32 m0, s83, 98304
    v_mfma_f32_16x16x32_bf16 v[84:87], v[212:215], v[232:235], v[84:87]
    s_add_u32 s89, s88, 31744
    v_mfma_f32_16x16x32_bf16 v[112:115], v[216:219], v[232:235], v[112:115]
    v_mfma_f32_16x16x32_bf16 v[116:119], v[220:223], v[232:235], v[116:119]
    ds_read_b64_tr_b16 v[232:233], v248 offset:16384
    ds_read_b64_tr_b16 v[234:235], v248 offset:17408
    buffer_load_dwordx4 v244, s[36:39], s88 offen nt lds
    v_mfma_f32_16x16x32_bf16 v[88:91], v[208:211], v[236:239], v[88:91]
    buffer_load_dwordx4 v244, s[36:39], s89 offen offset:1024 nt lds
    v_mfma_f32_16x16x32_bf16 v[92:95], v[212:215], v[236:239], v[92:95]
    v_mfma_f32_16x16x32_bf16 v[120:123], v[216:219], v[236:239], v[120:123]
    s_add_u32 s88, s88, 262144
    v_mfma_f32_16x16x32_bf16 v[124:127], v[220:223], v[236:239], v[124:127]
    ds_read_b64_tr_b16 v[236:237], v249 offset:16384
    ds_read_b64_tr_b16 v[238:239], v249 offset:17408
    s_waitcnt lgkmcnt(6)
    v_mfma_f32_16x16x32_bf16 v[0:3], v[192:195], v[224:227], v[0:3]
    ds_read_b128 v[208:211], v245 offset:8192
    v_mfma_f32_16x16x32_bf16 v[4:7], v[196:199], v[224:227], v[4:7]
    ds_read_b128 v[212:215], v245 offset:10240
    v_mfma_f32_16x16x32_bf16 v[32:35], v[200:203], v[224:227], v[32:35]
    ds_read_b128 v[216:219], v245 offset:12288
    v_mfma_f32_16x16x32_bf16 v[36:39], v[204:207], v[224:227], v[36:39]
    ds_read_b128 v[220:223], v245 offset:14336
    s_waitcnt lgkmcnt(8)
    v_mfma_f32_16x16x32_bf16 v[8:11], v[192:195], v[228:231], v[8:11]
    v_xor_b32 v245, 64, v245
    v_mfma_f32_16x16x32_bf16 v[12:15], v[196:199], v[228:231], v[12:15]
    v_add_u32 v245, 0xfffe0000, v245
    v_mfma_f32_16x16x32_bf16 v[40:43], v[200:203], v[228:231], v[40:43]
    v_xor_b32 v246, 0x10000, v246
    v_mfma_f32_16x16x32_bf16 v[44:47], v[204:207], v[228:231], v[44:47]
    v_xor_b32 v247, 0x10000, v247
    s_waitcnt lgkmcnt(6)
    v_mfma_f32_16x16x32_bf16 v[16:19], v[192:195], v[232:235], v[16:19]
    v_xor_b32 v248, 0x10000, v248
    v_mfma_f32_16x16x32_bf16 v[20:23], v[196:199], v[232:235], v[20:23]
    v_xor_b32 v249, 0x10000, v249
    v_mfma_f32_16x16x32_bf16 v[48:51], v[200:203], v[232:235], v[48:51]
    v_mfma_f32_16x16x32_bf16 v[52:55], v[204:207], v[232:235], v[52:55]
    s_waitcnt lgkmcnt(4)
    v_mfma_f32_16x16x32_bf16 v[24:27], v[192:195], v[236:239], v[24:27]
    v_mfma_f32_16x16x32_bf16 v[28:31], v[196:199], v[236:239], v[28:31]
    v_mfma_f32_16x16x32_bf16 v[56:59], v[200:203], v[236:239], v[56:59]
    v_mfma_f32_16x16x32_bf16 v[60:63], v[204:207], v[236:239], v[60:63]
    s_waitcnt vmcnt(8) lgkmcnt(0)
    s_barrier
    v_mfma_f32_16x16x32_bf16 v[64:67], v[208:211], v[224:227], v[64:67]
    ds_read_b128 v[192:195], v245 offset:0
    s_add_u32 m0, s83, 114688
    v_mfma_f32_16x16x32_bf16 v[68:71], v[212:215], v[224:227], v[68:71]
    ds_read_b128 v[196:199], v245 offset:2048
    s_add_u32 s89, s88, 31744
    v_mfma_f32_16x16x32_bf16 v[96:99], v[216:219], v[224:227], v[96:99]
    ds_read_b128 v[200:203], v245 offset:4096
    buffer_load_dwordx4 v244, s[36:39], s88 offen nt lds
    v_mfma_f32_16x16x32_bf16 v[100:103], v[220:223], v[224:227], v[100:103]
    ds_read_b64_tr_b16 v[224:225], v246 offset:0
    ds_read_b64_tr_b16 v[226:227], v246 offset:1024
    ds_read_b128 v[204:207], v245 offset:6144
    buffer_load_dwordx4 v244, s[36:39], s89 offen offset:1024 nt lds
    v_mfma_f32_16x16x32_bf16 v[72:75], v[208:211], v[228:231], v[72:75]
    s_add_u32 s88, s88, 262144
    v_mfma_f32_16x16x32_bf16 v[76:79], v[212:215], v[228:231], v[76:79]
    v_mfma_f32_16x16x32_bf16 v[104:107], v[216:219], v[228:231], v[104:107]
    s_add_u32 m0, s83, 122880
    v_mfma_f32_16x16x32_bf16 v[108:111], v[220:223], v[228:231], v[108:111]
    ds_read_b64_tr_b16 v[228:229], v247 offset:0
    ds_read_b64_tr_b16 v[230:231], v247 offset:1024
    s_add_u32 s77, s98, 31744
    v_mfma_f32_16x16x32_bf16 v[80:83], v[208:211], v[232:235], v[80:83]
    buffer_load_dwordx4 v244, s[48:51], s98 offen lds
    v_mfma_f32_16x16x32_bf16 v[84:87], v[212:215], v[232:235], v[84:87]
    buffer_load_dwordx4 v244, s[48:51], s77 offen offset:1024 lds
    v_mfma_f32_16x16x32_bf16 v[112:115], v[216:219], v[232:235], v[112:115]
    v_mfma_f32_16x16x32_bf16 v[116:119], v[220:223], v[232:235], v[116:119]
    ds_read_b64_tr_b16 v[232:233], v248 offset:0
    ds_read_b64_tr_b16 v[234:235], v248 offset:1024
    s_add_u32 m0, s94, 131072
    v_mfma_f32_16x16x32_bf16 v[88:91], v[208:211], v[236:239], v[88:91]
    s_add_u32 s98, s98, 262144
    v_mfma_f32_16x16x32_bf16 v[92:95], v[212:215], v[236:239], v[92:95]
    buffer_load_dwordx4 v241, s[52:55], s99 offen lds
    v_mfma_f32_16x16x32_bf16 v[120:123], v[216:219], v[236:239], v[120:123]
    s_add_u32 s99, s99, 110592
    v_mfma_f32_16x16x32_bf16 v[124:127], v[220:223], v[236:239], v[124:127]
    ds_read_b64_tr_b16 v[236:237], v249 offset:0
    ds_read_b64_tr_b16 v[238:239], v249 offset:1024
    s_waitcnt lgkmcnt(6)
    v_mfma_f32_16x16x32_bf16 v[0:3], v[192:195], v[224:227], v[0:3]
    ds_read_b128 v[208:211], v245 offset:8192
    v_mfma_f32_16x16x32_bf16 v[4:7], v[196:199], v[224:227], v[4:7]
    ds_read_b128 v[212:215], v245 offset:10240
    v_mfma_f32_16x16x32_bf16 v[32:35], v[200:203], v[224:227], v[32:35]
    ds_read_b128 v[216:219], v245 offset:12288
    v_mfma_f32_16x16x32_bf16 v[36:39], v[204:207], v[224:227], v[36:39]
    ds_read_b128 v[220:223], v245 offset:14336
    s_waitcnt lgkmcnt(8)
    v_mfma_f32_16x16x32_bf16 v[8:11], v[192:195], v[228:231], v[8:11]
    v_xor_b32 v245, 64, v245
    v_mfma_f32_16x16x32_bf16 v[12:15], v[196:199], v[228:231], v[12:15]
    v_mfma_f32_16x16x32_bf16 v[40:43], v[200:203], v[228:231], v[40:43]
    v_mfma_f32_16x16x32_bf16 v[44:47], v[204:207], v[228:231], v[44:47]
    s_waitcnt lgkmcnt(6)
    v_mfma_f32_16x16x32_bf16 v[16:19], v[192:195], v[232:235], v[16:19]
    v_mfma_f32_16x16x32_bf16 v[20:23], v[196:199], v[232:235], v[20:23]
    v_mfma_f32_16x16x32_bf16 v[48:51], v[200:203], v[232:235], v[48:51]
    v_mfma_f32_16x16x32_bf16 v[52:55], v[204:207], v[232:235], v[52:55]
    s_waitcnt lgkmcnt(4)
    v_mfma_f32_16x16x32_bf16 v[24:27], v[192:195], v[236:239], v[24:27]
    v_mfma_f32_16x16x32_bf16 v[28:31], v[196:199], v[236:239], v[28:31]
    v_mfma_f32_16x16x32_bf16 v[56:59], v[200:203], v[236:239], v[56:59]
    v_mfma_f32_16x16x32_bf16 v[60:63], v[204:207], v[236:239], v[60:63]
    s_waitcnt vmcnt(11) lgkmcnt(0)
    s_barrier
    v_mfma_f32_16x16x32_bf16 v[64:67], v[208:211], v[224:227], v[64:67]
    s_lshl_b32 s12, s73, 13
    v_mfma_f32_16x16x32_bf16 v[68:71], v[212:215], v[224:227], v[68:71]
    s_add_u32 s12, s12, s22
    v_mfma_f32_16x16x32_bf16 v[96:99], v[216:219], v[224:227], v[96:99]
    s_add_u32 s12, s12, 4096
    v_mfma_f32_16x16x32_bf16 v[100:103], v[220:223], v[224:227], v[100:103]
    ds_read_b64_tr_b16 v[224:225], v246 offset:16384
    ds_read_b64_tr_b16 v[226:227], v246 offset:17408
    v_lshrrev_b32 v254, 9, v240
    v_mfma_f32_16x16x32_bf16 v[72:75], v[208:211], v[228:231], v[72:75]
    v_lshl_or_b32 v254, v254, 26, v240
    v_mfma_f32_16x16x32_bf16 v[76:79], v[212:215], v[228:231], v[76:79]
    v_lshlrev_b32 v254, 4, v254
    v_mfma_f32_16x16x32_bf16 v[104:107], v[216:219], v[228:231], v[104:107]
    buffer_load_dword v254, v254, s[4:7], s12 offen offset:20 sc1
    v_mfma_f32_16x16x32_bf16 v[108:111], v[220:223], v[228:231], v[108:111]
    ds_read_b64_tr_b16 v[228:229], v247 offset:16384
    ds_read_b64_tr_b16 v[230:231], v247 offset:17408
    ds_read_b128 v[192:195], v245 offset:0
    v_mfma_f32_16x16x32_bf16 v[80:83], v[208:211], v[232:235], v[80:83]
    ds_read_b128 v[196:199], v245 offset:2048
    v_mfma_f32_16x16x32_bf16 v[84:87], v[212:215], v[232:235], v[84:87]
    ds_read_b128 v[200:203], v245 offset:4096
    v_mfma_f32_16x16x32_bf16 v[112:115], v[216:219], v[232:235], v[112:115]
    ds_read_b128 v[204:207], v245 offset:6144
    v_mfma_f32_16x16x32_bf16 v[116:119], v[220:223], v[232:235], v[116:119]
    ds_read_b64_tr_b16 v[232:233], v248 offset:16384
    ds_read_b64_tr_b16 v[234:235], v248 offset:17408
    v_mfma_f32_16x16x32_bf16 v[88:91], v[208:211], v[236:239], v[88:91]
    v_mfma_f32_16x16x32_bf16 v[92:95], v[212:215], v[236:239], v[92:95]
    v_mfma_f32_16x16x32_bf16 v[120:123], v[216:219], v[236:239], v[120:123]
    v_mfma_f32_16x16x32_bf16 v[124:127], v[220:223], v[236:239], v[124:127]
    ds_read_b64_tr_b16 v[236:237], v249 offset:16384
    ds_read_b64_tr_b16 v[238:239], v249 offset:17408
    s_waitcnt lgkmcnt(4)
    v_mfma_f32_16x16x32_bf16 v[0:3], v[192:195], v[224:227], v[0:3]
    ds_read_b128 v[208:211], v245 offset:8192
    s_waitcnt vmcnt(28)
    v_lshlrev_b32 v136, 16, v160
    v_mfma_f32_16x16x32_bf16 v[4:7], v[196:199], v[224:227], v[4:7]
    ds_read_b128 v[212:215], v245 offset:10240
    v_and_b32 v137, 0xffff0000, v160
    v_mfma_f32_16x16x32_bf16 v[32:35], v[200:203], v[224:227], v[32:35]
    ds_read_b128 v[216:219], v245 offset:12288
    v_lshlrev_b32 v138, 16, v161
    v_mfma_f32_16x16x32_bf16 v[36:39], v[204:207], v[224:227], v[36:39]
    ds_read_b128 v[220:223], v245 offset:14336
    v_and_b32 v139, 0xffff0000, v161
    v_mfma_f32_16x16x32_bf16 v[8:11], v[192:195], v[228:231], v[8:11]
    v_xor_b32 v245, 64, v245
    v_lshlrev_b32 v140, 16, v162
    v_mfma_f32_16x16x32_bf16 v[12:15], v[196:199], v[228:231], v[12:15]
    v_add_u32 v245, 0x10000, v245
    v_and_b32 v141, 0xffff0000, v162
    v_mfma_f32_16x16x32_bf16 v[40:43], v[200:203], v[228:231], v[40:43]
    v_xor_b32 v246, 0x10000, v246
    v_lshlrev_b32 v142, 16, v163
    v_mfma_f32_16x16x32_bf16 v[44:47], v[204:207], v[228:231], v[44:47]
    v_xor_b32 v247, 0x10000, v247
    v_and_b32 v143, 0xffff0000, v163
    s_waitcnt lgkmcnt(6)
    v_mfma_f32_16x16x32_bf16 v[16:19], v[192:195], v[232:235], v[16:19]
    v_xor_b32 v248, 0x10000, v248
    v_lshlrev_b32 v152, 16, v164
    v_mfma_f32_16x16x32_bf16 v[20:23], v[196:199], v[232:235], v[20:23]
    v_xor_b32 v249, 0x10000, v249
    v_and_b32 v153, 0xffff0000, v164
    v_mfma_f32_16x16x32_bf16 v[48:51], v[200:203], v[232:235], v[48:51]
    v_lshlrev_b32 v154, 16, v165
    v_mfma_f32_16x16x32_bf16 v[52:55], v[204:207], v[232:235], v[52:55]
    v_and_b32 v155, 0xffff0000, v165
    s_waitcnt lgkmcnt(4)
    v_mfma_f32_16x16x32_bf16 v[24:27], v[192:195], v[236:239], v[24:27]
    v_lshlrev_b32 v156, 16, v166
    v_mfma_f32_16x16x32_bf16 v[28:31], v[196:199], v[236:239], v[28:31]
    v_and_b32 v157, 0xffff0000, v166
    v_mfma_f32_16x16x32_bf16 v[56:59], v[200:203], v[236:239], v[56:59]
    v_lshlrev_b32 v158, 16, v167
    v_mfma_f32_16x16x32_bf16 v[60:63], v[204:207], v[236:239], v[60:63]
    v_and_b32 v159, 0xffff0000, v167
    s_waitcnt vmcnt(0) lgkmcnt(0)
    v_cmp_gt_u32 vcc, 1, v254
    s_and_b32 s30, vcc_lo, s15
    s_cbranch_scc0 KB_E14V_OK
    s_mov_b32 s23, 100000
KB_E14V_SPIN:
    s_sleep 10
    s_lshl_b32 s12, s73, 13
    s_add_u32 s12, s12, s22
    s_add_u32 s12, s12, 4096
    v_lshrrev_b32 v254, 9, v240
    v_lshl_or_b32 v254, v254, 26, v240
    v_lshlrev_b32 v254, 4, v254
    buffer_load_dword v254, v254, s[4:7], s12 offen offset:20 sc1
    s_waitcnt vmcnt(0)
    v_cmp_gt_u32 vcc, 1, v254
    s_and_b32 s30, vcc_lo, s15
    s_cbranch_scc0 KB_E14V_OK
    s_sub_u32 s23, s23, 1
    s_cbranch_scc0 KB_E14V_SPIN
KB_E14V_OK:
    s_barrier
    v_mfma_f32_16x16x32_bf16 v[64:67], v[208:211], v[224:227], v[64:67]
    ds_read_b128 v[192:195], v245 offset:0
    s_add_u32 m0, s83, 139264
    s_nop 0
    buffer_load_dwordx4 v240, s[44:47], s100 offen sc1 lds
    v_mfma_f32_16x16x32_bf16 v[68:71], v[212:215], v[224:227], v[68:71]
    ds_read_b128 v[196:199], v245 offset:2048
    buffer_load_dwordx4 v240, s[44:47], s100 offen offset:1024 sc1 lds
    s_add_u32 m0, s83, 147456
    s_add_u32 s100, s100, 2048
    v_mfma_f32_16x16x32_bf16 v[96:99], v[216:219], v[224:227], v[96:99]
    ds_read_b128 v[200:203], v245 offset:4096
    buffer_load_dwordx4 v240, s[44:47], s101 offen sc1 lds
    buffer_load_dwordx4 v240, s[44:47], s101 offen offset:1024 sc1 lds
    v_mfma_f32_16x16x32_bf16 v[100:103], v[220:223], v[224:227], v[100:103]
    ds_read_b64_tr_b16 v[224:225], v246 offset:0
    ds_read_b64_tr_b16 v[226:227], v246 offset:1024
    ds_read_b128 v[204:207], v245 offset:6144
    s_add_u32 s101, s101, 2048
    s_add_u32 m0, s83, 4294959104
    s_add_u32 s77, s98, 31744
    v_mfma_f32_16x16x32_bf16 v[72:75], v[208:211], v[228:231], v[72:75]
    buffer_load_dwordx4 v244, s[48:51], s98 offen lds
    buffer_load_dwordx4 v244, s[48:51], s77 offen offset:1024 lds
    v_mfma_f32_16x16x32_bf16 v[76:79], v[212:215], v[228:231], v[76:79]
    s_add_u32 m0, s94, 0
    s_add_u32 s98, s98, 262144
    buffer_load_dwordx4 v241, s[52:55], s99 offen lds
    v_mfma_f32_16x16x32_bf16 v[104:107], v[216:219], v[228:231], v[104:107]
    s_add_u32 m0, s83, 8192
    s_add_u32 s99, s99, 110592
    v_mfma_f32_16x16x32_bf16 v[108:111], v[220:223], v[228:231], v[108:111]
    ds_read_b64_tr_b16 v[228:229], v247 offset:0
    ds_read_b64_tr_b16 v[230:231], v247 offset:1024
    buffer_load_dwordx4 v240, s[44:47], s100 offen sc1 lds
    buffer_load_dwordx4 v240, s[44:47], s100 offen offset:1024 sc1 lds
    s_add_u32 m0, s83, 16384
    v_mfma_f32_16x16x32_bf16 v[80:83], v[208:211], v[232:235], v[80:83]
    s_add_u32 s100, s100, 2048
    buffer_load_dwordx4 v240, s[44:47], s101 offen sc1 lds
    buffer_load_dwordx4 v240, s[44:47], s101 offen offset:1024 sc1 lds
    v_mfma_f32_16x16x32_bf16 v[84:87], v[212:215], v[232:235], v[84:87]
    s_add_u32 s101, s101, 2048
    s_add_u32 m0, s83, 24576
    v_mfma_f32_16x16x32_bf16 v[112:115], v[216:219], v[232:235], v[112:115]
    s_add_u32 s77, s98, 31744
    buffer_load_dwordx4 v244, s[48:51], s98 offen lds
    buffer_load_dwordx4 v244, s[48:51], s77 offen offset:1024 lds
    v_mfma_f32_16x16x32_bf16 v[116:119], v[220:223], v[232:235], v[116:119]
    ds_read_b64_tr_b16 v[232:233], v248 offset:0
    ds_read_b64_tr_b16 v[234:235], v248 offset:1024
    s_add_u32 m0, s94, 32768
    s_add_u32 s98, s98, 262144
    v_mfma_f32_16x16x32_bf16 v[88:91], v[208:211], v[236:239], v[88:91]
    buffer_load_dwordx4 v241, s[52:55], s99 offen lds
    s_add_u32 m0, s83, 40960
    s_add_u32 s99, s99, 110592
    v_mfma_f32_16x16x32_bf16 v[92:95], v[212:215], v[236:239], v[92:95]
    buffer_load_dwordx4 v240, s[44:47], s100 offen sc1 lds
    buffer_load_dwordx4 v240, s[44:47], s100 offen offset:1024 sc1 lds
    v_mfma_f32_16x16x32_bf16 v[120:123], v[216:219], v[236:239], v[120:123]
    s_add_u32 m0, s83, 49152
    s_add_u32 s100, s100, 2048
    buffer_load_dwordx4 v240, s[44:47], s101 offen sc1 lds
    v_mfma_f32_16x16x32_bf16 v[124:127], v[220:223], v[236:239], v[124:127]
    ds_read_b64_tr_b16 v[236:237], v249 offset:0
    ds_read_b64_tr_b16 v[238:239], v249 offset:1024
    buffer_load_dwordx4 v240, s[44:47], s101 offen offset:1024 sc1 lds
    s_add_u32 s101, s101, 2048
    s_waitcnt lgkmcnt(6)
    v_mfma_f32_16x16x32_bf16 v[0:3], v[192:195], v[224:227], v[0:3]
    ds_read_b128 v[208:211], v245 offset:8192
    v_mfma_f32_16x16x32_bf16 v[4:7], v[196:199], v[224:227], v[4:7]
    ds_read_b128 v[212:215], v245 offset:10240
    v_mfma_f32_16x16x32_bf16 v[32:35], v[200:203], v[224:227], v[32:35]
    ds_read_b128 v[216:219], v245 offset:12288
    v_mfma_f32_16x16x32_bf16 v[36:39], v[204:207], v[224:227], v[36:39]
    ds_read_b128 v[220:223], v245 offset:14336
    s_waitcnt lgkmcnt(8)
    v_mfma_f32_16x16x32_bf16 v[8:11], v[192:195], v[228:231], v[8:11]
    v_xor_b32 v245, 64, v245
    v_mfma_f32_16x16x32_bf16 v[12:15], v[196:199], v[228:231], v[12:15]
    v_mfma_f32_16x16x32_bf16 v[40:43], v[200:203], v[228:231], v[40:43]
    v_mfma_f32_16x16x32_bf16 v[44:47], v[204:207], v[228:231], v[44:47]
    s_waitcnt lgkmcnt(6)
    v_mfma_f32_16x16x32_bf16 v[16:19], v[192:195], v[232:235], v[16:19]
    v_mfma_f32_16x16x32_bf16 v[20:23], v[196:199], v[232:235], v[20:23]
    v_mfma_f32_16x16x32_bf16 v[48:51], v[200:203], v[232:235], v[48:51]
    v_mfma_f32_16x16x32_bf16 v[52:55], v[204:207], v[232:235], v[52:55]
    s_waitcnt lgkmcnt(4)
    v_mfma_f32_16x16x32_bf16 v[24:27], v[192:195], v[236:239], v[24:27]
    v_mfma_f32_16x16x32_bf16 v[28:31], v[196:199], v[236:239], v[28:31]
    v_mfma_f32_16x16x32_bf16 v[56:59], v[200:203], v[236:239], v[56:59]
    v_mfma_f32_16x16x32_bf16 v[60:63], v[204:207], v[236:239], v[60:63]
    s_waitcnt vmcnt(22) lgkmcnt(0)
    s_barrier
    v_mfma_f32_16x16x32_bf16 v[64:67], v[208:211], v[224:227], v[64:67]
    ds_read_b128 v[192:195], v245 offset:0
    v_mfma_f32_16x16x32_bf16 v[68:71], v[212:215], v[224:227], v[68:71]
    ds_read_b128 v[196:199], v245 offset:2048
    v_mfma_f32_16x16x32_bf16 v[96:99], v[216:219], v[224:227], v[96:99]
    ds_read_b128 v[200:203], v245 offset:4096
    v_mfma_f32_16x16x32_bf16 v[100:103], v[220:223], v[224:227], v[100:103]
    ds_read_b64_tr_b16 v[224:225], v246 offset:16384
    ds_read_b64_tr_b16 v[226:227], v246 offset:17408
    ds_read_b128 v[204:207], v245 offset:6144
    v_mfma_f32_16x16x32_bf16 v[72:75], v[208:211], v[228:231], v[72:75]
    v_mfma_f32_16x16x32_bf16 v[76:79], v[212:215], v[228:231], v[76:79]
    v_mfma_f32_16x16x32_bf16 v[104:107], v[216:219], v[228:231], v[104:107]
    v_mfma_f32_16x16x32_bf16 v[108:111], v[220:223], v[228:231], v[108:111]
    ds_read_b64_tr_b16 v[228:229], v247 offset:16384
    ds_read_b64_tr_b16 v[230:231], v247 offset:17408
    v_mfma_f32_16x16x32_bf16 v[80:83], v[208:211], v[232:235], v[80:83]
    v_mfma_f32_16x16x32_bf16 v[84:87], v[212:215], v[232:235], v[84:87]
    v_mfma_f32_16x16x32_bf16 v[112:115], v[216:219], v[232:235], v[112:115]
    v_mfma_f32_16x16x32_bf16 v[116:119], v[220:223], v[232:235], v[116:119]
    ds_read_b64_tr_b16 v[232:233], v248 offset:16384
    ds_read_b64_tr_b16 v[234:235], v248 offset:17408
    v_mfma_f32_16x16x32_bf16 v[88:91], v[208:211], v[236:239], v[88:91]
    v_mfma_f32_16x16x32_bf16 v[92:95], v[212:215], v[236:239], v[92:95]
    v_mfma_f32_16x16x32_bf16 v[120:123], v[216:219], v[236:239], v[120:123]
    v_mfma_f32_16x16x32_bf16 v[124:127], v[220:223], v[236:239], v[124:127]
    ds_read_b64_tr_b16 v[236:237], v249 offset:16384
    ds_read_b64_tr_b16 v[238:239], v249 offset:17408
    s_waitcnt lgkmcnt(6)
    v_mfma_f32_16x16x32_bf16 v[0:3], v[192:195], v[224:227], v[0:3]
    ds_read_b128 v[208:211], v245 offset:8192
    v_mfma_f32_16x16x32_bf16 v[4:7], v[196:199], v[224:227], v[4:7]
    ds_read_b128 v[212:215], v245 offset:10240
    v_mfma_f32_16x16x32_bf16 v[32:35], v[200:203], v[224:227], v[32:35]
    ds_read_b128 v[216:219], v245 offset:12288
    v_mfma_f32_16x16x32_bf16 v[36:39], v[204:207], v[224:227], v[36:39]
    ds_read_b128 v[220:223], v245 offset:14336
    s_waitcnt lgkmcnt(8)
    v_mfma_f32_16x16x32_bf16 v[8:11], v[192:195], v[228:231], v[8:11]
    v_xor_b32 v245, 64, v250
    v_mfma_f32_16x16x32_bf16 v[12:15], v[196:199], v[228:231], v[12:15]
    v_xor_b32 v246, 64, v251
    v_mfma_f32_16x16x32_bf16 v[40:43], v[200:203], v[228:231], v[40:43]
    v_mfma_f32_16x16x32_bf16 v[44:47], v[204:207], v[228:231], v[44:47]
    s_waitcnt lgkmcnt(6)
    v_mfma_f32_16x16x32_bf16 v[16:19], v[192:195], v[232:235], v[16:19]
    v_mfma_f32_16x16x32_bf16 v[20:23], v[196:199], v[232:235], v[20:23]
    v_mfma_f32_16x16x32_bf16 v[48:51], v[200:203], v[232:235], v[48:51]
    v_mfma_f32_16x16x32_bf16 v[52:55], v[204:207], v[232:235], v[52:55]
    s_waitcnt lgkmcnt(4)
    v_mfma_f32_16x16x32_bf16 v[24:27], v[192:195], v[236:239], v[24:27]
    v_mfma_f32_16x16x32_bf16 v[28:31], v[196:199], v[236:239], v[28:31]
    v_mfma_f32_16x16x32_bf16 v[56:59], v[200:203], v[236:239], v[56:59]
    v_mfma_f32_16x16x32_bf16 v[60:63], v[204:207], v[236:239], v[60:63]
    s_waitcnt vmcnt(14) lgkmcnt(0)
    s_barrier
    v_mfma_f32_16x16x32_bf16 v[64:67], v[208:211], v[224:227], v[64:67]
    ds_read_b64_tr_b16 v[192:193], v250 offset:0
    s_add_u32 m0, s83, 57344
    s_add_u32 s77, s98, 31744
    v_mfma_f32_16x16x32_bf16 v[68:71], v[212:215], v[224:227], v[68:71]
    ds_read_b64_tr_b16 v[194:195], v250 offset:512
    buffer_load_dwordx4 v244, s[48:51], s98 offen lds
    buffer_load_dwordx4 v244, s[48:51], s77 offen offset:1024 lds
    v_mfma_f32_16x16x32_bf16 v[96:99], v[216:219], v[224:227], v[96:99]
    ds_read_b64_tr_b16 v[196:197], v251 offset:0
    s_add_u32 m0, s94, 65536
    s_add_u32 s98, s98, 262144
    v_mfma_f32_16x16x32_bf16 v[100:103], v[220:223], v[224:227], v[100:103]
    ds_read_b128 v[224:227], v242 offset:8192
    ds_read_b64_tr_b16 v[198:199], v251 offset:512
    buffer_load_dwordx4 v241, s[52:55], s99 offen lds
    s_add_u32 m0, s83, 73728
    v_mfma_f32_16x16x32_bf16 v[72:75], v[208:211], v[228:231], v[72:75]
    s_add_u32 s99, s99, 110592
    buffer_load_dwordx4 v240, s[44:47], s100 offen sc1 lds
    v_mfma_f32_16x16x32_bf16 v[76:79], v[212:215], v[228:231], v[76:79]
    buffer_load_dwordx4 v240, s[44:47], s100 offen offset:1024 sc1 lds
    s_add_u32 m0, s83, 81920
    v_mfma_f32_16x16x32_bf16 v[104:107], v[216:219], v[228:231], v[104:107]
    s_add_u32 s100, s100, 2048
    buffer_load_dwordx4 v240, s[44:47], s101 offen sc1 lds
    v_mfma_f32_16x16x32_bf16 v[108:111], v[220:223], v[228:231], v[108:111]
    ds_read_b128 v[228:231], v242 offset:9216
    buffer_load_dwordx4 v240, s[44:47], s101 offen offset:1024 sc1 lds
    s_add_u32 s101, s101, 2048
    v_mfma_f32_16x16x32_bf16 v[80:83], v[208:211], v[232:235], v[80:83]
    s_add_u32 m0, s83, 90112
    s_add_u32 s77, s98, 31744
    v_mfma_f32_16x16x32_bf16 v[84:87], v[212:215], v[232:235], v[84:87]
    buffer_load_dwordx4 v244, s[48:51], s98 offen lds
    buffer_load_dwordx4 v244, s[48:51], s77 offen offset:1024 lds
    v_mfma_f32_16x16x32_bf16 v[112:115], v[216:219], v[232:235], v[112:115]
    s_add_u32 m0, s94, 98304
    s_add_u32 s98, s98, 262144
    v_mfma_f32_16x16x32_bf16 v[116:119], v[220:223], v[232:235], v[116:119]
    ds_read_b128 v[232:235], v242 offset:0
    buffer_load_dwordx4 v241, s[52:55], s99 offen lds
    s_add_u32 m0, s83, 106496
    v_mfma_f32_16x16x32_bf16 v[88:91], v[208:211], v[236:239], v[88:91]
    s_add_u32 s99, s99, 110592
    buffer_load_dwordx4 v240, s[44:47], s100 offen sc1 lds
    v_mfma_f32_16x16x32_bf16 v[92:95], v[212:215], v[236:239], v[92:95]
    buffer_load_dwordx4 v240, s[44:47], s100 offen offset:1024 sc1 lds
    s_add_u32 m0, s83, 114688
    v_mfma_f32_16x16x32_bf16 v[120:123], v[216:219], v[236:239], v[120:123]
    s_add_u32 s100, s100, 2048
    buffer_load_dwordx4 v240, s[44:47], s101 offen sc1 lds
    v_mfma_f32_16x16x32_bf16 v[124:127], v[220:223], v[236:239], v[124:127]
    ds_read_b128 v[236:239], v242 offset:1024
    buffer_load_dwordx4 v240, s[44:47], s101 offen offset:1024 sc1 lds
    s_add_u32 s101, s101, 2048
KB_YT2:
    s_waitcnt lgkmcnt(3)
    v_mfma_f32_16x16x32_bf16 v[160:163], v[192:195], v[224:227], v[136:139]
    ds_read_b64_tr_b16 v[208:209], v245 offset:0
    ds_read_b64_tr_b16 v[210:211], v245 offset:512
    v_mfma_f32_16x16x32_bf16 v[164:167], v[196:199], v[224:227], v[140:143]
    ds_read_b64_tr_b16 v[212:213], v246 offset:0
    ds_read_b64_tr_b16 v[214:215], v246 offset:512
    s_waitcnt lgkmcnt(6)
    v_mfma_f32_16x16x32_bf16 v[168:171], v[192:195], v[228:231], v[136:139]
    v_add_u32 v250, 0xfffe0000, v250
    v_add_u32 v251, 0xfffe0000, v251
    v_mfma_f32_16x16x32_bf16 v[172:175], v[196:199], v[228:231], v[140:143]
    v_add_u32 v245, 0xfffe0000, v245
    v_add_u32 v246, 0xfffe0000, v246
    s_waitcnt lgkmcnt(5)
    v_mfma_f32_16x16x32_bf16 v[128:131], v[192:195], v[232:235], v[136:139]
    v_add_u32 v242, 0xfffe0000, v242
    v_mfma_f32_16x16x32_bf16 v[132:135], v[196:199], v[232:235], v[140:143]
    s_waitcnt lgkmcnt(4)
    v_mfma_f32_16x16x32_bf16 v[136:139], v[192:195], v[236:239], v[136:139]
    v_mfma_f32_16x16x32_bf16 v[140:143], v[196:199], v[236:239], v[140:143]
    s_waitcnt vmcnt(21) lgkmcnt(0)
    s_barrier
    v_mfma_f32_16x16x32_bf16 v[176:179], v[208:211], v[224:227], v[152:155]
    ds_read_b64_tr_b16 v[192:193], v250 offset:0
    s_add_u32 m0, s83, 122880
    s_add_u32 s77, s98, 31744
    v_mfma_f32_16x16x32_bf16 v[180:183], v[212:215], v[224:227], v[156:159]
    ds_read_b128 v[224:227], v242 offset:8192
    ds_read_b64_tr_b16 v[194:195], v250 offset:512
    buffer_load_dwordx4 v244, s[48:51], s98 offen lds
    buffer_load_dwordx4 v244, s[48:51], s77 offen offset:1024 lds
    v_mfma_f32_16x16x32_bf16 v[184:187], v[208:211], v[228:231], v[152:155]
    ds_read_b64_tr_b16 v[196:197], v251 offset:0
    s_add_u32 m0, s94, 131072
    s_add_u32 s98, s98, 262144
    v_mfma_f32_16x16x32_bf16 v[188:191], v[212:215], v[228:231], v[156:159]
    ds_read_b128 v[228:231], v242 offset:9216
    ds_read_b64_tr_b16 v[198:199], v251 offset:512
    buffer_load_dwordx4 v241, s[52:55], s99 offen lds
    s_add_u32 m0, s83, 139264
    v_mfma_f32_16x16x32_bf16 v[144:147], v[208:211], v[232:235], v[152:155]
    s_add_u32 s99, s99, 110592
    buffer_load_dwordx4 v240, s[44:47], s100 offen sc1 lds
    v_mfma_f32_16x16x32_bf16 v[148:151], v[212:215], v[232:235], v[156:159]
    ds_read_b128 v[232:235], v242 offset:0
    buffer_load_dwordx4 v240, s[44:47], s100 offen offset:1024 sc1 lds
    s_add_u32 m0, s83, 147456
    v_mfma_f32_16x16x32_bf16 v[152:155], v[208:211], v[236:239], v[152:155]
    s_add_u32 s100, s100, 2048
    buffer_load_dwordx4 v240, s[44:47], s101 offen sc1 lds
    v_mfma_f32_16x16x32_bf16 v[156:159], v[212:215], v[236:239], v[156:159]
    ds_read_b128 v[236:239], v242 offset:1024
    buffer_load_dwordx4 v240, s[44:47], s101 offen offset:1024 sc1 lds
    s_add_u32 s101, s101, 2048
    s_waitcnt lgkmcnt(2)
    v_mfma_f32_16x16x32_bf16 v[160:163], v[192:195], v[224:227], v[160:163]
    ds_read_b64_tr_b16 v[208:209], v245 offset:0
    v_pk_mul_f32 v[0:1], v[0:1], s[90:91]
    v_pk_mul_f32 v[2:3], v[2:3], s[90:91]
    v_mfma_f32_16x16x32_bf16 v[164:167], v[196:199], v[224:227], v[164:167]
    ds_read_b64_tr_b16 v[210:211], v245 offset:512
    v_pk_mul_f32 v[4:5], v[4:5], s[90:91]
    v_pk_mul_f32 v[6:7], v[6:7], s[90:91]
    v_mfma_f32_16x16x32_bf16 v[168:171], v[192:195], v[228:231], v[168:171]
    ds_read_b64_tr_b16 v[212:213], v246 offset:0
    v_pk_mul_f32 v[8:9], v[8:9], s[90:91]
    v_pk_mul_f32 v[10:11], v[10:11], s[90:91]
    v_mfma_f32_16x16x32_bf16 v[172:175], v[196:199], v[228:231], v[172:175]
    ds_read_b64_tr_b16 v[214:215], v246 offset:512
    v_pk_mul_f32 v[12:13], v[12:13], s[90:91]
    v_pk_mul_f32 v[14:15], v[14:15], s[90:91]
    s_waitcnt lgkmcnt(5)
    v_mfma_f32_16x16x32_bf16 v[128:131], v[192:195], v[232:235], v[128:131]
    v_cvt_pk_bf16_f32 v0, v0, v1
    v_cvt_pk_bf16_f32 v1, v2, v3
    v_mfma_f32_16x16x32_bf16 v[132:135], v[196:199], v[232:235], v[132:135]
    v_cvt_pk_bf16_f32 v2, v4, v5
    v_cvt_pk_bf16_f32 v3, v6, v7
    s_waitcnt lgkmcnt(4)
    v_mfma_f32_16x16x32_bf16 v[136:139], v[192:195], v[236:239], v[136:139]
    v_cvt_pk_bf16_f32 v4, v8, v9
    v_cvt_pk_bf16_f32 v5, v10, v11
    v_mfma_f32_16x16x32_bf16 v[140:143], v[196:199], v[236:239], v[140:143]
    v_cvt_pk_bf16_f32 v6, v12, v13
    v_cvt_pk_bf16_f32 v7, v14, v15
    s_waitcnt vmcnt(21) lgkmcnt(0)
    s_barrier
    v_mfma_f32_16x16x32_bf16 v[176:179], v[208:211], v[224:227], v[176:179]
    ds_read_b64_tr_b16 v[192:193], v250 offset:32768
    s_add_u32 m0, s83, 4294959104
    s_add_u32 s77, s98, 31744
    v_mfma_f32_16x16x32_bf16 v[180:183], v[212:215], v[224:227], v[180:183]
    ds_read_b128 v[224:227], v242 offset:40960
    ds_read_b64_tr_b16 v[194:195], v250 offset:33280
    buffer_load_dwordx4 v244, s[48:51], s98 offen lds
    buffer_load_dwordx4 v244, s[48:51], s77 offen offset:1024 lds
    v_mfma_f32_16x16x32_bf16 v[184:187], v[208:211], v[228:231], v[184:187]
    ds_read_b64_tr_b16 v[196:197], v251 offset:32768
    s_add_u32 m0, s94, 0
    s_add_u32 s98, s98, 262144
    v_mfma_f32_16x16x32_bf16 v[188:191], v[212:215], v[228:231], v[188:191]
    ds_read_b128 v[228:231], v242 offset:41984
    ds_read_b64_tr_b16 v[198:199], v251 offset:33280
    buffer_load_dwordx4 v241, s[52:55], s99 offen lds
    s_add_u32 m0, s83, 8192
    v_mfma_f32_16x16x32_bf16 v[144:147], v[208:211], v[232:235], v[144:147]
    s_add_u32 s99, s99, 110592
    buffer_load_dwordx4 v240, s[44:47], s100 offen sc1 lds
    v_mfma_f32_16x16x32_bf16 v[148:151], v[212:215], v[232:235], v[148:151]
    ds_read_b128 v[232:235], v242 offset:32768
    buffer_load_dwordx4 v240, s[44:47], s100 offen offset:1024 sc1 lds
    s_add_u32 m0, s83, 16384
    v_mfma_f32_16x16x32_bf16 v[152:155], v[208:211], v[236:239], v[152:155]
    s_add_u32 s100, s100, 2048
    buffer_load_dwordx4 v240, s[44:47], s101 offen sc1 lds
    v_mfma_f32_16x16x32_bf16 v[156:159], v[212:215], v[236:239], v[156:159]
    ds_read_b128 v[236:239], v242 offset:33792
    buffer_load_dwordx4 v240, s[44:47], s101 offen offset:1024 sc1 lds
    s_add_u32 s101, s101, 2048
    s_waitcnt lgkmcnt(2)
    v_mfma_f32_16x16x32_bf16 v[160:163], v[192:195], v[224:227], v[160:163]
    ds_read_b64_tr_b16 v[208:209], v245 offset:32768
    ds_read_b64_tr_b16 v[210:211], v245 offset:33280
    v_pk_mul_f32 v[16:17], v[16:17], s[90:91]
    v_pk_mul_f32 v[18:19], v[18:19], s[90:91]
    v_mfma_f32_16x16x32_bf16 v[164:167], v[196:199], v[224:227], v[164:167]
    ds_read_b64_tr_b16 v[212:213], v246 offset:32768
    ds_read_b64_tr_b16 v[214:215], v246 offset:33280
    v_pk_mul_f32 v[20:21], v[20:21], s[90:91]
    v_pk_mul_f32 v[22:23], v[22:23], s[90:91]
    v_mfma_f32_16x16x32_bf16 v[168:171], v[192:195], v[228:231], v[168:171]
    v_add_u32 v250, 0x10000, v250
    v_add_u32 v251, 0x10000, v251
    v_pk_mul_f32 v[24:25], v[24:25], s[90:91]
    v_pk_mul_f32 v[26:27], v[26:27], s[90:91]
    v_mfma_f32_16x16x32_bf16 v[172:175], v[196:199], v[228:231], v[172:175]
    v_add_u32 v245, 0x10000, v245
    v_add_u32 v246, 0x10000, v246
    v_pk_mul_f32 v[28:29], v[28:29], s[90:91]
    v_pk_mul_f32 v[30:31], v[30:31], s[90:91]
    s_waitcnt lgkmcnt(5)
    v_mfma_f32_16x16x32_bf16 v[128:131], v[192:195], v[232:235], v[128:131]
    v_add_u32 v242, 0x10000, v242
    v_cvt_pk_bf16_f32 v8, v16, v17
    v_cvt_pk_bf16_f32 v9, v18, v19
    v_mfma_f32_16x16x32_bf16 v[132:135], v[196:199], v[232:235], v[132:135]
    v_cvt_pk_bf16_f32 v10, v20, v21
    v_cvt_pk_bf16_f32 v11, v22, v23
    s_waitcnt lgkmcnt(4)
    v_mfma_f32_16x16x32_bf16 v[136:139], v[192:195], v[236:239], v[136:139]
    v_cvt_pk_bf16_f32 v12, v24, v25
    v_cvt_pk_bf16_f32 v13, v26, v27
    v_mfma_f32_16x16x32_bf16 v[140:143], v[196:199], v[236:239], v[140:143]
    v_cvt_pk_bf16_f32 v14, v28, v29
    v_cvt_pk_bf16_f32 v15, v30, v31
    s_waitcnt vmcnt(21) lgkmcnt(0)
    s_barrier
    v_mfma_f32_16x16x32_bf16 v[176:179], v[208:211], v[224:227], v[176:179]
    ds_read_b64_tr_b16 v[192:193], v250 offset:0
    s_add_u32 m0, s83, 24576
    s_add_u32 s77, s98, 31744
    v_mfma_f32_16x16x32_bf16 v[180:183], v[212:215], v[224:227], v[180:183]
    ds_read_b128 v[224:227], v242 offset:8192
    ds_read_b64_tr_b16 v[194:195], v250 offset:512
    buffer_load_dwordx4 v244, s[48:51], s98 offen lds
    buffer_load_dwordx4 v244, s[48:51], s77 offen offset:1024 lds
    v_mfma_f32_16x16x32_bf16 v[184:187], v[208:211], v[228:231], v[184:187]
    ds_read_b64_tr_b16 v[196:197], v251 offset:0
    s_add_u32 m0, s94, 32768
    s_add_u32 s98, s98, 262144
    v_mfma_f32_16x16x32_bf16 v[188:191], v[212:215], v[228:231], v[188:191]
    ds_read_b128 v[228:231], v242 offset:9216
    ds_read_b64_tr_b16 v[198:199], v251 offset:512
    buffer_load_dwordx4 v241, s[52:55], s99 offen lds
    s_add_u32 m0, s83, 40960
    v_mfma_f32_16x16x32_bf16 v[144:147], v[208:211], v[232:235], v[144:147]
    s_add_u32 s99, s99, 110592
    buffer_load_dwordx4 v240, s[44:47], s100 offen sc1 lds
    v_mfma_f32_16x16x32_bf16 v[148:151], v[212:215], v[232:235], v[148:151]
    ds_read_b128 v[232:235], v242 offset:0
    buffer_load_dwordx4 v240, s[44:47], s100 offen offset:1024 sc1 lds
    s_add_u32 m0, s83, 49152
    v_mfma_f32_16x16x32_bf16 v[152:155], v[208:211], v[236:239], v[152:155]
    s_add_u32 s100, s100, 2048
    buffer_load_dwordx4 v240, s[44:47], s101 offen sc1 lds
    v_mfma_f32_16x16x32_bf16 v[156:159], v[212:215], v[236:239], v[156:159]
    ds_read_b128 v[236:239], v242 offset:1024
    buffer_load_dwordx4 v240, s[44:47], s101 offen offset:1024 sc1 lds
    s_add_u32 s101, s101, 2048
    s_waitcnt lgkmcnt(2)
    v_mfma_f32_16x16x32_bf16 v[160:163], v[192:195], v[224:227], v[160:163]
    ds_read_b64_tr_b16 v[208:209], v245 offset:0
    v_pk_mul_f32 v[32:33], v[32:33], s[90:91]
    v_pk_mul_f32 v[34:35], v[34:35], s[90:91]
    v_mfma_f32_16x16x32_bf16 v[164:167], v[196:199], v[224:227], v[164:167]
    ds_read_b64_tr_b16 v[210:211], v245 offset:512
    v_pk_mul_f32 v[36:37], v[36:37], s[90:91]
    v_pk_mul_f32 v[38:39], v[38:39], s[90:91]
    v_mfma_f32_16x16x32_bf16 v[168:171], v[192:195], v[228:231], v[168:171]
    ds_read_b64_tr_b16 v[212:213], v246 offset:0
    v_pk_mul_f32 v[40:41], v[40:41], s[90:91]
    v_pk_mul_f32 v[42:43], v[42:43], s[90:91]
    v_mfma_f32_16x16x32_bf16 v[172:175], v[196:199], v[228:231], v[172:175]
    ds_read_b64_tr_b16 v[214:215], v246 offset:512
    v_pk_mul_f32 v[44:45], v[44:45], s[90:91]
    v_pk_mul_f32 v[46:47], v[46:47], s[90:91]
    s_waitcnt lgkmcnt(5)
    v_mfma_f32_16x16x32_bf16 v[128:131], v[192:195], v[232:235], v[128:131]
    v_cvt_pk_bf16_f32 v16, v32, v33
    v_cvt_pk_bf16_f32 v17, v34, v35
    v_mfma_f32_16x16x32_bf16 v[132:135], v[196:199], v[232:235], v[132:135]
    v_cvt_pk_bf16_f32 v18, v36, v37
    v_cvt_pk_bf16_f32 v19, v38, v39
    s_waitcnt lgkmcnt(4)
    v_mfma_f32_16x16x32_bf16 v[136:139], v[192:195], v[236:239], v[136:139]
    v_cvt_pk_bf16_f32 v20, v40, v41
    v_cvt_pk_bf16_f32 v21, v42, v43
    v_mfma_f32_16x16x32_bf16 v[140:143], v[196:199], v[236:239], v[140:143]
    v_cvt_pk_bf16_f32 v22, v44, v45
    v_cvt_pk_bf16_f32 v23, v46, v47
    s_waitcnt vmcnt(21) lgkmcnt(0)
    s_barrier
    v_mfma_f32_16x16x32_bf16 v[176:179], v[208:211], v[224:227], v[176:179]
    ds_read_b64_tr_b16 v[192:193], v250 offset:32768
    s_add_u32 m0, s83, 57344
    s_add_u32 s77, s98, 31744
    v_mfma_f32_16x16x32_bf16 v[180:183], v[212:215], v[224:227], v[180:183]
    ds_read_b128 v[224:227], v242 offset:40960
    ds_read_b64_tr_b16 v[194:195], v250 offset:33280
    buffer_load_dwordx4 v244, s[48:51], s98 offen lds
    buffer_load_dwordx4 v244, s[48:51], s77 offen offset:1024 lds
    v_mfma_f32_16x16x32_bf16 v[184:187], v[208:211], v[228:231], v[184:187]
    ds_read_b64_tr_b16 v[196:197], v251 offset:32768
    s_add_u32 m0, s94, 65536
    s_add_u32 s98, s98, 262144
    v_mfma_f32_16x16x32_bf16 v[188:191], v[212:215], v[228:231], v[188:191]
    ds_read_b128 v[228:231], v242 offset:41984
    ds_read_b64_tr_b16 v[198:199], v251 offset:33280
    buffer_load_dwordx4 v241, s[52:55], s99 offen lds
    s_add_u32 m0, s83, 73728
    v_mfma_f32_16x16x32_bf16 v[144:147], v[208:211], v[232:235], v[144:147]
    s_add_u32 s99, s99, 110592
    buffer_load_dwordx4 v240, s[44:47], s100 offen sc1 lds
    v_mfma_f32_16x16x32_bf16 v[148:151], v[212:215], v[232:235], v[148:151]
    ds_read_b128 v[232:235], v242 offset:32768
    buffer_load_dwordx4 v240, s[44:47], s100 offen offset:1024 sc1 lds
    s_add_u32 m0, s83, 81920
    v_mfma_f32_16x16x32_bf16 v[152:155], v[208:211], v[236:239], v[152:155]
    s_add_u32 s100, s100, 2048
    buffer_load_dwordx4 v240, s[44:47], s101 offen sc1 lds
    v_mfma_f32_16x16x32_bf16 v[156:159], v[212:215], v[236:239], v[156:159]
    ds_read_b128 v[236:239], v242 offset:33792
    buffer_load_dwordx4 v240, s[44:47], s101 offen offset:1024 sc1 lds
    s_add_u32 s101, s101, 2048
    s_waitcnt lgkmcnt(2)
    v_mfma_f32_16x16x32_bf16 v[160:163], v[192:195], v[224:227], v[160:163]
    ds_read_b64_tr_b16 v[208:209], v245 offset:32768
    ds_read_b64_tr_b16 v[210:211], v245 offset:33280
    v_pk_mul_f32 v[48:49], v[48:49], s[90:91]
    v_pk_mul_f32 v[50:51], v[50:51], s[90:91]
    v_mfma_f32_16x16x32_bf16 v[164:167], v[196:199], v[224:227], v[164:167]
    ds_read_b64_tr_b16 v[212:213], v246 offset:32768
    ds_read_b64_tr_b16 v[214:215], v246 offset:33280
    v_pk_mul_f32 v[52:53], v[52:53], s[90:91]
    v_pk_mul_f32 v[54:55], v[54:55], s[90:91]
    v_mfma_f32_16x16x32_bf16 v[168:171], v[192:195], v[228:231], v[168:171]
    v_add_u32 v250, 0x10000, v250
    v_add_u32 v251, 0x10000, v251
    v_pk_mul_f32 v[56:57], v[56:57], s[90:91]
    v_pk_mul_f32 v[58:59], v[58:59], s[90:91]
    v_mfma_f32_16x16x32_bf16 v[172:175], v[196:199], v[228:231], v[172:175]
    v_add_u32 v245, 0x10000, v245
    v_add_u32 v246, 0x10000, v246
    v_pk_mul_f32 v[60:61], v[60:61], s[90:91]
    v_pk_mul_f32 v[62:63], v[62:63], s[90:91]
    s_waitcnt lgkmcnt(5)
    v_mfma_f32_16x16x32_bf16 v[128:131], v[192:195], v[232:235], v[128:131]
    v_add_u32 v242, 0x10000, v242
    v_cvt_pk_bf16_f32 v24, v48, v49
    v_cvt_pk_bf16_f32 v25, v50, v51
    v_mfma_f32_16x16x32_bf16 v[132:135], v[196:199], v[232:235], v[132:135]
    v_cvt_pk_bf16_f32 v26, v52, v53
    v_cvt_pk_bf16_f32 v27, v54, v55
    s_waitcnt lgkmcnt(4)
    v_mfma_f32_16x16x32_bf16 v[136:139], v[192:195], v[236:239], v[136:139]
    v_cvt_pk_bf16_f32 v28, v56, v57
    v_cvt_pk_bf16_f32 v29, v58, v59
    v_mfma_f32_16x16x32_bf16 v[140:143], v[196:199], v[236:239], v[140:143]
    v_cvt_pk_bf16_f32 v30, v60, v61
    v_cvt_pk_bf16_f32 v31, v62, v63
    s_waitcnt vmcnt(21) lgkmcnt(0)
    s_barrier
    v_mfma_f32_16x16x32_bf16 v[176:179], v[208:211], v[224:227], v[176:179]
    ds_read_b64_tr_b16 v[192:193], v250 offset:0
    s_add_u32 m0, s83, 90112
    s_add_u32 s77, s98, 31744
    v_mfma_f32_16x16x32_bf16 v[180:183], v[212:215], v[224:227], v[180:183]
    ds_read_b128 v[224:227], v242 offset:8192
    ds_read_b64_tr_b16 v[194:195], v250 offset:512
    buffer_load_dwordx4 v244, s[48:51], s98 offen lds
    buffer_load_dwordx4 v244, s[48:51], s77 offen offset:1024 lds
    v_mfma_f32_16x16x32_bf16 v[184:187], v[208:211], v[228:231], v[184:187]
    ds_read_b64_tr_b16 v[196:197], v251 offset:0
    s_add_u32 m0, s94, 98304
    s_add_u32 s98, s98, 262144
    v_mfma_f32_16x16x32_bf16 v[188:191], v[212:215], v[228:231], v[188:191]
    ds_read_b128 v[228:231], v242 offset:9216
    ds_read_b64_tr_b16 v[198:199], v251 offset:512
    buffer_load_dwordx4 v241, s[52:55], s99 offen lds
    s_add_u32 m0, s83, 106496
    v_mfma_f32_16x16x32_bf16 v[144:147], v[208:211], v[232:235], v[144:147]
    s_add_u32 s99, s99, 110592
    buffer_load_dwordx4 v240, s[44:47], s100 offen sc1 lds
    v_mfma_f32_16x16x32_bf16 v[148:151], v[212:215], v[232:235], v[148:151]
    ds_read_b128 v[232:235], v242 offset:0
    buffer_load_dwordx4 v240, s[44:47], s100 offen offset:1024 sc1 lds
    s_add_u32 m0, s83, 114688
    v_mfma_f32_16x16x32_bf16 v[152:155], v[208:211], v[236:239], v[152:155]
    s_add_u32 s100, s100, 2048
    buffer_load_dwordx4 v240, s[44:47], s101 offen sc1 lds
    v_mfma_f32_16x16x32_bf16 v[156:159], v[212:215], v[236:239], v[156:159]
    ds_read_b128 v[236:239], v242 offset:1024
    buffer_load_dwordx4 v240, s[44:47], s101 offen offset:1024 sc1 lds
    s_add_u32 s101, s101, 2048
    s_waitcnt lgkmcnt(2)
    v_mfma_f32_16x16x32_bf16 v[160:163], v[192:195], v[224:227], v[160:163]
    ds_read_b64_tr_b16 v[208:209], v245 offset:0
    ds_read_b64_tr_b16 v[210:211], v245 offset:512
    v_pk_mul_f32 v[64:65], v[64:65], s[90:91]
    v_pk_mul_f32 v[66:67], v[66:67], s[90:91]
    v_mfma_f32_16x16x32_bf16 v[164:167], v[196:199], v[224:227], v[164:167]
    ds_read_b64_tr_b16 v[212:213], v246 offset:0
    ds_read_b64_tr_b16 v[214:215], v246 offset:512
    v_pk_mul_f32 v[68:69], v[68:69], s[90:91]
    v_pk_mul_f32 v[70:71], v[70:71], s[90:91]
    v_mfma_f32_16x16x32_bf16 v[168:171], v[192:195], v[228:231], v[168:171]
    v_add_u32 v250, 0xfffe0000, v250
    v_add_u32 v251, 0xfffe0000, v251
    v_pk_mul_f32 v[72:73], v[72:73], s[90:91]
    v_pk_mul_f32 v[74:75], v[74:75], s[90:91]
    v_mfma_f32_16x16x32_bf16 v[172:175], v[196:199], v[228:231], v[172:175]
    v_add_u32 v245, 0xfffe0000, v245
    v_add_u32 v246, 0xfffe0000, v246
    v_pk_mul_f32 v[76:77], v[76:77], s[90:91]
    v_pk_mul_f32 v[78:79], v[78:79], s[90:91]
    s_waitcnt lgkmcnt(5)
    v_mfma_f32_16x16x32_bf16 v[128:131], v[192:195], v[232:235], v[128:131]
    v_add_u32 v242, 0xfffe0000, v242
    v_cvt_pk_bf16_f32 v32, v64, v65
    v_cvt_pk_bf16_f32 v33, v66, v67
    v_mfma_f32_16x16x32_bf16 v[132:135], v[196:199], v[232:235], v[132:135]
    v_cvt_pk_bf16_f32 v34, v68, v69
    v_cvt_pk_bf16_f32 v35, v70, v71
    s_waitcnt lgkmcnt(4)
    v_mfma_f32_16x16x32_bf16 v[136:139], v[192:195], v[236:239], v[136:139]
    v_cvt_pk_bf16_f32 v36, v72, v73
    v_cvt_pk_bf16_f32 v37, v74, v75
    v_mfma_f32_16x16x32_bf16 v[140:143], v[196:199], v[236:239], v[140:143]
    v_cvt_pk_bf16_f32 v38, v76, v77
    v_cvt_pk_bf16_f32 v39, v78, v79
    s_waitcnt vmcnt(21) lgkmcnt(0)
    s_barrier
    v_mfma_f32_16x16x32_bf16 v[176:179], v[208:211], v[224:227], v[176:179]
    ds_read_b64_tr_b16 v[192:193], v250 offset:0
    s_add_u32 m0, s83, 122880
    s_add_u32 s77, s98, 31744
    v_mfma_f32_16x16x32_bf16 v[180:183], v[212:215], v[224:227], v[180:183]
    ds_read_b128 v[224:227], v242 offset:8192
    ds_read_b64_tr_b16 v[194:195], v250 offset:512
    buffer_load_dwordx4 v244, s[48:51], s98 offen lds
    buffer_load_dwordx4 v244, s[48:51], s77 offen offset:1024 lds
    v_mfma_f32_16x16x32_bf16 v[184:187], v[208:211], v[228:231], v[184:187]
    ds_read_b64_tr_b16 v[196:197], v251 offset:0
    s_add_u32 m0, s94, 131072
    s_add_u32 s98, s98, 262144
    v_mfma_f32_16x16x32_bf16 v[188:191], v[212:215], v[228:231], v[188:191]
    ds_read_b128 v[228:231], v242 offset:9216
    ds_read_b64_tr_b16 v[198:199], v251 offset:512
    buffer_load_dwordx4 v241, s[52:55], s99 offen lds
    s_add_u32 m0, s83, 139264
    v_mfma_f32_16x16x32_bf16 v[144:147], v[208:211], v[232:235], v[144:147]
    s_add_u32 s99, s99, 110592
    buffer_load_dwordx4 v240, s[44:47], s100 offen sc1 lds
    v_mfma_f32_16x16x32_bf16 v[148:151], v[212:215], v[232:235], v[148:151]
    ds_read_b128 v[232:235], v242 offset:0
    buffer_load_dwordx4 v240, s[44:47], s100 offen offset:1024 sc1 lds
    s_add_u32 m0, s83, 147456
    v_mfma_f32_16x16x32_bf16 v[152:155], v[208:211], v[236:239], v[152:155]
    s_add_u32 s100, s100, 2048
    buffer_load_dwordx4 v240, s[44:47], s101 offen sc1 lds
    v_mfma_f32_16x16x32_bf16 v[156:159], v[212:215], v[236:239], v[156:159]
    ds_read_b128 v[236:239], v242 offset:1024
    buffer_load_dwordx4 v240, s[44:47], s101 offen offset:1024 sc1 lds
    s_add_u32 s101, s101, 2048
    s_waitcnt lgkmcnt(2)
    v_mfma_f32_16x16x32_bf16 v[160:163], v[192:195], v[224:227], v[160:163]
    ds_read_b64_tr_b16 v[208:209], v245 offset:0
    v_pk_mul_f32 v[80:81], v[80:81], s[90:91]
    v_pk_mul_f32 v[82:83], v[82:83], s[90:91]
    v_mfma_f32_16x16x32_bf16 v[164:167], v[196:199], v[224:227], v[164:167]
    ds_read_b64_tr_b16 v[210:211], v245 offset:512
    v_pk_mul_f32 v[84:85], v[84:85], s[90:91]
    v_pk_mul_f32 v[86:87], v[86:87], s[90:91]
    v_mfma_f32_16x16x32_bf16 v[168:171], v[192:195], v[228:231], v[168:171]
    ds_read_b64_tr_b16 v[212:213], v246 offset:0
    v_pk_mul_f32 v[88:89], v[88:89], s[90:91]
    v_pk_mul_f32 v[90:91], v[90:91], s[90:91]
    v_mfma_f32_16x16x32_bf16 v[172:175], v[196:199], v[228:231], v[172:175]
    ds_read_b64_tr_b16 v[214:215], v246 offset:512
    v_pk_mul_f32 v[92:93], v[92:93], s[90:91]
    v_pk_mul_f32 v[94:95], v[94:95], s[90:91]
    s_waitcnt lgkmcnt(5)
    v_mfma_f32_16x16x32_bf16 v[128:131], v[192:195], v[232:235], v[128:131]
    v_cvt_pk_bf16_f32 v40, v80, v81
    v_cvt_pk_bf16_f32 v41, v82, v83
    v_mfma_f32_16x16x32_bf16 v[132:135], v[196:199], v[232:235], v[132:135]
    v_cvt_pk_bf16_f32 v42, v84, v85
    v_cvt_pk_bf16_f32 v43, v86, v87
    s_waitcnt lgkmcnt(4)
    v_mfma_f32_16x16x32_bf16 v[136:139], v[192:195], v[236:239], v[136:139]
    v_cvt_pk_bf16_f32 v44, v88, v89
    v_cvt_pk_bf16_f32 v45, v90, v91
    v_mfma_f32_16x16x32_bf16 v[140:143], v[196:199], v[236:239], v[140:143]
    v_cvt_pk_bf16_f32 v46, v92, v93
    v_cvt_pk_bf16_f32 v47, v94, v95
    s_waitcnt vmcnt(21) lgkmcnt(0)
    s_barrier
    v_mfma_f32_16x16x32_bf16 v[176:179], v[208:211], v[224:227], v[176:179]
    ds_read_b64_tr_b16 v[192:193], v250 offset:32768
    s_lshl_b32 s78, s2, 8
    s_add_u32 s78, s78, 4112
    v_mov_b32 v253, 1
    v_mfma_f32_16x16x32_bf16 v[180:183], v[212:215], v[224:227], v[180:183]
    ds_read_b128 v[224:227], v242 offset:40960
    ds_read_b64_tr_b16 v[194:195], v250 offset:33280
    buffer_store_dword v253, v252, s[4:7], s78 offen sc1
    s_add_u32 m0, s83, 4294959104
    v_mfma_f32_16x16x32_bf16 v[184:187], v[208:211], v[228:231], v[184:187]
    ds_read_b64_tr_b16 v[196:197], v251 offset:32768
    s_add_u32 s77, s98, 31744
    buffer_load_dwordx4 v244, s[48:51], s98 offen lds
    buffer_load_dwordx4 v244, s[48:51], s77 offen offset:1024 lds
    v_mfma_f32_16x16x32_bf16 v[188:191], v[212:215], v[228:231], v[188:191]
    ds_read_b128 v[228:231], v242 offset:41984
    ds_read_b64_tr_b16 v[198:199], v251 offset:33280
    s_add_u32 m0, s94, 0
    s_add_u32 s98, s98, 262144
    v_mfma_f32_16x16x32_bf16 v[144:147], v[208:211], v[232:235], v[144:147]
    buffer_load_dwordx4 v241, s[52:55], s99 offen lds
    s_add_u32 m0, s83, 8192
    s_add_u32 s99, s99, 110592
    v_mfma_f32_16x16x32_bf16 v[148:151], v[212:215], v[232:235], v[148:151]
    ds_read_b128 v[232:235], v242 offset:32768
    buffer_load_dwordx4 v240, s[44:47], s100 offen sc1 lds
    buffer_load_dwordx4 v240, s[44:47], s100 offen offset:1024 sc1 lds
    v_mfma_f32_16x16x32_bf16 v[152:155], v[208:211], v[236:239], v[152:155]
    s_add_u32 m0, s83, 16384
    s_add_u32 s100, s100, 2048
    buffer_load_dwordx4 v240, s[44:47], s101 offen sc1 lds
    v_mfma_f32_16x16x32_bf16 v[156:159], v[212:215], v[236:239], v[156:159]
    ds_read_b128 v[236:239], v242 offset:33792
    buffer_load_dwordx4 v240, s[44:47], s101 offen offset:1024 sc1 lds
    s_add_u32 s101, s101, 2048
    s_waitcnt lgkmcnt(2)
    v_mfma_f32_16x16x32_bf16 v[160:163], v[192:195], v[224:227], v[160:163]
    ds_read_b64_tr_b16 v[208:209], v245 offset:32768
    ds_read_b64_tr_b16 v[210:211], v245 offset:33280
    v_pk_mul_f32 v[96:97], v[96:97], s[90:91]
    v_pk_mul_f32 v[98:99], v[98:99], s[90:91]
    v_mfma_f32_16x16x32_bf16 v[164:167], v[196:199], v[224:227], v[164:167]
    ds_read_b64_tr_b16 v[212:213], v246 offset:32768
    ds_read_b64_tr_b16 v[214:215], v246 offset:33280
    v_pk_mul_f32 v[100:101], v[100:101], s[90:91]
    v_pk_mul_f32 v[102:103], v[102:103], s[90:91]
    v_mfma_f32_16x16x32_bf16 v[168:171], v[192:195], v[228:231], v[168:171]
    v_add_u32 v250, 0x10000, v250
    v_add_u32 v251, 0x10000, v251
    v_pk_mul_f32 v[104:105], v[104:105], s[90:91]
    v_pk_mul_f32 v[106:107], v[106:107], s[90:91]
    v_mfma_f32_16x16x32_bf16 v[172:175], v[196:199], v[228:231], v[172:175]
    v_add_u32 v245, 0x10000, v245
    v_add_u32 v246, 0x10000, v246
    v_pk_mul_f32 v[108:109], v[108:109], s[90:91]
    v_pk_mul_f32 v[110:111], v[110:111], s[90:91]
    s_waitcnt lgkmcnt(5)
    v_mfma_f32_16x16x32_bf16 v[128:131], v[192:195], v[232:235], v[128:131]
    v_add_u32 v242, 0x10000, v242
    v_cvt_pk_bf16_f32 v48, v96, v97
    v_cvt_pk_bf16_f32 v49, v98, v99
    v_mfma_f32_16x16x32_bf16 v[132:135], v[196:199], v[232:235], v[132:135]
    v_cvt_pk_bf16_f32 v50, v100, v101
    v_cvt_pk_bf16_f32 v51, v102, v103
    s_waitcnt lgkmcnt(4)
    v_mfma_f32_16x16x32_bf16 v[136:139], v[192:195], v[236:239], v[136:139]
    v_cvt_pk_bf16_f32 v52, v104, v105
    v_cvt_pk_bf16_f32 v53, v106, v107
    v_mfma_f32_16x16x32_bf16 v[140:143], v[196:199], v[236:239], v[140:143]
    v_cvt_pk_bf16_f32 v54, v108, v109
    v_cvt_pk_bf16_f32 v55, v110, v111
    s_waitcnt vmcnt(22) lgkmcnt(0)
    s_barrier
    v_mfma_f32_16x16x32_bf16 v[176:179], v[208:211], v[224:227], v[176:179]
    ds_read_b64_tr_b16 v[192:193], v250 offset:0
    s_add_u32 m0, s83, 24576
    s_add_u32 s77, s98, 31744
    v_mfma_f32_16x16x32_bf16 v[180:183], v[212:215], v[224:227], v[180:183]
    ds_read_b128 v[224:227], v242 offset:8192
    ds_read_b64_tr_b16 v[194:195], v250 offset:512
    buffer_load_dwordx4 v244, s[48:51], s98 offen lds
    buffer_load_dwordx4 v244, s[48:51], s77 offen offset:1024 lds
    v_mfma_f32_16x16x32_bf16 v[184:187], v[208:211], v[228:231], v[184:187]
    ds_read_b64_tr_b16 v[196:197], v251 offset:0
    s_add_u32 m0, s94, 32768
    s_add_u32 s98, s98, 262144
    v_mfma_f32_16x16x32_bf16 v[188:191], v[212:215], v[228:231], v[188:191]
    ds_read_b128 v[228:231], v242 offset:9216
    ds_read_b64_tr_b16 v[198:199], v251 offset:512
    buffer_load_dwordx4 v241, s[52:55], s99 offen lds
    s_add_u32 m0, s83, 40960
    v_mfma_f32_16x16x32_bf16 v[144:147], v[208:211], v[232:235], v[144:147]
    s_add_u32 s99, s99, 110592
    buffer_load_dwordx4 v240, s[44:47], s100 offen sc1 lds
    v_mfma_f32_16x16x32_bf16 v[148:151], v[212:215], v[232:235], v[148:151]
    ds_read_b128 v[232:235], v242 offset:0
    buffer_load_dwordx4 v240, s[44:47], s100 offen offset:1024 sc1 lds
    s_add_u32 m0, s83, 49152
    v_mfma_f32_16x16x32_bf16 v[152:155], v[208:211], v[236:239], v[152:155]
    s_add_u32 s100, s100, 2048
    buffer_load_dwordx4 v240, s[44:47], s101 offen sc1 lds
    v_mfma_f32_16x16x32_bf16 v[156:159], v[212:215], v[236:239], v[156:159]
    ds_read_b128 v[236:239], v242 offset:1024
    buffer_load_dwordx4 v240, s[44:47], s101 offen offset:1024 sc1 lds
    s_add_u32 s101, s101, 2048
    s_waitcnt lgkmcnt(2)
    v_mfma_f32_16x16x32_bf16 v[160:163], v[192:195], v[224:227], v[160:163]
    ds_read_b64_tr_b16 v[208:209], v245 offset:0
    v_pk_mul_f32 v[112:113], v[112:113], s[90:91]
    v_pk_mul_f32 v[114:115], v[114:115], s[90:91]
    v_mfma_f32_16x16x32_bf16 v[164:167], v[196:199], v[224:227], v[164:167]
    ds_read_b64_tr_b16 v[210:211], v245 offset:512
    v_pk_mul_f32 v[116:117], v[116:117], s[90:91]
    v_pk_mul_f32 v[118:119], v[118:119], s[90:91]
    v_mfma_f32_16x16x32_bf16 v[168:171], v[192:195], v[228:231], v[168:171]
    ds_read_b64_tr_b16 v[212:213], v246 offset:0
    v_pk_mul_f32 v[120:121], v[120:121], s[90:91]
    v_pk_mul_f32 v[122:123], v[122:123], s[90:91]
    v_mfma_f32_16x16x32_bf16 v[172:175], v[196:199], v[228:231], v[172:175]
    ds_read_b64_tr_b16 v[214:215], v246 offset:512
    v_pk_mul_f32 v[124:125], v[124:125], s[90:91]
    v_pk_mul_f32 v[126:127], v[126:127], s[90:91]
    s_waitcnt lgkmcnt(5)
    v_mfma_f32_16x16x32_bf16 v[128:131], v[192:195], v[232:235], v[128:131]
    v_cvt_pk_bf16_f32 v56, v112, v113
    v_cvt_pk_bf16_f32 v57, v114, v115
    v_mfma_f32_16x16x32_bf16 v[132:135], v[196:199], v[232:235], v[132:135]
    v_cvt_pk_bf16_f32 v58, v116, v117
    v_cvt_pk_bf16_f32 v59, v118, v119
    s_waitcnt lgkmcnt(4)
    v_mfma_f32_16x16x32_bf16 v[136:139], v[192:195], v[236:239], v[136:139]
    v_cvt_pk_bf16_f32 v60, v120, v121
    v_cvt_pk_bf16_f32 v61, v122, v123
    v_mfma_f32_16x16x32_bf16 v[140:143], v[196:199], v[236:239], v[140:143]
    v_cvt_pk_bf16_f32 v62, v124, v125
    v_cvt_pk_bf16_f32 v63, v126, v127
    s_waitcnt vmcnt(22) lgkmcnt(0)
    s_barrier
    v_mfma_f32_16x16x32_bf16 v[176:179], v[208:211], v[224:227], v[176:179]
    ds_read_b64_tr_b16 v[192:193], v250 offset:32768
    s_add_u32 m0, s83, 57344
    s_add_u32 s77, s98, 31744
    v_mfma_f32_16x16x32_bf16 v[180:183], v[212:215], v[224:227], v[180:183]
    ds_read_b128 v[224:227], v242 offset:40960
    ds_read_b64_tr_b16 v[194:195], v250 offset:33280
    buffer_load_dwordx4 v244, s[48:51], s98 offen lds
    buffer_load_dwordx4 v244, s[48:51], s77 offen offset:1024 lds
    v_mfma_f32_16x16x32_bf16 v[184:187], v[208:211], v[228:231], v[184:187]
    ds_read_b64_tr_b16 v[196:197], v251 offset:32768
    s_add_u32 m0, s94, 65536
    s_add_u32 s98, s98, 262144
    v_mfma_f32_16x16x32_bf16 v[188:191], v[212:215], v[228:231], v[188:191]
    ds_read_b128 v[228:231], v242 offset:41984
    ds_read_b64_tr_b16 v[198:199], v251 offset:33280
    buffer_load_dwordx4 v241, s[52:55], s99 offen lds
    s_add_u32 m0, s83, 73728
    v_mfma_f32_16x16x32_bf16 v[144:147], v[208:211], v[232:235], v[144:147]
    s_add_u32 s99, s99, 110592
    buffer_load_dwordx4 v240, s[44:47], s100 offen sc1 lds
    v_mfma_f32_16x16x32_bf16 v[148:151], v[212:215], v[232:235], v[148:151]
    ds_read_b128 v[232:235], v242 offset:32768
    buffer_load_dwordx4 v240, s[44:47], s100 offen offset:1024 sc1 lds
    s_add_u32 m0, s83, 81920
    v_mfma_f32_16x16x32_bf16 v[152:155], v[208:211], v[236:239], v[152:155]
    s_add_u32 s100, s100, 2048
    buffer_load_dwordx4 v240, s[44:47], s101 offen sc1 lds
    v_mfma_f32_16x16x32_bf16 v[156:159], v[212:215], v[236:239], v[156:159]
    ds_read_b128 v[236:239], v242 offset:33792
    buffer_load_dwordx4 v240, s[44:47], s101 offen offset:1024 sc1 lds
    s_add_u32 s101, s101, 2048
    s_waitcnt lgkmcnt(2)
    v_mfma_f32_16x16x32_bf16 v[160:163], v[192:195], v[224:227], v[160:163]
    ds_read_b64_tr_b16 v[208:209], v245 offset:32768
    ds_read_b64_tr_b16 v[210:211], v245 offset:33280
    v_mfma_f32_16x16x32_bf16 v[164:167], v[196:199], v[224:227], v[164:167]
    ds_read_b64_tr_b16 v[212:213], v246 offset:32768
    ds_read_b64_tr_b16 v[214:215], v246 offset:33280
    v_mfma_f32_16x16x32_bf16 v[168:171], v[192:195], v[228:231], v[168:171]
    v_add_u32 v250, 0x10000, v250
    v_add_u32 v251, 0x10000, v251
    v_mfma_f32_16x16x32_bf16 v[172:175], v[196:199], v[228:231], v[172:175]
    v_add_u32 v245, 0x10000, v245
    v_add_u32 v246, 0x10000, v246
    s_waitcnt lgkmcnt(5)
    v_mfma_f32_16x16x32_bf16 v[128:131], v[192:195], v[232:235], v[128:131]
    v_add_u32 v242, 0x10000, v242
    v_mfma_f32_16x16x32_bf16 v[132:135], v[196:199], v[232:235], v[132:135]
    s_waitcnt lgkmcnt(4)
    v_mfma_f32_16x16x32_bf16 v[136:139], v[192:195], v[236:239], v[136:139]
    v_mfma_f32_16x16x32_bf16 v[140:143], v[196:199], v[236:239], v[140:143]
    s_waitcnt vmcnt(22) lgkmcnt(0)
    s_barrier
    v_mfma_f32_16x16x32_bf16 v[176:179], v[208:211], v[224:227], v[176:179]
    ds_read_b64_tr_b16 v[192:193], v250 offset:0
    s_add_u32 m0, s83, 90112
    s_add_u32 s77, s98, 31744
    buffer_load_dwordx4 v244, s[48:51], s98 offen lds
    buffer_load_dwordx4 v244, s[48:51], s77 offen offset:1024 lds
    v_mfma_f32_16x16x32_bf16 v[180:183], v[212:215], v[224:227], v[180:183]
    ds_read_b128 v[224:227], v242 offset:8192
    ds_read_b64_tr_b16 v[194:195], v250 offset:512
    s_add_u32 m0, s94, 98304
    s_add_u32 s98, s98, 262144
    buffer_load_dwordx4 v241, s[52:55], s99 offen lds
    v_mfma_f32_16x16x32_bf16 v[184:187], v[208:211], v[228:231], v[184:187]
    ds_read_b64_tr_b16 v[196:197], v251 offset:0
    s_add_u32 m0, s83, 106496
    s_add_u32 s99, s99, 110592
    buffer_load_dwordx4 v240, s[44:47], s100 offen sc1 lds
    buffer_load_dwordx4 v240, s[44:47], s100 offen offset:1024 sc1 lds
    v_mfma_f32_16x16x32_bf16 v[188:191], v[212:215], v[228:231], v[188:191]
    ds_read_b128 v[228:231], v242 offset:9216
    ds_read_b64_tr_b16 v[198:199], v251 offset:512
    s_add_u32 m0, s83, 114688
    s_add_u32 s100, s100, 2048
    buffer_load_dwordx4 v240, s[44:47], s101 offen sc1 lds
    v_mfma_f32_16x16x32_bf16 v[144:147], v[208:211], v[232:235], v[144:147]
    buffer_load_dwordx4 v240, s[44:47], s101 offen offset:1024 sc1 lds
    s_add_u32 s101, s101, 2048
    s_lshl_b32 s95, s76, 12
    v_mfma_f32_16x16x32_bf16 v[148:151], v[212:215], v[232:235], v[148:151]
    ds_read_b128 v[232:235], v242 offset:0
    s_lshl_b32 s92, s72, 19
    s_add_u32 s92, s92, s95
    s_add_u32 s93, s92, 16760832
    s_mov_b32 s88, 0
    v_mfma_f32_16x16x32_bf16 v[152:155], v[208:211], v[236:239], v[152:155]
    s_lshl_b32 s89, s74, 1
    s_add_u32 s89, s89, 3
    s_lshl_b32 s16, s75, 1
    v_mfma_f32_16x16x32_bf16 v[156:159], v[212:215], v[236:239], v[156:159]
    ds_read_b128 v[236:239], v242 offset:1024
    s_add_u32 s16, s16, 3
    s_mov_b32 s86, 0
    s_mov_b32 s87, 0
    s_waitcnt lgkmcnt(2)
    v_mfma_f32_16x16x32_bf16 v[160:163], v[192:195], v[224:227], v[160:163]
    ds_read_b64_tr_b16 v[208:209], v245 offset:0
    ds_read_b64_tr_b16 v[210:211], v245 offset:512
    v_mfma_f32_16x16x32_bf16 v[164:167], v[196:199], v[224:227], v[164:167]
    ds_read_b64_tr_b16 v[212:213], v246 offset:0
    ds_read_b64_tr_b16 v[214:215], v246 offset:512
    v_mfma_f32_16x16x32_bf16 v[168:171], v[192:195], v[228:231], v[168:171]
    v_add_u32 v250, 0xfffe0000, v250
    v_add_u32 v251, 0xfffe0000, v251
    v_mfma_f32_16x16x32_bf16 v[172:175], v[196:199], v[228:231], v[172:175]
    v_add_u32 v245, 0xfffe0000, v245
    v_add_u32 v246, 0xfffe0000, v246
    s_waitcnt lgkmcnt(5)
    v_mfma_f32_16x16x32_bf16 v[128:131], v[192:195], v[232:235], v[128:131]
    v_add_u32 v242, 0xfffe0000, v242
    v_mfma_f32_16x16x32_bf16 v[132:135], v[196:199], v[232:235], v[132:135]
    s_waitcnt lgkmcnt(4)
    v_mfma_f32_16x16x32_bf16 v[136:139], v[192:195], v[236:239], v[136:139]
    v_mfma_f32_16x16x32_bf16 v[140:143], v[196:199], v[236:239], v[140:143]
    s_waitcnt vmcnt(21) lgkmcnt(0)
    s_barrier
    v_mfma_f32_16x16x32_bf16 v[176:179], v[208:211], v[224:227], v[176:179]
    ds_read_b64_tr_b16 v[192:193], v250 offset:0
    s_lshl_b32 s78, s2, 8
    s_add_u32 s78, s78, 4112
    v_mov_b32 v253, 2
    v_mfma_f32_16x16x32_bf16 v[180:183], v[212:215], v[224:227], v[180:183]
    ds_read_b128 v[224:227], v242 offset:8192
    ds_read_b64_tr_b16 v[194:195], v250 offset:512
    buffer_store_dword v253, v252, s[4:7], s78 offen sc1
    s_add_u32 m0, s83, 122880
    v_mfma_f32_16x16x32_bf16 v[184:187], v[208:211], v[228:231], v[184:187]
    ds_read_b64_tr_b16 v[196:197], v251 offset:0
    s_add_u32 s77, s98, 31744
    buffer_load_dwordx4 v244, s[48:51], s98 offen lds
    buffer_load_dwordx4 v244, s[48:51], s77 offen offset:1024 lds
    v_mfma_f32_16x16x32_bf16 v[188:191], v[212:215], v[228:231], v[188:191]
    ds_read_b128 v[228:231], v242 offset:9216
    ds_read_b64_tr_b16 v[198:199], v251 offset:512
    s_add_u32 m0, s94, 131072
    s_add_u32 s98, s98, 262144
    v_mfma_f32_16x16x32_bf16 v[144:147], v[208:211], v[232:235], v[144:147]
    buffer_load_dwordx4 v241, s[52:55], s99 offen lds
    s_add_u32 m0, s83, 139264
    s_add_u32 s99, s99, 110592
    v_mfma_f32_16x16x32_bf16 v[148:151], v[212:215], v[232:235], v[148:151]
    ds_read_b128 v[232:235], v242 offset:0
    buffer_load_dwordx4 v240, s[44:47], s100 offen sc1 lds
    buffer_load_dwordx4 v240, s[44:47], s100 offen offset:1024 sc1 lds
    v_mfma_f32_16x16x32_bf16 v[152:155], v[208:211], v[236:239], v[152:155]
    s_add_u32 m0, s83, 147456
    s_add_u32 s100, s100, 2048
    buffer_load_dwordx4 v240, s[44:47], s101 offen sc1 lds
    v_mfma_f32_16x16x32_bf16 v[156:159], v[212:215], v[236:239], v[156:159]
    ds_read_b128 v[236:239], v242 offset:1024
    buffer_load_dwordx4 v240, s[44:47], s101 offen offset:1024 sc1 lds
    s_add_u32 s101, s101, 2048
    s_waitcnt lgkmcnt(2)
    v_mfma_f32_16x16x32_bf16 v[160:163], v[192:195], v[224:227], v[160:163]
    ds_read_b64_tr_b16 v[208:209], v245 offset:0
    v_mfma_f32_16x16x32_bf16 v[164:167], v[196:199], v[224:227], v[164:167]
    ds_read_b64_tr_b16 v[210:211], v245 offset:512
    v_mfma_f32_16x16x32_bf16 v[168:171], v[192:195], v[228:231], v[168:171]
    ds_read_b64_tr_b16 v[212:213], v246 offset:0
    v_mfma_f32_16x16x32_bf16 v[172:175], v[196:199], v[228:231], v[172:175]
    ds_read_b64_tr_b16 v[214:215], v246 offset:512
    s_waitcnt lgkmcnt(5)
    v_mfma_f32_16x16x32_bf16 v[128:131], v[192:195], v[232:235], v[128:131]
    v_mfma_f32_16x16x32_bf16 v[132:135], v[196:199], v[232:235], v[132:135]
    s_waitcnt lgkmcnt(4)
    v_mfma_f32_16x16x32_bf16 v[136:139], v[192:195], v[236:239], v[136:139]
    v_mfma_f32_16x16x32_bf16 v[140:143], v[196:199], v[236:239], v[140:143]
    s_waitcnt vmcnt(22) lgkmcnt(0)
    s_barrier
    v_mfma_f32_16x16x32_bf16 v[176:179], v[208:211], v[224:227], v[176:179]
    ds_read_b64_tr_b16 v[192:193], v250 offset:32768
    s_add_u32 m0, s83, 4294959104
    s_add_u32 s77, s98, 31744
    v_mfma_f32_16x16x32_bf16 v[180:183], v[212:215], v[224:227], v[180:183]
    ds_read_b128 v[224:227], v242 offset:40960
    ds_read_b64_tr_b16 v[194:195], v250 offset:33280
    buffer_load_dwordx4 v244, s[48:51], s98 offen lds
    buffer_load_dwordx4 v244, s[48:51], s77 offen offset:1024 lds
    v_mfma_f32_16x16x32_bf16 v[184:187], v[208:211], v[228:231], v[184:187]
    ds_read_b64_tr_b16 v[196:197], v251 offset:32768
    s_add_u32 m0, s94, 0
    s_add_u32 s98, s98, 262144
    v_mfma_f32_16x16x32_bf16 v[188:191], v[212:215], v[228:231], v[188:191]
    ds_read_b128 v[228:231], v242 offset:41984
    ds_read_b64_tr_b16 v[198:199], v251 offset:33280
    buffer_load_dwordx4 v241, s[52:55], s99 offen lds
    s_add_u32 m0, s83, 8192
    v_mfma_f32_16x16x32_bf16 v[144:147], v[208:211], v[232:235], v[144:147]
    s_add_u32 s99, s99, 110592
    buffer_load_dwordx4 v240, s[44:47], s100 offen sc1 lds
    v_mfma_f32_16x16x32_bf16 v[148:151], v[212:215], v[232:235], v[148:151]
    ds_read_b128 v[232:235], v242 offset:32768
    buffer_load_dwordx4 v240, s[44:47], s100 offen offset:1024 sc1 lds
    s_add_u32 m0, s83, 16384
    v_mfma_f32_16x16x32_bf16 v[152:155], v[208:211], v[236:239], v[152:155]
    s_add_u32 s100, s100, 2048
    buffer_load_dwordx4 v240, s[44:47], s101 offen sc1 lds
    v_mfma_f32_16x16x32_bf16 v[156:159], v[212:215], v[236:239], v[156:159]
    ds_read_b128 v[236:239], v242 offset:33792
    buffer_load_dwordx4 v240, s[44:47], s101 offen offset:1024 sc1 lds
    s_add_u32 s101, s101, 2048
    s_waitcnt lgkmcnt(2)
    v_mfma_f32_16x16x32_bf16 v[160:163], v[192:195], v[224:227], v[160:163]
    ds_read_b64_tr_b16 v[208:209], v245 offset:32768
    ds_read_b64_tr_b16 v[210:211], v245 offset:33280
    v_mfma_f32_16x16x32_bf16 v[164:167], v[196:199], v[224:227], v[164:167]
    ds_read_b64_tr_b16 v[212:213], v246 offset:32768
    ds_read_b64_tr_b16 v[214:215], v246 offset:33280
    v_mfma_f32_16x16x32_bf16 v[168:171], v[192:195], v[228:231], v[168:171]
    v_add_u32 v250, 0x10000, v250
    v_add_u32 v251, 0x10000, v251
    v_mfma_f32_16x16x32_bf16 v[172:175], v[196:199], v[228:231], v[172:175]
    v_add_u32 v245, 0x10000, v245
    v_add_u32 v246, 0x10000, v246
    s_waitcnt lgkmcnt(5)
    v_mfma_f32_16x16x32_bf16 v[128:131], v[192:195], v[232:235], v[128:131]
    v_add_u32 v242, 0x10000, v242
    v_mfma_f32_16x16x32_bf16 v[132:135], v[196:199], v[232:235], v[132:135]
    s_waitcnt lgkmcnt(4)
    v_mfma_f32_16x16x32_bf16 v[136:139], v[192:195], v[236:239], v[136:139]
    v_mfma_f32_16x16x32_bf16 v[140:143], v[196:199], v[236:239], v[140:143]
    s_waitcnt vmcnt(22) lgkmcnt(0)
    s_barrier
    v_mfma_f32_16x16x32_bf16 v[176:179], v[208:211], v[224:227], v[176:179]
    ds_read_b64_tr_b16 v[192:193], v250 offset:0
    s_add_u32 m0, s83, 24576
    s_add_u32 s77, s98, 31744
    v_mfma_f32_16x16x32_bf16 v[180:183], v[212:215], v[224:227], v[180:183]
    ds_read_b128 v[224:227], v242 offset:8192
    ds_read_b64_tr_b16 v[194:195], v250 offset:512
    buffer_load_dwordx4 v244, s[48:51], s98 offen lds
    buffer_load_dwordx4 v244, s[48:51], s77 offen offset:1024 lds
    v_mfma_f32_16x16x32_bf16 v[184:187], v[208:211], v[228:231], v[184:187]
    ds_read_b64_tr_b16 v[196:197], v251 offset:0
    s_add_u32 m0, s94, 32768
    s_add_u32 s98, s98, 262144
    v_mfma_f32_16x16x32_bf16 v[188:191], v[212:215], v[228:231], v[188:191]
    ds_read_b128 v[228:231], v242 offset:9216
    ds_read_b64_tr_b16 v[198:199], v251 offset:512
    buffer_load_dwordx4 v241, s[52:55], s99 offen lds
    s_add_u32 m0, s83, 40960
    v_mfma_f32_16x16x32_bf16 v[144:147], v[208:211], v[232:235], v[144:147]
    s_add_u32 s99, s99, 110592
    buffer_load_dwordx4 v240, s[44:47], s100 offen sc1 lds
    v_mfma_f32_16x16x32_bf16 v[148:151], v[212:215], v[232:235], v[148:151]
    ds_read_b128 v[232:235], v242 offset:0
    buffer_load_dwordx4 v240, s[44:47], s100 offen offset:1024 sc1 lds
    s_add_u32 m0, s83, 49152
    v_mfma_f32_16x16x32_bf16 v[152:155], v[208:211], v[236:239], v[152:155]
    s_add_u32 s100, s100, 2048
    buffer_load_dwordx4 v240, s[44:47], s101 offen sc1 lds
    v_mfma_f32_16x16x32_bf16 v[156:159], v[212:215], v[236:239], v[156:159]
    ds_read_b128 v[236:239], v242 offset:1024
    buffer_load_dwordx4 v240, s[44:47], s101 offen offset:1024 sc1 lds
    s_add_u32 s101, s101, 2048
    s_waitcnt lgkmcnt(2)
    v_mfma_f32_16x16x32_bf16 v[160:163], v[192:195], v[224:227], v[160:163]
    ds_read_b64_tr_b16 v[208:209], v245 offset:0
    v_mfma_f32_16x16x32_bf16 v[164:167], v[196:199], v[224:227], v[164:167]
    ds_read_b64_tr_b16 v[210:211], v245 offset:512
    v_mfma_f32_16x16x32_bf16 v[168:171], v[192:195], v[228:231], v[168:171]
    ds_read_b64_tr_b16 v[212:213], v246 offset:0
    v_mfma_f32_16x16x32_bf16 v[172:175], v[196:199], v[228:231], v[172:175]
    ds_read_b64_tr_b16 v[214:215], v246 offset:512
    s_waitcnt lgkmcnt(5)
    v_mfma_f32_16x16x32_bf16 v[128:131], v[192:195], v[232:235], v[128:131]
    v_mfma_f32_16x16x32_bf16 v[132:135], v[196:199], v[232:235], v[132:135]
    s_waitcnt lgkmcnt(4)
    v_mfma_f32_16x16x32_bf16 v[136:139], v[192:195], v[236:239], v[136:139]
    v_mfma_f32_16x16x32_bf16 v[140:143], v[196:199], v[236:239], v[140:143]
    s_waitcnt vmcnt(22) lgkmcnt(0)
    s_barrier
    v_mfma_f32_16x16x32_bf16 v[176:179], v[208:211], v[224:227], v[176:179]
    ds_read_b64_tr_b16 v[192:193], v250 offset:32768
    s_add_u32 m0, s83, 57344
    s_add_u32 s77, s98, 31744
    v_mfma_f32_16x16x32_bf16 v[180:183], v[212:215], v[224:227], v[180:183]
    ds_read_b128 v[224:227], v242 offset:40960
    ds_read_b64_tr_b16 v[194:195], v250 offset:33280
    buffer_load_dwordx4 v244, s[48:51], s98 offen lds
    buffer_load_dwordx4 v244, s[48:51], s77 offen offset:1024 lds
    v_mfma_f32_16x16x32_bf16 v[184:187], v[208:211], v[228:231], v[184:187]
    ds_read_b64_tr_b16 v[196:197], v251 offset:32768
    s_add_u32 m0, s94, 65536
    s_add_u32 s98, s98, 262144
    v_mfma_f32_16x16x32_bf16 v[188:191], v[212:215], v[228:231], v[188:191]
    ds_read_b128 v[228:231], v242 offset:41984
    ds_read_b64_tr_b16 v[198:199], v251 offset:33280
    buffer_load_dwordx4 v241, s[52:55], s99 offen lds
    s_add_u32 m0, s83, 73728
    v_mfma_f32_16x16x32_bf16 v[144:147], v[208:211], v[232:235], v[144:147]
    s_add_u32 s99, s99, 110592
    buffer_load_dwordx4 v240, s[44:47], s100 offen sc1 lds
    v_mfma_f32_16x16x32_bf16 v[148:151], v[212:215], v[232:235], v[148:151]
    ds_read_b128 v[232:235], v242 offset:32768
    buffer_load_dwordx4 v240, s[44:47], s100 offen offset:1024 sc1 lds
    s_add_u32 m0, s83, 81920
    v_mfma_f32_16x16x32_bf16 v[152:155], v[208:211], v[236:239], v[152:155]
    s_add_u32 s100, s100, 2048
    buffer_load_dwordx4 v240, s[44:47], s101 offen sc1 lds
    v_mfma_f32_16x16x32_bf16 v[156:159], v[212:215], v[236:239], v[156:159]
    ds_read_b128 v[236:239], v242 offset:33792
    buffer_load_dwordx4 v240, s[44:47], s101 offen offset:1024 sc1 lds
    s_add_u32 s101, s101, 2048
    s_waitcnt lgkmcnt(2)
    v_mfma_f32_16x16x32_bf16 v[160:163], v[192:195], v[224:227], v[160:163]
    ds_read_b64_tr_b16 v[208:209], v245 offset:32768
    ds_read_b64_tr_b16 v[210:211], v245 offset:33280
    v_mfma_f32_16x16x32_bf16 v[164:167], v[196:199], v[224:227], v[164:167]
    ds_read_b64_tr_b16 v[212:213], v246 offset:32768
    ds_read_b64_tr_b16 v[214:215], v246 offset:33280
    v_mfma_f32_16x16x32_bf16 v[168:171], v[192:195], v[228:231], v[168:171]
    v_add_u32 v250, 0x10000, v250
    v_add_u32 v251, 0x10000, v251
    v_mfma_f32_16x16x32_bf16 v[172:175], v[196:199], v[228:231], v[172:175]
    v_add_u32 v245, 0x10000, v245
    v_add_u32 v246, 0x10000, v246
    s_waitcnt lgkmcnt(5)
    v_mfma_f32_16x16x32_bf16 v[128:131], v[192:195], v[232:235], v[128:131]
    v_add_u32 v242, 0x10000, v242
    v_mfma_f32_16x16x32_bf16 v[132:135], v[196:199], v[232:235], v[132:135]
    s_waitcnt lgkmcnt(4)
    v_mfma_f32_16x16x32_bf16 v[136:139], v[192:195], v[236:239], v[136:139]
    v_mfma_f32_16x16x32_bf16 v[140:143], v[196:199], v[236:239], v[140:143]
    s_waitcnt vmcnt(21) lgkmcnt(0)
    s_barrier
    v_mfma_f32_16x16x32_bf16 v[176:179], v[208:211], v[224:227], v[176:179]
    ds_read_b64_tr_b16 v[192:193], v250 offset:0
    s_lshl_b32 s78, s2, 8
    s_add_u32 s78, s78, 4112
    v_mov_b32 v253, 3
    v_mfma_f32_16x16x32_bf16 v[180:183], v[212:215], v[224:227], v[180:183]
    ds_read_b128 v[224:227], v242 offset:8192
    ds_read_b64_tr_b16 v[194:195], v250 offset:512
    buffer_store_dword v253, v252, s[4:7], s78 offen sc1
    s_add_u32 m0, s83, 90112
    v_mfma_f32_16x16x32_bf16 v[184:187], v[208:211], v[228:231], v[184:187]
    ds_read_b64_tr_b16 v[196:197], v251 offset:0
    s_add_u32 s77, s98, 31744
    buffer_load_dwordx4 v244, s[48:51], s98 offen lds
    buffer_load_dwordx4 v244, s[48:51], s77 offen offset:1024 lds
    v_mfma_f32_16x16x32_bf16 v[188:191], v[212:215], v[228:231], v[188:191]
    ds_read_b128 v[228:231], v242 offset:9216
    ds_read_b64_tr_b16 v[198:199], v251 offset:512
    s_add_u32 m0, s94, 98304
    s_add_u32 s98, s98, 262144
    v_mfma_f32_16x16x32_bf16 v[144:147], v[208:211], v[232:235], v[144:147]
    buffer_load_dwordx4 v241, s[52:55], s99 offen lds
    s_add_u32 m0, s83, 106496
    s_add_u32 s99, s99, 110592
    v_mfma_f32_16x16x32_bf16 v[148:151], v[212:215], v[232:235], v[148:151]
    ds_read_b128 v[232:235], v242 offset:0
    buffer_load_dwordx4 v240, s[44:47], s100 offen sc1 lds
    buffer_load_dwordx4 v240, s[44:47], s100 offen offset:1024 sc1 lds
    v_mfma_f32_16x16x32_bf16 v[152:155], v[208:211], v[236:239], v[152:155]
    s_add_u32 m0, s83, 114688
    s_add_u32 s100, s100, 2048
    buffer_load_dwordx4 v240, s[44:47], s101 offen sc1 lds
    v_mfma_f32_16x16x32_bf16 v[156:159], v[212:215], v[236:239], v[156:159]
    ds_read_b128 v[236:239], v242 offset:1024
    buffer_load_dwordx4 v240, s[44:47], s101 offen offset:1024 sc1 lds
    s_add_u32 s101, s101, 2048
    s_waitcnt lgkmcnt(2)
    v_mfma_f32_16x16x32_bf16 v[160:163], v[192:195], v[224:227], v[160:163]
    ds_read_b64_tr_b16 v[208:209], v245 offset:0
    ds_read_b64_tr_b16 v[210:211], v245 offset:512
    v_mfma_f32_16x16x32_bf16 v[164:167], v[196:199], v[224:227], v[164:167]
    ds_read_b64_tr_b16 v[212:213], v246 offset:0
    ds_read_b64_tr_b16 v[214:215], v246 offset:512
    v_mfma_f32_16x16x32_bf16 v[168:171], v[192:195], v[228:231], v[168:171]
    v_add_u32 v250, 0xfffe0000, v250
    v_add_u32 v251, 0xfffe0000, v251
    v_mfma_f32_16x16x32_bf16 v[172:175], v[196:199], v[228:231], v[172:175]
    v_add_u32 v245, 0xfffe0000, v245
    v_add_u32 v246, 0xfffe0000, v246
    s_waitcnt lgkmcnt(5)
    v_mfma_f32_16x16x32_bf16 v[128:131], v[192:195], v[232:235], v[128:131]
    v_add_u32 v242, 0xfffe0000, v242
    v_mfma_f32_16x16x32_bf16 v[132:135], v[196:199], v[232:235], v[132:135]
    s_waitcnt lgkmcnt(4)
    v_mfma_f32_16x16x32_bf16 v[136:139], v[192:195], v[236:239], v[136:139]
    v_mfma_f32_16x16x32_bf16 v[140:143], v[196:199], v[236:239], v[140:143]
    s_waitcnt vmcnt(22) lgkmcnt(0)
    s_barrier
    v_mfma_f32_16x16x32_bf16 v[176:179], v[208:211], v[224:227], v[176:179]
    ds_read_b64_tr_b16 v[192:193], v250 offset:0
    s_lshl_b32 s12, s72, 8
    v_mfma_f32_16x16x32_bf16 v[180:183], v[212:215], v[224:227], v[180:183]
    ds_read_b128 v[224:227], v242 offset:8192
    ds_read_b64_tr_b16 v[194:195], v250 offset:512
    s_add_u32 s12, s12, s22
    v_mfma_f32_16x16x32_bf16 v[184:187], v[208:211], v[228:231], v[184:187]
    ds_read_b64_tr_b16 v[196:197], v251 offset:0
    v_mfma_f32_16x16x32_bf16 v[188:191], v[212:215], v[228:231], v[188:191]
    ds_read_b128 v[228:231], v242 offset:9216
    ds_read_b64_tr_b16 v[198:199], v251 offset:512
    s_add_u32 s12, s12, 4096
    v_mfma_f32_16x16x32_bf16 v[144:147], v[208:211], v[232:235], v[144:147]
    v_lshlrev_b32 v254, 9, v240
    v_mfma_f32_16x16x32_bf16 v[148:151], v[212:215], v[232:235], v[148:151]
    ds_read_b128 v[232:235], v242 offset:0
    v_mfma_f32_16x16x32_bf16 v[152:155], v[208:211], v[236:239], v[152:155]
    buffer_load_dword v254, v254, s[4:7], s12 offen offset:16 sc1
    v_mfma_f32_16x16x32_bf16 v[156:159], v[212:215], v[236:239], v[156:159]
    ds_read_b128 v[236:239], v242 offset:1024
    s_waitcnt lgkmcnt(2)
    v_mfma_f32_16x16x32_bf16 v[160:163], v[192:195], v[224:227], v[160:163]
    ds_read_b64_tr_b16 v[208:209], v245 offset:0
    v_mfma_f32_16x16x32_bf16 v[164:167], v[196:199], v[224:227], v[164:167]
    ds_read_b64_tr_b16 v[210:211], v245 offset:512
    v_mfma_f32_16x16x32_bf16 v[168:171], v[192:195], v[228:231], v[168:171]
    ds_read_b64_tr_b16 v[212:213], v246 offset:0
    v_mfma_f32_16x16x32_bf16 v[172:175], v[196:199], v[228:231], v[172:175]
    ds_read_b64_tr_b16 v[214:215], v246 offset:512
    s_waitcnt lgkmcnt(5)
    v_mfma_f32_16x16x32_bf16 v[128:131], v[192:195], v[232:235], v[128:131]
    v_mfma_f32_16x16x32_bf16 v[132:135], v[196:199], v[232:235], v[132:135]
    s_waitcnt lgkmcnt(4)
    v_mfma_f32_16x16x32_bf16 v[136:139], v[192:195], v[236:239], v[136:139]
    v_mfma_f32_16x16x32_bf16 v[140:143], v[196:199], v[236:239], v[140:143]
    s_waitcnt vmcnt(16) lgkmcnt(0)
    s_barrier
    v_mfma_f32_16x16x32_bf16 v[176:179], v[208:211], v[224:227], v[176:179]
    ds_read_b64_tr_b16 v[192:193], v250 offset:32768
    v_mfma_f32_16x16x32_bf16 v[180:183], v[212:215], v[224:227], v[180:183]
    ds_read_b128 v[224:227], v242 offset:40960
    ds_read_b64_tr_b16 v[194:195], v250 offset:33280
    v_mfma_f32_16x16x32_bf16 v[184:187], v[208:211], v[228:231], v[184:187]
    ds_read_b64_tr_b16 v[196:197], v251 offset:32768
    v_mfma_f32_16x16x32_bf16 v[188:191], v[212:215], v[228:231], v[188:191]
    ds_read_b128 v[228:231], v242 offset:41984
    ds_read_b64_tr_b16 v[198:199], v251 offset:33280
    v_mfma_f32_16x16x32_bf16 v[144:147], v[208:211], v[232:235], v[144:147]
    v_mfma_f32_16x16x32_bf16 v[148:151], v[212:215], v[232:235], v[148:151]
    ds_read_b128 v[232:235], v242 offset:32768
    v_mfma_f32_16x16x32_bf16 v[152:155], v[208:211], v[236:239], v[152:155]
    v_mfma_f32_16x16x32_bf16 v[156:159], v[212:215], v[236:239], v[156:159]
    ds_read_b128 v[236:239], v242 offset:33792
    s_waitcnt lgkmcnt(2)
    v_mfma_f32_16x16x32_bf16 v[160:163], v[192:195], v[224:227], v[160:163]
    ds_read_b64_tr_b16 v[208:209], v245 offset:32768
    ds_read_b64_tr_b16 v[210:211], v245 offset:33280
    v_mfma_f32_16x16x32_bf16 v[164:167], v[196:199], v[224:227], v[164:167]
    ds_read_b64_tr_b16 v[212:213], v246 offset:32768
    ds_read_b64_tr_b16 v[214:215], v246 offset:33280
    v_mfma_f32_16x16x32_bf16 v[168:171], v[192:195], v[228:231], v[168:171]
    v_add_u32 v250, 0x10000, v250
    v_add_u32 v251, 0x10000, v251
    v_mfma_f32_16x16x32_bf16 v[172:175], v[196:199], v[228:231], v[172:175]
    v_add_u32 v245, 0x10000, v245
    v_add_u32 v246, 0x10000, v246
    s_waitcnt lgkmcnt(5)
    v_mfma_f32_16x16x32_bf16 v[128:131], v[192:195], v[232:235], v[128:131]
    v_add_u32 v242, 0x10000, v242
    v_mfma_f32_16x16x32_bf16 v[132:135], v[196:199], v[232:235], v[132:135]
    s_waitcnt lgkmcnt(4)
    v_mfma_f32_16x16x32_bf16 v[136:139], v[192:195], v[236:239], v[136:139]
    v_mfma_f32_16x16x32_bf16 v[140:143], v[196:199], v[236:239], v[140:143]
    s_waitcnt vmcnt(0) lgkmcnt(0)
    v_cmp_gt_u32 vcc, 1, v254
    s_and_b32 s30, vcc_lo, s14
    s_cbranch_scc0 KB_E34V_OK
    s_mov_b32 s23, 100000
KB_E34V_SPIN:
    s_sleep 10
    s_lshl_b32 s12, s72, 8
    s_add_u32 s12, s12, s22
    s_add_u32 s12, s12, 4096
    v_lshlrev_b32 v254, 9, v240
    buffer_load_dword v254, v254, s[4:7], s12 offen offset:16 sc1
    s_waitcnt vmcnt(0)
    v_cmp_gt_u32 vcc, 1, v254
    s_and_b32 s30, vcc_lo, s14
    s_cbranch_scc0 KB_E34V_OK
    s_sub_u32 s23, s23, 1
    s_cbranch_scc0 KB_E34V_SPIN
KB_E34V_OK:
    s_barrier
    v_mfma_f32_16x16x32_bf16 v[176:179], v[208:211], v[224:227], v[176:179]
    ds_read_b64_tr_b16 v[192:193], v250 offset:0
    s_cmp_eq_u32 s88, 0
    s_cselect_b32 s86, s92, s86
    s_cselect_b32 s77, 0x40000000, s87
    v_mfma_f32_16x16x32_bf16 v[180:183], v[212:215], v[224:227], v[180:183]
    ds_read_b128 v[224:227], v242 offset:8192
    ds_read_b64_tr_b16 v[194:195], v250 offset:512
    s_cselect_b32 s87, s93, s87
    s_cselect_b32 s88, s89, s88
    s_cselect_b32 s89, s16, s89
    v_mfma_f32_16x16x32_bf16 v[184:187], v[208:211], v[228:231], v[184:187]
    ds_read_b64_tr_b16 v[196:197], v251 offset:0
    s_cmp_eq_u32 s88, 1
    s_cselect_b32 s78, 0x40000000, s86
    v_mfma_f32_16x16x32_bf16 v[188:191], v[212:215], v[228:231], v[188:191]
    ds_read_b128 v[228:231], v242 offset:9216
    ds_read_b64_tr_b16 v[198:199], v251 offset:512
    s_add_u32 m0, s95, 0
    s_sub_u32 s88, s88, 1
    buffer_load_dwordx4 v240, s[40:43], s78 offen offset:0 sc1 lds
    v_mfma_f32_16x16x32_bf16 v[144:147], v[208:211], v[232:235], v[144:147]
    buffer_load_dwordx4 v240, s[40:43], s78 offen offset:1024 sc1 lds
    buffer_load_dwordx4 v240, s[40:43], s78 offen offset:2048 sc1 lds
    buffer_load_dwordx4 v240, s[40:43], s78 offen offset:3072 sc1 lds
    v_mfma_f32_16x16x32_bf16 v[148:151], v[212:215], v[232:235], v[148:151]
    ds_read_b128 v[232:235], v242 offset:0
    s_add_u32 m0, s95, 16384
    s_add_u32 s86, s86, 16384
    v_mfma_f32_16x16x32_bf16 v[152:155], v[208:211], v[236:239], v[152:155]
    buffer_load_dwordx4 v240, s[40:43], s77 offen offset:0 sc1 lds
    buffer_load_dwordx4 v240, s[40:43], s77 offen offset:1024 sc1 lds
    buffer_load_dwordx4 v240, s[40:43], s77 offen offset:2048 sc1 lds
    v_mfma_f32_16x16x32_bf16 v[156:159], v[212:215], v[236:239], v[156:159]
    ds_read_b128 v[236:239], v242 offset:1024
    buffer_load_dwordx4 v240, s[40:43], s77 offen offset:3072 sc1 lds
    s_add_u32 s87, s87, 16384
    s_waitcnt lgkmcnt(2)
    v_mfma_f32_16x16x32_bf16 v[160:163], v[192:195], v[224:227], v[160:163]
    ds_read_b64_tr_b16 v[208:209], v245 offset:0
    v_mfma_f32_16x16x32_bf16 v[164:167], v[196:199], v[224:227], v[164:167]
    ds_read_b64_tr_b16 v[210:211], v245 offset:512
    v_mfma_f32_16x16x32_bf16 v[168:171], v[192:195], v[228:231], v[168:171]
    ds_read_b64_tr_b16 v[212:213], v246 offset:0
    v_mfma_f32_16x16x32_bf16 v[172:175], v[196:199], v[228:231], v[172:175]
    ds_read_b64_tr_b16 v[214:215], v246 offset:512
    s_waitcnt lgkmcnt(5)
    v_mfma_f32_16x16x32_bf16 v[128:131], v[192:195], v[232:235], v[128:131]
    v_mfma_f32_16x16x32_bf16 v[132:135], v[196:199], v[232:235], v[132:135]
    s_waitcnt lgkmcnt(4)
    v_mfma_f32_16x16x32_bf16 v[136:139], v[192:195], v[236:239], v[136:139]
    v_mfma_f32_16x16x32_bf16 v[140:143], v[196:199], v[236:239], v[140:143]
    s_waitcnt vmcnt(9) lgkmcnt(0)
    s_barrier
    v_mfma_f32_16x16x32_bf16 v[176:179], v[208:211], v[224:227], v[176:179]
    ds_read_b64_tr_b16 v[192:193], v250 offset:32768
    s_lshl_b32 s78, s2, 8
    s_add_u32 s78, s78, 4112
    v_mov_b32 v253, 4
    buffer_store_dword v253, v252, s[4:7], s78 offen sc1
    v_mfma_f32_16x16x32_bf16 v[180:183], v[212:215], v[224:227], v[180:183]
    ds_read_b128 v[224:227], v242 offset:40960
    ds_read_b64_tr_b16 v[194:195], v250 offset:33280
    s_cmp_eq_u32 s88, 0
    s_cselect_b32 s86, s92, s86
    s_cselect_b32 s77, 0x40000000, s87
    v_mfma_f32_16x16x32_bf16 v[184:187], v[208:211], v[228:231], v[184:187]
    ds_read_b64_tr_b16 v[196:197], v251 offset:32768
    s_cselect_b32 s87, s93, s87
    s_cselect_b32 s88, s89, s88
    s_cselect_b32 s89, s16, s89
    v_mfma_f32_16x16x32_bf16 v[188:191], v[212:215], v[228:231], v[188:191]
    ds_read_b128 v[228:231], v242 offset:41984
    ds_read_b64_tr_b16 v[198:199], v251 offset:33280
    s_cmp_eq_u32 s88, 1
    s_cselect_b32 s78, 0x40000000, s86
    s_add_u32 m0, s95, 32768
    v_mfma_f32_16x16x32_bf16 v[144:147], v[208:211], v[232:235], v[144:147]
    s_sub_u32 s88, s88, 1
    buffer_load_dwordx4 v240, s[40:43], s78 offen offset:0 sc1 lds
    buffer_load_dwordx4 v240, s[40:43], s78 offen offset:1024 sc1 lds
    v_mfma_f32_16x16x32_bf16 v[148:151], v[212:215], v[232:235], v[148:151]
    ds_read_b128 v[232:235], v242 offset:32768
    buffer_load_dwordx4 v240, s[40:43], s78 offen offset:2048 sc1 lds
    buffer_load_dwordx4 v240, s[40:43], s78 offen offset:3072 sc1 lds
    s_add_u32 m0, s95, 49152
    v_mfma_f32_16x16x32_bf16 v[152:155], v[208:211], v[236:239], v[152:155]
    s_add_u32 s86, s86, 16384
    buffer_load_dwordx4 v240, s[40:43], s77 offen offset:0 sc1 lds
    buffer_load_dwordx4 v240, s[40:43], s77 offen offset:1024 sc1 lds
    v_mfma_f32_16x16x32_bf16 v[156:159], v[212:215], v[236:239], v[156:159]
    ds_read_b128 v[236:239], v242 offset:33792
    buffer_load_dwordx4 v240, s[40:43], s77 offen offset:2048 sc1 lds
    buffer_load_dwordx4 v240, s[40:43], s77 offen offset:3072 sc1 lds
    s_add_u32 s87, s87, 16384
    s_waitcnt lgkmcnt(2)
    v_mfma_f32_16x16x32_bf16 v[160:163], v[192:195], v[224:227], v[160:163]
    ds_read_b64_tr_b16 v[208:209], v245 offset:32768
    v_mfma_f32_16x16x32_bf16 v[164:167], v[196:199], v[224:227], v[164:167]
    ds_read_b64_tr_b16 v[210:211], v245 offset:33280
    v_mfma_f32_16x16x32_bf16 v[168:171], v[192:195], v[228:231], v[168:171]
    ds_read_b64_tr_b16 v[212:213], v246 offset:32768
    v_mfma_f32_16x16x32_bf16 v[172:175], v[196:199], v[228:231], v[172:175]
    ds_read_b64_tr_b16 v[214:215], v246 offset:33280
    s_waitcnt lgkmcnt(5)
    v_mfma_f32_16x16x32_bf16 v[128:131], v[192:195], v[232:235], v[128:131]
    v_mfma_f32_16x16x32_bf16 v[132:135], v[196:199], v[232:235], v[132:135]
    s_waitcnt lgkmcnt(4)
    v_mfma_f32_16x16x32_bf16 v[136:139], v[192:195], v[236:239], v[136:139]
    v_mfma_f32_16x16x32_bf16 v[140:143], v[196:199], v[236:239], v[140:143]
    s_waitcnt lgkmcnt(0)
    v_mfma_f32_16x16x32_bf16 v[176:179], v[208:211], v[224:227], v[176:179]
    v_mfma_f32_16x16x32_bf16 v[180:183], v[212:215], v[224:227], v[180:183]
    v_mfma_f32_16x16x32_bf16 v[184:187], v[208:211], v[228:231], v[184:187]
    v_mfma_f32_16x16x32_bf16 v[188:191], v[212:215], v[228:231], v[188:191]
    v_mfma_f32_16x16x32_bf16 v[144:147], v[208:211], v[232:235], v[144:147]
    v_mfma_f32_16x16x32_bf16 v[148:151], v[212:215], v[232:235], v[148:151]
    v_mfma_f32_16x16x32_bf16 v[152:155], v[208:211], v[236:239], v[152:155]
    v_mfma_f32_16x16x32_bf16 v[156:159], v[212:215], v[236:239], v[156:159]
    s_setprio 0
    s_add_u32 s68, s28, 62914560
    s_addc_u32 s69, s29, 0
    s_mov_b32 s70, 7454720
    s_mov_b32 s71, 0x20000
    s_load_dwordx2 s[32:33], s[0:1], 0
    s_load_dwordx2 s[36:37], s[0:1], 80
    s_nop 7
    s_waitcnt vmcnt(9)
    s_barrier
    s_cmp_eq_u32 s88, 0
    s_cselect_b32 s86, s92, s86
    s_cselect_b32 s77, 0x40000000, s87
    s_cselect_b32 s87, s93, s87
    s_cselect_b32 s88, s89, s88
    s_cselect_b32 s89, s16, s89
    s_cmp_eq_u32 s88, 1
    s_cselect_b32 s78, 0x40000000, s86
    s_add_u32 m0, s95, 65536
    s_sub_u32 s88, s88, 1
    buffer_load_dwordx4 v240, s[40:43], s78 offen offset:0 sc1 lds
    buffer_load_dwordx4 v240, s[40:43], s78 offen offset:1024 sc1 lds
    buffer_load_dwordx4 v240, s[40:43], s78 offen offset:2048 sc1 lds
    buffer_load_dwordx4 v240, s[40:43], s78 offen offset:3072 sc1 lds
    s_add_u32 m0, s95, 81920
    s_add_u32 s86, s86, 16384
    buffer_load_dwordx4 v240, s[40:43], s77 offen offset:0 sc1 lds
    buffer_load_dwordx4 v240, s[40:43], s77 offen offset:1024 sc1 lds
    buffer_load_dwordx4 v240, s[40:43], s77 offen offset:2048 sc1 lds
    buffer_load_dwordx4 v240, s[40:43], s77 offen offset:3072 sc1 lds
    s_add_u32 s87, s87, 16384
    s_lshl_b32 s12, s72, 8
    s_add_u32 s12, s12, s22
    s_add_u32 s12, s12, 4096
    v_lshlrev_b32 v254, 9, v240
    buffer_load_dword v254, v254, s[4:7], s12 offen offset:16 sc1
    v_min_f32 v243, 0x41f00000, v128
    v_min_f32 v244, 0x41f00000, v129
    v_mul_f32 v243, s97, v243
    v_mul_f32 v244, s97, v244
    v_exp_f32 v243, v243
    v_exp_f32 v244, v244
    v_add_f32 v245, 2.0, v243
    v_add_f32 v246, 2.0, v244
    v_mul_f32 v245, v245, v243
    v_mul_f32 v246, v246, v244
    v_add_f32 v247, 2.0, v245
    v_add_f32 v248, 2.0, v246
    v_rcp_f32 v247, v247
    v_rcp_f32 v248, v248
    v_mul_f32 v245, v245, v128
    v_mul_f32 v246, v246, v129
    v_mul_f32 v245, v245, v247
    v_mul_f32 v246, v246, v248
    v_cvt_pk_bf16_f32 v128, v245, v246
    v_min_f32 v243, 0x41f00000, v130
    v_min_f32 v244, 0x41f00000, v131
    v_mul_f32 v243, s97, v243
    v_mul_f32 v244, s97, v244
    v_exp_f32 v243, v243
    v_exp_f32 v244, v244
    v_add_f32 v245, 2.0, v243
    v_add_f32 v246, 2.0, v244
    v_mul_f32 v245, v245, v243
    v_mul_f32 v246, v246, v244
    v_add_f32 v247, 2.0, v245
    v_add_f32 v248, 2.0, v246
    v_rcp_f32 v247, v247
    v_rcp_f32 v248, v248
    v_mul_f32 v245, v245, v130
    v_mul_f32 v246, v246, v131
    v_mul_f32 v245, v245, v247
    v_mul_f32 v246, v246, v248
    v_cvt_pk_bf16_f32 v129, v245, v246
    s_waitcnt vmcnt(9)
    s_barrier
    s_cmp_eq_u32 s88, 0
    s_cselect_b32 s86, s92, s86
    s_cselect_b32 s77, 0x40000000, s87
    s_cselect_b32 s87, s93, s87
    s_cselect_b32 s88, s89, s88
    s_cselect_b32 s89, s16, s89
    s_cmp_eq_u32 s88, 1
    s_cselect_b32 s78, 0x40000000, s86
    s_add_u32 m0, s95, 98304
    s_sub_u32 s88, s88, 1
    buffer_load_dwordx4 v240, s[40:43], s78 offen offset:0 sc1 lds
    buffer_load_dwordx4 v240, s[40:43], s78 offen offset:1024 sc1 lds
    buffer_load_dwordx4 v240, s[40:43], s78 offen offset:2048 sc1 lds
    buffer_load_dwordx4 v240, s[40:43], s78 offen offset:3072 sc1 lds
    s_add_u32 m0, s95, 114688
    s_add_u32 s86, s86, 16384
    buffer_load_dwordx4 v240, s[40:43], s77 offen offset:0 sc1 lds
    buffer_load_dwordx4 v240, s[40:43], s77 offen offset:1024 sc1 lds
    buffer_load_dwordx4 v240, s[40:43], s77 offen offset:2048 sc1 lds
    buffer_load_dwordx4 v240, s[40:43], s77 offen offset:3072 sc1 lds
    s_add_u32 s87, s87, 16384
    s_add_u32 s78, s31, 0
    buffer_store_dwordx4 v[0:3], v240, s[40:43], s78 offen offset:0 sc1
    s_add_u32 s78, s31, 0
    buffer_store_dwordx4 v[4:7], v240, s[40:43], s78 offen offset:1024 sc1
    v_min_f32 v243, 0x41f00000, v132
    v_min_f32 v244, 0x41f00000, v133
    v_mul_f32 v243, s97, v243
    v_mul_f32 v244, s97, v244
    v_exp_f32 v243, v243
    v_exp_f32 v244, v244
    v_add_f32 v245, 2.0, v243
    v_add_f32 v246, 2.0, v244
    v_mul_f32 v245, v245, v243
    v_mul_f32 v246, v246, v244
    v_add_f32 v247, 2.0, v245
    v_add_f32 v248, 2.0, v246
    v_rcp_f32 v247, v247
    v_rcp_f32 v248, v248
    v_mul_f32 v245, v245, v132
    v_mul_f32 v246, v246, v133
    v_mul_f32 v245, v245, v247
    v_mul_f32 v246, v246, v248
    v_cvt_pk_bf16_f32 v130, v245, v246
    v_min_f32 v243, 0x41f00000, v134
    v_min_f32 v244, 0x41f00000, v135
    v_mul_f32 v243, s97, v243
    v_mul_f32 v244, s97, v244
    v_exp_f32 v243, v243
    v_exp_f32 v244, v244
    v_add_f32 v245, 2.0, v243
    v_add_f32 v246, 2.0, v244
    v_mul_f32 v245, v245, v243
    v_mul_f32 v246, v246, v244
    v_add_f32 v247, 2.0, v245
    v_add_f32 v248, 2.0, v246
    v_rcp_f32 v247, v247
    v_rcp_f32 v248, v248
    v_mul_f32 v245, v245, v134
    v_mul_f32 v246, v246, v135
    v_mul_f32 v245, v245, v247
    v_mul_f32 v246, v246, v248
    v_cvt_pk_bf16_f32 v131, v245, v246
    s_lshl_b32 s77, s74, 1
    s_lshr_b32 s78, s76, 1
    s_add_u32 s77, s77, s78
    s_mul_i32 s77, s77, 364
    s_lshl_b32 s78, s72, 2
    s_add_u32 s77, s77, s78
    s_and_b32 s78, s76, 1
    s_add_u32 s77, s77, s78
    s_add_u32 s77, s77, 256
    s_lshl_b32 s77, s77, 1
    s_lshl_b32 s77, s77, 10
    s_cmp_ge_u32 s72, 27
    s_cselect_b32 s77, 0x40000000, s77
    buffer_store_dwordx4 v[128:131], v240, s[56:59], s77 offen offset:0 sc1
    s_waitcnt vmcnt(11)
    v_cmp_gt_u32 vcc, 2, v254
    s_and_b32 s30, vcc_lo, s14
    s_cbranch_scc0 KB_E32_OK
    s_mov_b32 s23, 100000
KB_E32_SPIN:
    s_sleep 10
    s_lshl_b32 s12, s72, 8
    s_add_u32 s12, s12, s22
    s_add_u32 s12, s12, 4096
    v_lshlrev_b32 v254, 9, v240
    buffer_load_dword v254, v254, s[4:7], s12 offen offset:16 sc1
    s_waitcnt vmcnt(0)
    v_cmp_gt_u32 vcc, 2, v254
    s_and_b32 s30, vcc_lo, s14
    s_cbranch_scc0 KB_E32_OK
    s_sub_u32 s23, s23, 1
    s_cbranch_scc0 KB_E32_SPIN
KB_E32_OK:
    s_barrier
    s_cmp_eq_u32 s88, 0
    s_cselect_b32 s86, s92, s86
    s_cselect_b32 s77, 0x40000000, s87
    s_cselect_b32 s87, s93, s87
    s_cselect_b32 s88, s89, s88
    s_cselect_b32 s89, s16, s89
    s_cmp_eq_u32 s88, 1
    s_cselect_b32 s78, 0x40000000, s86
    s_add_u32 m0, s95, 0
    s_sub_u32 s88, s88, 1
    buffer_load_dwordx4 v240, s[40:43], s78 offen offset:0 sc1 lds
    buffer_load_dwordx4 v240, s[40:43], s78 offen offset:1024 sc1 lds
    buffer_load_dwordx4 v240, s[40:43], s78 offen offset:2048 sc1 lds
    buffer_load_dwordx4 v240, s[40:43], s78 offen offset:3072 sc1 lds
    s_add_u32 m0, s95, 16384
    s_add_u32 s86, s86, 16384
    buffer_load_dwordx4 v240, s[40:43], s77 offen offset:0 sc1 lds
    buffer_load_dwordx4 v240, s[40:43], s77 offen offset:1024 sc1 lds
    buffer_load_dwordx4 v240, s[40:43], s77 offen offset:2048 sc1 lds
    buffer_load_dwordx4 v240, s[40:43], s77 offen offset:3072 sc1 lds
    s_add_u32 s87, s87, 16384
    v_min_f32 v243, 0x41f00000, v136
    v_min_f32 v244, 0x41f00000, v137
    v_mul_f32 v243, s97, v243
    v_mul_f32 v244, s97, v244
    v_exp_f32 v243, v243
    v_exp_f32 v244, v244
    v_add_f32 v245, 2.0, v243
    v_add_f32 v246, 2.0, v244
    v_mul_f32 v245, v245, v243
    v_mul_f32 v246, v246, v244
    v_add_f32 v247, 2.0, v245
    v_add_f32 v248, 2.0, v246
    v_rcp_f32 v247, v247
    v_rcp_f32 v248, v248
    v_mul_f32 v245, v245, v136
    v_mul_f32 v246, v246, v137
    v_mul_f32 v245, v245, v247
    v_mul_f32 v246, v246, v248
    v_cvt_pk_bf16_f32 v136, v245, v246
    v_min_f32 v243, 0x41f00000, v138
    v_min_f32 v244, 0x41f00000, v139
    v_mul_f32 v243, s97, v243
    v_mul_f32 v244, s97, v244
    v_exp_f32 v243, v243
    v_exp_f32 v244, v244
    v_add_f32 v245, 2.0, v243
    v_add_f32 v246, 2.0, v244
    v_mul_f32 v245, v245, v243
    v_mul_f32 v246, v246, v244
    v_add_f32 v247, 2.0, v245
    v_add_f32 v248, 2.0, v246
    v_rcp_f32 v247, v247
    v_rcp_f32 v248, v248
    v_mul_f32 v245, v245, v138
    v_mul_f32 v246, v246, v139
    v_mul_f32 v245, v245, v247
    v_mul_f32 v246, v246, v248
    v_cvt_pk_bf16_f32 v137, v245, v246
    s_waitcnt vmcnt(11)
    s_barrier
    s_cmp_eq_u32 s88, 0
    s_cselect_b32 s86, s92, s86
    s_cselect_b32 s77, 0x40000000, s87
    s_cselect_b32 s87, s93, s87
    s_cselect_b32 s88, s89, s88
    s_cselect_b32 s89, s16, s89
    s_cmp_eq_u32 s88, 1
    s_cselect_b32 s78, 0x40000000, s86
    s_add_u32 m0, s95, 32768
    s_sub_u32 s88, s88, 1
    buffer_load_dwordx4 v240, s[40:43], s78 offen offset:0 sc1 lds
    buffer_load_dwordx4 v240, s[40:43], s78 offen offset:1024 sc1 lds
    buffer_load_dwordx4 v240, s[40:43], s78 offen offset:2048 sc1 lds
    buffer_load_dwordx4 v240, s[40:43], s78 offen offset:3072 sc1 lds
    s_add_u32 m0, s95, 49152
    s_add_u32 s86, s86, 16384
    buffer_load_dwordx4 v240, s[40:43], s77 offen offset:0 sc1 lds
    buffer_load_dwordx4 v240, s[40:43], s77 offen offset:1024 sc1 lds
    buffer_load_dwordx4 v240, s[40:43], s77 offen offset:2048 sc1 lds
    buffer_load_dwordx4 v240, s[40:43], s77 offen offset:3072 sc1 lds
    s_add_u32 s87, s87, 16384
    s_add_u32 s78, s31, 2048
    buffer_store_dwordx4 v[8:11], v240, s[40:43], s78 offen offset:0 sc1
    s_add_u32 s78, s31, 2048
    buffer_store_dwordx4 v[12:15], v240, s[40:43], s78 offen offset:1024 sc1
    v_min_f32 v243, 0x41f00000, v140
    v_min_f32 v244, 0x41f00000, v141
    v_mul_f32 v243, s97, v243
    v_mul_f32 v244, s97, v244
    v_exp_f32 v243, v243
    v_exp_f32 v244, v244
    v_add_f32 v245, 2.0, v243
    v_add_f32 v246, 2.0, v244
    v_mul_f32 v245, v245, v243
    v_mul_f32 v246, v246, v244
    v_add_f32 v247, 2.0, v245
    v_add_f32 v248, 2.0, v246
    v_rcp_f32 v247, v247
    v_rcp_f32 v248, v248
    v_mul_f32 v245, v245, v140
    v_mul_f32 v246, v246, v141
    v_mul_f32 v245, v245, v247
    v_mul_f32 v246, v246, v248
    v_cvt_pk_bf16_f32 v138, v245, v246
    v_min_f32 v243, 0x41f00000, v142
    v_min_f32 v244, 0x41f00000, v143
    v_mul_f32 v243, s97, v243
    v_mul_f32 v244, s97, v244
    v_exp_f32 v243, v243
    v_exp_f32 v244, v244
    v_add_f32 v245, 2.0, v243
    v_add_f32 v246, 2.0, v244
    v_mul_f32 v245, v245, v243
    v_mul_f32 v246, v246, v244
    v_add_f32 v247, 2.0, v245
    v_add_f32 v248, 2.0, v246
    v_rcp_f32 v247, v247
    v_rcp_f32 v248, v248
    v_mul_f32 v245, v245, v142
    v_mul_f32 v246, v246, v143
    v_mul_f32 v245, v245, v247
    v_mul_f32 v246, v246, v248
    v_cvt_pk_bf16_f32 v139, v245, v246
    s_lshl_b32 s77, s74, 1
    s_lshr_b32 s78, s76, 1
    s_add_u32 s77, s77, s78
    s_mul_i32 s77, s77, 364
    s_lshl_b32 s78, s72, 2
    s_add_u32 s77, s77, s78
    s_and_b32 s78, s76, 1
    s_add_u32 s77, s77, s78
    s_add_u32 s77, s77, 256
    s_lshl_b32 s77, s77, 1
    s_lshl_b32 s77, s77, 10
    s_cmp_ge_u32 s72, 27
    s_cselect_b32 s77, 0x40000000, s77
    buffer_store_dwordx4 v[136:139], v240, s[56:59], s77 offen offset:1024 sc1
    s_waitcnt vmcnt(11)
    s_barrier
    s_cmp_eq_u32 s88, 0
    s_cselect_b32 s86, s92, s86
    s_cselect_b32 s77, 0x40000000, s87
    s_cselect_b32 s87, s93, s87
    s_cselect_b32 s88, s89, s88
    s_cselect_b32 s89, s16, s89
    s_cmp_eq_u32 s88, 1
    s_cselect_b32 s78, 0x40000000, s86
    s_add_u32 m0, s95, 65536
    s_sub_u32 s88, s88, 1
    buffer_load_dwordx4 v240, s[40:43], s78 offen offset:0 sc1 lds
    buffer_load_dwordx4 v240, s[40:43], s78 offen offset:1024 sc1 lds
    buffer_load_dwordx4 v240, s[40:43], s78 offen offset:2048 sc1 lds
    buffer_load_dwordx4 v240, s[40:43], s78 offen offset:3072 sc1 lds
    s_add_u32 m0, s95, 81920
    s_add_u32 s86, s86, 16384
    buffer_load_dwordx4 v240, s[40:43], s77 offen offset:0 sc1 lds
    buffer_load_dwordx4 v240, s[40:43], s77 offen offset:1024 sc1 lds
    buffer_load_dwordx4 v240, s[40:43], s77 offen offset:2048 sc1 lds
    buffer_load_dwordx4 v240, s[40:43], s77 offen offset:3072 sc1 lds
    s_add_u32 s87, s87, 16384
    s_lshl_b32 s12, s72, 8
    s_add_u32 s12, s12, s22
    s_add_u32 s12, s12, 4096
    v_lshlrev_b32 v254, 9, v240
    buffer_load_dword v254, v254, s[4:7], s12 offen offset:16 sc1
    v_min_f32 v243, 0x41f00000, v144
    v_min_f32 v244, 0x41f00000, v145
    v_mul_f32 v243, s97, v243
    v_mul_f32 v244, s97, v244
    v_exp_f32 v243, v243
    v_exp_f32 v244, v244
    v_add_f32 v245, 2.0, v243
    v_add_f32 v246, 2.0, v244
    v_mul_f32 v245, v245, v243
    v_mul_f32 v246, v246, v244
    v_add_f32 v247, 2.0, v245
    v_add_f32 v248, 2.0, v246
    v_rcp_f32 v247, v247
    v_rcp_f32 v248, v248
    v_mul_f32 v245, v245, v144
    v_mul_f32 v246, v246, v145
    v_mul_f32 v245, v245, v247
    v_mul_f32 v246, v246, v248
    v_cvt_pk_bf16_f32 v144, v245, v246
    v_min_f32 v243, 0x41f00000, v146
    v_min_f32 v244, 0x41f00000, v147
    v_mul_f32 v243, s97, v243
    v_mul_f32 v244, s97, v244
    v_exp_f32 v243, v243
    v_exp_f32 v244, v244
    v_add_f32 v245, 2.0, v243
    v_add_f32 v246, 2.0, v244
    v_mul_f32 v245, v245, v243
    v_mul_f32 v246, v246, v244
    v_add_f32 v247, 2.0, v245
    v_add_f32 v248, 2.0, v246
    v_rcp_f32 v247, v247
    v_rcp_f32 v248, v248
    v_mul_f32 v245, v245, v146
    v_mul_f32 v246, v246, v147
    v_mul_f32 v245, v245, v247
    v_mul_f32 v246, v246, v248
    v_cvt_pk_bf16_f32 v145, v245, v246
    s_waitcnt vmcnt(12)
    s_barrier
    s_cmp_eq_u32 s88, 0
    s_cselect_b32 s86, s92, s86
    s_cselect_b32 s77, 0x40000000, s87
    s_cselect_b32 s87, s93, s87
    s_cselect_b32 s88, s89, s88
    s_cselect_b32 s89, s16, s89
    s_cmp_eq_u32 s88, 1
    s_cselect_b32 s78, 0x40000000, s86
    s_add_u32 m0, s95, 98304
    s_sub_u32 s88, s88, 1
    buffer_load_dwordx4 v240, s[40:43], s78 offen offset:0 sc1 lds
    buffer_load_dwordx4 v240, s[40:43], s78 offen offset:1024 sc1 lds
    buffer_load_dwordx4 v240, s[40:43], s78 offen offset:2048 sc1 lds
    buffer_load_dwordx4 v240, s[40:43], s78 offen offset:3072 sc1 lds
    s_add_u32 m0, s95, 114688
    s_add_u32 s86, s86, 16384
    buffer_load_dwordx4 v240, s[40:43], s77 offen offset:0 sc1 lds
    buffer_load_dwordx4 v240, s[40:43], s77 offen offset:1024 sc1 lds
    buffer_load_dwordx4 v240, s[40:43], s77 offen offset:2048 sc1 lds
    buffer_load_dwordx4 v240, s[40:43], s77 offen offset:3072 sc1 lds
    s_add_u32 s87, s87, 16384
    s_add_u32 s78, s31, 65536
    buffer_store_dwordx4 v[16:19], v240, s[40:43], s78 offen offset:0 sc1
    s_add_u32 s78, s31, 65536
    buffer_store_dwordx4 v[20:23], v240, s[40:43], s78 offen offset:1024 sc1
    v_min_f32 v243, 0x41f00000, v148
    v_min_f32 v244, 0x41f00000, v149
    v_mul_f32 v243, s97, v243
    v_mul_f32 v244, s97, v244
    v_exp_f32 v243, v243
    v_exp_f32 v244, v244
    v_add_f32 v245, 2.0, v243
    v_add_f32 v246, 2.0, v244
    v_mul_f32 v245, v245, v243
    v_mul_f32 v246, v246, v244
    v_add_f32 v247, 2.0, v245
    v_add_f32 v248, 2.0, v246
    v_rcp_f32 v247, v247
    v_rcp_f32 v248, v248
    v_mul_f32 v245, v245, v148
    v_mul_f32 v246, v246, v149
    v_mul_f32 v245, v245, v247
    v_mul_f32 v246, v246, v248
    v_cvt_pk_bf16_f32 v146, v245, v246
    v_min_f32 v243, 0x41f00000, v150
    v_min_f32 v244, 0x41f00000, v151
    v_mul_f32 v243, s97, v243
    v_mul_f32 v244, s97, v244
    v_exp_f32 v243, v243
    v_exp_f32 v244, v244
    v_add_f32 v245, 2.0, v243
    v_add_f32 v246, 2.0, v244
    v_mul_f32 v245, v245, v243
    v_mul_f32 v246, v246, v244
    v_add_f32 v247, 2.0, v245
    v_add_f32 v248, 2.0, v246
    v_rcp_f32 v247, v247
    v_rcp_f32 v248, v248
    v_mul_f32 v245, v245, v150
    v_mul_f32 v246, v246, v151
    v_mul_f32 v245, v245, v247
    v_mul_f32 v246, v246, v248
    v_cvt_pk_bf16_f32 v147, v245, v246
    s_lshl_b32 s77, s74, 1
    s_lshr_b32 s78, s76, 1
    s_add_u32 s77, s77, s78
    s_mul_i32 s77, s77, 364
    s_lshl_b32 s78, s72, 2
    s_add_u32 s77, s77, s78
    s_and_b32 s78, s76, 1
    s_add_u32 s77, s77, s78
    s_add_u32 s77, s77, 258
    s_lshl_b32 s77, s77, 1
    s_lshl_b32 s77, s77, 10
    s_cmp_ge_u32 s72, 27
    s_cselect_b32 s77, 0x40000000, s77
    buffer_store_dwordx4 v[144:147], v240, s[56:59], s77 offen offset:0 sc1
    s_waitcnt vmcnt(11)
    v_cmp_gt_u32 vcc, 3, v254
    s_and_b32 s30, vcc_lo, s14
    s_cbranch_scc0 KB_E36_OK
    s_mov_b32 s23, 100000
KB_E36_SPIN:
    s_sleep 10
    s_lshl_b32 s12, s72, 8
    s_add_u32 s12, s12, s22
    s_add_u32 s12, s12, 4096
    v_lshlrev_b32 v254, 9, v240
    buffer_load_dword v254, v254, s[4:7], s12 offen offset:16 sc1
    s_waitcnt vmcnt(0)
    v_cmp_gt_u32 vcc, 3, v254
    s_and_b32 s30, vcc_lo, s14
    s_cbranch_scc0 KB_E36_OK
    s_sub_u32 s23, s23, 1
    s_cbranch_scc0 KB_E36_SPIN
KB_E36_OK:
    s_barrier
    s_cmp_eq_u32 s88, 0
    s_cselect_b32 s86, s92, s86
    s_cselect_b32 s77, 0x40000000, s87
    s_cselect_b32 s87, s93, s87
    s_cselect_b32 s88, s89, s88
    s_cselect_b32 s89, s16, s89
    s_cmp_eq_u32 s88, 1
    s_cselect_b32 s78, 0x40000000, s86
    s_add_u32 m0, s95, 0
    s_sub_u32 s88, s88, 1
    buffer_load_dwordx4 v240, s[40:43], s78 offen offset:0 sc1 lds
    buffer_load_dwordx4 v240, s[40:43], s78 offen offset:1024 sc1 lds
    buffer_load_dwordx4 v240, s[40:43], s78 offen offset:2048 sc1 lds
    buffer_load_dwordx4 v240, s[40:43], s78 offen offset:3072 sc1 lds
    s_add_u32 m0, s95, 16384
    s_add_u32 s86, s86, 16384
    buffer_load_dwordx4 v240, s[40:43], s77 offen offset:0 sc1 lds
    buffer_load_dwordx4 v240, s[40:43], s77 offen offset:1024 sc1 lds
    buffer_load_dwordx4 v240, s[40:43], s77 offen offset:2048 sc1 lds
    buffer_load_dwordx4 v240, s[40:43], s77 offen offset:3072 sc1 lds
    s_add_u32 s87, s87, 16384
    v_min_f32 v243, 0x41f00000, v152
    v_min_f32 v244, 0x41f00000, v153
    v_mul_f32 v243, s97, v243
    v_mul_f32 v244, s97, v244
    v_exp_f32 v243, v243
    v_exp_f32 v244, v244
    v_add_f32 v245, 2.0, v243
    v_add_f32 v246, 2.0, v244
    v_mul_f32 v245, v245, v243
    v_mul_f32 v246, v246, v244
    v_add_f32 v247, 2.0, v245
    v_add_f32 v248, 2.0, v246
    v_rcp_f32 v247, v247
    v_rcp_f32 v248, v248
    v_mul_f32 v245, v245, v152
    v_mul_f32 v246, v246, v153
    v_mul_f32 v245, v245, v247
    v_mul_f32 v246, v246, v248
    v_cvt_pk_bf16_f32 v152, v245, v246
    v_min_f32 v243, 0x41f00000, v154
    v_min_f32 v244, 0x41f00000, v155
    v_mul_f32 v243, s97, v243
    v_mul_f32 v244, s97, v244
    v_exp_f32 v243, v243
    v_exp_f32 v244, v244
    v_add_f32 v245, 2.0, v243
    v_add_f32 v246, 2.0, v244
    v_mul_f32 v245, v245, v243
    v_mul_f32 v246, v246, v244
    v_add_f32 v247, 2.0, v245
    v_add_f32 v248, 2.0, v246
    v_rcp_f32 v247, v247
    v_rcp_f32 v248, v248
    v_mul_f32 v245, v245, v154
    v_mul_f32 v246, v246, v155
    v_mul_f32 v245, v245, v247
    v_mul_f32 v246, v246, v248
    v_cvt_pk_bf16_f32 v153, v245, v246
    s_waitcnt vmcnt(11)
    s_barrier
    s_cmp_eq_u32 s88, 0
    s_cselect_b32 s86, s92, s86
    s_cselect_b32 s77, 0x40000000, s87
    s_cselect_b32 s87, s93, s87
    s_cselect_b32 s88, s89, s88
    s_cselect_b32 s89, s16, s89
    s_cmp_eq_u32 s88, 1
    s_cselect_b32 s78, 0x40000000, s86
    s_add_u32 m0, s95, 32768
    s_sub_u32 s88, s88, 1
    buffer_load_dwordx4 v240, s[40:43], s78 offen offset:0 sc1 lds
    buffer_load_dwordx4 v240, s[40:43], s78 offen offset:1024 sc1 lds
    buffer_load_dwordx4 v240, s[40:43], s78 offen offset:2048 sc1 lds
    buffer_load_dwordx4 v240, s[40:43], s78 offen offset:3072 sc1 lds
    s_add_u32 m0, s95, 49152
    s_add_u32 s86, s86, 16384
    buffer_load_dwordx4 v240, s[40:43], s77 offen offset:0 sc1 lds
    buffer_load_dwordx4 v240, s[40:43], s77 offen offset:1024 sc1 lds
    buffer_load_dwordx4 v240, s[40:43], s77 offen offset:2048 sc1 lds
    buffer_load_dwordx4 v240, s[40:43], s77 offen offset:3072 sc1 lds
    s_add_u32 s87, s87, 16384
    s_lshl_b32 s78, s2, 8
    s_add_u32 s78, s78, 4112
    v_mov_b32 v253, 5
    buffer_store_dword v253, v252, s[4:7], s78 offen sc1
    s_add_u32 s78, s31, 67584
    buffer_store_dwordx4 v[24:27], v240, s[40:43], s78 offen offset:0 sc1
    s_add_u32 s78, s31, 67584
    buffer_store_dwordx4 v[28:31], v240, s[40:43], s78 offen offset:1024 sc1
    v_min_f32 v243, 0x41f00000, v156
    v_min_f32 v244, 0x41f00000, v157
    v_mul_f32 v243, s97, v243
    v_mul_f32 v244, s97, v244
    v_exp_f32 v243, v243
    v_exp_f32 v244, v244
    v_add_f32 v245, 2.0, v243
    v_add_f32 v246, 2.0, v244
    v_mul_f32 v245, v245, v243
    v_mul_f32 v246, v246, v244
    v_add_f32 v247, 2.0, v245
    v_add_f32 v248, 2.0, v246
    v_rcp_f32 v247, v247
    v_rcp_f32 v248, v248
    v_mul_f32 v245, v245, v156
    v_mul_f32 v246, v246, v157
    v_mul_f32 v245, v245, v247
    v_mul_f32 v246, v246, v248
    v_cvt_pk_bf16_f32 v154, v245, v246
    v_min_f32 v243, 0x41f00000, v158
    v_min_f32 v244, 0x41f00000, v159
    v_mul_f32 v243, s97, v243
    v_mul_f32 v244, s97, v244
    v_exp_f32 v243, v243
    v_exp_f32 v244, v244
    v_add_f32 v245, 2.0, v243
    v_add_f32 v246, 2.0, v244
    v_mul_f32 v245, v245, v243
    v_mul_f32 v246, v246, v244
    v_add_f32 v247, 2.0, v245
    v_add_f32 v248, 2.0, v246
    v_rcp_f32 v247, v247
    v_rcp_f32 v248, v248
    v_mul_f32 v245, v245, v158
    v_mul_f32 v246, v246, v159
    v_mul_f32 v245, v245, v247
    v_mul_f32 v246, v246, v248
    v_cvt_pk_bf16_f32 v155, v245, v246
    s_lshl_b32 s77, s74, 1
    s_lshr_b32 s78, s76, 1
    s_add_u32 s77, s77, s78
    s_mul_i32 s77, s77, 364
    s_lshl_b32 s78, s72, 2
    s_add_u32 s77, s77, s78
    s_and_b32 s78, s76, 1
    s_add_u32 s77, s77, s78
    s_add_u32 s77, s77, 258
    s_lshl_b32 s77, s77, 1
    s_lshl_b32 s77, s77, 10
    s_cmp_ge_u32 s72, 27
    s_cselect_b32 s77, 0x40000000, s77
    buffer_store_dwordx4 v[152:155], v240, s[56:59], s77 offen offset:1024 sc1
    s_waitcnt vmcnt(12)
    s_barrier
    s_cmp_eq_u32 s88, 0
    s_cselect_b32 s86, s92, s86
    s_cselect_b32 s77, 0x40000000, s87
    s_cselect_b32 s87, s93, s87
    s_cselect_b32 s88, s89, s88
    s_cselect_b32 s89, s16, s89
    s_cmp_eq_u32 s88, 1
    s_cselect_b32 s78, 0x40000000, s86
    s_add_u32 m0, s95, 65536
    s_sub_u32 s88, s88, 1
    buffer_load_dwordx4 v240, s[40:43], s78 offen offset:0 sc1 lds
    buffer_load_dwordx4 v240, s[40:43], s78 offen offset:1024 sc1 lds
    buffer_load_dwordx4 v240, s[40:43], s78 offen offset:2048 sc1 lds
    buffer_load_dwordx4 v240, s[40:43], s78 offen offset:3072 sc1 lds
    s_add_u32 m0, s95, 81920
    s_add_u32 s86, s86, 16384
    buffer_load_dwordx4 v240, s[40:43], s77 offen offset:0 sc1 lds
    buffer_load_dwordx4 v240, s[40:43], s77 offen offset:1024 sc1 lds
    buffer_load_dwordx4 v240, s[40:43], s77 offen offset:2048 sc1 lds
    buffer_load_dwordx4 v240, s[40:43], s77 offen offset:3072 sc1 lds
    s_add_u32 s87, s87, 16384
    s_lshl_b32 s12, s72, 8
    s_add_u32 s12, s12, s22
    s_add_u32 s12, s12, 4096
    v_lshlrev_b32 v254, 9, v240
    buffer_load_dword v254, v254, s[4:7], s12 offen offset:16 sc1
    v_min_f32 v243, 0x41f00000, v160
    v_min_f32 v244, 0x41f00000, v161
    v_mul_f32 v243, s97, v243
    v_mul_f32 v244, s97, v244
    v_exp_f32 v243, v243
    v_exp_f32 v244, v244
    v_add_f32 v245, 2.0, v243
    v_add_f32 v246, 2.0, v244
    v_mul_f32 v245, v245, v243
    v_mul_f32 v246, v246, v244
    v_add_f32 v247, 2.0, v245
    v_add_f32 v248, 2.0, v246
    v_rcp_f32 v247, v247
    v_rcp_f32 v248, v248
    v_mul_f32 v245, v245, v160
    v_mul_f32 v246, v246, v161
    v_mul_f32 v245, v245, v247
    v_mul_f32 v246, v246, v248
    v_cvt_pk_bf16_f32 v160, v245, v246
    v_min_f32 v243, 0x41f00000, v162
    v_min_f32 v244, 0x41f00000, v163
    v_mul_f32 v243, s97, v243
    v_mul_f32 v244, s97, v244
    v_exp_f32 v243, v243
    v_exp_f32 v244, v244
    v_add_f32 v245, 2.0, v243
    v_add_f32 v246, 2.0, v244
    v_mul_f32 v245, v245, v243
    v_mul_f32 v246, v246, v244
    v_add_f32 v247, 2.0, v245
    v_add_f32 v248, 2.0, v246
    v_rcp_f32 v247, v247
    v_rcp_f32 v248, v248
    v_mul_f32 v245, v245, v162
    v_mul_f32 v246, v246, v163
    v_mul_f32 v245, v245, v247
    v_mul_f32 v246, v246, v248
    v_cvt_pk_bf16_f32 v161, v245, v246
    s_waitcnt vmcnt(13)
    s_barrier
    s_cmp_eq_u32 s88, 0
    s_cselect_b32 s86, s92, s86
    s_cselect_b32 s77, 0x40000000, s87
    s_cselect_b32 s87, s93, s87
    s_cselect_b32 s88, s89, s88
    s_cselect_b32 s89, s16, s89
    s_cmp_eq_u32 s88, 1
    s_cselect_b32 s78, 0x40000000, s86
    s_add_u32 m0, s95, 98304
    s_sub_u32 s88, s88, 1
    buffer_load_dwordx4 v240, s[40:43], s78 offen offset:0 sc1 lds
    buffer_load_dwordx4 v240, s[40:43], s78 offen offset:1024 sc1 lds
    buffer_load_dwordx4 v240, s[40:43], s78 offen offset:2048 sc1 lds
    buffer_load_dwordx4 v240, s[40:43], s78 offen offset:3072 sc1 lds
    s_add_u32 m0, s95, 114688
    s_add_u32 s86, s86, 16384
    buffer_load_dwordx4 v240, s[40:43], s77 offen offset:0 sc1 lds
    buffer_load_dwordx4 v240, s[40:43], s77 offen offset:1024 sc1 lds
    buffer_load_dwordx4 v240, s[40:43], s77 offen offset:2048 sc1 lds
    buffer_load_dwordx4 v240, s[40:43], s77 offen offset:3072 sc1 lds
    s_add_u32 s87, s87, 16384
    s_add_u32 s78, s31, 131072
    buffer_store_dwordx4 v[32:35], v240, s[40:43], s78 offen offset:0 sc1
    s_add_u32 s78, s31, 131072
    buffer_store_dwordx4 v[36:39], v240, s[40:43], s78 offen offset:1024 sc1
    v_min_f32 v243, 0x41f00000, v164
    v_min_f32 v244, 0x41f00000, v165
    v_mul_f32 v243, s97, v243
    v_mul_f32 v244, s97, v244
    v_exp_f32 v243, v243
    v_exp_f32 v244, v244
    v_add_f32 v245, 2.0, v243
    v_add_f32 v246, 2.0, v244
    v_mul_f32 v245, v245, v243
    v_mul_f32 v246, v246, v244
    v_add_f32 v247, 2.0, v245
    v_add_f32 v248, 2.0, v246
    v_rcp_f32 v247, v247
    v_rcp_f32 v248, v248
    v_mul_f32 v245, v245, v164
    v_mul_f32 v246, v246, v165
    v_mul_f32 v245, v245, v247
    v_mul_f32 v246, v246, v248
    v_cvt_pk_bf16_f32 v162, v245, v246
    v_min_f32 v243, 0x41f00000, v166
    v_min_f32 v244, 0x41f00000, v167
    v_mul_f32 v243, s97, v243
    v_mul_f32 v244, s97, v244
    v_exp_f32 v243, v243
    v_exp_f32 v244, v244
    v_add_f32 v245, 2.0, v243
    v_add_f32 v246, 2.0, v244
    v_mul_f32 v245, v245, v243
    v_mul_f32 v246, v246, v244
    v_add_f32 v247, 2.0, v245
    v_add_f32 v248, 2.0, v246
    v_rcp_f32 v247, v247
    v_rcp_f32 v248, v248
    v_mul_f32 v245, v245, v166
    v_mul_f32 v246, v246, v167
    v_mul_f32 v245, v245, v247
    v_mul_f32 v246, v246, v248
    v_cvt_pk_bf16_f32 v163, v245, v246
    s_lshl_b32 s77, s75, 1
    s_lshr_b32 s78, s76, 1
    s_add_u32 s77, s77, s78
    s_mul_i32 s77, s77, 364
    s_lshl_b32 s78, s72, 2
    s_add_u32 s77, s77, s78
    s_and_b32 s78, s76, 1
    s_add_u32 s77, s77, s78
    s_add_u32 s77, s77, 256
    s_lshl_b32 s77, s77, 1
    s_lshl_b32 s77, s77, 10
    s_cmp_ge_u32 s72, 27
    s_cselect_b32 s77, 0x40000000, s77
    buffer_store_dwordx4 v[160:163], v240, s[56:59], s77 offen offset:0 sc1
    s_waitcnt vmcnt(11)
    v_cmp_gt_u32 vcc, 4, v254
    s_and_b32 s30, vcc_lo, s14
    s_cbranch_scc0 KB_E310_OK
    s_mov_b32 s23, 100000
KB_E310_SPIN:
    s_sleep 10
    s_lshl_b32 s12, s72, 8
    s_add_u32 s12, s12, s22
    s_add_u32 s12, s12, 4096
    v_lshlrev_b32 v254, 9, v240
    buffer_load_dword v254, v254, s[4:7], s12 offen offset:16 sc1
    s_waitcnt vmcnt(0)
    v_cmp_gt_u32 vcc, 4, v254
    s_and_b32 s30, vcc_lo, s14
    s_cbranch_scc0 KB_E310_OK
    s_sub_u32 s23, s23, 1
    s_cbranch_scc0 KB_E310_SPIN
KB_E310_OK:
    s_barrier
    s_cmp_eq_u32 s88, 0
    s_cselect_b32 s86, s92, s86
    s_cselect_b32 s77, 0x40000000, s87
    s_cselect_b32 s87, s93, s87
    s_cselect_b32 s88, s89, s88
    s_cselect_b32 s89, s16, s89
    s_cmp_eq_u32 s88, 1
    s_cselect_b32 s78, 0x40000000, s86
    s_add_u32 m0, s95, 0
    s_sub_u32 s88, s88, 1
    buffer_load_dwordx4 v240, s[40:43], s78 offen offset:0 sc1 lds
    buffer_load_dwordx4 v240, s[40:43], s78 offen offset:1024 sc1 lds
    buffer_load_dwordx4 v240, s[40:43], s78 offen offset:2048 sc1 lds
    buffer_load_dwordx4 v240, s[40:43], s78 offen offset:3072 sc1 lds
    s_add_u32 m0, s95, 16384
    s_add_u32 s86, s86, 16384
    buffer_load_dwordx4 v240, s[40:43], s77 offen offset:0 sc1 lds
    buffer_load_dwordx4 v240, s[40:43], s77 offen offset:1024 sc1 lds
    buffer_load_dwordx4 v240, s[40:43], s77 offen offset:2048 sc1 lds
    buffer_load_dwordx4 v240, s[40:43], s77 offen offset:3072 sc1 lds
    s_add_u32 s87, s87, 16384
    v_min_f32 v243, 0x41f00000, v168
    v_min_f32 v244, 0x41f00000, v169
    v_mul_f32 v243, s97, v243
    v_mul_f32 v244, s97, v244
    v_exp_f32 v243, v243
    v_exp_f32 v244, v244
    v_add_f32 v245, 2.0, v243
    v_add_f32 v246, 2.0, v244
    v_mul_f32 v245, v245, v243
    v_mul_f32 v246, v246, v244
    v_add_f32 v247, 2.0, v245
    v_add_f32 v248, 2.0, v246
    v_rcp_f32 v247, v247
    v_rcp_f32 v248, v248
    v_mul_f32 v245, v245, v168
    v_mul_f32 v246, v246, v169
    v_mul_f32 v245, v245, v247
    v_mul_f32 v246, v246, v248
    v_cvt_pk_bf16_f32 v168, v245, v246
    v_min_f32 v243, 0x41f00000, v170
    v_min_f32 v244, 0x41f00000, v171
    v_mul_f32 v243, s97, v243
    v_mul_f32 v244, s97, v244
    v_exp_f32 v243, v243
    v_exp_f32 v244, v244
    v_add_f32 v245, 2.0, v243
    v_add_f32 v246, 2.0, v244
    v_mul_f32 v245, v245, v243
    v_mul_f32 v246, v246, v244
    v_add_f32 v247, 2.0, v245
    v_add_f32 v248, 2.0, v246
    v_rcp_f32 v247, v247
    v_rcp_f32 v248, v248
    v_mul_f32 v245, v245, v170
    v_mul_f32 v246, v246, v171
    v_mul_f32 v245, v245, v247
    v_mul_f32 v246, v246, v248
    v_cvt_pk_bf16_f32 v169, v245, v246
    s_waitcnt vmcnt(11)
    s_barrier
    s_cmp_eq_u32 s88, 0
    s_cselect_b32 s86, s92, s86
    s_cselect_b32 s77, 0x40000000, s87
    s_cselect_b32 s87, s93, s87
    s_cselect_b32 s88, s89, s88
    s_cselect_b32 s89, s16, s89
    s_cmp_eq_u32 s88, 1
    s_cselect_b32 s78, 0x40000000, s86
    s_add_u32 m0, s95, 32768
    s_sub_u32 s88, s88, 1
    buffer_load_dwordx4 v240, s[40:43], s78 offen offset:0 sc1 lds
    buffer_load_dwordx4 v240, s[40:43], s78 offen offset:1024 sc1 lds
    buffer_load_dwordx4 v240, s[40:43], s78 offen offset:2048 sc1 lds
    buffer_load_dwordx4 v240, s[40:43], s78 offen offset:3072 sc1 lds
    s_add_u32 m0, s95, 49152
    s_add_u32 s86, s86, 16384
    buffer_load_dwordx4 v240, s[40:43], s77 offen offset:0 sc1 lds
    buffer_load_dwordx4 v240, s[40:43], s77 offen offset:1024 sc1 lds
    buffer_load_dwordx4 v240, s[40:43], s77 offen offset:2048 sc1 lds
    buffer_load_dwordx4 v240, s[40:43], s77 offen offset:3072 sc1 lds
    s_add_u32 s87, s87, 16384
    s_lshl_b32 s78, s2, 8
    s_add_u32 s78, s78, 4112
    v_mov_b32 v253, 6
    buffer_store_dword v253, v252, s[4:7], s78 offen sc1
    s_add_u32 s78, s31, 133120
    buffer_store_dwordx4 v[40:43], v240, s[40:43], s78 offen offset:0 sc1
    s_add_u32 s78, s31, 133120
    buffer_store_dwordx4 v[44:47], v240, s[40:43], s78 offen offset:1024 sc1
    v_min_f32 v243, 0x41f00000, v172
    v_min_f32 v244, 0x41f00000, v173
    v_mul_f32 v243, s97, v243
    v_mul_f32 v244, s97, v244
    v_exp_f32 v243, v243
    v_exp_f32 v244, v244
    v_add_f32 v245, 2.0, v243
    v_add_f32 v246, 2.0, v244
    v_mul_f32 v245, v245, v243
    v_mul_f32 v246, v246, v244
    v_add_f32 v247, 2.0, v245
    v_add_f32 v248, 2.0, v246
    v_rcp_f32 v247, v247
    v_rcp_f32 v248, v248
    v_mul_f32 v245, v245, v172
    v_mul_f32 v246, v246, v173
    v_mul_f32 v245, v245, v247
    v_mul_f32 v246, v246, v248
    v_cvt_pk_bf16_f32 v170, v245, v246
    v_min_f32 v243, 0x41f00000, v174
    v_min_f32 v244, 0x41f00000, v175
    v_mul_f32 v243, s97, v243
    v_mul_f32 v244, s97, v244
    v_exp_f32 v243, v243
    v_exp_f32 v244, v244
    v_add_f32 v245, 2.0, v243
    v_add_f32 v246, 2.0, v244
    v_mul_f32 v245, v245, v243
    v_mul_f32 v246, v246, v244
    v_add_f32 v247, 2.0, v245
    v_add_f32 v248, 2.0, v246
    v_rcp_f32 v247, v247
    v_rcp_f32 v248, v248
    v_mul_f32 v245, v245, v174
    v_mul_f32 v246, v246, v175
    v_mul_f32 v245, v245, v247
    v_mul_f32 v246, v246, v248
    v_cvt_pk_bf16_f32 v171, v245, v246
    s_lshl_b32 s77, s75, 1
    s_lshr_b32 s78, s76, 1
    s_add_u32 s77, s77, s78
    s_mul_i32 s77, s77, 364
    s_lshl_b32 s78, s72, 2
    s_add_u32 s77, s77, s78
    s_and_b32 s78, s76, 1
    s_add_u32 s77, s77, s78
    s_add_u32 s77, s77, 256
    s_lshl_b32 s77, s77, 1
    s_lshl_b32 s77, s77, 10
    s_cmp_ge_u32 s72, 27
    s_cselect_b32 s77, 0x40000000, s77
    buffer_store_dwordx4 v[168:171], v240, s[56:59], s77 offen offset:1024 sc1
    s_waitcnt vmcnt(12)
    s_barrier
    s_cmp_eq_u32 s88, 0
    s_cselect_b32 s86, s92, s86
    s_cselect_b32 s77, 0x40000000, s87
    s_cselect_b32 s87, s93, s87
    s_cselect_b32 s88, s89, s88
    s_cselect_b32 s89, s16, s89
    s_cmp_eq_u32 s88, 1
    s_cselect_b32 s78, 0x40000000, s86
    s_add_u32 m0, s95, 65536
    s_sub_u32 s88, s88, 1
    buffer_load_dwordx4 v240, s[40:43], s78 offen offset:0 sc1 lds
    buffer_load_dwordx4 v240, s[40:43], s78 offen offset:1024 sc1 lds
    buffer_load_dwordx4 v240, s[40:43], s78 offen offset:2048 sc1 lds
    buffer_load_dwordx4 v240, s[40:43], s78 offen offset:3072 sc1 lds
    s_add_u32 m0, s95, 81920
    s_add_u32 s86, s86, 16384
    buffer_load_dwordx4 v240, s[40:43], s77 offen offset:0 sc1 lds
    buffer_load_dwordx4 v240, s[40:43], s77 offen offset:1024 sc1 lds
    buffer_load_dwordx4 v240, s[40:43], s77 offen offset:2048 sc1 lds
    buffer_load_dwordx4 v240, s[40:43], s77 offen offset:3072 sc1 lds
    s_add_u32 s87, s87, 16384
    v_min_f32 v243, 0x41f00000, v176
    v_min_f32 v244, 0x41f00000, v177
    v_mul_f32 v243, s97, v243
    v_mul_f32 v244, s97, v244
    v_exp_f32 v243, v243
    v_exp_f32 v244, v244
    v_add_f32 v245, 2.0, v243
    v_add_f32 v246, 2.0, v244
    v_mul_f32 v245, v245, v243
    v_mul_f32 v246, v246, v244
    v_add_f32 v247, 2.0, v245
    v_add_f32 v248, 2.0, v246
    v_rcp_f32 v247, v247
    v_rcp_f32 v248, v248
    v_mul_f32 v245, v245, v176
    v_mul_f32 v246, v246, v177
    v_mul_f32 v245, v245, v247
    v_mul_f32 v246, v246, v248
    v_cvt_pk_bf16_f32 v176, v245, v246
    v_min_f32 v243, 0x41f00000, v178
    v_min_f32 v244, 0x41f00000, v179
    v_mul_f32 v243, s97, v243
    v_mul_f32 v244, s97, v244
    v_exp_f32 v243, v243
    v_exp_f32 v244, v244
    v_add_f32 v245, 2.0, v243
    v_add_f32 v246, 2.0, v244
    v_mul_f32 v245, v245, v243
    v_mul_f32 v246, v246, v244
    v_add_f32 v247, 2.0, v245
    v_add_f32 v248, 2.0, v246
    v_rcp_f32 v247, v247
    v_rcp_f32 v248, v248
    v_mul_f32 v245, v245, v178
    v_mul_f32 v246, v246, v179
    v_mul_f32 v245, v245, v247
    v_mul_f32 v246, v246, v248
    v_cvt_pk_bf16_f32 v177, v245, v246
    s_waitcnt vmcnt(12)
    s_barrier
    s_cmp_eq_u32 s88, 0
    s_cselect_b32 s86, s92, s86
    s_cselect_b32 s77, 0x40000000, s87
    s_cselect_b32 s87, s93, s87
    s_cselect_b32 s88, s89, s88
    s_cselect_b32 s89, s16, s89
    s_cmp_eq_u32 s88, 1
    s_cselect_b32 s78, 0x40000000, s86
    s_add_u32 m0, s95, 98304
    s_sub_u32 s88, s88, 1
    buffer_load_dwordx4 v240, s[40:43], s78 offen offset:0 sc1 lds
    buffer_load_dwordx4 v240, s[40:43], s78 offen offset:1024 sc1 lds
    buffer_load_dwordx4 v240, s[40:43], s78 offen offset:2048 sc1 lds
    buffer_load_dwordx4 v240, s[40:43], s78 offen offset:3072 sc1 lds
    s_add_u32 m0, s95, 114688
    s_add_u32 s86, s86, 16384
    buffer_load_dwordx4 v240, s[40:43], s77 offen offset:0 sc1 lds
    buffer_load_dwordx4 v240, s[40:43], s77 offen offset:1024 sc1 lds
    buffer_load_dwordx4 v240, s[40:43], s77 offen offset:2048 sc1 lds
    buffer_load_dwordx4 v240, s[40:43], s77 offen offset:3072 sc1 lds
    s_add_u32 s87, s87, 16384
    s_add_u32 s78, s31, 196608
    buffer_store_dwordx4 v[48:51], v240, s[40:43], s78 offen offset:0 sc1
    s_add_u32 s78, s31, 196608
    buffer_store_dwordx4 v[52:55], v240, s[40:43], s78 offen offset:1024 sc1
    v_min_f32 v243, 0x41f00000, v180
    v_min_f32 v244, 0x41f00000, v181
    v_mul_f32 v243, s97, v243
    v_mul_f32 v244, s97, v244
    v_exp_f32 v243, v243
    v_exp_f32 v244, v244
    v_add_f32 v245, 2.0, v243
    v_add_f32 v246, 2.0, v244
    v_mul_f32 v245, v245, v243
    v_mul_f32 v246, v246, v244
    v_add_f32 v247, 2.0, v245
    v_add_f32 v248, 2.0, v246
    v_rcp_f32 v247, v247
    v_rcp_f32 v248, v248
    v_mul_f32 v245, v245, v180
    v_mul_f32 v246, v246, v181
    v_mul_f32 v245, v245, v247
    v_mul_f32 v246, v246, v248
    v_cvt_pk_bf16_f32 v178, v245, v246
    v_min_f32 v243, 0x41f00000, v182
    v_min_f32 v244, 0x41f00000, v183
    v_mul_f32 v243, s97, v243
    v_mul_f32 v244, s97, v244
    v_exp_f32 v243, v243
    v_exp_f32 v244, v244
    v_add_f32 v245, 2.0, v243
    v_add_f32 v246, 2.0, v244
    v_mul_f32 v245, v245, v243
    v_mul_f32 v246, v246, v244
    v_add_f32 v247, 2.0, v245
    v_add_f32 v248, 2.0, v246
    v_rcp_f32 v247, v247
    v_rcp_f32 v248, v248
    v_mul_f32 v245, v245, v182
    v_mul_f32 v246, v246, v183
    v_mul_f32 v245, v245, v247
    v_mul_f32 v246, v246, v248
    v_cvt_pk_bf16_f32 v179, v245, v246
    s_lshl_b32 s77, s75, 1
    s_lshr_b32 s78, s76, 1
    s_add_u32 s77, s77, s78
    s_mul_i32 s77, s77, 364
    s_lshl_b32 s78, s72, 2
    s_add_u32 s77, s77, s78
    s_and_b32 s78, s76, 1
    s_add_u32 s77, s77, s78
    s_add_u32 s77, s77, 258
    s_lshl_b32 s77, s77, 1
    s_lshl_b32 s77, s77, 10
    s_cmp_ge_u32 s72, 27
    s_cselect_b32 s77, 0x40000000, s77
    buffer_store_dwordx4 v[176:179], v240, s[56:59], s77 offen offset:0 sc1
    s_waitcnt vmcnt(11)
    s_barrier
    s_cmp_eq_u32 s88, 0
    s_cselect_b32 s86, s92, s86
    s_cselect_b32 s77, 0x40000000, s87
    s_cselect_b32 s87, s93, s87
    s_cselect_b32 s88, s89, s88
    s_cselect_b32 s89, s16, s89
    s_cmp_eq_u32 s88, 1
    s_cselect_b32 s78, 0x40000000, s86
    s_add_u32 m0, s95, 0
    s_sub_u32 s88, s88, 1
    buffer_load_dwordx4 v240, s[40:43], s78 offen offset:0 sc1 lds
    buffer_load_dwordx4 v240, s[40:43], s78 offen offset:1024 sc1 lds
    buffer_load_dwordx4 v240, s[40:43], s78 offen offset:2048 sc1 lds
    buffer_load_dwordx4 v240, s[40:43], s78 offen offset:3072 sc1 lds
    s_add_u32 m0, s95, 16384
    s_add_u32 s86, s86, 16384
    buffer_load_dwordx4 v240, s[40:43], s77 offen offset:0 sc1 lds
    buffer_load_dwordx4 v240, s[40:43], s77 offen offset:1024 sc1 lds
    buffer_load_dwordx4 v240, s[40:43], s77 offen offset:2048 sc1 lds
    buffer_load_dwordx4 v240, s[40:43], s77 offen offset:3072 sc1 lds
    s_add_u32 s87, s87, 16384
    v_min_f32 v243, 0x41f00000, v184
    v_min_f32 v244, 0x41f00000, v185
    v_mul_f32 v243, s97, v243
    v_mul_f32 v244, s97, v244
    v_exp_f32 v243, v243
    v_exp_f32 v244, v244
    v_add_f32 v245, 2.0, v243
    v_add_f32 v246, 2.0, v244
    v_mul_f32 v245, v245, v243
    v_mul_f32 v246, v246, v244
    v_add_f32 v247, 2.0, v245
    v_add_f32 v248, 2.0, v246
    v_rcp_f32 v247, v247
    v_rcp_f32 v248, v248
    v_mul_f32 v245, v245, v184
    v_mul_f32 v246, v246, v185
    v_mul_f32 v245, v245, v247
    v_mul_f32 v246, v246, v248
    v_cvt_pk_bf16_f32 v184, v245, v246
    v_min_f32 v243, 0x41f00000, v186
    v_min_f32 v244, 0x41f00000, v187
    v_mul_f32 v243, s97, v243
    v_mul_f32 v244, s97, v244
    v_exp_f32 v243, v243
    v_exp_f32 v244, v244
    v_add_f32 v245, 2.0, v243
    v_add_f32 v246, 2.0, v244
    v_mul_f32 v245, v245, v243
    v_mul_f32 v246, v246, v244
    v_add_f32 v247, 2.0, v245
    v_add_f32 v248, 2.0, v246
    v_rcp_f32 v247, v247
    v_rcp_f32 v248, v248
    v_mul_f32 v245, v245, v186
    v_mul_f32 v246, v246, v187
    v_mul_f32 v245, v245, v247
    v_mul_f32 v246, v246, v248
    v_cvt_pk_bf16_f32 v185, v245, v246
    s_waitcnt vmcnt(11)
    s_barrier
    s_cmp_eq_u32 s88, 0
    s_cselect_b32 s86, s92, s86
    s_cselect_b32 s77, 0x40000000, s87
    s_cselect_b32 s87, s93, s87
    s_cselect_b32 s88, s89, s88
    s_cselect_b32 s89, s16, s89
    s_cmp_eq_u32 s88, 1
    s_cselect_b32 s78, 0x40000000, s86
    s_add_u32 m0, s95, 32768
    s_sub_u32 s88, s88, 1
    buffer_load_dwordx4 v240, s[40:43], s78 offen offset:0 sc1 lds
    buffer_load_dwordx4 v240, s[40:43], s78 offen offset:1024 sc1 lds
    buffer_load_dwordx4 v240, s[40:43], s78 offen offset:2048 sc1 lds
    buffer_load_dwordx4 v240, s[40:43], s78 offen offset:3072 sc1 lds
    s_add_u32 m0, s95, 49152
    s_add_u32 s86, s86, 16384
    buffer_load_dwordx4 v240, s[40:43], s77 offen offset:0 sc1 lds
    buffer_load_dwordx4 v240, s[40:43], s77 offen offset:1024 sc1 lds
    buffer_load_dwordx4 v240, s[40:43], s77 offen offset:2048 sc1 lds
    buffer_load_dwordx4 v240, s[40:43], s77 offen offset:3072 sc1 lds
    s_add_u32 s87, s87, 16384
    s_lshl_b32 s12, s72, 8
    s_add_u32 s12, s12, s22
    s_add_u32 s12, s12, 4096
    v_lshlrev_b32 v254, 9, v240
    buffer_load_dword v254, v254, s[4:7], s12 offen offset:16 sc1
    s_lshl_b32 s78, s2, 8
    s_add_u32 s78, s78, 4112
    v_mov_b32 v253, 7
    buffer_store_dword v253, v252, s[4:7], s78 offen sc1
    s_add_u32 s78, s31, 198656
    buffer_store_dwordx4 v[56:59], v240, s[40:43], s78 offen offset:0 sc1
    s_add_u32 s78, s31, 198656
    buffer_store_dwordx4 v[60:63], v240, s[40:43], s78 offen offset:1024 sc1
    v_min_f32 v243, 0x41f00000, v188
    v_min_f32 v244, 0x41f00000, v189
    v_mul_f32 v243, s97, v243
    v_mul_f32 v244, s97, v244
    v_exp_f32 v243, v243
    v_exp_f32 v244, v244
    v_add_f32 v245, 2.0, v243
    v_add_f32 v246, 2.0, v244
    v_mul_f32 v245, v245, v243
    v_mul_f32 v246, v246, v244
    v_add_f32 v247, 2.0, v245
    v_add_f32 v248, 2.0, v246
    v_rcp_f32 v247, v247
    v_rcp_f32 v248, v248
    v_mul_f32 v245, v245, v188
    v_mul_f32 v246, v246, v189
    v_mul_f32 v245, v245, v247
    v_mul_f32 v246, v246, v248
    v_cvt_pk_bf16_f32 v186, v245, v246
    v_min_f32 v243, 0x41f00000, v190
    v_min_f32 v244, 0x41f00000, v191
    v_mul_f32 v243, s97, v243
    v_mul_f32 v244, s97, v244
    v_exp_f32 v243, v243
    v_exp_f32 v244, v244
    v_add_f32 v245, 2.0, v243
    v_add_f32 v246, 2.0, v244
    v_mul_f32 v245, v245, v243
    v_mul_f32 v246, v246, v244
    v_add_f32 v247, 2.0, v245
    v_add_f32 v248, 2.0, v246
    v_rcp_f32 v247, v247
    v_rcp_f32 v248, v248
    v_mul_f32 v245, v245, v190
    v_mul_f32 v246, v246, v191
    v_mul_f32 v245, v245, v247
    v_mul_f32 v246, v246, v248
    v_cvt_pk_bf16_f32 v187, v245, v246
    s_lshl_b32 s77, s75, 1
    s_lshr_b32 s78, s76, 1
    s_add_u32 s77, s77, s78
    s_mul_i32 s77, s77, 364
    s_lshl_b32 s78, s72, 2
    s_add_u32 s77, s77, s78
    s_and_b32 s78, s76, 1
    s_add_u32 s77, s77, s78
    s_add_u32 s77, s77, 258
    s_lshl_b32 s77, s77, 1
    s_lshl_b32 s77, s77, 10
    s_cmp_ge_u32 s72, 27
    s_cselect_b32 s77, 0x40000000, s77
    buffer_store_dwordx4 v[184:187], v240, s[56:59], s77 offen offset:1024 sc1
    s_waitcnt vmcnt(13)
    s_barrier
    s_cmp_eq_u32 s88, 0
    s_cselect_b32 s86, s92, s86
    s_cselect_b32 s77, 0x40000000, s87
    s_cselect_b32 s87, s93, s87
    s_cselect_b32 s88, s89, s88
    s_cselect_b32 s89, s16, s89
    s_cmp_eq_u32 s88, 1
    s_cselect_b32 s78, 0x40000000, s86
    s_add_u32 m0, s95, 65536
    s_sub_u32 s88, s88, 1
    buffer_load_dwordx4 v240, s[40:43], s78 offen offset:0 sc1 lds
    buffer_load_dwordx4 v240, s[40:43], s78 offen offset:1024 sc1 lds
    buffer_load_dwordx4 v240, s[40:43], s78 offen offset:2048 sc1 lds
    buffer_load_dwordx4 v240, s[40:43], s78 offen offset:3072 sc1 lds
    s_add_u32 m0, s95, 81920
    s_add_u32 s86, s86, 16384
    buffer_load_dwordx4 v240, s[40:43], s77 offen offset:0 sc1 lds
    buffer_load_dwordx4 v240, s[40:43], s77 offen offset:1024 sc1 lds
    buffer_load_dwordx4 v240, s[40:43], s77 offen offset:2048 sc1 lds
    buffer_load_dwordx4 v240, s[40:43], s77 offen offset:3072 sc1 lds
    s_add_u32 s87, s87, 16384
    s_waitcnt vmcnt(12)
    v_cmp_gt_u32 vcc, 5, v254
    s_and_b32 s30, vcc_lo, s14
    s_cbranch_scc0 KB_E317_OK
    s_mov_b32 s23, 100000
KB_E317_SPIN:
    s_sleep 10
    s_lshl_b32 s12, s72, 8
    s_add_u32 s12, s12, s22
    s_add_u32 s12, s12, 4096
    v_lshlrev_b32 v254, 9, v240
    buffer_load_dword v254, v254, s[4:7], s12 offen offset:16 sc1
    s_waitcnt vmcnt(0)
    v_cmp_gt_u32 vcc, 5, v254
    s_and_b32 s30, vcc_lo, s14
    s_cbranch_scc0 KB_E317_OK
    s_sub_u32 s23, s23, 1
    s_cbranch_scc0 KB_E317_SPIN
KB_E317_OK:
    s_barrier
    s_cmp_eq_u32 s88, 0
    s_cselect_b32 s86, s92, s86
    s_cselect_b32 s77, 0x40000000, s87
    s_cselect_b32 s87, s93, s87
    s_cselect_b32 s88, s89, s88
    s_cselect_b32 s89, s16, s89
    s_cmp_eq_u32 s88, 1
    s_cselect_b32 s78, 0x40000000, s86
    s_add_u32 m0, s95, 98304
    s_sub_u32 s88, s88, 1
    buffer_load_dwordx4 v240, s[40:43], s78 offen offset:0 sc1 lds
    buffer_load_dwordx4 v240, s[40:43], s78 offen offset:1024 sc1 lds
    buffer_load_dwordx4 v240, s[40:43], s78 offen offset:2048 sc1 lds
    buffer_load_dwordx4 v240, s[40:43], s78 offen offset:3072 sc1 lds
    s_add_u32 m0, s95, 114688
    s_add_u32 s86, s86, 16384
    buffer_load_dwordx4 v240, s[40:43], s77 offen offset:0 sc1 lds
    buffer_load_dwordx4 v240, s[40:43], s77 offen offset:1024 sc1 lds
    buffer_load_dwordx4 v240, s[40:43], s77 offen offset:2048 sc1 lds
    buffer_load_dwordx4 v240, s[40:43], s77 offen offset:3072 sc1 lds
    s_add_u32 s87, s87, 16384
    s_waitcnt vmcnt(8)
    s_barrier
    s_cmp_eq_u32 s88, 0
    s_cselect_b32 s86, s92, s86
    s_cselect_b32 s77, 0x40000000, s87
    s_cselect_b32 s87, s93, s87
    s_cselect_b32 s88, s89, s88
    s_cselect_b32 s89, s16, s89
    s_cmp_eq_u32 s88, 1
    s_cselect_b32 s78, 0x40000000, s86
    s_add_u32 m0, s95, 0
    s_sub_u32 s88, s88, 1
    buffer_load_dwordx4 v240, s[40:43], s78 offen offset:0 sc1 lds
    buffer_load_dwordx4 v240, s[40:43], s78 offen offset:1024 sc1 lds
    buffer_load_dwordx4 v240, s[40:43], s78 offen offset:2048 sc1 lds
    buffer_load_dwordx4 v240, s[40:43], s78 offen offset:3072 sc1 lds
    s_add_u32 m0, s95, 16384
    s_add_u32 s86, s86, 16384
    buffer_load_dwordx4 v240, s[40:43], s77 offen offset:0 sc1 lds
    buffer_load_dwordx4 v240, s[40:43], s77 offen offset:1024 sc1 lds
    buffer_load_dwordx4 v240, s[40:43], s77 offen offset:2048 sc1 lds
    buffer_load_dwordx4 v240, s[40:43], s77 offen offset:3072 sc1 lds
    s_add_u32 s87, s87, 16384
    v_lshrrev_b32 v227, 4, v240
    v_lshrrev_b32 v224, 4, v227
    v_lshlrev_b32 v225, 2, v224
    v_and_b32 v226, 15, v227
    v_xor_b32 v225, v225, v226
    v_lshlrev_b32 v225, 4, v225
    s_movk_i32 s77, 1280
    v_mul_lo_u32 v228, v224, s77
    v_add_u32 v228, v228, v225
    s_lshl_b32 s78, s76, 13
    s_add_u32 s78, s78, 131072
    s_add_u32 m0, s78, 0
    s_add_u32 s77, s26, 0
    buffer_load_dwordx4 v228, s[64:67], s77 offen nt lds
    s_add_u32 m0, s78, 1024
    s_add_u32 s77, s26, 5120
    buffer_load_dwordx4 v228, s[64:67], s77 offen nt lds
    s_add_u32 m0, s78, 2048
    s_add_u32 s77, s26, 10240
    buffer_load_dwordx4 v228, s[64:67], s77 offen nt lds
    s_add_u32 m0, s78, 3072
    s_add_u32 s77, s26, 15360
    buffer_load_dwordx4 v228, s[64:67], s77 offen nt lds
    s_add_u32 m0, s78, 4096
    s_add_u32 s77, s26, 20480
    buffer_load_dwordx4 v228, s[64:67], s77 offen nt lds
    s_add_u32 m0, s78, 5120
    s_add_u32 s77, s26, 25600
    buffer_load_dwordx4 v228, s[64:67], s77 offen nt lds
    s_add_u32 m0, s78, 6144
    s_add_u32 s77, s26, 30720
    buffer_load_dwordx4 v228, s[64:67], s77 offen nt lds
    s_add_u32 m0, s78, 7168
    s_add_u32 s77, s26, 35840
    buffer_load_dwordx4 v228, s[64:67], s77 offen nt lds
    s_waitcnt vmcnt(16)
    s_barrier
    s_cmp_eq_u32 s88, 0
    s_cselect_b32 s86, s92, s86
    s_cselect_b32 s77, 0x40000000, s87
    s_cselect_b32 s87, s93, s87
    s_cselect_b32 s88, s89, s88
    s_cselect_b32 s89, s16, s89
    s_cmp_eq_u32 s88, 1
    s_cselect_b32 s78, 0x40000000, s86
    s_add_u32 m0, s95, 32768
    s_sub_u32 s88, s88, 1
    buffer_load_dwordx4 v240, s[40:43], s78 offen offset:0 sc1 lds
    buffer_load_dwordx4 v240, s[40:43], s78 offen offset:1024 sc1 lds
    buffer_load_dwordx4 v240, s[40:43], s78 offen offset:2048 sc1 lds
    buffer_load_dwordx4 v240, s[40:43], s78 offen offset:3072 sc1 lds
    s_add_u32 m0, s95, 49152
    s_add_u32 s86, s86, 16384
    buffer_load_dwordx4 v240, s[40:43], s77 offen offset:0 sc1 lds
    buffer_load_dwordx4 v240, s[40:43], s77 offen offset:1024 sc1 lds
    buffer_load_dwordx4 v240, s[40:43], s77 offen offset:2048 sc1 lds
    buffer_load_dwordx4 v240, s[40:43], s77 offen offset:3072 sc1 lds
    s_add_u32 s87, s87, 16384
    s_lshl_b32 s12, s72, 8
    s_add_u32 s12, s12, s22
    s_add_u32 s12, s12, 4096
    v_lshlrev_b32 v254, 9, v240
    buffer_load_dword v254, v254, s[4:7], s12 offen offset:16 sc1
    s_lshl_b32 s78, s2, 8
    s_add_u32 s78, s78, 4112
    v_mov_b32 v253, 8
    buffer_store_dword v253, v252, s[4:7], s78 offen sc1
    s_waitcnt vmcnt(18)
    s_barrier
    s_cmp_eq_u32 s88, 0
    s_cselect_b32 s86, s92, s86
    s_cselect_b32 s77, 0x40000000, s87
    s_cselect_b32 s87, s93, s87
    s_cselect_b32 s88, s89, s88
    s_cselect_b32 s89, s16, s89
    s_cmp_eq_u32 s88, 1
    s_cselect_b32 s78, 0x40000000, s86
    s_add_u32 m0, s95, 65536
    s_sub_u32 s88, s88, 1
    buffer_load_dwordx4 v240, s[40:43], s78 offen offset:0 sc1 lds
    buffer_load_dwordx4 v240, s[40:43], s78 offen offset:1024 sc1 lds
    buffer_load_dwordx4 v240, s[40:43], s78 offen offset:2048 sc1 lds
    buffer_load_dwordx4 v240, s[40:43], s78 offen offset:3072 sc1 lds
    s_add_u32 m0, s95, 81920
    s_add_u32 s86, s86, 16384
    buffer_load_dwordx4 v240, s[40:43], s77 offen offset:0 sc1 lds
    buffer_load_dwordx4 v240, s[40:43], s77 offen offset:1024 sc1 lds
    buffer_load_dwordx4 v240, s[40:43], s77 offen offset:2048 sc1 lds
    buffer_load_dwordx4 v240, s[40:43], s77 offen offset:3072 sc1 lds
    s_add_u32 s87, s87, 16384
    s_waitcnt vmcnt(9)
    v_cmp_gt_u32 vcc, 6, v254
    s_and_b32 s30, vcc_lo, s14
    s_cbranch_scc0 KB_E321_OK
    s_mov_b32 s23, 100000
KB_E321_SPIN:
    s_sleep 10
    s_lshl_b32 s12, s72, 8
    s_add_u32 s12, s12, s22
    s_add_u32 s12, s12, 4096
    v_lshlrev_b32 v254, 9, v240
    buffer_load_dword v254, v254, s[4:7], s12 offen offset:16 sc1
    s_waitcnt vmcnt(0)
    v_cmp_gt_u32 vcc, 6, v254
    s_and_b32 s30, vcc_lo, s14
    s_cbranch_scc0 KB_E321_OK
    s_sub_u32 s23, s23, 1
    s_cbranch_scc0 KB_E321_SPIN
KB_E321_OK:
    s_barrier
    s_cmp_eq_u32 s88, 0
    s_cselect_b32 s86, s92, s86
    s_cselect_b32 s77, 0x40000000, s87
    s_cselect_b32 s87, s93, s87
    s_cselect_b32 s88, s89, s88
    s_cselect_b32 s89, s16, s89
    s_cmp_eq_u32 s88, 1
    s_cselect_b32 s78, 0x40000000, s86
    s_add_u32 m0, s95, 98304
    s_sub_u32 s88, s88, 1
    buffer_load_dwordx4 v240, s[40:43], s78 offen offset:0 sc1 lds
    buffer_load_dwordx4 v240, s[40:43], s78 offen offset:1024 sc1 lds
    buffer_load_dwordx4 v240, s[40:43], s78 offen offset:2048 sc1 lds
    buffer_load_dwordx4 v240, s[40:43], s78 offen offset:3072 sc1 lds
    s_add_u32 m0, s95, 114688
    s_add_u32 s86, s86, 16384
    buffer_load_dwordx4 v240, s[40:43], s77 offen offset:0 sc1 lds
    buffer_load_dwordx4 v240, s[40:43], s77 offen offset:1024 sc1 lds
    buffer_load_dwordx4 v240, s[40:43], s77 offen offset:2048 sc1 lds
    buffer_load_dwordx4 v240, s[40:43], s77 offen offset:3072 sc1 lds
    s_add_u32 s87, s87, 16384
    v_bfe_u32 v224, v227, 2, 2
    v_lshrrev_b32 v226, 2, v227
    v_lshlrev_b32 v226, 8, v226
    v_lshl_add_u32 v226, v224, 6, v226
    v_and_b32 v225, 3, v227
    v_lshl_add_u32 v226, v225, 3, v226
    s_lshl_b32 s78, s76, 13
    s_add_u32 s78, s78, 131072
    v_add_u32 v226, s78, v226
    v_add_u32 v224, s78, v240
    v_xor_b32 v228, 0, v226
    v_xor_b32 v229, 64, v226
    v_xor_b32 v230, 128, v226
    v_xor_b32 v231, 192, v226
    s_waitcnt vmcnt(26)
    ds_read_b64_tr_b16 v[192:193], v228 offset:0
    ds_read_b64_tr_b16 v[194:195], v228 offset:4096
    ds_read_b64_tr_b16 v[196:197], v228 offset:32
    ds_read_b64_tr_b16 v[198:199], v228 offset:4128
    ds_read_b64_tr_b16 v[200:201], v229 offset:0
    ds_read_b64_tr_b16 v[202:203], v229 offset:4096
    ds_read_b64_tr_b16 v[204:205], v229 offset:32
    ds_read_b64_tr_b16 v[206:207], v229 offset:4128
    ds_read_b64_tr_b16 v[208:209], v230 offset:0
    ds_read_b64_tr_b16 v[210:211], v230 offset:4096
    ds_read_b64_tr_b16 v[212:213], v230 offset:32
    ds_read_b64_tr_b16 v[214:215], v230 offset:4128
    ds_read_b64_tr_b16 v[216:217], v231 offset:0
    ds_read_b64_tr_b16 v[218:219], v231 offset:4096
    ds_read_b64_tr_b16 v[220:221], v231 offset:32
    ds_read_b64_tr_b16 v[222:223], v231 offset:4128
    s_waitcnt vmcnt(8)
    s_barrier
    s_cmp_eq_u32 s88, 0
    s_cselect_b32 s86, s92, s86
    s_cselect_b32 s77, 0x40000000, s87
    s_cselect_b32 s87, s93, s87
    s_cselect_b32 s88, s89, s88
    s_cselect_b32 s89, s16, s89
    s_cmp_eq_u32 s88, 1
    s_cselect_b32 s78, 0x40000000, s86
    s_add_u32 m0, s95, 0
    s_sub_u32 s88, s88, 1
    buffer_load_dwordx4 v240, s[40:43], s78 offen offset:0 sc1 lds
    buffer_load_dwordx4 v240, s[40:43], s78 offen offset:1024 sc1 lds
    buffer_load_dwordx4 v240, s[40:43], s78 offen offset:2048 sc1 lds
    buffer_load_dwordx4 v240, s[40:43], s78 offen offset:3072 sc1 lds
    s_add_u32 m0, s95, 16384
    s_add_u32 s86, s86, 16384
    buffer_load_dwordx4 v240, s[40:43], s77 offen offset:0 sc1 lds
    buffer_load_dwordx4 v240, s[40:43], s77 offen offset:1024 sc1 lds
    buffer_load_dwordx4 v240, s[40:43], s77 offen offset:2048 sc1 lds
    buffer_load_dwordx4 v240, s[40:43], s77 offen offset:3072 sc1 lds
    s_add_u32 s87, s87, 16384
    s_and_b32 s78, s27, 7
    s_sub_u32 s27, s27, s78
    s_mul_i32 s78, s78, 416
    s_waitcnt lgkmcnt(0)
    s_add_u32 s77, s78, 0
    s_lshr_b32 s77, s77, 8
    s_mul_i32 s77, s77, 926720
    s_add_u32 s77, s77, s27
    buffer_store_dwordx4 v[192:195], v240, s[68:71], s77 offen offset:0 sc1
    s_add_u32 s77, s78, 52
    s_lshr_b32 s77, s77, 8
    s_mul_i32 s77, s77, 926720
    s_add_u32 s77, s77, s27
    buffer_store_dwordx4 v[196:199], v240, s[68:71], s77 offen offset:1024 sc1
    s_add_u32 s77, s78, 104
    s_lshr_b32 s77, s77, 8
    s_mul_i32 s77, s77, 926720
    s_add_u32 s77, s77, s27
    buffer_store_dwordx4 v[200:203], v240, s[68:71], s77 offen offset:2048 sc1
    s_add_u32 s77, s78, 156
    s_lshr_b32 s77, s77, 8
    s_mul_i32 s77, s77, 926720
    s_add_u32 s77, s77, s27
    buffer_store_dwordx4 v[204:207], v240, s[68:71], s77 offen offset:3072 sc1
    s_add_u32 s27, s27, 4096
    s_add_u32 s77, s78, 208
    s_lshr_b32 s77, s77, 8
    s_mul_i32 s77, s77, 926720
    s_add_u32 s77, s77, s27
    buffer_store_dwordx4 v[208:211], v240, s[68:71], s77 offen offset:0 sc1
    s_add_u32 s77, s78, 260
    s_lshr_b32 s77, s77, 8
    s_mul_i32 s77, s77, 926720
    s_add_u32 s77, s77, s27
    buffer_store_dwordx4 v[212:215], v240, s[68:71], s77 offen offset:1024 sc1
    s_add_u32 s77, s78, 312
    s_lshr_b32 s77, s77, 8
    s_mul_i32 s77, s77, 926720
    s_add_u32 s77, s77, s27
    buffer_store_dwordx4 v[216:219], v240, s[68:71], s77 offen offset:2048 sc1
    s_add_u32 s77, s78, 364
    s_lshr_b32 s77, s77, 8
    s_mul_i32 s77, s77, 926720
    s_add_u32 s77, s77, s27
    buffer_store_dwordx4 v[220:223], v240, s[68:71], s77 offen offset:3072 sc1
    s_waitcnt vmcnt(16)
    s_barrier
    s_cmp_eq_u32 s88, 0
    s_cselect_b32 s86, s92, s86
    s_cselect_b32 s77, 0x40000000, s87
    s_cselect_b32 s87, s93, s87
    s_cselect_b32 s88, s89, s88
    s_cselect_b32 s89, s16, s89
    s_cmp_eq_u32 s88, 1
    s_cselect_b32 s78, 0x40000000, s86
    s_add_u32 m0, s95, 32768
    s_sub_u32 s88, s88, 1
    buffer_load_dwordx4 v240, s[40:43], s78 offen offset:0 sc1 lds
    buffer_load_dwordx4 v240, s[40:43], s78 offen offset:1024 sc1 lds
    buffer_load_dwordx4 v240, s[40:43], s78 offen offset:2048 sc1 lds
    buffer_load_dwordx4 v240, s[40:43], s78 offen offset:3072 sc1 lds
    s_add_u32 m0, s95, 49152
    s_add_u32 s86, s86, 16384
    buffer_load_dwordx4 v240, s[40:43], s77 offen offset:0 sc1 lds
    buffer_load_dwordx4 v240, s[40:43], s77 offen offset:1024 sc1 lds
    buffer_load_dwordx4 v240, s[40:43], s77 offen offset:2048 sc1 lds
    buffer_load_dwordx4 v240, s[40:43], s77 offen offset:3072 sc1 lds
    s_add_u32 s87, s87, 16384
    s_lshl_b32 s12, s72, 8
    s_add_u32 s12, s12, s22
    s_add_u32 s12, s12, 4096
    v_lshlrev_b32 v254, 9, v240
    buffer_load_dword v254, v254, s[4:7], s12 offen offset:16 sc1
    s_waitcnt vmcnt(17)
    s_barrier
    s_cmp_eq_u32 s88, 0
    s_cselect_b32 s86, s92, s86
    s_cselect_b32 s77, 0x40000000, s87
    s_cselect_b32 s87, s93, s87
    s_cselect_b32 s88, s89, s88
    s_cselect_b32 s89, s16, s89
    s_cmp_eq_u32 s88, 1
    s_cselect_b32 s78, 0x40000000, s86
    s_add_u32 m0, s95, 65536
    s_sub_u32 s88, s88, 1
    buffer_load_dwordx4 v240, s[40:43], s78 offen offset:0 sc1 lds
    buffer_load_dwordx4 v240, s[40:43], s78 offen offset:1024 sc1 lds
    buffer_load_dwordx4 v240, s[40:43], s78 offen offset:2048 sc1 lds
    buffer_load_dwordx4 v240, s[40:43], s78 offen offset:3072 sc1 lds
    s_add_u32 m0, s95, 81920
    s_add_u32 s86, s86, 16384
    buffer_load_dwordx4 v240, s[40:43], s77 offen offset:0 sc1 lds
    buffer_load_dwordx4 v240, s[40:43], s77 offen offset:1024 sc1 lds
    buffer_load_dwordx4 v240, s[40:43], s77 offen offset:2048 sc1 lds
    buffer_load_dwordx4 v240, s[40:43], s77 offen offset:3072 sc1 lds
    s_add_u32 s87, s87, 16384
    s_waitcnt vmcnt(8)
    v_cmp_gt_u32 vcc, 7, v254
    s_and_b32 s30, vcc_lo, s14
    s_cbranch_scc0 KB_E325_OK
    s_mov_b32 s23, 100000
KB_E325_SPIN:
    s_sleep 10
    s_lshl_b32 s12, s72, 8
    s_add_u32 s12, s12, s22
    s_add_u32 s12, s12, 4096
    v_lshlrev_b32 v254, 9, v240
    buffer_load_dword v254, v254, s[4:7], s12 offen offset:16 sc1
    s_waitcnt vmcnt(0)
    v_cmp_gt_u32 vcc, 7, v254
    s_and_b32 s30, vcc_lo, s14
    s_cbranch_scc0 KB_E325_OK
    s_sub_u32 s23, s23, 1
    s_cbranch_scc0 KB_E325_SPIN
KB_E325_OK:
    s_barrier
    s_cmp_eq_u32 s88, 0
    s_cselect_b32 s86, s92, s86
    s_cselect_b32 s77, 0x40000000, s87
    s_cselect_b32 s87, s93, s87
    s_cselect_b32 s88, s89, s88
    s_cselect_b32 s89, s16, s89
    s_cmp_eq_u32 s88, 1
    s_cselect_b32 s78, 0x40000000, s86
    s_add_u32 m0, s95, 98304
    s_sub_u32 s88, s88, 1
    buffer_load_dwordx4 v240, s[40:43], s78 offen offset:0 sc1 lds
    buffer_load_dwordx4 v240, s[40:43], s78 offen offset:1024 sc1 lds
    buffer_load_dwordx4 v240, s[40:43], s78 offen offset:2048 sc1 lds
    buffer_load_dwordx4 v240, s[40:43], s78 offen offset:3072 sc1 lds
    s_add_u32 m0, s95, 114688
    s_add_u32 s86, s86, 16384
    buffer_load_dwordx4 v240, s[40:43], s77 offen offset:0 sc1 lds
    buffer_load_dwordx4 v240, s[40:43], s77 offen offset:1024 sc1 lds
    buffer_load_dwordx4 v240, s[40:43], s77 offen offset:2048 sc1 lds
    buffer_load_dwordx4 v240, s[40:43], s77 offen offset:3072 sc1 lds
    s_add_u32 s87, s87, 16384
    s_lshl_b32 s78, s2, 2
    s_add_u32 s78, s78, 2048
    v_mov_b32 v253, 1
    buffer_store_dword v253, v252, s[4:7], s78 offen sc1
    s_waitcnt vmcnt(9)
    s_barrier
    s_cmp_eq_u32 s88, 0
    s_cselect_b32 s86, s92, s86
    s_cselect_b32 s77, 0x40000000, s87
    s_cselect_b32 s87, s93, s87
    s_cselect_b32 s88, s89, s88
    s_cselect_b32 s89, s16, s89
    s_cmp_eq_u32 s88, 1
    s_cselect_b32 s78, 0x40000000, s86
    s_add_u32 m0, s95, 0
    s_sub_u32 s88, s88, 1
    buffer_load_dwordx4 v240, s[40:43], s78 offen offset:0 sc1 lds
    buffer_load_dwordx4 v240, s[40:43], s78 offen offset:1024 sc1 lds
    buffer_load_dwordx4 v240, s[40:43], s78 offen offset:2048 sc1 lds
    buffer_load_dwordx4 v240, s[40:43], s78 offen offset:3072 sc1 lds
    s_add_u32 m0, s95, 16384
    s_add_u32 s86, s86, 16384
    buffer_load_dwordx4 v240, s[40:43], s77 offen offset:0 sc1 lds
    buffer_load_dwordx4 v240, s[40:43], s77 offen offset:1024 sc1 lds
    buffer_load_dwordx4 v240, s[40:43], s77 offen offset:2048 sc1 lds
    buffer_load_dwordx4 v240, s[40:43], s77 offen offset:3072 sc1 lds
    s_add_u32 s87, s87, 16384
    s_waitcnt vmcnt(9)
    s_barrier
    s_cmp_eq_u32 s88, 0
    s_cselect_b32 s86, s92, s86
    s_cselect_b32 s77, 0x40000000, s87
    s_cselect_b32 s87, s93, s87
    s_cselect_b32 s88, s89, s88
    s_cselect_b32 s89, s16, s89
    s_cmp_eq_u32 s88, 1
    s_cselect_b32 s78, 0x40000000, s86
    s_add_u32 m0, s95, 32768
    s_sub_u32 s88, s88, 1
    buffer_load_dwordx4 v240, s[40:43], s78 offen offset:0 sc1 lds
    buffer_load_dwordx4 v240, s[40:43], s78 offen offset:1024 sc1 lds
    buffer_load_dwordx4 v240, s[40:43], s78 offen offset:2048 sc1 lds
    buffer_load_dwordx4 v240, s[40:43], s78 offen offset:3072 sc1 lds
    s_add_u32 m0, s95, 49152
    s_add_u32 s86, s86, 16384
    buffer_load_dwordx4 v240, s[40:43], s77 offen offset:0 sc1 lds
    buffer_load_dwordx4 v240, s[40:43], s77 offen offset:1024 sc1 lds
    buffer_load_dwordx4 v240, s[40:43], s77 offen offset:2048 sc1 lds
    buffer_load_dwordx4 v240, s[40:43], s77 offen offset:3072 sc1 lds
    s_add_u32 s87, s87, 16384
    s_lshl_b32 s12, s72, 8
    s_add_u32 s12, s12, s22
    s_add_u32 s12, s12, 4096
    v_lshlrev_b32 v254, 9, v240
    buffer_load_dword v254, v254, s[4:7], s12 offen offset:16 sc1
    s_waitcnt vmcnt(9)
    s_barrier
    s_cmp_eq_u32 s88, 0
    s_cselect_b32 s86, s92, s86
    s_cselect_b32 s77, 0x40000000, s87
    s_cselect_b32 s87, s93, s87
    s_cselect_b32 s88, s89, s88
    s_cselect_b32 s89, s16, s89
    s_cmp_eq_u32 s88, 1
    s_cselect_b32 s78, 0x40000000, s86
    s_add_u32 m0, s95, 65536
    s_sub_u32 s88, s88, 1
    buffer_load_dwordx4 v240, s[40:43], s78 offen offset:0 sc1 lds
    buffer_load_dwordx4 v240, s[40:43], s78 offen offset:1024 sc1 lds
    buffer_load_dwordx4 v240, s[40:43], s78 offen offset:2048 sc1 lds
    buffer_load_dwordx4 v240, s[40:43], s78 offen offset:3072 sc1 lds
    s_add_u32 m0, s95, 81920
    s_add_u32 s86, s86, 16384
    buffer_load_dwordx4 v240, s[40:43], s77 offen offset:0 sc1 lds
    buffer_load_dwordx4 v240, s[40:43], s77 offen offset:1024 sc1 lds
    buffer_load_dwordx4 v240, s[40:43], s77 offen offset:2048 sc1 lds
    buffer_load_dwordx4 v240, s[40:43], s77 offen offset:3072 sc1 lds
    s_add_u32 s87, s87, 16384
    s_waitcnt vmcnt(8)
    v_cmp_gt_u32 vcc, 8, v254
    s_and_b32 s30, vcc_lo, s14
    s_cbranch_scc0 KB_E329_OK
    s_mov_b32 s23, 100000
KB_E329_SPIN:
    s_sleep 10
    s_lshl_b32 s12, s72, 8
    s_add_u32 s12, s12, s22
    s_add_u32 s12, s12, 4096
    v_lshlrev_b32 v254, 9, v240
    buffer_load_dword v254, v254, s[4:7], s12 offen offset:16 sc1
    s_waitcnt vmcnt(0)
    v_cmp_gt_u32 vcc, 8, v254
    s_and_b32 s30, vcc_lo, s14
    s_cbranch_scc0 KB_E329_OK
    s_sub_u32 s23, s23, 1
    s_cbranch_scc0 KB_E329_SPIN
KB_E329_OK:
    s_barrier
    s_cmp_eq_u32 s88, 0
    s_cselect_b32 s86, s92, s86
    s_cselect_b32 s77, 0x40000000, s87
    s_cselect_b32 s87, s93, s87
    s_cselect_b32 s88, s89, s88
    s_cselect_b32 s89, s16, s89
    s_cmp_eq_u32 s88, 1
    s_cselect_b32 s78, 0x40000000, s86
    s_add_u32 m0, s95, 98304
    s_sub_u32 s88, s88, 1
    buffer_load_dwordx4 v240, s[40:43], s78 offen offset:0 sc1 lds
    buffer_load_dwordx4 v240, s[40:43], s78 offen offset:1024 sc1 lds
    buffer_load_dwordx4 v240, s[40:43], s78 offen offset:2048 sc1 lds
    buffer_load_dwordx4 v240, s[40:43], s78 offen offset:3072 sc1 lds
    s_add_u32 m0, s95, 114688
    s_add_u32 s86, s86, 16384
    buffer_load_dwordx4 v240, s[40:43], s77 offen offset:0 sc1 lds
    buffer_load_dwordx4 v240, s[40:43], s77 offen offset:1024 sc1 lds
    buffer_load_dwordx4 v240, s[40:43], s77 offen offset:2048 sc1 lds
    buffer_load_dwordx4 v240, s[40:43], s77 offen offset:3072 sc1 lds
    s_add_u32 s87, s87, 16384
    s_waitcnt vmcnt(8)
    s_barrier
    s_cmp_eq_u32 s88, 0
    s_cselect_b32 s86, s92, s86
    s_cselect_b32 s77, 0x40000000, s87
    s_cselect_b32 s87, s93, s87
    s_cselect_b32 s88, s89, s88
    s_cselect_b32 s89, s16, s89
    s_cmp_eq_u32 s88, 1
    s_cselect_b32 s78, 0x40000000, s86
    s_add_u32 m0, s95, 0
    s_sub_u32 s88, s88, 1
    buffer_load_dwordx4 v240, s[40:43], s78 offen offset:0 sc1 lds
    buffer_load_dwordx4 v240, s[40:43], s78 offen offset:1024 sc1 lds
    buffer_load_dwordx4 v240, s[40:43], s78 offen offset:2048 sc1 lds
    buffer_load_dwordx4 v240, s[40:43], s78 offen offset:3072 sc1 lds
    s_add_u32 m0, s95, 16384
    s_add_u32 s86, s86, 16384
    buffer_load_dwordx4 v240, s[40:43], s77 offen offset:0 sc1 lds
    buffer_load_dwordx4 v240, s[40:43], s77 offen offset:1024 sc1 lds
    buffer_load_dwordx4 v240, s[40:43], s77 offen offset:2048 sc1 lds
    buffer_load_dwordx4 v240, s[40:43], s77 offen offset:3072 sc1 lds
    s_add_u32 s87, s87, 16384
    buffer_load_dwordx4 v[80:83], v240, s[4:7], s22 offen offset:2048 sc1
    s_waitcnt vmcnt(9)
    s_barrier
    s_cmp_eq_u32 s88, 0
    s_cselect_b32 s86, s92, s86
    s_cselect_b32 s77, 0x40000000, s87
    s_cselect_b32 s87, s93, s87
    s_cselect_b32 s88, s89, s88
    s_cselect_b32 s89, s16, s89
    s_cmp_eq_u32 s88, 1
    s_cselect_b32 s78, 0x40000000, s86
    s_add_u32 m0, s95, 32768
    s_sub_u32 s88, s88, 1
    buffer_load_dwordx4 v240, s[40:43], s78 offen offset:0 sc1 lds
    buffer_load_dwordx4 v240, s[40:43], s78 offen offset:1024 sc1 lds
    buffer_load_dwordx4 v240, s[40:43], s78 offen offset:2048 sc1 lds
    buffer_load_dwordx4 v240, s[40:43], s78 offen offset:3072 sc1 lds
    s_add_u32 m0, s95, 49152
    s_add_u32 s86, s86, 16384
    buffer_load_dwordx4 v240, s[40:43], s77 offen offset:0 sc1 lds
    buffer_load_dwordx4 v240, s[40:43], s77 offen offset:1024 sc1 lds
    buffer_load_dwordx4 v240, s[40:43], s77 offen offset:2048 sc1 lds
    buffer_load_dwordx4 v240, s[40:43], s77 offen offset:3072 sc1 lds
    s_add_u32 s87, s87, 16384
    s_bfe_u32 s77, s2, 0x10001
    s_lshl_b32 s77, s77, 3
    s_add_u32 s77, s77, s73
    s_bitcmp0_b32 s2, 0
    s_cselect_b32 s78, 16, 0
    s_add_u32 s77, s77, s78
    s_and_b32 s78, s2, 4
    s_bfe_u32 s79, s2, 0x20003
    s_add_u32 s78, s78, s79
    s_lshl_b32 s19, s77, 6
    s_lshl_b32 s79, s76, 4
    s_add_u32 s19, s19, s79
    v_bfe_u32 v229, v240, 4, 4
    v_add_u32 v229, s19, v229
    s_movk_i32 s79, 1280
    v_mul_lo_u32 v229, v229, s79
    v_lshrrev_b32 v228, 8, v240
    v_lshl_add_u32 v229, v228, 3, v229
    s_mul_i32 s79, s78, 160
    v_add_u32 v229, s79, v229
    s_mul_i32 s77, s77, 745472
    s_mul_i32 s78, s78, 931840
    s_mul_i32 s79, s76, 14
    s_cmp_eq_u32 s76, 3
    s_cselect_b32 s17, -1, 0
    s_add_u32 s79, s79, s17
    s_add_u32 s79, s79, 128
    s_lshl_b32 s17, s79, 12
    s_add_u32 s17, s17, s77
    s_mul_i32 s18, s79, 5120
    s_add_u32 s18, s18, s78
    s_add_u32 s19, s17, 53248
    s_add_u32 s20, s18, 66560
    s_cmp_ge_u32 s76, 2
    s_cselect_b32 s19, 0x40000000, s19
    s_cselect_b32 s20, 0x40000000, s20
    v_add_u32 v228, 4096, v240
    s_mov_b32 s21, 0xbfb8aa3b
    s_waitcnt lgkmcnt(0)
    s_mov_b32 s34, 2621440
    s_mov_b32 s35, 0x20000
    s_mov_b32 s38, 2621440
    s_mov_b32 s39, 0x20000
    v_add_u32 v224, 0, v240
    v_add_u32 v225, 1024, v240
    v_add_u32 v226, 2048, v240
    v_add_u32 v227, 3072, v240
    s_waitcnt vmcnt(8)
    v_min3_u32 v80, v80, v81, v82
    v_min_u32 v80, v80, v83
    v_cmp_gt_u32 vcc, 1, v80
    s_or_b32 s30, vcc_lo, vcc_hi
    s_and_b32 s30, s30, s15
    s_cbranch_scc0 KB_EA_OK
    s_mov_b32 s23, 100000
KB_EA_SPIN:
    s_sleep 6
    buffer_load_dwordx4 v[80:83], v240, s[4:7], s22 offen offset:2048 sc1
    s_waitcnt vmcnt(0)
    v_min3_u32 v80, v80, v81, v82
    v_min_u32 v80, v80, v83
    v_cmp_gt_u32 vcc, 1, v80
    s_or_b32 s30, vcc_lo, vcc_hi
    s_and_b32 s30, s30, s15
    s_cbranch_scc0 KB_EA_OK
    s_sub_u32 s23, s23, 1
    s_cbranch_scc0 KB_EA_SPIN
KB_EA_OK:
    s_barrier
    s_cmp_eq_u32 s88, 0
    s_cselect_b32 s86, s92, s86
    s_cselect_b32 s77, 0x40000000, s87
    s_cselect_b32 s87, s93, s87
    s_cselect_b32 s88, s89, s88
    s_cselect_b32 s89, s16, s89
    s_cmp_eq_u32 s88, 1
    s_cselect_b32 s78, 0x40000000, s86
    s_add_u32 m0, s95, 65536
    s_sub_u32 s88, s88, 1
    buffer_load_dwordx4 v240, s[40:43], s78 offen offset:0 sc1 lds
    buffer_load_dwordx4 v240, s[40:43], s78 offen offset:1024 sc1 lds
    buffer_load_dwordx4 v240, s[40:43], s78 offen offset:2048 sc1 lds
    buffer_load_dwordx4 v240, s[40:43], s78 offen offset:3072 sc1 lds
    s_add_u32 m0, s95, 81920
    s_add_u32 s86, s86, 16384
    buffer_load_dwordx4 v240, s[40:43], s77 offen offset:0 sc1 lds
    buffer_load_dwordx4 v240, s[40:43], s77 offen offset:1024 sc1 lds
    buffer_load_dwordx4 v240, s[40:43], s77 offen offset:2048 sc1 lds
    buffer_load_dwordx4 v240, s[40:43], s77 offen offset:3072 sc1 lds
    s_add_u32 s87, s87, 16384
    buffer_load_dwordx4 v[204:207], v240, s[68:71], s18 offen offset:0 sc1
    buffer_load_dwordx4 v[208:211], v240, s[68:71], s18 offen offset:1024 sc1
    buffer_load_dwordx4 v[212:215], v240, s[68:71], s18 offen offset:2048 sc1
    buffer_load_dwordx4 v[216:219], v240, s[68:71], s18 offen offset:3072 sc1
    buffer_load_dwordx4 v[220:223], v228, s[68:71], s18 offen sc1
    buffer_load_dwordx4 v[188:191], v224, s[56:59], s17 offen sc1
    buffer_load_dwordx4 v[192:195], v225, s[56:59], s17 offen sc1
    buffer_load_dwordx4 v[196:199], v226, s[56:59], s17 offen sc1
    buffer_load_dwordx4 v[200:203], v227, s[56:59], s17 offen sc1
    s_add_u32 s17, s17, 4096
    s_add_u32 s18, s18, 5120
    s_waitcnt vmcnt(17)
    s_barrier
    s_cmp_eq_u32 s88, 0
    s_cselect_b32 s86, s92, s86
    s_cselect_b32 s77, 0x40000000, s87
    s_cselect_b32 s87, s93, s87
    s_cselect_b32 s88, s89, s88
    s_cselect_b32 s89, s16, s89
    s_cmp_eq_u32 s88, 1
    s_cselect_b32 s78, 0x40000000, s86
    s_add_u32 m0, s95, 98304
    s_sub_u32 s88, s88, 1
    buffer_load_dwordx4 v240, s[40:43], s78 offen offset:0 sc1 lds
    buffer_load_dwordx4 v240, s[40:43], s78 offen offset:1024 sc1 lds
    buffer_load_dwordx4 v240, s[40:43], s78 offen offset:2048 sc1 lds
    buffer_load_dwordx4 v240, s[40:43], s78 offen offset:3072 sc1 lds
    s_add_u32 m0, s95, 114688
    s_add_u32 s86, s86, 16384
    buffer_load_dwordx4 v240, s[40:43], s77 offen offset:0 sc1 lds
    buffer_load_dwordx4 v240, s[40:43], s77 offen offset:1024 sc1 lds
    buffer_load_dwordx4 v240, s[40:43], s77 offen offset:2048 sc1 lds
    buffer_load_dwordx4 v240, s[40:43], s77 offen offset:3072 sc1 lds
    s_add_u32 s87, s87, 16384
    buffer_load_dwordx4 v[96:99], v240, s[68:71], s18 offen offset:0 sc1
    buffer_load_dwordx4 v[100:103], v240, s[68:71], s18 offen offset:1024 sc1
    buffer_load_dwordx4 v[104:107], v240, s[68:71], s18 offen offset:2048 sc1
    buffer_load_dwordx4 v[108:111], v240, s[68:71], s18 offen offset:3072 sc1
    buffer_load_dwordx4 v[112:115], v228, s[68:71], s18 offen sc1
    buffer_load_dwordx4 v[80:83], v224, s[56:59], s17 offen sc1
    buffer_load_dwordx4 v[84:87], v225, s[56:59], s17 offen sc1
    buffer_load_dwordx4 v[88:91], v226, s[56:59], s17 offen sc1
    buffer_load_dwordx4 v[92:95], v227, s[56:59], s17 offen sc1
    s_add_u32 s17, s17, 4096
    s_add_u32 s18, s18, 5120
    s_lshl_b32 s95, s76, 13
    v_add_u32 v242, s95, v240
    v_add_u32 v243, 131072, v242
    v_add_u32 v244, 65536, v242
    s_waitcnt vmcnt(26)
    s_barrier
    buffer_load_dwordx4 v[132:135], v240, s[68:71], s18 offen offset:0 sc1
    buffer_load_dwordx4 v[136:139], v240, s[68:71], s18 offen offset:1024 sc1
    buffer_load_dwordx4 v[140:143], v240, s[68:71], s18 offen offset:2048 sc1
    buffer_load_dwordx4 v[144:147], v240, s[68:71], s18 offen offset:3072 sc1
    buffer_load_dwordx4 v[148:151], v228, s[68:71], s18 offen sc1
    buffer_load_dwordx4 v[116:119], v224, s[56:59], s17 offen sc1
    buffer_load_dwordx4 v[120:123], v225, s[56:59], s17 offen sc1
    buffer_load_dwordx4 v[124:127], v226, s[56:59], s17 offen sc1
    buffer_load_dwordx4 v[128:131], v227, s[56:59], s17 offen sc1
    s_add_u32 s17, s17, 4096
    s_add_u32 s18, s18, 5120
    buffer_load_dwordx2 v[230:231], v229, s[32:35], 0 offen offset:0 nt
    buffer_load_dwordx2 v[232:233], v229, s[32:35], 0 offen offset:32 nt
    buffer_load_dwordx2 v[234:235], v229, s[32:35], 0 offen offset:64 nt
    buffer_load_dwordx2 v[236:237], v229, s[32:35], 0 offen offset:96 nt
    buffer_load_dwordx2 v[238:239], v229, s[32:35], 0 offen offset:128 nt
    s_waitcnt vmcnt(23)
    s_barrier
    s_setprio 1
    buffer_load_dwordx4 v[168:171], v240, s[68:71], s18 offen offset:0 sc1
    buffer_load_dwordx4 v[172:175], v240, s[68:71], s18 offen offset:1024 sc1
    buffer_load_dwordx4 v[176:179], v240, s[68:71], s18 offen offset:2048 sc1
    buffer_load_dwordx4 v[180:183], v240, s[68:71], s18 offen offset:3072 sc1
    buffer_load_dwordx4 v[184:187], v228, s[68:71], s18 offen sc1
    buffer_load_dwordx4 v[152:155], v224, s[56:59], s17 offen sc1
    buffer_load_dwordx4 v[156:159], v225, s[56:59], s17 offen sc1
    buffer_load_dwordx4 v[160:163], v226, s[56:59], s17 offen sc1
    buffer_load_dwordx4 v[164:167], v227, s[56:59], s17 offen sc1
    s_add_u32 s17, s17, 4096
    s_add_u32 s18, s18, 5120
    s_add_u32 m0, s95, 131072
    s_nop 0
    buffer_load_dwordx4 v240, s[68:71], s18 offen offset:0 sc1 lds
    s_add_u32 m0, s95, 131072
    s_nop 0
    buffer_load_dwordx4 v240, s[68:71], s18 offen offset:1024 sc1 lds
    s_add_u32 m0, s95, 131072
    s_nop 0
    buffer_load_dwordx4 v240, s[68:71], s18 offen offset:2048 sc1 lds
    s_add_u32 m0, s95, 131072
    s_nop 0
    buffer_load_dwordx4 v240, s[68:71], s18 offen offset:3072 sc1 lds
    s_add_u32 m0, s95, 135168
    s_nop 0
    buffer_load_dwordx4 v228, s[68:71], s18 offen offset:0 sc1 lds
    s_add_u32 m0, s95, 136192
    s_nop 0
    buffer_load_dwordx4 v224, s[56:59], s17 offen offset:0 sc1 lds
    s_add_u32 m0, s95, 137216
    s_nop 0
    buffer_load_dwordx4 v225, s[56:59], s17 offen offset:0 sc1 lds
    s_add_u32 m0, s95, 138240
    s_nop 0
    buffer_load_dwordx4 v226, s[56:59], s17 offen offset:0 sc1 lds
    s_add_u32 m0, s95, 0
    s_nop 0
    buffer_load_dwordx4 v227, s[56:59], s17 offen offset:0 sc1 lds
    s_add_u32 s17, s17, 4096
    s_add_u32 s18, s18, 5120
    s_add_u32 m0, s95, 1024
    s_nop 0
    buffer_load_dwordx4 v240, s[68:71], s18 offen offset:0 sc1 lds
    s_add_u32 m0, s95, 1024
    s_nop 0
    buffer_load_dwordx4 v240, s[68:71], s18 offen offset:1024 sc1 lds
    s_add_u32 m0, s95, 1024
    s_nop 0
    buffer_load_dwordx4 v240, s[68:71], s18 offen offset:2048 sc1 lds
    s_add_u32 m0, s95, 1024
    s_nop 0
    buffer_load_dwordx4 v240, s[68:71], s18 offen offset:3072 sc1 lds
    s_add_u32 m0, s95, 5120
    s_nop 0
    buffer_load_dwordx4 v228, s[68:71], s18 offen offset:0 sc1 lds
    s_add_u32 m0, s95, 6144
    s_nop 0
    buffer_load_dwordx4 v224, s[56:59], s17 offen offset:0 sc1 lds
    s_add_u32 m0, s95, 7168
    s_nop 0
    buffer_load_dwordx4 v225, s[56:59], s17 offen offset:0 sc1 lds
    s_add_u32 m0, s95, 32768
    s_nop 0
    buffer_load_dwordx4 v226, s[56:59], s17 offen offset:0 sc1 lds
    s_add_u32 m0, s95, 33792
    s_nop 0
    buffer_load_dwordx4 v227, s[56:59], s17 offen offset:0 sc1 lds
    s_add_u32 s17, s17, 4096
    s_add_u32 s18, s18, 5120
    s_add_u32 m0, s95, 34816
    s_nop 0
    buffer_load_dwordx4 v240, s[68:71], s18 offen offset:0 sc1 lds
    s_add_u32 m0, s95, 34816
    s_nop 0
    buffer_load_dwordx4 v240, s[68:71], s18 offen offset:1024 sc1 lds
    s_add_u32 m0, s95, 34816
    s_nop 0
    buffer_load_dwordx4 v240, s[68:71], s18 offen offset:2048 sc1 lds
    s_add_u32 m0, s95, 34816
    s_nop 0
    buffer_load_dwordx4 v240, s[68:71], s18 offen offset:3072 sc1 lds
    s_add_u32 m0, s95, 38912
    s_nop 0
    buffer_load_dwordx4 v228, s[68:71], s18 offen offset:0 sc1 lds
    s_add_u32 m0, s95, 39936
    s_nop 0
    buffer_load_dwordx4 v224, s[56:59], s17 offen offset:0 sc1 lds
    s_add_u32 m0, s95, 65536
    s_nop 0
    buffer_load_dwordx4 v225, s[56:59], s17 offen offset:0 sc1 lds
    s_add_u32 m0, s95, 66560
    s_nop 0
    buffer_load_dwordx4 v226, s[56:59], s17 offen offset:0 sc1 lds
    s_add_u32 m0, s95, 67584
    s_nop 0
    buffer_load_dwordx4 v227, s[56:59], s17 offen offset:0 sc1 lds
    s_add_u32 s17, s17, 4096
    s_add_u32 s18, s18, 5120
    s_add_u32 m0, s95, 68608
    s_nop 0
    buffer_load_dwordx4 v240, s[68:71], s18 offen offset:0 sc1 lds
    s_add_u32 m0, s95, 68608
    s_nop 0
    buffer_load_dwordx4 v240, s[68:71], s18 offen offset:1024 sc1 lds
    s_add_u32 m0, s95, 68608
    s_nop 0
    buffer_load_dwordx4 v240, s[68:71], s18 offen offset:2048 sc1 lds
    s_add_u32 m0, s95, 68608
    s_nop 0
    buffer_load_dwordx4 v240, s[68:71], s18 offen offset:3072 sc1 lds
    s_add_u32 m0, s95, 72704
    s_nop 0
    buffer_load_dwordx4 v228, s[68:71], s18 offen offset:0 sc1 lds
    s_mov_b32 s26, s17
    s_add_u32 s17, s17, 4096
    s_add_u32 s18, s18, 5120
    s_waitcnt vmcnt(63)
    v_mfma_f32_16x16x32_bf16 v[0:3], v[204:207], v[188:191], 0
    v_mfma_f32_16x16x32_bf16 v[20:23], v[204:207], v[192:195], 0
    v_mfma_f32_16x16x32_bf16 v[40:43], v[204:207], v[196:199], 0
    v_mfma_f32_16x16x32_bf16 v[60:63], v[204:207], v[200:203], 0
    v_mfma_f32_16x16x32_bf16 v[4:7], v[208:211], v[188:191], 0
    v_mfma_f32_16x16x32_bf16 v[24:27], v[208:211], v[192:195], 0
    v_mfma_f32_16x16x32_bf16 v[44:47], v[208:211], v[196:199], 0
    v_mfma_f32_16x16x32_bf16 v[64:67], v[208:211], v[200:203], 0
    v_mfma_f32_16x16x32_bf16 v[8:11], v[212:215], v[188:191], 0
    v_mfma_f32_16x16x32_bf16 v[28:31], v[212:215], v[192:195], 0
    v_mfma_f32_16x16x32_bf16 v[48:51], v[212:215], v[196:199], 0
    v_mfma_f32_16x16x32_bf16 v[68:71], v[212:215], v[200:203], 0
    v_mfma_f32_16x16x32_bf16 v[12:15], v[216:219], v[188:191], 0
    v_mfma_f32_16x16x32_bf16 v[32:35], v[216:219], v[192:195], 0
    v_mfma_f32_16x16x32_bf16 v[52:55], v[216:219], v[196:199], 0
    v_mfma_f32_16x16x32_bf16 v[72:75], v[216:219], v[200:203], 0
    v_mfma_f32_16x16x32_bf16 v[16:19], v[220:223], v[188:191], 0
    v_mfma_f32_16x16x32_bf16 v[36:39], v[220:223], v[192:195], 0
    v_mfma_f32_16x16x32_bf16 v[56:59], v[220:223], v[196:199], 0
    v_mfma_f32_16x16x32_bf16 v[76:79], v[220:223], v[200:203], 0
    s_waitcnt vmcnt(23)
    ds_read_b128 v[204:207], v243 offset:0
    ds_read_b128 v[208:211], v243 offset:1024
    ds_read_b128 v[212:215], v243 offset:2048
    ds_read_b128 v[216:219], v243 offset:3072
    ds_read_b128 v[220:223], v243 offset:4096
    ds_read_b128 v[188:191], v243 offset:5120
    ds_read_b128 v[192:195], v243 offset:6144
    ds_read_b128 v[196:199], v243 offset:7168
    ds_read_b128 v[200:203], v242 offset:0
    s_waitcnt vmcnt(55)
    v_mfma_f32_16x16x32_bf16 v[0:3], v[96:99], v[80:83], v[0:3]
    v_mfma_f32_16x16x32_bf16 v[20:23], v[96:99], v[84:87], v[20:23]
    v_mfma_f32_16x16x32_bf16 v[40:43], v[96:99], v[88:91], v[40:43]
    v_mfma_f32_16x16x32_bf16 v[60:63], v[96:99], v[92:95], v[60:63]
    buffer_load_dwordx4 v[96:99], v240, s[68:71], s18 offen offset:0 sc1
    v_mfma_f32_16x16x32_bf16 v[4:7], v[100:103], v[80:83], v[4:7]
    v_mfma_f32_16x16x32_bf16 v[24:27], v[100:103], v[84:87], v[24:27]
    v_mfma_f32_16x16x32_bf16 v[44:47], v[100:103], v[88:91], v[44:47]
    v_mfma_f32_16x16x32_bf16 v[64:67], v[100:103], v[92:95], v[64:67]
    buffer_load_dwordx4 v[100:103], v240, s[68:71], s18 offen offset:1024 sc1
    v_mfma_f32_16x16x32_bf16 v[8:11], v[104:107], v[80:83], v[8:11]
    v_mfma_f32_16x16x32_bf16 v[28:31], v[104:107], v[84:87], v[28:31]
    v_mfma_f32_16x16x32_bf16 v[48:51], v[104:107], v[88:91], v[48:51]
    v_mfma_f32_16x16x32_bf16 v[68:71], v[104:107], v[92:95], v[68:71]
    buffer_load_dwordx4 v[104:107], v240, s[68:71], s18 offen offset:2048 sc1
    v_mfma_f32_16x16x32_bf16 v[12:15], v[108:111], v[80:83], v[12:15]
    v_mfma_f32_16x16x32_bf16 v[32:35], v[108:111], v[84:87], v[32:35]
    v_mfma_f32_16x16x32_bf16 v[52:55], v[108:111], v[88:91], v[52:55]
    v_mfma_f32_16x16x32_bf16 v[72:75], v[108:111], v[92:95], v[72:75]
    buffer_load_dwordx4 v[108:111], v240, s[68:71], s18 offen offset:3072 sc1
    v_mfma_f32_16x16x32_bf16 v[16:19], v[112:115], v[80:83], v[16:19]
    v_mfma_f32_16x16x32_bf16 v[36:39], v[112:115], v[84:87], v[36:39]
    v_mfma_f32_16x16x32_bf16 v[56:59], v[112:115], v[88:91], v[56:59]
    v_mfma_f32_16x16x32_bf16 v[76:79], v[112:115], v[92:95], v[76:79]
    buffer_load_dwordx4 v[112:115], v228, s[68:71], s18 offen sc1
    buffer_load_dwordx4 v[80:83], v224, s[56:59], s17 offen sc1
    buffer_load_dwordx4 v[84:87], v225, s[56:59], s17 offen sc1
    buffer_load_dwordx4 v[88:91], v226, s[56:59], s17 offen sc1
    buffer_load_dwordx4 v[92:95], v227, s[56:59], s17 offen sc1
    s_add_u32 s17, s17, 4096
    s_add_u32 s18, s18, 5120
    s_waitcnt vmcnt(55)
    v_mfma_f32_16x16x32_bf16 v[0:3], v[132:135], v[116:119], v[0:3]
    v_mfma_f32_16x16x32_bf16 v[20:23], v[132:135], v[120:123], v[20:23]
    v_mfma_f32_16x16x32_bf16 v[40:43], v[132:135], v[124:127], v[40:43]
    v_mfma_f32_16x16x32_bf16 v[60:63], v[132:135], v[128:131], v[60:63]
    buffer_load_dwordx4 v[132:135], v240, s[68:71], s18 offen offset:0 sc1
    v_mfma_f32_16x16x32_bf16 v[4:7], v[136:139], v[116:119], v[4:7]
    v_mfma_f32_16x16x32_bf16 v[24:27], v[136:139], v[120:123], v[24:27]
    v_mfma_f32_16x16x32_bf16 v[44:47], v[136:139], v[124:127], v[44:47]
    v_mfma_f32_16x16x32_bf16 v[64:67], v[136:139], v[128:131], v[64:67]
    buffer_load_dwordx4 v[136:139], v240, s[68:71], s18 offen offset:1024 sc1
    v_mfma_f32_16x16x32_bf16 v[8:11], v[140:143], v[116:119], v[8:11]
    v_mfma_f32_16x16x32_bf16 v[28:31], v[140:143], v[120:123], v[28:31]
    v_mfma_f32_16x16x32_bf16 v[48:51], v[140:143], v[124:127], v[48:51]
    v_mfma_f32_16x16x32_bf16 v[68:71], v[140:143], v[128:131], v[68:71]
    buffer_load_dwordx4 v[140:143], v240, s[68:71], s18 offen offset:2048 sc1
    v_mfma_f32_16x16x32_bf16 v[12:15], v[144:147], v[116:119], v[12:15]
    v_mfma_f32_16x16x32_bf16 v[32:35], v[144:147], v[120:123], v[32:35]
    v_mfma_f32_16x16x32_bf16 v[52:55], v[144:147], v[124:127], v[52:55]
    v_mfma_f32_16x16x32_bf16 v[72:75], v[144:147], v[128:131], v[72:75]
    buffer_load_dwordx4 v[144:147], v240, s[68:71], s18 offen offset:3072 sc1
    v_mfma_f32_16x16x32_bf16 v[16:19], v[148:151], v[116:119], v[16:19]
    v_mfma_f32_16x16x32_bf16 v[36:39], v[148:151], v[120:123], v[36:39]
    v_mfma_f32_16x16x32_bf16 v[56:59], v[148:151], v[124:127], v[56:59]
    v_mfma_f32_16x16x32_bf16 v[76:79], v[148:151], v[128:131], v[76:79]
    buffer_load_dwordx4 v[148:151], v228, s[68:71], s18 offen sc1
    buffer_load_dwordx4 v[116:119], v224, s[56:59], s17 offen sc1
    buffer_load_dwordx4 v[120:123], v225, s[56:59], s17 offen sc1
    buffer_load_dwordx4 v[124:127], v226, s[56:59], s17 offen sc1
    buffer_load_dwordx4 v[128:131], v227, s[56:59], s17 offen sc1
    s_add_u32 s17, s17, 4096
    s_add_u32 s18, s18, 5120
    s_waitcnt vmcnt(50)
    v_mfma_f32_16x16x32_bf16 v[0:3], v[168:171], v[152:155], v[0:3]
    v_mfma_f32_16x16x32_bf16 v[20:23], v[168:171], v[156:159], v[20:23]
    v_mfma_f32_16x16x32_bf16 v[40:43], v[168:171], v[160:163], v[40:43]
    v_mfma_f32_16x16x32_bf16 v[60:63], v[168:171], v[164:167], v[60:63]
    buffer_load_dwordx4 v[168:171], v240, s[68:71], s18 offen offset:0 sc1
    v_mfma_f32_16x16x32_bf16 v[4:7], v[172:175], v[152:155], v[4:7]
    v_mfma_f32_16x16x32_bf16 v[24:27], v[172:175], v[156:159], v[24:27]
    v_mfma_f32_16x16x32_bf16 v[44:47], v[172:175], v[160:163], v[44:47]
    v_mfma_f32_16x16x32_bf16 v[64:67], v[172:175], v[164:167], v[64:67]
    buffer_load_dwordx4 v[172:175], v240, s[68:71], s18 offen offset:1024 sc1
    v_mfma_f32_16x16x32_bf16 v[8:11], v[176:179], v[152:155], v[8:11]
    v_mfma_f32_16x16x32_bf16 v[28:31], v[176:179], v[156:159], v[28:31]
    v_mfma_f32_16x16x32_bf16 v[48:51], v[176:179], v[160:163], v[48:51]
    v_mfma_f32_16x16x32_bf16 v[68:71], v[176:179], v[164:167], v[68:71]
    buffer_load_dwordx4 v[176:179], v240, s[68:71], s18 offen offset:2048 sc1
    v_mfma_f32_16x16x32_bf16 v[12:15], v[180:183], v[152:155], v[12:15]
    v_mfma_f32_16x16x32_bf16 v[32:35], v[180:183], v[156:159], v[32:35]
    v_mfma_f32_16x16x32_bf16 v[52:55], v[180:183], v[160:163], v[52:55]
    v_mfma_f32_16x16x32_bf16 v[72:75], v[180:183], v[164:167], v[72:75]
    buffer_load_dwordx4 v[180:183], v240, s[68:71], s18 offen offset:3072 sc1
    v_mfma_f32_16x16x32_bf16 v[16:19], v[184:187], v[152:155], v[16:19]
    v_mfma_f32_16x16x32_bf16 v[36:39], v[184:187], v[156:159], v[36:39]
    v_mfma_f32_16x16x32_bf16 v[56:59], v[184:187], v[160:163], v[56:59]
    v_mfma_f32_16x16x32_bf16 v[76:79], v[184:187], v[164:167], v[76:79]
    buffer_load_dwordx4 v[184:187], v228, s[68:71], s18 offen sc1
    buffer_load_dwordx4 v[152:155], v224, s[56:59], s17 offen sc1
    buffer_load_dwordx4 v[156:159], v225, s[56:59], s17 offen sc1
    buffer_load_dwordx4 v[160:163], v226, s[56:59], s17 offen sc1
    buffer_load_dwordx4 v[164:167], v227, s[56:59], s17 offen sc1
    s_add_u32 s17, s17, 4096
    s_add_u32 s18, s18, 5120
    s_waitcnt lgkmcnt(0)
    v_mfma_f32_16x16x32_bf16 v[0:3], v[204:207], v[188:191], v[0:3]
    v_mfma_f32_16x16x32_bf16 v[20:23], v[204:207], v[192:195], v[20:23]
    v_mfma_f32_16x16x32_bf16 v[40:43], v[204:207], v[196:199], v[40:43]
    v_mfma_f32_16x16x32_bf16 v[60:63], v[204:207], v[200:203], v[60:63]
    v_mfma_f32_16x16x32_bf16 v[4:7], v[208:211], v[188:191], v[4:7]
    v_mfma_f32_16x16x32_bf16 v[24:27], v[208:211], v[192:195], v[24:27]
    v_mfma_f32_16x16x32_bf16 v[44:47], v[208:211], v[196:199], v[44:47]
    v_mfma_f32_16x16x32_bf16 v[64:67], v[208:211], v[200:203], v[64:67]
    v_mfma_f32_16x16x32_bf16 v[8:11], v[212:215], v[188:191], v[8:11]
    v_mfma_f32_16x16x32_bf16 v[28:31], v[212:215], v[192:195], v[28:31]
    v_mfma_f32_16x16x32_bf16 v[48:51], v[212:215], v[196:199], v[48:51]
    v_mfma_f32_16x16x32_bf16 v[68:71], v[212:215], v[200:203], v[68:71]
    v_mfma_f32_16x16x32_bf16 v[12:15], v[216:219], v[188:191], v[12:15]
    v_mfma_f32_16x16x32_bf16 v[32:35], v[216:219], v[192:195], v[32:35]
    v_mfma_f32_16x16x32_bf16 v[52:55], v[216:219], v[196:199], v[52:55]
    v_mfma_f32_16x16x32_bf16 v[72:75], v[216:219], v[200:203], v[72:75]
    v_mfma_f32_16x16x32_bf16 v[16:19], v[220:223], v[188:191], v[16:19]
    v_mfma_f32_16x16x32_bf16 v[36:39], v[220:223], v[192:195], v[36:39]
    v_mfma_f32_16x16x32_bf16 v[56:59], v[220:223], v[196:199], v[56:59]
    v_mfma_f32_16x16x32_bf16 v[76:79], v[220:223], v[200:203], v[76:79]
    s_waitcnt vmcnt(41)
    ds_read_b128 v[204:207], v242 offset:1024
    ds_read_b128 v[208:211], v242 offset:2048
    ds_read_b128 v[212:215], v242 offset:3072
    ds_read_b128 v[216:219], v242 offset:4096
    ds_read_b128 v[220:223], v242 offset:5120
    ds_read_b128 v[188:191], v242 offset:6144
    ds_read_b128 v[192:195], v242 offset:7168
    ds_read_b128 v[196:199], v242 offset:32768
    ds_read_b128 v[200:203], v242 offset:33792
    s_waitcnt vmcnt(18)
    v_mfma_f32_16x16x32_bf16 v[0:3], v[96:99], v[80:83], v[0:3]
    v_mfma_f32_16x16x32_bf16 v[20:23], v[96:99], v[84:87], v[20:23]
    v_mfma_f32_16x16x32_bf16 v[40:43], v[96:99], v[88:91], v[40:43]
    v_mfma_f32_16x16x32_bf16 v[60:63], v[96:99], v[92:95], v[60:63]
    buffer_load_dwordx4 v[96:99], v240, s[68:71], s18 offen offset:0 sc1
    v_mfma_f32_16x16x32_bf16 v[4:7], v[100:103], v[80:83], v[4:7]
    v_mfma_f32_16x16x32_bf16 v[24:27], v[100:103], v[84:87], v[24:27]
    v_mfma_f32_16x16x32_bf16 v[44:47], v[100:103], v[88:91], v[44:47]
    v_mfma_f32_16x16x32_bf16 v[64:67], v[100:103], v[92:95], v[64:67]
    buffer_load_dwordx4 v[100:103], v240, s[68:71], s18 offen offset:1024 sc1
    v_mfma_f32_16x16x32_bf16 v[8:11], v[104:107], v[80:83], v[8:11]
    v_mfma_f32_16x16x32_bf16 v[28:31], v[104:107], v[84:87], v[28:31]
    v_mfma_f32_16x16x32_bf16 v[48:51], v[104:107], v[88:91], v[48:51]
    v_mfma_f32_16x16x32_bf16 v[68:71], v[104:107], v[92:95], v[68:71]
    buffer_load_dwordx4 v[104:107], v240, s[68:71], s18 offen offset:2048 sc1
    v_mfma_f32_16x16x32_bf16 v[12:15], v[108:111], v[80:83], v[12:15]
    v_mfma_f32_16x16x32_bf16 v[32:35], v[108:111], v[84:87], v[32:35]
    v_mfma_f32_16x16x32_bf16 v[52:55], v[108:111], v[88:91], v[52:55]
    v_mfma_f32_16x16x32_bf16 v[72:75], v[108:111], v[92:95], v[72:75]
    buffer_load_dwordx4 v[108:111], v240, s[68:71], s18 offen offset:3072 sc1
    v_mfma_f32_16x16x32_bf16 v[16:19], v[112:115], v[80:83], v[16:19]
    v_mfma_f32_16x16x32_bf16 v[36:39], v[112:115], v[84:87], v[36:39]
    v_mfma_f32_16x16x32_bf16 v[56:59], v[112:115], v[88:91], v[56:59]
    v_mfma_f32_16x16x32_bf16 v[76:79], v[112:115], v[92:95], v[76:79]
    buffer_load_dwordx4 v[112:115], v228, s[68:71], s18 offen sc1
    buffer_load_dwordx4 v[80:83], v224, s[56:59], s17 offen sc1
    buffer_load_dwordx4 v[84:87], v225, s[56:59], s17 offen sc1
    buffer_load_dwordx4 v[88:91], v226, s[56:59], s17 offen sc1
    buffer_load_dwordx4 v[92:95], v227, s[56:59], s17 offen sc1
    s_add_u32 s17, s17, 4096
    s_add_u32 s18, s18, 5120
    s_waitcnt lgkmcnt(0)
    v_mfma_f32_16x16x32_bf16 v[0:3], v[204:207], v[188:191], v[0:3]
    v_mfma_f32_16x16x32_bf16 v[20:23], v[204:207], v[192:195], v[20:23]
    v_mfma_f32_16x16x32_bf16 v[40:43], v[204:207], v[196:199], v[40:43]
    v_mfma_f32_16x16x32_bf16 v[60:63], v[204:207], v[200:203], v[60:63]
    v_mfma_f32_16x16x32_bf16 v[4:7], v[208:211], v[188:191], v[4:7]
    v_mfma_f32_16x16x32_bf16 v[24:27], v[208:211], v[192:195], v[24:27]
    v_mfma_f32_16x16x32_bf16 v[44:47], v[208:211], v[196:199], v[44:47]
    v_mfma_f32_16x16x32_bf16 v[64:67], v[208:211], v[200:203], v[64:67]
    v_mfma_f32_16x16x32_bf16 v[8:11], v[212:215], v[188:191], v[8:11]
    v_mfma_f32_16x16x32_bf16 v[28:31], v[212:215], v[192:195], v[28:31]
    v_mfma_f32_16x16x32_bf16 v[48:51], v[212:215], v[196:199], v[48:51]
    v_mfma_f32_16x16x32_bf16 v[68:71], v[212:215], v[200:203], v[68:71]
    v_mfma_f32_16x16x32_bf16 v[12:15], v[216:219], v[188:191], v[12:15]
    v_mfma_f32_16x16x32_bf16 v[32:35], v[216:219], v[192:195], v[32:35]
    v_mfma_f32_16x16x32_bf16 v[52:55], v[216:219], v[196:199], v[52:55]
    v_mfma_f32_16x16x32_bf16 v[72:75], v[216:219], v[200:203], v[72:75]
    v_mfma_f32_16x16x32_bf16 v[16:19], v[220:223], v[188:191], v[16:19]
    v_mfma_f32_16x16x32_bf16 v[36:39], v[220:223], v[192:195], v[36:39]
    v_mfma_f32_16x16x32_bf16 v[56:59], v[220:223], v[196:199], v[56:59]
    v_mfma_f32_16x16x32_bf16 v[76:79], v[220:223], v[200:203], v[76:79]
    s_waitcnt vmcnt(41)
    ds_read_b128 v[204:207], v242 offset:34816
    ds_read_b128 v[208:211], v242 offset:35840
    ds_read_b128 v[212:215], v242 offset:36864
    ds_read_b128 v[216:219], v242 offset:37888
    ds_read_b128 v[220:223], v242 offset:38912
    ds_read_b128 v[188:191], v242 offset:39936
    ds_read_b128 v[192:195], v244 offset:0
    ds_read_b128 v[196:199], v244 offset:1024
    ds_read_b128 v[200:203], v244 offset:2048
    s_waitcnt vmcnt(18)
    v_mfma_f32_16x16x32_bf16 v[0:3], v[132:135], v[116:119], v[0:3]
    v_mfma_f32_16x16x32_bf16 v[20:23], v[132:135], v[120:123], v[20:23]
    v_mfma_f32_16x16x32_bf16 v[40:43], v[132:135], v[124:127], v[40:43]
    v_mfma_f32_16x16x32_bf16 v[60:63], v[132:135], v[128:131], v[60:63]
    buffer_load_dwordx4 v[132:135], v240, s[68:71], s18 offen offset:0 sc1
    v_mfma_f32_16x16x32_bf16 v[4:7], v[136:139], v[116:119], v[4:7]
    v_mfma_f32_16x16x32_bf16 v[24:27], v[136:139], v[120:123], v[24:27]
    v_mfma_f32_16x16x32_bf16 v[44:47], v[136:139], v[124:127], v[44:47]
    v_mfma_f32_16x16x32_bf16 v[64:67], v[136:139], v[128:131], v[64:67]
    buffer_load_dwordx4 v[136:139], v240, s[68:71], s18 offen offset:1024 sc1
    v_mfma_f32_16x16x32_bf16 v[8:11], v[140:143], v[116:119], v[8:11]
    v_mfma_f32_16x16x32_bf16 v[28:31], v[140:143], v[120:123], v[28:31]
    v_mfma_f32_16x16x32_bf16 v[48:51], v[140:143], v[124:127], v[48:51]
    v_mfma_f32_16x16x32_bf16 v[68:71], v[140:143], v[128:131], v[68:71]
    buffer_load_dwordx4 v[140:143], v240, s[68:71], s18 offen offset:2048 sc1
    v_mfma_f32_16x16x32_bf16 v[12:15], v[144:147], v[116:119], v[12:15]
    v_mfma_f32_16x16x32_bf16 v[32:35], v[144:147], v[120:123], v[32:35]
    v_mfma_f32_16x16x32_bf16 v[52:55], v[144:147], v[124:127], v[52:55]
    v_mfma_f32_16x16x32_bf16 v[72:75], v[144:147], v[128:131], v[72:75]
    buffer_load_dwordx4 v[144:147], v240, s[68:71], s18 offen offset:3072 sc1
    v_mfma_f32_16x16x32_bf16 v[16:19], v[148:151], v[116:119], v[16:19]
    v_mfma_f32_16x16x32_bf16 v[36:39], v[148:151], v[120:123], v[36:39]
    v_mfma_f32_16x16x32_bf16 v[56:59], v[148:151], v[124:127], v[56:59]
    v_mfma_f32_16x16x32_bf16 v[76:79], v[148:151], v[128:131], v[76:79]
    buffer_load_dwordx4 v[148:151], v228, s[68:71], s18 offen sc1
    buffer_load_dwordx4 v[116:119], v224, s[56:59], s17 offen sc1
    buffer_load_dwordx4 v[120:123], v225, s[56:59], s17 offen sc1
    buffer_load_dwordx4 v[124:127], v226, s[56:59], s17 offen sc1
    buffer_load_dwordx4 v[128:131], v227, s[56:59], s17 offen sc1
    s_mov_b32 s17, s19
    s_mov_b32 s18, s20
    s_waitcnt lgkmcnt(0)
    v_mfma_f32_16x16x32_bf16 v[0:3], v[204:207], v[188:191], v[0:3]
    v_mfma_f32_16x16x32_bf16 v[20:23], v[204:207], v[192:195], v[20:23]
    v_mfma_f32_16x16x32_bf16 v[40:43], v[204:207], v[196:199], v[40:43]
    v_mfma_f32_16x16x32_bf16 v[60:63], v[204:207], v[200:203], v[60:63]
    v_mfma_f32_16x16x32_bf16 v[4:7], v[208:211], v[188:191], v[4:7]
    v_mfma_f32_16x16x32_bf16 v[24:27], v[208:211], v[192:195], v[24:27]
    v_mfma_f32_16x16x32_bf16 v[44:47], v[208:211], v[196:199], v[44:47]
    v_mfma_f32_16x16x32_bf16 v[64:67], v[208:211], v[200:203], v[64:67]
    v_mfma_f32_16x16x32_bf16 v[8:11], v[212:215], v[188:191], v[8:11]
    v_mfma_f32_16x16x32_bf16 v[28:31], v[212:215], v[192:195], v[28:31]
    v_mfma_f32_16x16x32_bf16 v[48:51], v[212:215], v[196:199], v[48:51]
    v_mfma_f32_16x16x32_bf16 v[68:71], v[212:215], v[200:203], v[68:71]
    v_mfma_f32_16x16x32_bf16 v[12:15], v[216:219], v[188:191], v[12:15]
    v_mfma_f32_16x16x32_bf16 v[32:35], v[216:219], v[192:195], v[32:35]
    v_mfma_f32_16x16x32_bf16 v[52:55], v[216:219], v[196:199], v[52:55]
    v_mfma_f32_16x16x32_bf16 v[72:75], v[216:219], v[200:203], v[72:75]
    v_mfma_f32_16x16x32_bf16 v[16:19], v[220:223], v[188:191], v[16:19]
    v_mfma_f32_16x16x32_bf16 v[36:39], v[220:223], v[192:195], v[36:39]
    v_mfma_f32_16x16x32_bf16 v[56:59], v[220:223], v[196:199], v[56:59]
    v_mfma_f32_16x16x32_bf16 v[76:79], v[220:223], v[200:203], v[76:79]
    s_waitcnt vmcnt(18)
    s_waitcnt vmcnt(45)
    v_mfma_f32_16x16x32_bf16 v[0:3], v[168:171], v[152:155], v[0:3]
    v_mfma_f32_16x16x32_bf16 v[20:23], v[168:171], v[156:159], v[20:23]
    v_mfma_f32_16x16x32_bf16 v[40:43], v[168:171], v[160:163], v[40:43]
    v_mfma_f32_16x16x32_bf16 v[60:63], v[168:171], v[164:167], v[60:63]
    ds_read_b128 v[168:171], v244 offset:3072
    v_mfma_f32_16x16x32_bf16 v[4:7], v[172:175], v[152:155], v[4:7]
    v_mfma_f32_16x16x32_bf16 v[24:27], v[172:175], v[156:159], v[24:27]
    v_mfma_f32_16x16x32_bf16 v[44:47], v[172:175], v[160:163], v[44:47]
    v_mfma_f32_16x16x32_bf16 v[64:67], v[172:175], v[164:167], v[64:67]
    ds_read_b128 v[172:175], v244 offset:4096
    v_mfma_f32_16x16x32_bf16 v[8:11], v[176:179], v[152:155], v[8:11]
    v_mfma_f32_16x16x32_bf16 v[28:31], v[176:179], v[156:159], v[28:31]
    v_mfma_f32_16x16x32_bf16 v[48:51], v[176:179], v[160:163], v[48:51]
    v_mfma_f32_16x16x32_bf16 v[68:71], v[176:179], v[164:167], v[68:71]
    ds_read_b128 v[176:179], v244 offset:5120
    v_mfma_f32_16x16x32_bf16 v[12:15], v[180:183], v[152:155], v[12:15]
    v_mfma_f32_16x16x32_bf16 v[32:35], v[180:183], v[156:159], v[32:35]
    v_mfma_f32_16x16x32_bf16 v[52:55], v[180:183], v[160:163], v[52:55]
    v_mfma_f32_16x16x32_bf16 v[72:75], v[180:183], v[164:167], v[72:75]
    ds_read_b128 v[180:183], v244 offset:6144
    v_mfma_f32_16x16x32_bf16 v[16:19], v[184:187], v[152:155], v[16:19]
    v_mfma_f32_16x16x32_bf16 v[36:39], v[184:187], v[156:159], v[36:39]
    v_mfma_f32_16x16x32_bf16 v[56:59], v[184:187], v[160:163], v[56:59]
    v_mfma_f32_16x16x32_bf16 v[76:79], v[184:187], v[164:167], v[76:79]
    ds_read_b128 v[184:187], v244 offset:7168
    buffer_load_dwordx4 v[152:155], v224, s[56:59], s26 offen sc1
    buffer_load_dwordx4 v[156:159], v225, s[56:59], s26 offen sc1
    buffer_load_dwordx4 v[160:163], v226, s[56:59], s26 offen sc1
    buffer_load_dwordx4 v[164:167], v227, s[56:59], s26 offen sc1
    s_waitcnt vmcnt(13)
    v_mfma_f32_16x16x32_bf16 v[0:3], v[96:99], v[80:83], v[0:3]
    v_mfma_f32_16x16x32_bf16 v[20:23], v[96:99], v[84:87], v[20:23]
    v_mfma_f32_16x16x32_bf16 v[40:43], v[96:99], v[88:91], v[40:43]
    v_mfma_f32_16x16x32_bf16 v[60:63], v[96:99], v[92:95], v[60:63]
    buffer_load_dwordx4 v[96:99], v240, s[68:71], s18 offen offset:0 sc1
    v_mfma_f32_16x16x32_bf16 v[4:7], v[100:103], v[80:83], v[4:7]
    v_mfma_f32_16x16x32_bf16 v[24:27], v[100:103], v[84:87], v[24:27]
    v_mfma_f32_16x16x32_bf16 v[44:47], v[100:103], v[88:91], v[44:47]
    v_mfma_f32_16x16x32_bf16 v[64:67], v[100:103], v[92:95], v[64:67]
    buffer_load_dwordx4 v[100:103], v240, s[68:71], s18 offen offset:1024 sc1
    v_mfma_f32_16x16x32_bf16 v[8:11], v[104:107], v[80:83], v[8:11]
    v_mfma_f32_16x16x32_bf16 v[28:31], v[104:107], v[84:87], v[28:31]
    v_mfma_f32_16x16x32_bf16 v[48:51], v[104:107], v[88:91], v[48:51]
    v_mfma_f32_16x16x32_bf16 v[68:71], v[104:107], v[92:95], v[68:71]
    buffer_load_dwordx4 v[104:107], v240, s[68:71], s18 offen offset:2048 sc1
    v_mfma_f32_16x16x32_bf16 v[12:15], v[108:111], v[80:83], v[12:15]
    v_mfma_f32_16x16x32_bf16 v[32:35], v[108:111], v[84:87], v[32:35]
    v_mfma_f32_16x16x32_bf16 v[52:55], v[108:111], v[88:91], v[52:55]
    v_mfma_f32_16x16x32_bf16 v[72:75], v[108:111], v[92:95], v[72:75]
    buffer_load_dwordx4 v[108:111], v240, s[68:71], s18 offen offset:3072 sc1
    v_mfma_f32_16x16x32_bf16 v[16:19], v[112:115], v[80:83], v[16:19]
    v_mfma_f32_16x16x32_bf16 v[36:39], v[112:115], v[84:87], v[36:39]
    v_mfma_f32_16x16x32_bf16 v[56:59], v[112:115], v[88:91], v[56:59]
    v_mfma_f32_16x16x32_bf16 v[76:79], v[112:115], v[92:95], v[76:79]
    buffer_load_dwordx4 v[112:115], v228, s[68:71], s18 offen sc1
    buffer_load_dwordx4 v[80:83], v224, s[56:59], s17 offen sc1
    buffer_load_dwordx4 v[84:87], v225, s[56:59], s17 offen sc1
    buffer_load_dwordx4 v[88:91], v226, s[56:59], s17 offen sc1
    buffer_load_dwordx4 v[92:95], v227, s[56:59], s17 offen sc1
    s_add_u32 s17, s17, 4096
    s_add_u32 s18, s18, 5120
    s_waitcnt vmcnt(13)
    v_mfma_f32_16x16x32_bf16 v[0:3], v[132:135], v[116:119], v[0:3]
    v_mfma_f32_16x16x32_bf16 v[20:23], v[132:135], v[120:123], v[20:23]
    v_mfma_f32_16x16x32_bf16 v[40:43], v[132:135], v[124:127], v[40:43]
    v_mfma_f32_16x16x32_bf16 v[60:63], v[132:135], v[128:131], v[60:63]
    v_mfma_f32_16x16x32_bf16 v[4:7], v[136:139], v[116:119], v[4:7]
    v_mfma_f32_16x16x32_bf16 v[24:27], v[136:139], v[120:123], v[24:27]
    v_mfma_f32_16x16x32_bf16 v[44:47], v[136:139], v[124:127], v[44:47]
    v_mfma_f32_16x16x32_bf16 v[64:67], v[136:139], v[128:131], v[64:67]
    v_mfma_f32_16x16x32_bf16 v[8:11], v[140:143], v[116:119], v[8:11]
    v_mfma_f32_16x16x32_bf16 v[28:31], v[140:143], v[120:123], v[28:31]
    v_mfma_f32_16x16x32_bf16 v[48:51], v[140:143], v[124:127], v[48:51]
    v_mfma_f32_16x16x32_bf16 v[68:71], v[140:143], v[128:131], v[68:71]
    v_mfma_f32_16x16x32_bf16 v[12:15], v[144:147], v[116:119], v[12:15]
    v_mfma_f32_16x16x32_bf16 v[32:35], v[144:147], v[120:123], v[32:35]
    v_mfma_f32_16x16x32_bf16 v[52:55], v[144:147], v[124:127], v[52:55]
    v_mfma_f32_16x16x32_bf16 v[72:75], v[144:147], v[128:131], v[72:75]
    v_mfma_f32_16x16x32_bf16 v[16:19], v[148:151], v[116:119], v[16:19]
    v_mfma_f32_16x16x32_bf16 v[36:39], v[148:151], v[120:123], v[36:39]
    v_mfma_f32_16x16x32_bf16 v[56:59], v[148:151], v[124:127], v[56:59]
    v_mfma_f32_16x16x32_bf16 v[76:79], v[148:151], v[128:131], v[76:79]
    s_waitcnt vmcnt(9) lgkmcnt(0)
    v_mfma_f32_16x16x32_bf16 v[0:3], v[168:171], v[152:155], v[0:3]
    v_mfma_f32_16x16x32_bf16 v[20:23], v[168:171], v[156:159], v[20:23]
    v_mfma_f32_16x16x32_bf16 v[40:43], v[168:171], v[160:163], v[40:43]
    v_mfma_f32_16x16x32_bf16 v[60:63], v[168:171], v[164:167], v[60:63]
    v_mfma_f32_16x16x32_bf16 v[4:7], v[172:175], v[152:155], v[4:7]
    v_mfma_f32_16x16x32_bf16 v[24:27], v[172:175], v[156:159], v[24:27]
    v_mfma_f32_16x16x32_bf16 v[44:47], v[172:175], v[160:163], v[44:47]
    v_mfma_f32_16x16x32_bf16 v[64:67], v[172:175], v[164:167], v[64:67]
    v_mfma_f32_16x16x32_bf16 v[8:11], v[176:179], v[152:155], v[8:11]
    v_mfma_f32_16x16x32_bf16 v[28:31], v[176:179], v[156:159], v[28:31]
    v_mfma_f32_16x16x32_bf16 v[48:51], v[176:179], v[160:163], v[48:51]
    v_mfma_f32_16x16x32_bf16 v[68:71], v[176:179], v[164:167], v[68:71]
    v_mfma_f32_16x16x32_bf16 v[12:15], v[180:183], v[152:155], v[12:15]
    v_mfma_f32_16x16x32_bf16 v[32:35], v[180:183], v[156:159], v[32:35]
    v_mfma_f32_16x16x32_bf16 v[52:55], v[180:183], v[160:163], v[52:55]
    v_mfma_f32_16x16x32_bf16 v[72:75], v[180:183], v[164:167], v[72:75]
    v_mfma_f32_16x16x32_bf16 v[16:19], v[184:187], v[152:155], v[16:19]
    v_mfma_f32_16x16x32_bf16 v[36:39], v[184:187], v[156:159], v[36:39]
    v_mfma_f32_16x16x32_bf16 v[56:59], v[184:187], v[160:163], v[56:59]
    v_mfma_f32_16x16x32_bf16 v[76:79], v[184:187], v[164:167], v[76:79]
    s_waitcnt vmcnt(0)
    v_mfma_f32_16x16x32_bf16 v[0:3], v[96:99], v[80:83], v[0:3]
    v_mfma_f32_16x16x32_bf16 v[20:23], v[96:99], v[84:87], v[20:23]
    v_mfma_f32_16x16x32_bf16 v[40:43], v[96:99], v[88:91], v[40:43]
    v_mfma_f32_16x16x32_bf16 v[60:63], v[96:99], v[92:95], v[60:63]
    v_mfma_f32_16x16x32_bf16 v[4:7], v[100:103], v[80:83], v[4:7]
    v_mfma_f32_16x16x32_bf16 v[24:27], v[100:103], v[84:87], v[24:27]
    v_mfma_f32_16x16x32_bf16 v[44:47], v[100:103], v[88:91], v[44:47]
    v_mfma_f32_16x16x32_bf16 v[64:67], v[100:103], v[92:95], v[64:67]
    v_mfma_f32_16x16x32_bf16 v[8:11], v[104:107], v[80:83], v[8:11]
    v_mfma_f32_16x16x32_bf16 v[28:31], v[104:107], v[84:87], v[28:31]
    v_mfma_f32_16x16x32_bf16 v[48:51], v[104:107], v[88:91], v[48:51]
    v_mfma_f32_16x16x32_bf16 v[68:71], v[104:107], v[92:95], v[68:71]
    v_mfma_f32_16x16x32_bf16 v[12:15], v[108:111], v[80:83], v[12:15]
    v_mfma_f32_16x16x32_bf16 v[32:35], v[108:111], v[84:87], v[32:35]
    v_mfma_f32_16x16x32_bf16 v[52:55], v[108:111], v[88:91], v[52:55]
    v_mfma_f32_16x16x32_bf16 v[72:75], v[108:111], v[92:95], v[72:75]
    v_mfma_f32_16x16x32_bf16 v[16:19], v[112:115], v[80:83], v[16:19]
    v_mfma_f32_16x16x32_bf16 v[36:39], v[112:115], v[84:87], v[36:39]
    v_mfma_f32_16x16x32_bf16 v[56:59], v[112:115], v[88:91], v[56:59]
    v_mfma_f32_16x16x32_bf16 v[76:79], v[112:115], v[92:95], v[76:79]
    s_barrier
    s_mul_i32 s77, s76, 20480
    v_add_u32 v243, s77, v240
    s_nop 6
    ds_write_b128 v243, v[0:3] offset:0
    ds_write_b128 v243, v[4:7] offset:1024
    ds_write_b128 v243, v[8:11] offset:2048
    ds_write_b128 v243, v[12:15] offset:3072
    ds_write_b128 v243, v[16:19] offset:4096
    ds_write_b128 v243, v[20:23] offset:5120
    ds_write_b128 v243, v[24:27] offset:6144
    ds_write_b128 v243, v[28:31] offset:7168
    ds_write_b128 v243, v[32:35] offset:8192
    ds_write_b128 v243, v[36:39] offset:9216
    ds_write_b128 v243, v[40:43] offset:10240
    ds_write_b128 v243, v[44:47] offset:11264
    ds_write_b128 v243, v[48:51] offset:12288
    ds_write_b128 v243, v[52:55] offset:13312
    ds_write_b128 v243, v[56:59] offset:14336
    ds_write_b128 v243, v[60:63] offset:15360
    ds_write_b128 v243, v[64:67] offset:16384
    ds_write_b128 v243, v[68:71] offset:17408
    ds_write_b128 v243, v[72:75] offset:18432
    ds_write_b128 v243, v[76:79] offset:19456
    s_mul_i32 s77, s76, 5120
    v_add_u32 v243, s77, v240
    v_add_u32 v244, 40960, v243
    v_add_u32 v245, 81920, v243
    v_add_u32 v246, 122880, v243
    s_waitcnt lgkmcnt(0)
    s_barrier
    ds_read_b128 v[80:83], v243 offset:0
    ds_read_b128 v[84:87], v243 offset:1024
    ds_read_b128 v[88:91], v243 offset:2048
    ds_read_b128 v[92:95], v243 offset:3072
    ds_read_b128 v[96:99], v243 offset:4096
    ds_read_b128 v[100:103], v243 offset:20480
    ds_read_b128 v[104:107], v243 offset:21504
    ds_read_b128 v[108:111], v243 offset:22528
    ds_read_b128 v[112:115], v243 offset:23552
    ds_read_b128 v[116:119], v243 offset:24576
    ds_read_b128 v[120:123], v244 offset:0
    ds_read_b128 v[124:127], v244 offset:1024
    ds_read_b128 v[128:131], v244 offset:2048
    ds_read_b128 v[132:135], v244 offset:3072
    ds_read_b128 v[136:139], v244 offset:4096
    ds_read_b128 v[140:143], v244 offset:20480
    ds_read_b128 v[144:147], v244 offset:21504
    ds_read_b128 v[148:151], v244 offset:22528
    ds_read_b128 v[152:155], v244 offset:23552
    ds_read_b128 v[156:159], v244 offset:24576
    s_waitcnt lgkmcnt(0)
    v_add_f32 v80, v80, v100
    v_add_f32 v120, v120, v140
    v_add_f32 v81, v81, v101
    v_add_f32 v121, v121, v141
    v_add_f32 v82, v82, v102
    v_add_f32 v122, v122, v142
    v_add_f32 v83, v83, v103
    v_add_f32 v123, v123, v143
    v_add_f32 v84, v84, v104
    v_add_f32 v124, v124, v144
    v_add_f32 v85, v85, v105
    v_add_f32 v125, v125, v145
    v_add_f32 v86, v86, v106
    v_add_f32 v126, v126, v146
    v_add_f32 v87, v87, v107
    v_add_f32 v127, v127, v147
    v_add_f32 v88, v88, v108
    v_add_f32 v128, v128, v148
    v_add_f32 v89, v89, v109
    v_add_f32 v129, v129, v149
    v_add_f32 v90, v90, v110
    v_add_f32 v130, v130, v150
    v_add_f32 v91, v91, v111
    v_add_f32 v131, v131, v151
    v_add_f32 v92, v92, v112
    v_add_f32 v132, v132, v152
    v_add_f32 v93, v93, v113
    v_add_f32 v133, v133, v153
    v_add_f32 v94, v94, v114
    v_add_f32 v134, v134, v154
    v_add_f32 v95, v95, v115
    v_add_f32 v135, v135, v155
    v_add_f32 v96, v96, v116
    v_add_f32 v136, v136, v156
    v_add_f32 v97, v97, v117
    v_add_f32 v137, v137, v157
    v_add_f32 v98, v98, v118
    v_add_f32 v138, v138, v158
    v_add_f32 v99, v99, v119
    v_add_f32 v139, v139, v159
    v_add_f32 v80, v80, v120
    v_add_f32 v81, v81, v121
    v_add_f32 v82, v82, v122
    v_add_f32 v83, v83, v123
    v_add_f32 v84, v84, v124
    v_add_f32 v85, v85, v125
    v_add_f32 v86, v86, v126
    v_add_f32 v87, v87, v127
    v_add_f32 v88, v88, v128
    v_add_f32 v89, v89, v129
    v_add_f32 v90, v90, v130
    v_add_f32 v91, v91, v131
    v_add_f32 v92, v92, v132
    v_add_f32 v93, v93, v133
    v_add_f32 v94, v94, v134
    v_add_f32 v95, v95, v135
    v_add_f32 v96, v96, v136
    v_add_f32 v97, v97, v137
    v_add_f32 v98, v98, v138
    v_add_f32 v99, v99, v139
    v_cvt_pk_bf16_f32 v100, v80, v81
    v_lshlrev_b32 v80, 16, v100
    v_and_b32 v81, 0xffff0000, v100
    v_cvt_pk_bf16_f32 v102, v82, v83
    v_lshlrev_b32 v82, 16, v102
    v_and_b32 v83, 0xffff0000, v102
    v_cvt_pk_bf16_f32 v104, v84, v85
    v_lshlrev_b32 v84, 16, v104
    v_and_b32 v85, 0xffff0000, v104
    v_cvt_pk_bf16_f32 v106, v86, v87
    v_lshlrev_b32 v86, 16, v106
    v_and_b32 v87, 0xffff0000, v106
    v_cvt_pk_bf16_f32 v108, v88, v89
    v_lshlrev_b32 v88, 16, v108
    v_and_b32 v89, 0xffff0000, v108
    v_cvt_pk_bf16_f32 v110, v90, v91
    v_lshlrev_b32 v90, 16, v110
    v_and_b32 v91, 0xffff0000, v110
    v_cvt_pk_bf16_f32 v112, v92, v93
    v_lshlrev_b32 v92, 16, v112
    v_and_b32 v93, 0xffff0000, v112
    v_cvt_pk_bf16_f32 v114, v94, v95
    v_lshlrev_b32 v94, 16, v114
    v_and_b32 v95, 0xffff0000, v114
    v_cvt_pk_bf16_f32 v116, v96, v97
    v_lshlrev_b32 v96, 16, v116
    v_and_b32 v97, 0xffff0000, v116
    v_cvt_pk_bf16_f32 v118, v98, v99
    v_lshlrev_b32 v98, 16, v118
    v_and_b32 v99, 0xffff0000, v118
    v_mul_f32 v100, s21, v80
    v_mul_f32 v101, s21, v81
    v_mul_f32 v102, s21, v82
    v_mul_f32 v103, s21, v83
    v_mul_f32 v104, s21, v84
    v_mul_f32 v105, s21, v85
    v_mul_f32 v106, s21, v86
    v_mul_f32 v107, s21, v87
    v_mul_f32 v108, s21, v88
    v_mul_f32 v109, s21, v89
    v_mul_f32 v110, s21, v90
    v_mul_f32 v111, s21, v91
    v_mul_f32 v112, s21, v92
    v_mul_f32 v113, s21, v93
    v_mul_f32 v114, s21, v94
    v_mul_f32 v115, s21, v95
    v_mul_f32 v116, s21, v96
    v_mul_f32 v117, s21, v97
    v_mul_f32 v118, s21, v98
    v_mul_f32 v119, s21, v99
    v_exp_f32 v100, v100
    v_exp_f32 v101, v101
    v_exp_f32 v102, v102
    v_exp_f32 v103, v103
    v_exp_f32 v104, v104
    v_exp_f32 v105, v105
    v_exp_f32 v106, v106
    v_exp_f32 v107, v107
    v_exp_f32 v108, v108
    v_exp_f32 v109, v109
    v_exp_f32 v110, v110
    v_exp_f32 v111, v111
    v_exp_f32 v112, v112
    v_exp_f32 v113, v113
    v_exp_f32 v114, v114
    v_exp_f32 v115, v115
    v_exp_f32 v116, v116
    v_exp_f32 v117, v117
    v_exp_f32 v118, v118
    v_exp_f32 v119, v119
    v_add_f32 v100, 1.0, v100
    v_add_f32 v101, 1.0, v101
    v_add_f32 v102, 1.0, v102
    v_add_f32 v103, 1.0, v103
    v_add_f32 v104, 1.0, v104
    v_add_f32 v105, 1.0, v105
    v_add_f32 v106, 1.0, v106
    v_add_f32 v107, 1.0, v107
    v_add_f32 v108, 1.0, v108
    v_add_f32 v109, 1.0, v109
    v_add_f32 v110, 1.0, v110
    v_add_f32 v111, 1.0, v111
    v_add_f32 v112, 1.0, v112
    v_add_f32 v113, 1.0, v113
    v_add_f32 v114, 1.0, v114
    v_add_f32 v115, 1.0, v115
    v_add_f32 v116, 1.0, v116
    v_add_f32 v117, 1.0, v117
    v_add_f32 v118, 1.0, v118
    v_add_f32 v119, 1.0, v119
    v_rcp_f32 v100, v100
    v_rcp_f32 v101, v101
    v_rcp_f32 v102, v102
    v_rcp_f32 v103, v103
    v_rcp_f32 v104, v104
    v_rcp_f32 v105, v105
    v_rcp_f32 v106, v106
    v_rcp_f32 v107, v107
    v_rcp_f32 v108, v108
    v_rcp_f32 v109, v109
    v_rcp_f32 v110, v110
    v_rcp_f32 v111, v111
    v_rcp_f32 v112, v112
    v_rcp_f32 v113, v113
    v_rcp_f32 v114, v114
    v_rcp_f32 v115, v115
    v_rcp_f32 v116, v116
    v_rcp_f32 v117, v117
    v_rcp_f32 v118, v118
    v_rcp_f32 v119, v119
    v_mul_f32 v80, v80, v100
    v_mul_f32 v81, v81, v101
    v_mul_f32 v82, v82, v102
    v_mul_f32 v83, v83, v103
    v_mul_f32 v84, v84, v104
    v_mul_f32 v85, v85, v105
    v_mul_f32 v86, v86, v106
    v_mul_f32 v87, v87, v107
    v_mul_f32 v88, v88, v108
    v_mul_f32 v89, v89, v109
    v_mul_f32 v90, v90, v110
    v_mul_f32 v91, v91, v111
    v_mul_f32 v92, v92, v112
    v_mul_f32 v93, v93, v113
    v_mul_f32 v94, v94, v114
    v_mul_f32 v95, v95, v115
    v_mul_f32 v96, v96, v116
    v_mul_f32 v97, v97, v117
    v_mul_f32 v98, v98, v118
    v_mul_f32 v99, v99, v119
    v_cvt_pk_bf16_f32 v100, v80, v81
    v_lshlrev_b32 v80, 16, v100
    v_and_b32 v81, 0xffff0000, v100
    v_cvt_pk_bf16_f32 v102, v82, v83
    v_lshlrev_b32 v82, 16, v102
    v_and_b32 v83, 0xffff0000, v102
    v_cvt_pk_bf16_f32 v104, v84, v85
    v_lshlrev_b32 v84, 16, v104
    v_and_b32 v85, 0xffff0000, v104
    v_cvt_pk_bf16_f32 v106, v86, v87
    v_lshlrev_b32 v86, 16, v106
    v_and_b32 v87, 0xffff0000, v106
    v_cvt_pk_bf16_f32 v108, v88, v89
    v_lshlrev_b32 v88, 16, v108
    v_and_b32 v89, 0xffff0000, v108
    v_cvt_pk_bf16_f32 v110, v90, v91
    v_lshlrev_b32 v90, 16, v110
    v_and_b32 v91, 0xffff0000, v110
    v_cvt_pk_bf16_f32 v112, v92, v93
    v_lshlrev_b32 v92, 16, v112
    v_and_b32 v93, 0xffff0000, v112
    v_cvt_pk_bf16_f32 v114, v94, v95
    v_lshlrev_b32 v94, 16, v114
    v_and_b32 v95, 0xffff0000, v114
    v_cvt_pk_bf16_f32 v116, v96, v97
    v_lshlrev_b32 v96, 16, v116
    v_and_b32 v97, 0xffff0000, v116
    v_cvt_pk_bf16_f32 v118, v98, v99
    v_lshlrev_b32 v98, 16, v118
    v_and_b32 v99, 0xffff0000, v118
    s_waitcnt vmcnt(0)
    v_lshlrev_b32 v100, 16, v230
    v_and_b32 v101, 0xffff0000, v230
    v_lshlrev_b32 v102, 16, v231
    v_and_b32 v103, 0xffff0000, v231
    v_lshlrev_b32 v104, 16, v232
    v_and_b32 v105, 0xffff0000, v232
    v_lshlrev_b32 v106, 16, v233
    v_and_b32 v107, 0xffff0000, v233
    v_lshlrev_b32 v108, 16, v234
    v_and_b32 v109, 0xffff0000, v234
    v_lshlrev_b32 v110, 16, v235
    v_and_b32 v111, 0xffff0000, v235
    v_lshlrev_b32 v112, 16, v236
    v_and_b32 v113, 0xffff0000, v236
    v_lshlrev_b32 v114, 16, v237
    v_and_b32 v115, 0xffff0000, v237
    v_lshlrev_b32 v116, 16, v238
    v_and_b32 v117, 0xffff0000, v238
    v_lshlrev_b32 v118, 16, v239
    v_and_b32 v119, 0xffff0000, v239
    s_setprio 3
    s_barrier
    ds_read_b128 v[0:3], v245 offset:0
    ds_read_b128 v[4:7], v245 offset:20480
    ds_read_b128 v[8:11], v246 offset:0
    ds_read_b128 v[12:15], v246 offset:20480
    ds_read_b128 v[16:19], v245 offset:1024
    ds_read_b128 v[20:23], v245 offset:21504
    ds_read_b128 v[24:27], v246 offset:1024
    ds_read_b128 v[28:31], v246 offset:21504
    ds_read_b128 v[32:35], v245 offset:2048
    ds_read_b128 v[36:39], v245 offset:22528
    ds_read_b128 v[40:43], v246 offset:2048
    ds_read_b128 v[44:47], v246 offset:22528
    ds_read_b128 v[48:51], v245 offset:3072
    ds_read_b128 v[52:55], v245 offset:23552
    ds_read_b128 v[56:59], v246 offset:3072
    ds_read_b128 v[60:63], v246 offset:23552
    ds_read_b128 v[64:67], v245 offset:4096
    ds_read_b128 v[68:71], v245 offset:24576
    ds_read_b128 v[72:75], v246 offset:4096
    ds_read_b128 v[76:79], v246 offset:24576
    s_waitcnt lgkmcnt(15)
    v_pk_add_f32 v[0:1], v[0:1], v[4:5]
    v_pk_add_f32 v[8:9], v[8:9], v[12:13]
    v_pk_add_f32 v[2:3], v[2:3], v[6:7]
    v_pk_add_f32 v[10:11], v[10:11], v[14:15]
    v_pk_add_f32 v[0:1], v[0:1], v[8:9]
    v_pk_add_f32 v[2:3], v[2:3], v[10:11]
    v_cvt_pk_bf16_f32 v4, v0, v1
    v_cvt_pk_bf16_f32 v6, v2, v3
    v_lshlrev_b32 v0, 16, v4
    v_lshlrev_b32 v2, 16, v6
    v_and_b32 v1, 0xffff0000, v4
    v_and_b32 v3, 0xffff0000, v6
    v_pk_mul_f32 v[0:1], v[0:1], v[80:81]
    v_pk_mul_f32 v[2:3], v[2:3], v[82:83]
    v_cvt_pk_bf16_f32 v4, v0, v1
    v_cvt_pk_bf16_f32 v6, v2, v3
    v_lshlrev_b32 v0, 16, v4
    v_lshlrev_b32 v2, 16, v6
    v_and_b32 v1, 0xffff0000, v4
    v_and_b32 v3, 0xffff0000, v6
    v_pk_add_f32 v[0:1], v[0:1], v[100:101]
    v_pk_add_f32 v[2:3], v[2:3], v[102:103]
    v_cvt_pk_bf16_f32 v8, v0, v1
    v_cvt_pk_bf16_f32 v9, v2, v3
    buffer_store_dwordx2 v[8:9], v229, s[36:39], 0 offen offset:0
    s_waitcnt lgkmcnt(12)
    v_pk_add_f32 v[16:17], v[16:17], v[20:21]
    v_pk_add_f32 v[24:25], v[24:25], v[28:29]
    v_pk_add_f32 v[18:19], v[18:19], v[22:23]
    v_pk_add_f32 v[26:27], v[26:27], v[30:31]
    v_pk_add_f32 v[16:17], v[16:17], v[24:25]
    v_pk_add_f32 v[18:19], v[18:19], v[26:27]
    v_cvt_pk_bf16_f32 v20, v16, v17
    v_cvt_pk_bf16_f32 v22, v18, v19
    v_lshlrev_b32 v16, 16, v20
    v_lshlrev_b32 v18, 16, v22
    v_and_b32 v17, 0xffff0000, v20
    v_and_b32 v19, 0xffff0000, v22
    v_pk_mul_f32 v[16:17], v[16:17], v[84:85]
    v_pk_mul_f32 v[18:19], v[18:19], v[86:87]
    v_cvt_pk_bf16_f32 v20, v16, v17
    v_cvt_pk_bf16_f32 v22, v18, v19
    v_lshlrev_b32 v16, 16, v20
    v_lshlrev_b32 v18, 16, v22
    v_and_b32 v17, 0xffff0000, v20
    v_and_b32 v19, 0xffff0000, v22
    v_pk_add_f32 v[16:17], v[16:17], v[104:105]
    v_pk_add_f32 v[18:19], v[18:19], v[106:107]
    v_cvt_pk_bf16_f32 v24, v16, v17
    v_cvt_pk_bf16_f32 v25, v18, v19
    buffer_store_dwordx2 v[24:25], v229, s[36:39], 0 offen offset:32
    s_waitcnt lgkmcnt(8)
    v_pk_add_f32 v[32:33], v[32:33], v[36:37]
    v_pk_add_f32 v[40:41], v[40:41], v[44:45]
    v_pk_add_f32 v[34:35], v[34:35], v[38:39]
    v_pk_add_f32 v[42:43], v[42:43], v[46:47]
    v_pk_add_f32 v[32:33], v[32:33], v[40:41]
    v_pk_add_f32 v[34:35], v[34:35], v[42:43]
    v_cvt_pk_bf16_f32 v36, v32, v33
    v_cvt_pk_bf16_f32 v38, v34, v35
    v_lshlrev_b32 v32, 16, v36
    v_lshlrev_b32 v34, 16, v38
    v_and_b32 v33, 0xffff0000, v36
    v_and_b32 v35, 0xffff0000, v38
    v_pk_mul_f32 v[32:33], v[32:33], v[88:89]
    v_pk_mul_f32 v[34:35], v[34:35], v[90:91]
    v_cvt_pk_bf16_f32 v36, v32, v33
    v_cvt_pk_bf16_f32 v38, v34, v35
    v_lshlrev_b32 v32, 16, v36
    v_lshlrev_b32 v34, 16, v38
    v_and_b32 v33, 0xffff0000, v36
    v_and_b32 v35, 0xffff0000, v38
    v_pk_add_f32 v[32:33], v[32:33], v[108:109]
    v_pk_add_f32 v[34:35], v[34:35], v[110:111]
    v_cvt_pk_bf16_f32 v40, v32, v33
    v_cvt_pk_bf16_f32 v41, v34, v35
    buffer_store_dwordx2 v[40:41], v229, s[36:39], 0 offen offset:64
    s_waitcnt lgkmcnt(4)
    v_pk_add_f32 v[48:49], v[48:49], v[52:53]
    v_pk_add_f32 v[56:57], v[56:57], v[60:61]
    v_pk_add_f32 v[50:51], v[50:51], v[54:55]
    v_pk_add_f32 v[58:59], v[58:59], v[62:63]
    v_pk_add_f32 v[48:49], v[48:49], v[56:57]
    v_pk_add_f32 v[50:51], v[50:51], v[58:59]
    v_cvt_pk_bf16_f32 v52, v48, v49
    v_cvt_pk_bf16_f32 v54, v50, v51
    v_lshlrev_b32 v48, 16, v52
    v_lshlrev_b32 v50, 16, v54
    v_and_b32 v49, 0xffff0000, v52
    v_and_b32 v51, 0xffff0000, v54
    v_pk_mul_f32 v[48:49], v[48:49], v[92:93]
    v_pk_mul_f32 v[50:51], v[50:51], v[94:95]
    v_cvt_pk_bf16_f32 v52, v48, v49
    v_cvt_pk_bf16_f32 v54, v50, v51
    v_lshlrev_b32 v48, 16, v52
    v_lshlrev_b32 v50, 16, v54
    v_and_b32 v49, 0xffff0000, v52
    v_and_b32 v51, 0xffff0000, v54
    v_pk_add_f32 v[48:49], v[48:49], v[112:113]
    v_pk_add_f32 v[50:51], v[50:51], v[114:115]
    v_cvt_pk_bf16_f32 v56, v48, v49
    v_cvt_pk_bf16_f32 v57, v50, v51
    buffer_store_dwordx2 v[56:57], v229, s[36:39], 0 offen offset:96
    s_waitcnt lgkmcnt(0)
    v_pk_add_f32 v[64:65], v[64:65], v[68:69]
    v_pk_add_f32 v[72:73], v[72:73], v[76:77]
    v_pk_add_f32 v[66:67], v[66:67], v[70:71]
    v_pk_add_f32 v[74:75], v[74:75], v[78:79]
    v_pk_add_f32 v[64:65], v[64:65], v[72:73]
    v_pk_add_f32 v[66:67], v[66:67], v[74:75]
    v_cvt_pk_bf16_f32 v68, v64, v65
    v_cvt_pk_bf16_f32 v70, v66, v67
    v_lshlrev_b32 v64, 16, v68
    v_lshlrev_b32 v66, 16, v70
    v_and_b32 v65, 0xffff0000, v68
    v_and_b32 v67, 0xffff0000, v70
    v_pk_mul_f32 v[64:65], v[64:65], v[96:97]
    v_pk_mul_f32 v[66:67], v[66:67], v[98:99]
    v_cvt_pk_bf16_f32 v68, v64, v65
    v_cvt_pk_bf16_f32 v70, v66, v67
    v_lshlrev_b32 v64, 16, v68
    v_lshlrev_b32 v66, 16, v70
    v_and_b32 v65, 0xffff0000, v68
    v_and_b32 v67, 0xffff0000, v70
    v_pk_add_f32 v[64:65], v[64:65], v[116:117]
    v_pk_add_f32 v[66:67], v[66:67], v[118:119]
    v_cvt_pk_bf16_f32 v72, v64, v65
    v_cvt_pk_bf16_f32 v73, v66, v67
    buffer_store_dwordx2 v[72:73], v229, s[36:39], 0 offen offset:128
KB_END:
    s_endpgm
KB_YK:
    s_waitcnt lgkmcnt(6)
    v_mfma_f32_16x16x32_bf16 v[0:3], v[224:227], v[192:195], 0
    ds_read_b128 v[208:211], v245 offset:8192
    s_add_u32 m0, s83, 114688
    v_mfma_f32_16x16x32_bf16 v[8:11], v[224:227], v[196:199], 0
    ds_read_b128 v[212:215], v245 offset:10240
    s_add_u32 s89, s88, 31744
    v_mfma_f32_16x16x32_bf16 v[32:35], v[224:227], v[200:203], 0
    ds_read_b128 v[216:219], v245 offset:12288
    v_mfma_f32_16x16x32_bf16 v[40:43], v[224:227], v[204:207], 0
    ds_read_b128 v[220:223], v245 offset:14336
    buffer_load_dwordx4 v244, s[36:39], s88 offen nt lds
    s_waitcnt lgkmcnt(8)
    v_mfma_f32_16x16x32_bf16 v[4:7], v[228:231], v[192:195], 0
    v_xor_b32 v245, 64, v245
    v_mfma_f32_16x16x32_bf16 v[12:15], v[228:231], v[196:199], 0
    buffer_load_dwordx4 v244, s[36:39], s89 offen offset:1024 nt lds
    v_mfma_f32_16x16x32_bf16 v[36:39], v[228:231], v[200:203], 0
    v_mfma_f32_16x16x32_bf16 v[44:47], v[228:231], v[204:207], 0
    s_add_u32 s88, s88, 262144
    s_waitcnt lgkmcnt(6)
    v_mfma_f32_16x16x32_bf16 v[16:19], v[232:235], v[192:195], 0
    s_add_u32 m0, s81, 131072
    v_mfma_f32_16x16x32_bf16 v[24:27], v[232:235], v[196:199], 0
    v_mfma_f32_16x16x32_bf16 v[48:51], v[232:235], v[200:203], 0
    s_nop 0
    v_mfma_f32_16x16x32_bf16 v[56:59], v[232:235], v[204:207], 0
    s_waitcnt lgkmcnt(4)
    v_mfma_f32_16x16x32_bf16 v[20:23], v[236:239], v[192:195], 0
    buffer_load_dwordx4 v243, s[32:35], s86 offen lds
    v_mfma_f32_16x16x32_bf16 v[28:31], v[236:239], v[196:199], 0
    v_mfma_f32_16x16x32_bf16 v[52:55], v[236:239], v[200:203], 0
    buffer_load_dwordx4 v183, s[32:35], s86 offen offset:1024 lds
    v_mfma_f32_16x16x32_bf16 v[60:63], v[236:239], v[204:207], 0
    s_waitcnt vmcnt(10) lgkmcnt(0)
    s_barrier
    v_mfma_f32_16x16x32_bf16 v[64:67], v[224:227], v[208:211], 0
    ds_read_b128 v[192:195], v245 offset:0
    s_add_u32 m0, s81, 131072
    v_mfma_f32_16x16x32_bf16 v[72:75], v[224:227], v[212:215], 0
    ds_read_b128 v[196:199], v245 offset:2048
    s_add_u32 s87, s86, 14336
    v_mfma_f32_16x16x32_bf16 v[96:99], v[224:227], v[216:219], 0
    ds_read_b128 v[200:203], v245 offset:4096
    v_mfma_f32_16x16x32_bf16 v[104:107], v[224:227], v[220:223], 0
    ds_read_b64_tr_b16 v[224:225], v246 offset:16384
    ds_read_b64_tr_b16 v[226:227], v246 offset:17408
    ds_read_b128 v[204:207], v245 offset:6144
    buffer_load_dwordx4 v243, s[32:35], s87 offen offset:2048 lds
    v_mfma_f32_16x16x32_bf16 v[68:71], v[228:231], v[208:211], 0
    buffer_load_dwordx4 v183, s[32:35], s87 offen offset:3072 lds
    v_mfma_f32_16x16x32_bf16 v[76:79], v[228:231], v[212:215], 0
    v_mfma_f32_16x16x32_bf16 v[100:103], v[228:231], v[216:219], 0
    s_add_u32 s86, s86, 128
    v_mfma_f32_16x16x32_bf16 v[108:111], v[228:231], v[220:223], 0
    ds_read_b64_tr_b16 v[228:229], v247 offset:16384
    ds_read_b64_tr_b16 v[230:231], v247 offset:17408
    v_mfma_f32_16x16x32_bf16 v[80:83], v[232:235], v[208:211], 0
    s_add_u32 m0, s83, 32768
    v_mfma_f32_16x16x32_bf16 v[88:91], v[232:235], v[212:215], 0
    s_add_u32 s89, s88, 31744
    v_mfma_f32_16x16x32_bf16 v[112:115], v[232:235], v[216:219], 0
    v_mfma_f32_16x16x32_bf16 v[120:123], v[232:235], v[220:223], 0
    ds_read_b64_tr_b16 v[232:233], v248 offset:16384
    ds_read_b64_tr_b16 v[234:235], v248 offset:17408
    buffer_load_dwordx4 v244, s[36:39], s88 offen nt lds
    v_mfma_f32_16x16x32_bf16 v[84:87], v[236:239], v[208:211], 0
    buffer_load_dwordx4 v244, s[36:39], s89 offen offset:1024 nt lds
    v_mfma_f32_16x16x32_bf16 v[92:95], v[236:239], v[212:215], 0
    v_mfma_f32_16x16x32_bf16 v[116:119], v[236:239], v[216:219], 0
    s_add_u32 s88, s88, 262144
    v_mfma_f32_16x16x32_bf16 v[124:127], v[236:239], v[220:223], 0
    ds_read_b64_tr_b16 v[236:237], v249 offset:16384
    ds_read_b64_tr_b16 v[238:239], v249 offset:17408
    s_waitcnt lgkmcnt(6)
    v_mfma_f32_16x16x32_bf16 v[0:3], v[224:227], v[192:195], v[0:3]
    ds_read_b128 v[208:211], v245 offset:8192
    v_mfma_f32_16x16x32_bf16 v[8:11], v[224:227], v[196:199], v[8:11]
    ds_read_b128 v[212:215], v245 offset:10240
    v_mfma_f32_16x16x32_bf16 v[32:35], v[224:227], v[200:203], v[32:35]
    ds_read_b128 v[216:219], v245 offset:12288
    v_mfma_f32_16x16x32_bf16 v[40:43], v[224:227], v[204:207], v[40:43]
    ds_read_b128 v[220:223], v245 offset:14336
    s_waitcnt lgkmcnt(8)
    v_mfma_f32_16x16x32_bf16 v[4:7], v[228:231], v[192:195], v[4:7]
    v_xor_b32 v245, 64, v245
    v_mfma_f32_16x16x32_bf16 v[12:15], v[228:231], v[196:199], v[12:15]
    v_add_u32 v245, 0x10000, v245
    v_mfma_f32_16x16x32_bf16 v[36:39], v[228:231], v[200:203], v[36:39]
    v_xor_b32 v246, 0x10000, v246
    v_mfma_f32_16x16x32_bf16 v[44:47], v[228:231], v[204:207], v[44:47]
    v_xor_b32 v247, 0x10000, v247
    s_waitcnt lgkmcnt(6)
    v_mfma_f32_16x16x32_bf16 v[16:19], v[232:235], v[192:195], v[16:19]
    v_xor_b32 v248, 0x10000, v248
    v_mfma_f32_16x16x32_bf16 v[24:27], v[232:235], v[196:199], v[24:27]
    v_xor_b32 v249, 0x10000, v249
    v_mfma_f32_16x16x32_bf16 v[48:51], v[232:235], v[200:203], v[48:51]
    v_mfma_f32_16x16x32_bf16 v[56:59], v[232:235], v[204:207], v[56:59]
    s_waitcnt lgkmcnt(4)
    v_mfma_f32_16x16x32_bf16 v[20:23], v[236:239], v[192:195], v[20:23]
    v_mfma_f32_16x16x32_bf16 v[28:31], v[236:239], v[196:199], v[28:31]
    v_mfma_f32_16x16x32_bf16 v[52:55], v[236:239], v[200:203], v[52:55]
    v_mfma_f32_16x16x32_bf16 v[60:63], v[236:239], v[204:207], v[60:63]
    s_waitcnt vmcnt(8) lgkmcnt(0)
    s_barrier
    v_mfma_f32_16x16x32_bf16 v[64:67], v[224:227], v[208:211], v[64:67]
    ds_read_b128 v[192:195], v245 offset:0
    s_add_u32 m0, s83, 49152
    v_mfma_f32_16x16x32_bf16 v[72:75], v[224:227], v[212:215], v[72:75]
    ds_read_b128 v[196:199], v245 offset:2048
    s_add_u32 s89, s88, 31744
    v_mfma_f32_16x16x32_bf16 v[96:99], v[224:227], v[216:219], v[96:99]
    ds_read_b128 v[200:203], v245 offset:4096
    v_mfma_f32_16x16x32_bf16 v[104:107], v[224:227], v[220:223], v[104:107]
    ds_read_b64_tr_b16 v[224:225], v246 offset:0
    ds_read_b64_tr_b16 v[226:227], v246 offset:1024
    ds_read_b128 v[204:207], v245 offset:6144
    buffer_load_dwordx4 v244, s[36:39], s88 offen nt lds
    v_mfma_f32_16x16x32_bf16 v[68:71], v[228:231], v[208:211], v[68:71]
    v_mfma_f32_16x16x32_bf16 v[76:79], v[228:231], v[212:215], v[76:79]
    buffer_load_dwordx4 v244, s[36:39], s89 offen offset:1024 nt lds
    v_mfma_f32_16x16x32_bf16 v[100:103], v[228:231], v[216:219], v[100:103]
    v_mfma_f32_16x16x32_bf16 v[108:111], v[228:231], v[220:223], v[108:111]
    ds_read_b64_tr_b16 v[228:229], v247 offset:0
    ds_read_b64_tr_b16 v[230:231], v247 offset:1024
    s_add_u32 s88, s88, 262144
    v_mfma_f32_16x16x32_bf16 v[80:83], v[232:235], v[208:211], v[80:83]
    s_add_u32 m0, s81, 0
    v_mfma_f32_16x16x32_bf16 v[88:91], v[232:235], v[212:215], v[88:91]
    v_mfma_f32_16x16x32_bf16 v[112:115], v[232:235], v[216:219], v[112:115]
    s_nop 0
    v_mfma_f32_16x16x32_bf16 v[120:123], v[232:235], v[220:223], v[120:123]
    ds_read_b64_tr_b16 v[232:233], v248 offset:0
    ds_read_b64_tr_b16 v[234:235], v248 offset:1024
    v_mfma_f32_16x16x32_bf16 v[84:87], v[236:239], v[208:211], v[84:87]
    buffer_load_dwordx4 v243, s[32:35], s86 offen lds
    v_mfma_f32_16x16x32_bf16 v[92:95], v[236:239], v[212:215], v[92:95]
    v_mfma_f32_16x16x32_bf16 v[116:119], v[236:239], v[216:219], v[116:119]
    buffer_load_dwordx4 v183, s[32:35], s86 offen offset:1024 lds
    v_mfma_f32_16x16x32_bf16 v[124:127], v[236:239], v[220:223], v[124:127]
    ds_read_b64_tr_b16 v[236:237], v249 offset:0
    ds_read_b64_tr_b16 v[238:239], v249 offset:1024
    s_waitcnt lgkmcnt(6)
    v_mfma_f32_16x16x32_bf16 v[0:3], v[224:227], v[192:195], v[0:3]
    ds_read_b128 v[208:211], v245 offset:8192
    v_mfma_f32_16x16x32_bf16 v[8:11], v[224:227], v[196:199], v[8:11]
    ds_read_b128 v[212:215], v245 offset:10240
    v_mfma_f32_16x16x32_bf16 v[32:35], v[224:227], v[200:203], v[32:35]
    ds_read_b128 v[216:219], v245 offset:12288
    v_mfma_f32_16x16x32_bf16 v[40:43], v[224:227], v[204:207], v[40:43]
    ds_read_b128 v[220:223], v245 offset:14336
    s_waitcnt lgkmcnt(8)
    v_mfma_f32_16x16x32_bf16 v[4:7], v[228:231], v[192:195], v[4:7]
    v_xor_b32 v245, 64, v245
    v_mfma_f32_16x16x32_bf16 v[12:15], v[228:231], v[196:199], v[12:15]
    v_mfma_f32_16x16x32_bf16 v[36:39], v[228:231], v[200:203], v[36:39]
    v_mfma_f32_16x16x32_bf16 v[44:47], v[228:231], v[204:207], v[44:47]
    s_waitcnt lgkmcnt(6)
    v_mfma_f32_16x16x32_bf16 v[16:19], v[232:235], v[192:195], v[16:19]
    v_mfma_f32_16x16x32_bf16 v[24:27], v[232:235], v[196:199], v[24:27]
    v_mfma_f32_16x16x32_bf16 v[48:51], v[232:235], v[200:203], v[48:51]
    v_mfma_f32_16x16x32_bf16 v[56:59], v[232:235], v[204:207], v[56:59]
    s_waitcnt lgkmcnt(4)
    v_mfma_f32_16x16x32_bf16 v[20:23], v[236:239], v[192:195], v[20:23]
    v_mfma_f32_16x16x32_bf16 v[28:31], v[236:239], v[196:199], v[28:31]
    v_mfma_f32_16x16x32_bf16 v[52:55], v[236:239], v[200:203], v[52:55]
    v_mfma_f32_16x16x32_bf16 v[60:63], v[236:239], v[204:207], v[60:63]
    s_waitcnt vmcnt(10) lgkmcnt(0)
    s_barrier
    v_mfma_f32_16x16x32_bf16 v[64:67], v[224:227], v[208:211], v[64:67]
    ds_read_b128 v[192:195], v245 offset:0
    s_add_u32 m0, s81, 0
    v_mfma_f32_16x16x32_bf16 v[72:75], v[224:227], v[212:215], v[72:75]
    ds_read_b128 v[196:199], v245 offset:2048
    s_add_u32 s87, s86, 14336
    v_mfma_f32_16x16x32_bf16 v[96:99], v[224:227], v[216:219], v[96:99]
    ds_read_b128 v[200:203], v245 offset:4096
    v_mfma_f32_16x16x32_bf16 v[104:107], v[224:227], v[220:223], v[104:107]
    ds_read_b64_tr_b16 v[224:225], v246 offset:16384
    ds_read_b64_tr_b16 v[226:227], v246 offset:17408
    ds_read_b128 v[204:207], v245 offset:6144
    buffer_load_dwordx4 v243, s[32:35], s87 offen offset:2048 lds
    v_mfma_f32_16x16x32_bf16 v[68:71], v[228:231], v[208:211], v[68:71]
    buffer_load_dwordx4 v183, s[32:35], s87 offen offset:3072 lds
    v_mfma_f32_16x16x32_bf16 v[76:79], v[228:231], v[212:215], v[76:79]
    v_mfma_f32_16x16x32_bf16 v[100:103], v[228:231], v[216:219], v[100:103]
    s_add_u32 s86, s86, 128
    v_mfma_f32_16x16x32_bf16 v[108:111], v[228:231], v[220:223], v[108:111]
    ds_read_b64_tr_b16 v[228:229], v247 offset:16384
    ds_read_b64_tr_b16 v[230:231], v247 offset:17408
    v_mfma_f32_16x16x32_bf16 v[80:83], v[232:235], v[208:211], v[80:83]
    s_add_u32 m0, s83, 98304
    v_mfma_f32_16x16x32_bf16 v[88:91], v[232:235], v[212:215], v[88:91]
    s_add_u32 s89, s88, 31744
    v_mfma_f32_16x16x32_bf16 v[112:115], v[232:235], v[216:219], v[112:115]
    v_mfma_f32_16x16x32_bf16 v[120:123], v[232:235], v[220:223], v[120:123]
    ds_read_b64_tr_b16 v[232:233], v248 offset:16384
    ds_read_b64_tr_b16 v[234:235], v248 offset:17408
    buffer_load_dwordx4 v244, s[36:39], s88 offen nt lds
    v_mfma_f32_16x16x32_bf16 v[84:87], v[236:239], v[208:211], v[84:87]
    buffer_load_dwordx4 v244, s[36:39], s89 offen offset:1024 nt lds
    v_mfma_f32_16x16x32_bf16 v[92:95], v[236:239], v[212:215], v[92:95]
    v_mfma_f32_16x16x32_bf16 v[116:119], v[236:239], v[216:219], v[116:119]
    s_add_u32 s88, s88, 262144
    v_mfma_f32_16x16x32_bf16 v[124:127], v[236:239], v[220:223], v[124:127]
    ds_read_b64_tr_b16 v[236:237], v249 offset:16384
    ds_read_b64_tr_b16 v[238:239], v249 offset:17408
    s_waitcnt lgkmcnt(6)
    v_mfma_f32_16x16x32_bf16 v[0:3], v[224:227], v[192:195], v[0:3]
    ds_read_b128 v[208:211], v245 offset:8192
    v_mfma_f32_16x16x32_bf16 v[8:11], v[224:227], v[196:199], v[8:11]
    ds_read_b128 v[212:215], v245 offset:10240
    v_mfma_f32_16x16x32_bf16 v[32:35], v[224:227], v[200:203], v[32:35]
    ds_read_b128 v[216:219], v245 offset:12288
    v_mfma_f32_16x16x32_bf16 v[40:43], v[224:227], v[204:207], v[40:43]
    ds_read_b128 v[220:223], v245 offset:14336
    s_waitcnt lgkmcnt(8)
    v_mfma_f32_16x16x32_bf16 v[4:7], v[228:231], v[192:195], v[4:7]
    v_xor_b32 v245, 64, v245
    v_mfma_f32_16x16x32_bf16 v[12:15], v[228:231], v[196:199], v[12:15]
    v_add_u32 v245, 0x10000, v245
    v_mfma_f32_16x16x32_bf16 v[36:39], v[228:231], v[200:203], v[36:39]
    v_xor_b32 v246, 0x10000, v246
    v_mfma_f32_16x16x32_bf16 v[44:47], v[228:231], v[204:207], v[44:47]
    v_xor_b32 v247, 0x10000, v247
    s_waitcnt lgkmcnt(6)
    v_mfma_f32_16x16x32_bf16 v[16:19], v[232:235], v[192:195], v[16:19]
    v_xor_b32 v248, 0x10000, v248
    v_mfma_f32_16x16x32_bf16 v[24:27], v[232:235], v[196:199], v[24:27]
    v_xor_b32 v249, 0x10000, v249
    v_mfma_f32_16x16x32_bf16 v[48:51], v[232:235], v[200:203], v[48:51]
    v_mfma_f32_16x16x32_bf16 v[56:59], v[232:235], v[204:207], v[56:59]
    s_waitcnt lgkmcnt(4)
    v_mfma_f32_16x16x32_bf16 v[20:23], v[236:239], v[192:195], v[20:23]
    v_mfma_f32_16x16x32_bf16 v[28:31], v[236:239], v[196:199], v[28:31]
    v_mfma_f32_16x16x32_bf16 v[52:55], v[236:239], v[200:203], v[52:55]
    v_mfma_f32_16x16x32_bf16 v[60:63], v[236:239], v[204:207], v[60:63]
    s_waitcnt vmcnt(8) lgkmcnt(0)
    s_barrier
    v_mfma_f32_16x16x32_bf16 v[64:67], v[224:227], v[208:211], v[64:67]
    ds_read_b128 v[192:195], v245 offset:0
    s_add_u32 m0, s83, 114688
    v_mfma_f32_16x16x32_bf16 v[72:75], v[224:227], v[212:215], v[72:75]
    ds_read_b128 v[196:199], v245 offset:2048
    s_add_u32 s89, s88, 31744
    v_mfma_f32_16x16x32_bf16 v[96:99], v[224:227], v[216:219], v[96:99]
    ds_read_b128 v[200:203], v245 offset:4096
    v_mfma_f32_16x16x32_bf16 v[104:107], v[224:227], v[220:223], v[104:107]
    ds_read_b64_tr_b16 v[224:225], v246 offset:0
    ds_read_b64_tr_b16 v[226:227], v246 offset:1024
    ds_read_b128 v[204:207], v245 offset:6144
    buffer_load_dwordx4 v244, s[36:39], s88 offen nt lds
    v_mfma_f32_16x16x32_bf16 v[68:71], v[228:231], v[208:211], v[68:71]
    v_mfma_f32_16x16x32_bf16 v[76:79], v[228:231], v[212:215], v[76:79]
    buffer_load_dwordx4 v244, s[36:39], s89 offen offset:1024 nt lds
    v_mfma_f32_16x16x32_bf16 v[100:103], v[228:231], v[216:219], v[100:103]
    v_mfma_f32_16x16x32_bf16 v[108:111], v[228:231], v[220:223], v[108:111]
    ds_read_b64_tr_b16 v[228:229], v247 offset:0
    ds_read_b64_tr_b16 v[230:231], v247 offset:1024
    s_add_u32 s88, s88, 262144
    v_mfma_f32_16x16x32_bf16 v[80:83], v[232:235], v[208:211], v[80:83]
    s_add_u32 m0, s81, 65536
    v_mfma_f32_16x16x32_bf16 v[88:91], v[232:235], v[212:215], v[88:91]
    v_mfma_f32_16x16x32_bf16 v[112:115], v[232:235], v[216:219], v[112:115]
    s_nop 0
    v_mfma_f32_16x16x32_bf16 v[120:123], v[232:235], v[220:223], v[120:123]
    ds_read_b64_tr_b16 v[232:233], v248 offset:0
    ds_read_b64_tr_b16 v[234:235], v248 offset:1024
    v_mfma_f32_16x16x32_bf16 v[84:87], v[236:239], v[208:211], v[84:87]
    buffer_load_dwordx4 v243, s[32:35], s86 offen lds
    v_mfma_f32_16x16x32_bf16 v[92:95], v[236:239], v[212:215], v[92:95]
    v_mfma_f32_16x16x32_bf16 v[116:119], v[236:239], v[216:219], v[116:119]
    buffer_load_dwordx4 v183, s[32:35], s86 offen offset:1024 lds
    v_mfma_f32_16x16x32_bf16 v[124:127], v[236:239], v[220:223], v[124:127]
    ds_read_b64_tr_b16 v[236:237], v249 offset:0
    ds_read_b64_tr_b16 v[238:239], v249 offset:1024
    s_waitcnt lgkmcnt(6)
    v_mfma_f32_16x16x32_bf16 v[0:3], v[224:227], v[192:195], v[0:3]
    ds_read_b128 v[208:211], v245 offset:8192
    v_mfma_f32_16x16x32_bf16 v[8:11], v[224:227], v[196:199], v[8:11]
    ds_read_b128 v[212:215], v245 offset:10240
    v_mfma_f32_16x16x32_bf16 v[32:35], v[224:227], v[200:203], v[32:35]
    ds_read_b128 v[216:219], v245 offset:12288
    v_mfma_f32_16x16x32_bf16 v[40:43], v[224:227], v[204:207], v[40:43]
    ds_read_b128 v[220:223], v245 offset:14336
    s_waitcnt lgkmcnt(8)
    v_mfma_f32_16x16x32_bf16 v[4:7], v[228:231], v[192:195], v[4:7]
    v_xor_b32 v245, 64, v245
    v_mfma_f32_16x16x32_bf16 v[12:15], v[228:231], v[196:199], v[12:15]
    v_mfma_f32_16x16x32_bf16 v[36:39], v[228:231], v[200:203], v[36:39]
    v_mfma_f32_16x16x32_bf16 v[44:47], v[228:231], v[204:207], v[44:47]
    s_waitcnt lgkmcnt(6)
    v_mfma_f32_16x16x32_bf16 v[16:19], v[232:235], v[192:195], v[16:19]
    v_mfma_f32_16x16x32_bf16 v[24:27], v[232:235], v[196:199], v[24:27]
    v_mfma_f32_16x16x32_bf16 v[48:51], v[232:235], v[200:203], v[48:51]
    v_mfma_f32_16x16x32_bf16 v[56:59], v[232:235], v[204:207], v[56:59]
    s_waitcnt lgkmcnt(4)
    v_mfma_f32_16x16x32_bf16 v[20:23], v[236:239], v[192:195], v[20:23]
    v_mfma_f32_16x16x32_bf16 v[28:31], v[236:239], v[196:199], v[28:31]
    v_mfma_f32_16x16x32_bf16 v[52:55], v[236:239], v[200:203], v[52:55]
    v_mfma_f32_16x16x32_bf16 v[60:63], v[236:239], v[204:207], v[60:63]
    s_waitcnt vmcnt(10) lgkmcnt(0)
    s_barrier
    v_mfma_f32_16x16x32_bf16 v[64:67], v[224:227], v[208:211], v[64:67]
    ds_read_b128 v[192:195], v245 offset:0
    s_add_u32 m0, s81, 65536
    v_mfma_f32_16x16x32_bf16 v[72:75], v[224:227], v[212:215], v[72:75]
    ds_read_b128 v[196:199], v245 offset:2048
    s_add_u32 s87, s86, 14336
    v_mfma_f32_16x16x32_bf16 v[96:99], v[224:227], v[216:219], v[96:99]
    ds_read_b128 v[200:203], v245 offset:4096
    v_mfma_f32_16x16x32_bf16 v[104:107], v[224:227], v[220:223], v[104:107]
    ds_read_b64_tr_b16 v[224:225], v246 offset:16384
    ds_read_b64_tr_b16 v[226:227], v246 offset:17408
    ds_read_b128 v[204:207], v245 offset:6144
    buffer_load_dwordx4 v243, s[32:35], s87 offen offset:2048 lds
    v_mfma_f32_16x16x32_bf16 v[68:71], v[228:231], v[208:211], v[68:71]
    buffer_load_dwordx4 v183, s[32:35], s87 offen offset:3072 lds
    v_mfma_f32_16x16x32_bf16 v[76:79], v[228:231], v[212:215], v[76:79]
    v_mfma_f32_16x16x32_bf16 v[100:103], v[228:231], v[216:219], v[100:103]
    s_add_u32 s86, s86, 128
    v_mfma_f32_16x16x32_bf16 v[108:111], v[228:231], v[220:223], v[108:111]
    ds_read_b64_tr_b16 v[228:229], v247 offset:16384
    ds_read_b64_tr_b16 v[230:231], v247 offset:17408
    v_mfma_f32_16x16x32_bf16 v[80:83], v[232:235], v[208:211], v[80:83]
    s_add_u32 m0, s83, 32768
    v_mfma_f32_16x16x32_bf16 v[88:91], v[232:235], v[212:215], v[88:91]
    s_add_u32 s89, s88, 31744
    v_mfma_f32_16x16x32_bf16 v[112:115], v[232:235], v[216:219], v[112:115]
    v_mfma_f32_16x16x32_bf16 v[120:123], v[232:235], v[220:223], v[120:123]
    ds_read_b64_tr_b16 v[232:233], v248 offset:16384
    ds_read_b64_tr_b16 v[234:235], v248 offset:17408
    buffer_load_dwordx4 v244, s[36:39], s88 offen nt lds
    v_mfma_f32_16x16x32_bf16 v[84:87], v[236:239], v[208:211], v[84:87]
    buffer_load_dwordx4 v244, s[36:39], s89 offen offset:1024 nt lds
    v_mfma_f32_16x16x32_bf16 v[92:95], v[236:239], v[212:215], v[92:95]
    v_mfma_f32_16x16x32_bf16 v[116:119], v[236:239], v[216:219], v[116:119]
    s_add_u32 s88, s88, 262144
    v_mfma_f32_16x16x32_bf16 v[124:127], v[236:239], v[220:223], v[124:127]
    ds_read_b64_tr_b16 v[236:237], v249 offset:16384
    ds_read_b64_tr_b16 v[238:239], v249 offset:17408
    s_waitcnt lgkmcnt(6)
    v_mfma_f32_16x16x32_bf16 v[0:3], v[224:227], v[192:195], v[0:3]
    ds_read_b128 v[208:211], v245 offset:8192
    v_mfma_f32_16x16x32_bf16 v[8:11], v[224:227], v[196:199], v[8:11]
    ds_read_b128 v[212:215], v245 offset:10240
    v_mfma_f32_16x16x32_bf16 v[32:35], v[224:227], v[200:203], v[32:35]
    ds_read_b128 v[216:219], v245 offset:12288
    v_mfma_f32_16x16x32_bf16 v[40:43], v[224:227], v[204:207], v[40:43]
    ds_read_b128 v[220:223], v245 offset:14336
    s_waitcnt lgkmcnt(8)
    v_mfma_f32_16x16x32_bf16 v[4:7], v[228:231], v[192:195], v[4:7]
    v_xor_b32 v245, 64, v245
    v_mfma_f32_16x16x32_bf16 v[12:15], v[228:231], v[196:199], v[12:15]
    v_add_u32 v245, 0xfffe0000, v245
    v_mfma_f32_16x16x32_bf16 v[36:39], v[228:231], v[200:203], v[36:39]
    v_xor_b32 v246, 0x10000, v246
    v_mfma_f32_16x16x32_bf16 v[44:47], v[228:231], v[204:207], v[44:47]
    v_xor_b32 v247, 0x10000, v247
    s_waitcnt lgkmcnt(6)
    v_mfma_f32_16x16x32_bf16 v[16:19], v[232:235], v[192:195], v[16:19]
    v_xor_b32 v248, 0x10000, v248
    v_mfma_f32_16x16x32_bf16 v[24:27], v[232:235], v[196:199], v[24:27]
    v_xor_b32 v249, 0x10000, v249
    v_mfma_f32_16x16x32_bf16 v[48:51], v[232:235], v[200:203], v[48:51]
    v_mfma_f32_16x16x32_bf16 v[56:59], v[232:235], v[204:207], v[56:59]
    s_waitcnt lgkmcnt(4)
    v_mfma_f32_16x16x32_bf16 v[20:23], v[236:239], v[192:195], v[20:23]
    v_mfma_f32_16x16x32_bf16 v[28:31], v[236:239], v[196:199], v[28:31]
    v_mfma_f32_16x16x32_bf16 v[52:55], v[236:239], v[200:203], v[52:55]
    v_mfma_f32_16x16x32_bf16 v[60:63], v[236:239], v[204:207], v[60:63]
    s_waitcnt vmcnt(8) lgkmcnt(0)
    s_barrier
    v_mfma_f32_16x16x32_bf16 v[64:67], v[224:227], v[208:211], v[64:67]
    ds_read_b128 v[192:195], v245 offset:0
    s_add_u32 m0, s83, 49152
    v_mfma_f32_16x16x32_bf16 v[72:75], v[224:227], v[212:215], v[72:75]
    ds_read_b128 v[196:199], v245 offset:2048
    s_add_u32 s89, s88, 31744
    v_mfma_f32_16x16x32_bf16 v[96:99], v[224:227], v[216:219], v[96:99]
    ds_read_b128 v[200:203], v245 offset:4096
    v_mfma_f32_16x16x32_bf16 v[104:107], v[224:227], v[220:223], v[104:107]
    ds_read_b64_tr_b16 v[224:225], v246 offset:0
    ds_read_b64_tr_b16 v[226:227], v246 offset:1024
    ds_read_b128 v[204:207], v245 offset:6144
    buffer_load_dwordx4 v244, s[36:39], s88 offen nt lds
    v_mfma_f32_16x16x32_bf16 v[68:71], v[228:231], v[208:211], v[68:71]
    v_mfma_f32_16x16x32_bf16 v[76:79], v[228:231], v[212:215], v[76:79]
    buffer_load_dwordx4 v244, s[36:39], s89 offen offset:1024 nt lds
    v_mfma_f32_16x16x32_bf16 v[100:103], v[228:231], v[216:219], v[100:103]
    v_mfma_f32_16x16x32_bf16 v[108:111], v[228:231], v[220:223], v[108:111]
    ds_read_b64_tr_b16 v[228:229], v247 offset:0
    ds_read_b64_tr_b16 v[230:231], v247 offset:1024
    s_add_u32 s88, s88, 262144
    v_mfma_f32_16x16x32_bf16 v[80:83], v[232:235], v[208:211], v[80:83]
    s_add_u32 m0, s81, 131072
    v_mfma_f32_16x16x32_bf16 v[88:91], v[232:235], v[212:215], v[88:91]
    v_mfma_f32_16x16x32_bf16 v[112:115], v[232:235], v[216:219], v[112:115]
    s_nop 0
    v_mfma_f32_16x16x32_bf16 v[120:123], v[232:235], v[220:223], v[120:123]
    ds_read_b64_tr_b16 v[232:233], v248 offset:0
    ds_read_b64_tr_b16 v[234:235], v248 offset:1024
    v_mfma_f32_16x16x32_bf16 v[84:87], v[236:239], v[208:211], v[84:87]
    buffer_load_dwordx4 v243, s[32:35], s86 offen lds
    v_mfma_f32_16x16x32_bf16 v[92:95], v[236:239], v[212:215], v[92:95]
    v_mfma_f32_16x16x32_bf16 v[116:119], v[236:239], v[216:219], v[116:119]
    buffer_load_dwordx4 v183, s[32:35], s86 offen offset:1024 lds
    v_mfma_f32_16x16x32_bf16 v[124:127], v[236:239], v[220:223], v[124:127]
    ds_read_b64_tr_b16 v[236:237], v249 offset:0
    ds_read_b64_tr_b16 v[238:239], v249 offset:1024
    s_waitcnt lgkmcnt(6)
    v_mfma_f32_16x16x32_bf16 v[0:3], v[224:227], v[192:195], v[0:3]
    ds_read_b128 v[208:211], v245 offset:8192
    s_min_u32 s13, s72, 26
    v_mfma_f32_16x16x32_bf16 v[8:11], v[224:227], v[196:199], v[8:11]
    ds_read_b128 v[212:215], v245 offset:10240
    v_mfma_f32_16x16x32_bf16 v[32:35], v[224:227], v[200:203], v[32:35]
    ds_read_b128 v[216:219], v245 offset:12288
    s_lshl_b32 s13, s13, 7
    v_mfma_f32_16x16x32_bf16 v[40:43], v[224:227], v[204:207], v[40:43]
    ds_read_b128 v[220:223], v245 offset:14336
    s_waitcnt lgkmcnt(8)
    v_mfma_f32_16x16x32_bf16 v[4:7], v[228:231], v[192:195], v[4:7]
    v_xor_b32 v245, 64, v245
    v_lshrrev_b32 v168, 8, v240
    v_mfma_f32_16x16x32_bf16 v[12:15], v[228:231], v[196:199], v[12:15]
    v_mfma_f32_16x16x32_bf16 v[36:39], v[228:231], v[200:203], v[36:39]
    v_lshlrev_b32 v168, 3, v168
    v_mfma_f32_16x16x32_bf16 v[44:47], v[228:231], v[204:207], v[44:47]
    s_waitcnt lgkmcnt(6)
    v_mfma_f32_16x16x32_bf16 v[16:19], v[232:235], v[192:195], v[16:19]
    buffer_load_dwordx2 v[160:161], v168, s[68:71], s13 offen offset:0
    v_mfma_f32_16x16x32_bf16 v[24:27], v[232:235], v[196:199], v[24:27]
    v_mfma_f32_16x16x32_bf16 v[48:51], v[232:235], v[200:203], v[48:51]
    buffer_load_dwordx2 v[162:163], v168, s[68:71], s13 offen offset:32
    v_mfma_f32_16x16x32_bf16 v[56:59], v[232:235], v[204:207], v[56:59]
    s_waitcnt lgkmcnt(4)
    v_mfma_f32_16x16x32_bf16 v[20:23], v[236:239], v[192:195], v[20:23]
    buffer_load_dwordx2 v[164:165], v168, s[68:71], s13 offen offset:64
    v_mfma_f32_16x16x32_bf16 v[28:31], v[236:239], v[196:199], v[28:31]
    v_mfma_f32_16x16x32_bf16 v[52:55], v[236:239], v[200:203], v[52:55]
    buffer_load_dwordx2 v[166:167], v168, s[68:71], s13 offen offset:96
    v_mfma_f32_16x16x32_bf16 v[60:63], v[236:239], v[204:207], v[60:63]
    s_waitcnt vmcnt(14) lgkmcnt(0)
    s_barrier
    v_mfma_f32_16x16x32_bf16 v[64:67], v[224:227], v[208:211], v[64:67]
    ds_read_b128 v[192:195], v245 offset:0
    s_add_u32 m0, s81, 131072
    v_mfma_f32_16x16x32_bf16 v[72:75], v[224:227], v[212:215], v[72:75]
    ds_read_b128 v[196:199], v245 offset:2048
    s_add_u32 s87, s86, 14336
    v_mfma_f32_16x16x32_bf16 v[96:99], v[224:227], v[216:219], v[96:99]
    ds_read_b128 v[200:203], v245 offset:4096
    v_mfma_f32_16x16x32_bf16 v[104:107], v[224:227], v[220:223], v[104:107]
    ds_read_b64_tr_b16 v[224:225], v246 offset:16384
    ds_read_b64_tr_b16 v[226:227], v246 offset:17408
    ds_read_b128 v[204:207], v245 offset:6144
    buffer_load_dwordx4 v243, s[32:35], s87 offen offset:2048 lds
    v_mfma_f32_16x16x32_bf16 v[68:71], v[228:231], v[208:211], v[68:71]
    buffer_load_dwordx4 v183, s[32:35], s87 offen offset:3072 lds
    v_mfma_f32_16x16x32_bf16 v[76:79], v[228:231], v[212:215], v[76:79]
    v_mfma_f32_16x16x32_bf16 v[100:103], v[228:231], v[216:219], v[100:103]
    s_add_u32 s86, s86, 128
    v_mfma_f32_16x16x32_bf16 v[108:111], v[228:231], v[220:223], v[108:111]
    ds_read_b64_tr_b16 v[228:229], v247 offset:16384
    ds_read_b64_tr_b16 v[230:231], v247 offset:17408
    v_mfma_f32_16x16x32_bf16 v[80:83], v[232:235], v[208:211], v[80:83]
    s_add_u32 m0, s83, 98304
    v_mfma_f32_16x16x32_bf16 v[88:91], v[232:235], v[212:215], v[88:91]
    s_add_u32 s89, s88, 31744
    v_mfma_f32_16x16x32_bf16 v[112:115], v[232:235], v[216:219], v[112:115]
    v_mfma_f32_16x16x32_bf16 v[120:123], v[232:235], v[220:223], v[120:123]
    ds_read_b64_tr_b16 v[232:233], v248 offset:16384
    ds_read_b64_tr_b16 v[234:235], v248 offset:17408
    buffer_load_dwordx4 v244, s[36:39], s88 offen nt lds
    v_mfma_f32_16x16x32_bf16 v[84:87], v[236:239], v[208:211], v[84:87]
    buffer_load_dwordx4 v244, s[36:39], s89 offen offset:1024 nt lds
    v_mfma_f32_16x16x32_bf16 v[92:95], v[236:239], v[212:215], v[92:95]
    v_mfma_f32_16x16x32_bf16 v[116:119], v[236:239], v[216:219], v[116:119]
    s_add_u32 s88, s88, 262144
    v_mfma_f32_16x16x32_bf16 v[124:127], v[236:239], v[220:223], v[124:127]
    ds_read_b64_tr_b16 v[236:237], v249 offset:16384
    ds_read_b64_tr_b16 v[238:239], v249 offset:17408
    s_waitcnt lgkmcnt(6)
    v_mfma_f32_16x16x32_bf16 v[0:3], v[224:227], v[192:195], v[0:3]
    ds_read_b128 v[208:211], v245 offset:8192
    v_mfma_f32_16x16x32_bf16 v[8:11], v[224:227], v[196:199], v[8:11]
    ds_read_b128 v[212:215], v245 offset:10240
    v_mfma_f32_16x16x32_bf16 v[32:35], v[224:227], v[200:203], v[32:35]
    ds_read_b128 v[216:219], v245 offset:12288
    v_mfma_f32_16x16x32_bf16 v[40:43], v[224:227], v[204:207], v[40:43]
    ds_read_b128 v[220:223], v245 offset:14336
    s_waitcnt lgkmcnt(8)
    v_mfma_f32_16x16x32_bf16 v[4:7], v[228:231], v[192:195], v[4:7]
    v_xor_b32 v245, 64, v245
    v_mfma_f32_16x16x32_bf16 v[12:15], v[228:231], v[196:199], v[12:15]
    v_add_u32 v245, 0x10000, v245
    v_mfma_f32_16x16x32_bf16 v[36:39], v[228:231], v[200:203], v[36:39]
    v_xor_b32 v246, 0x10000, v246
    v_mfma_f32_16x16x32_bf16 v[44:47], v[228:231], v[204:207], v[44:47]
    v_xor_b32 v247, 0x10000, v247
    s_waitcnt lgkmcnt(6)
    v_mfma_f32_16x16x32_bf16 v[16:19], v[232:235], v[192:195], v[16:19]
    v_xor_b32 v248, 0x10000, v248
    v_mfma_f32_16x16x32_bf16 v[24:27], v[232:235], v[196:199], v[24:27]
    v_xor_b32 v249, 0x10000, v249
    v_mfma_f32_16x16x32_bf16 v[48:51], v[232:235], v[200:203], v[48:51]
    v_mfma_f32_16x16x32_bf16 v[56:59], v[232:235], v[204:207], v[56:59]
    s_waitcnt lgkmcnt(4)
    v_mfma_f32_16x16x32_bf16 v[20:23], v[236:239], v[192:195], v[20:23]
    v_mfma_f32_16x16x32_bf16 v[28:31], v[236:239], v[196:199], v[28:31]
    v_mfma_f32_16x16x32_bf16 v[52:55], v[236:239], v[200:203], v[52:55]
    v_mfma_f32_16x16x32_bf16 v[60:63], v[236:239], v[204:207], v[60:63]
    s_waitcnt vmcnt(12) lgkmcnt(0)
    s_barrier
    v_mfma_f32_16x16x32_bf16 v[64:67], v[224:227], v[208:211], v[64:67]
    buffer_load_dword v254, off, s[60:63], s22 sc1
    s_add_u32 m0, s83, 114688
    v_mfma_f32_16x16x32_bf16 v[72:75], v[224:227], v[212:215], v[72:75]
    ds_read_b128 v[192:195], v245 offset:0
    s_add_u32 s89, s88, 31744
    v_mfma_f32_16x16x32_bf16 v[96:99], v[224:227], v[216:219], v[96:99]
    ds_read_b128 v[196:199], v245 offset:2048
    v_mfma_f32_16x16x32_bf16 v[104:107], v[224:227], v[220:223], v[104:107]
    ds_read_b64_tr_b16 v[224:225], v246 offset:0
    ds_read_b64_tr_b16 v[226:227], v246 offset:1024
    ds_read_b128 v[200:203], v245 offset:4096
    buffer_load_dwordx4 v244, s[36:39], s88 offen nt lds
    v_mfma_f32_16x16x32_bf16 v[68:71], v[228:231], v[208:211], v[68:71]
    ds_read_b128 v[204:207], v245 offset:6144
    v_mfma_f32_16x16x32_bf16 v[76:79], v[228:231], v[212:215], v[76:79]
    buffer_load_dwordx4 v244, s[36:39], s89 offen offset:1024 nt lds
    v_mfma_f32_16x16x32_bf16 v[100:103], v[228:231], v[216:219], v[100:103]
    v_mfma_f32_16x16x32_bf16 v[108:111], v[228:231], v[220:223], v[108:111]
    ds_read_b64_tr_b16 v[228:229], v247 offset:0
    ds_read_b64_tr_b16 v[230:231], v247 offset:1024
    s_add_u32 s88, s88, 262144
    v_mfma_f32_16x16x32_bf16 v[80:83], v[232:235], v[208:211], v[80:83]
    s_add_u32 m0, s81, 0
    v_mfma_f32_16x16x32_bf16 v[88:91], v[232:235], v[212:215], v[88:91]
    v_mfma_f32_16x16x32_bf16 v[112:115], v[232:235], v[216:219], v[112:115]
    s_nop 0
    v_mfma_f32_16x16x32_bf16 v[120:123], v[232:235], v[220:223], v[120:123]
    ds_read_b64_tr_b16 v[232:233], v248 offset:0
    ds_read_b64_tr_b16 v[234:235], v248 offset:1024
    v_mfma_f32_16x16x32_bf16 v[84:87], v[236:239], v[208:211], v[84:87]
    buffer_load_dwordx4 v243, s[32:35], s86 offen lds
    v_mfma_f32_16x16x32_bf16 v[92:95], v[236:239], v[212:215], v[92:95]
    v_mfma_f32_16x16x32_bf16 v[116:119], v[236:239], v[216:219], v[116:119]
    buffer_load_dwordx4 v183, s[32:35], s86 offen offset:1024 lds
    v_mfma_f32_16x16x32_bf16 v[124:127], v[236:239], v[220:223], v[124:127]
    ds_read_b64_tr_b16 v[236:237], v249 offset:0
    ds_read_b64_tr_b16 v[238:239], v249 offset:1024
    s_waitcnt lgkmcnt(6)
    v_mfma_f32_16x16x32_bf16 v[0:3], v[224:227], v[192:195], v[0:3]
    ds_read_b128 v[208:211], v245 offset:8192
    v_mfma_f32_16x16x32_bf16 v[8:11], v[224:227], v[196:199], v[8:11]
    ds_read_b128 v[212:215], v245 offset:10240
    v_mfma_f32_16x16x32_bf16 v[32:35], v[224:227], v[200:203], v[32:35]
    ds_read_b128 v[216:219], v245 offset:12288
    v_mfma_f32_16x16x32_bf16 v[40:43], v[224:227], v[204:207], v[40:43]
    ds_read_b128 v[220:223], v245 offset:14336
    s_waitcnt lgkmcnt(8)
    v_mfma_f32_16x16x32_bf16 v[4:7], v[228:231], v[192:195], v[4:7]
    v_xor_b32 v245, 64, v245
    v_mfma_f32_16x16x32_bf16 v[12:15], v[228:231], v[196:199], v[12:15]
    v_mfma_f32_16x16x32_bf16 v[36:39], v[228:231], v[200:203], v[36:39]
    v_mfma_f32_16x16x32_bf16 v[44:47], v[228:231], v[204:207], v[44:47]
    s_waitcnt lgkmcnt(6)
    v_mfma_f32_16x16x32_bf16 v[16:19], v[232:235], v[192:195], v[16:19]
    v_mfma_f32_16x16x32_bf16 v[24:27], v[232:235], v[196:199], v[24:27]
    v_mfma_f32_16x16x32_bf16 v[48:51], v[232:235], v[200:203], v[48:51]
    v_mfma_f32_16x16x32_bf16 v[56:59], v[232:235], v[204:207], v[56:59]
    s_waitcnt lgkmcnt(4)
    v_mfma_f32_16x16x32_bf16 v[20:23], v[236:239], v[192:195], v[20:23]
    v_mfma_f32_16x16x32_bf16 v[28:31], v[236:239], v[196:199], v[28:31]
    v_mfma_f32_16x16x32_bf16 v[52:55], v[236:239], v[200:203], v[52:55]
    v_mfma_f32_16x16x32_bf16 v[60:63], v[236:239], v[204:207], v[60:63]
    s_waitcnt vmcnt(4) lgkmcnt(0)
    v_cmp_gt_u32 vcc, 1, v254
    s_and_b32 s30, vcc_lo, s15
    s_cbranch_scc0 KB_E9K_OK
    s_mov_b32 s23, 100000
KB_E9K_SPIN:
    s_sleep 10
    buffer_load_dword v254, off, s[60:63], s22 sc1
    s_waitcnt vmcnt(0)
    v_cmp_gt_u32 vcc, 1, v254
    s_and_b32 s30, vcc_lo, s15
    s_cbranch_scc0 KB_E9K_OK
    s_sub_u32 s23, s23, 1
    s_cbranch_scc0 KB_E9K_SPIN
KB_E9K_OK:
    s_barrier
    v_mfma_f32_16x16x32_bf16 v[64:67], v[224:227], v[208:211], v[64:67]
    ds_read_b128 v[192:195], v245 offset:0
    s_lshr_b32 s77, s2, 4
    s_sub_u32 s78, 15, s77
    v_mfma_f32_16x16x32_bf16 v[72:75], v[224:227], v[212:215], v[72:75]
    ds_read_b128 v[196:199], v245 offset:2048
    s_min_u32 s78, s78, s77
    v_mfma_f32_16x16x32_bf16 v[96:99], v[224:227], v[216:219], v[96:99]
    ds_read_b128 v[200:203], v245 offset:4096
    s_lshl_b32 s78, s78, 1
    s_lshr_b32 s77, s77, 3
    v_mfma_f32_16x16x32_bf16 v[104:107], v[224:227], v[220:223], v[104:107]
    ds_read_b64_tr_b16 v[224:225], v246 offset:16384
    ds_read_b64_tr_b16 v[226:227], v246 offset:17408
    ds_read_b128 v[204:207], v245 offset:6144
    s_add_u32 s78, s78, s77
    v_mfma_f32_16x16x32_bf16 v[68:71], v[228:231], v[208:211], v[68:71]
    s_lshl_b32 s78, s78, 4
    s_and_b32 s77, s2, 15
    v_mfma_f32_16x16x32_bf16 v[76:79], v[228:231], v[212:215], v[76:79]
    s_add_u32 s78, s78, s77
    v_mfma_f32_16x16x32_bf16 v[100:103], v[228:231], v[216:219], v[100:103]
    s_lshl_b32 s78, s78, 8
    s_add_u32 s78, s78, 4116
    v_mfma_f32_16x16x32_bf16 v[108:111], v[228:231], v[220:223], v[108:111]
    ds_read_b64_tr_b16 v[228:229], v247 offset:16384
    ds_read_b64_tr_b16 v[230:231], v247 offset:17408
    v_mov_b32 v253, 1
    v_mfma_f32_16x16x32_bf16 v[80:83], v[232:235], v[208:211], v[80:83]
    buffer_store_dword v253, v252, s[4:7], s78 offen sc1
    v_mfma_f32_16x16x32_bf16 v[88:91], v[232:235], v[212:215], v[88:91]
    s_add_u32 m0, s81, 0
    s_add_u32 s87, s86, 14336
    v_mfma_f32_16x16x32_bf16 v[112:115], v[232:235], v[216:219], v[112:115]
    buffer_load_dwordx4 v243, s[32:35], s87 offen offset:2048 lds
    v_mfma_f32_16x16x32_bf16 v[120:123], v[232:235], v[220:223], v[120:123]
    ds_read_b64_tr_b16 v[232:233], v248 offset:16384
    ds_read_b64_tr_b16 v[234:235], v248 offset:17408
    buffer_load_dwordx4 v183, s[32:35], s87 offen offset:3072 lds
    s_add_u32 s86, s86, 128
    v_mfma_f32_16x16x32_bf16 v[84:87], v[236:239], v[208:211], v[84:87]
    s_add_u32 m0, s83, 32768
    v_mfma_f32_16x16x32_bf16 v[92:95], v[236:239], v[212:215], v[92:95]
    s_add_u32 s89, s88, 31744
    buffer_load_dwordx4 v244, s[36:39], s88 offen nt lds
    v_mfma_f32_16x16x32_bf16 v[116:119], v[236:239], v[216:219], v[116:119]
    buffer_load_dwordx4 v244, s[36:39], s89 offen offset:1024 nt lds
    v_mfma_f32_16x16x32_bf16 v[124:127], v[236:239], v[220:223], v[124:127]
    ds_read_b64_tr_b16 v[236:237], v249 offset:16384
    ds_read_b64_tr_b16 v[238:239], v249 offset:17408
    s_add_u32 s88, s88, 262144
    s_waitcnt lgkmcnt(6)
    v_mfma_f32_16x16x32_bf16 v[0:3], v[224:227], v[192:195], v[0:3]
    ds_read_b128 v[208:211], v245 offset:8192
    v_mfma_f32_16x16x32_bf16 v[8:11], v[224:227], v[196:199], v[8:11]
    ds_read_b128 v[212:215], v245 offset:10240
    v_mfma_f32_16x16x32_bf16 v[32:35], v[224:227], v[200:203], v[32:35]
    ds_read_b128 v[216:219], v245 offset:12288
    v_mfma_f32_16x16x32_bf16 v[40:43], v[224:227], v[204:207], v[40:43]
    ds_read_b128 v[220:223], v245 offset:14336
    s_waitcnt lgkmcnt(8)
    v_mfma_f32_16x16x32_bf16 v[4:7], v[228:231], v[192:195], v[4:7]
    v_xor_b32 v245, 64, v245
    v_mfma_f32_16x16x32_bf16 v[12:15], v[228:231], v[196:199], v[12:15]
    v_add_u32 v245, 0x10000, v245
    v_mfma_f32_16x16x32_bf16 v[36:39], v[228:231], v[200:203], v[36:39]
    v_xor_b32 v246, 0x10000, v246
    v_mfma_f32_16x16x32_bf16 v[44:47], v[228:231], v[204:207], v[44:47]
    v_xor_b32 v247, 0x10000, v247
    s_waitcnt lgkmcnt(6)
    v_mfma_f32_16x16x32_bf16 v[16:19], v[232:235], v[192:195], v[16:19]
    v_xor_b32 v248, 0x10000, v248
    v_mfma_f32_16x16x32_bf16 v[24:27], v[232:235], v[196:199], v[24:27]
    v_xor_b32 v249, 0x10000, v249
    v_mfma_f32_16x16x32_bf16 v[48:51], v[232:235], v[200:203], v[48:51]
    v_mfma_f32_16x16x32_bf16 v[56:59], v[232:235], v[204:207], v[56:59]
    s_waitcnt lgkmcnt(4)
    v_mfma_f32_16x16x32_bf16 v[20:23], v[236:239], v[192:195], v[20:23]
    v_mfma_f32_16x16x32_bf16 v[28:31], v[236:239], v[196:199], v[28:31]
    v_mfma_f32_16x16x32_bf16 v[52:55], v[236:239], v[200:203], v[52:55]
    v_mfma_f32_16x16x32_bf16 v[60:63], v[236:239], v[204:207], v[60:63]
    s_waitcnt vmcnt(10) lgkmcnt(0)
    s_barrier
    v_mfma_f32_16x16x32_bf16 v[64:67], v[224:227], v[208:211], v[64:67]
    ds_read_b128 v[192:195], v245 offset:0
    s_add_u32 m0, s83, 49152
    v_mfma_f32_16x16x32_bf16 v[72:75], v[224:227], v[212:215], v[72:75]
    ds_read_b128 v[196:199], v245 offset:2048
    s_add_u32 s89, s88, 31744
    v_mfma_f32_16x16x32_bf16 v[96:99], v[224:227], v[216:219], v[96:99]
    ds_read_b128 v[200:203], v245 offset:4096
    v_mfma_f32_16x16x32_bf16 v[104:107], v[224:227], v[220:223], v[104:107]
    ds_read_b64_tr_b16 v[224:225], v246 offset:0
    ds_read_b64_tr_b16 v[226:227], v246 offset:1024
    ds_read_b128 v[204:207], v245 offset:6144
    buffer_load_dwordx4 v244, s[36:39], s88 offen nt lds
    v_mfma_f32_16x16x32_bf16 v[68:71], v[228:231], v[208:211], v[68:71]
    v_mfma_f32_16x16x32_bf16 v[76:79], v[228:231], v[212:215], v[76:79]
    buffer_load_dwordx4 v244, s[36:39], s89 offen offset:1024 nt lds
    v_mfma_f32_16x16x32_bf16 v[100:103], v[228:231], v[216:219], v[100:103]
    v_mfma_f32_16x16x32_bf16 v[108:111], v[228:231], v[220:223], v[108:111]
    ds_read_b64_tr_b16 v[228:229], v247 offset:0
    ds_read_b64_tr_b16 v[230:231], v247 offset:1024
    s_add_u32 s88, s88, 262144
    v_mfma_f32_16x16x32_bf16 v[80:83], v[232:235], v[208:211], v[80:83]
    s_add_u32 m0, s81, 65536
    v_mfma_f32_16x16x32_bf16 v[88:91], v[232:235], v[212:215], v[88:91]
    v_mfma_f32_16x16x32_bf16 v[112:115], v[232:235], v[216:219], v[112:115]
    s_nop 0
    v_mfma_f32_16x16x32_bf16 v[120:123], v[232:235], v[220:223], v[120:123]
    ds_read_b64_tr_b16 v[232:233], v248 offset:0
    ds_read_b64_tr_b16 v[234:235], v248 offset:1024
    v_mfma_f32_16x16x32_bf16 v[84:87], v[236:239], v[208:211], v[84:87]
    buffer_load_dwordx4 v243, s[32:35], s86 offen lds
    v_mfma_f32_16x16x32_bf16 v[92:95], v[236:239], v[212:215], v[92:95]
    v_mfma_f32_16x16x32_bf16 v[116:119], v[236:239], v[216:219], v[116:119]
    buffer_load_dwordx4 v183, s[32:35], s86 offen offset:1024 lds
    v_mfma_f32_16x16x32_bf16 v[124:127], v[236:239], v[220:223], v[124:127]
    ds_read_b64_tr_b16 v[236:237], v249 offset:0
    ds_read_b64_tr_b16 v[238:239], v249 offset:1024
    s_waitcnt lgkmcnt(6)
    v_mfma_f32_16x16x32_bf16 v[0:3], v[224:227], v[192:195], v[0:3]
    ds_read_b128 v[208:211], v245 offset:8192
    v_mfma_f32_16x16x32_bf16 v[8:11], v[224:227], v[196:199], v[8:11]
    ds_read_b128 v[212:215], v245 offset:10240
    v_mfma_f32_16x16x32_bf16 v[32:35], v[224:227], v[200:203], v[32:35]
    ds_read_b128 v[216:219], v245 offset:12288
    v_mfma_f32_16x16x32_bf16 v[40:43], v[224:227], v[204:207], v[40:43]
    ds_read_b128 v[220:223], v245 offset:14336
    s_waitcnt lgkmcnt(8)
    v_mfma_f32_16x16x32_bf16 v[4:7], v[228:231], v[192:195], v[4:7]
    v_xor_b32 v245, 64, v245
    v_mfma_f32_16x16x32_bf16 v[12:15], v[228:231], v[196:199], v[12:15]
    v_mfma_f32_16x16x32_bf16 v[36:39], v[228:231], v[200:203], v[36:39]
    v_mfma_f32_16x16x32_bf16 v[44:47], v[228:231], v[204:207], v[44:47]
    s_waitcnt lgkmcnt(6)
    v_mfma_f32_16x16x32_bf16 v[16:19], v[232:235], v[192:195], v[16:19]
    v_mfma_f32_16x16x32_bf16 v[24:27], v[232:235], v[196:199], v[24:27]
    v_mfma_f32_16x16x32_bf16 v[48:51], v[232:235], v[200:203], v[48:51]
    v_mfma_f32_16x16x32_bf16 v[56:59], v[232:235], v[204:207], v[56:59]
    s_waitcnt lgkmcnt(4)
    v_mfma_f32_16x16x32_bf16 v[20:23], v[236:239], v[192:195], v[20:23]
    v_mfma_f32_16x16x32_bf16 v[28:31], v[236:239], v[196:199], v[28:31]
    v_mfma_f32_16x16x32_bf16 v[52:55], v[236:239], v[200:203], v[52:55]
    v_mfma_f32_16x16x32_bf16 v[60:63], v[236:239], v[204:207], v[60:63]
    s_waitcnt vmcnt(11) lgkmcnt(0)
    s_barrier
    v_mfma_f32_16x16x32_bf16 v[64:67], v[224:227], v[208:211], v[64:67]
    ds_read_b128 v[192:195], v245 offset:0
    s_add_u32 m0, s81, 65536
    v_mfma_f32_16x16x32_bf16 v[72:75], v[224:227], v[212:215], v[72:75]
    ds_read_b128 v[196:199], v245 offset:2048
    s_add_u32 s87, s86, 14336
    v_mfma_f32_16x16x32_bf16 v[96:99], v[224:227], v[216:219], v[96:99]
    ds_read_b128 v[200:203], v245 offset:4096
    v_mfma_f32_16x16x32_bf16 v[104:107], v[224:227], v[220:223], v[104:107]
    ds_read_b64_tr_b16 v[224:225], v246 offset:16384
    ds_read_b64_tr_b16 v[226:227], v246 offset:17408
    ds_read_b128 v[204:207], v245 offset:6144
    buffer_load_dwordx4 v243, s[32:35], s87 offen offset:2048 lds
    v_mfma_f32_16x16x32_bf16 v[68:71], v[228:231], v[208:211], v[68:71]
    buffer_load_dwordx4 v183, s[32:35], s87 offen offset:3072 lds
    v_mfma_f32_16x16x32_bf16 v[76:79], v[228:231], v[212:215], v[76:79]
    v_mfma_f32_16x16x32_bf16 v[100:103], v[228:231], v[216:219], v[100:103]
    s_add_u32 s86, s86, 128
    v_mfma_f32_16x16x32_bf16 v[108:111], v[228:231], v[220:223], v[108:111]
    ds_read_b64_tr_b16 v[228:229], v247 offset:16384
    ds_read_b64_tr_b16 v[230:231], v247 offset:17408
    v_mfma_f32_16x16x32_bf16 v[80:83], v[232:235], v[208:211], v[80:83]
    s_add_u32 m0, s83, 98304
    v_mfma_f32_16x16x32_bf16 v[88:91], v[232:235], v[212:215], v[88:91]
    s_add_u32 s89, s88, 31744
    v_mfma_f32_16x16x32_bf16 v[112:115], v[232:235], v[216:219], v[112:115]
    v_mfma_f32_16x16x32_bf16 v[120:123], v[232:235], v[220:223], v[120:123]
    ds_read_b64_tr_b16 v[232:233], v248 offset:16384
    ds_read_b64_tr_b16 v[234:235], v248 offset:17408
    buffer_load_dwordx4 v244, s[36:39], s88 offen nt lds
    v_mfma_f32_16x16x32_bf16 v[84:87], v[236:239], v[208:211], v[84:87]
    buffer_load_dwordx4 v244, s[36:39], s89 offen offset:1024 nt lds
    v_mfma_f32_16x16x32_bf16 v[92:95], v[236:239], v[212:215], v[92:95]
    v_mfma_f32_16x16x32_bf16 v[116:119], v[236:239], v[216:219], v[116:119]
    s_add_u32 s88, s88, 262144
    v_mfma_f32_16x16x32_bf16 v[124:127], v[236:239], v[220:223], v[124:127]
    ds_read_b64_tr_b16 v[236:237], v249 offset:16384
    ds_read_b64_tr_b16 v[238:239], v249 offset:17408
    s_waitcnt lgkmcnt(6)
    v_mfma_f32_16x16x32_bf16 v[0:3], v[224:227], v[192:195], v[0:3]
    ds_read_b128 v[208:211], v245 offset:8192
    v_mfma_f32_16x16x32_bf16 v[8:11], v[224:227], v[196:199], v[8:11]
    ds_read_b128 v[212:215], v245 offset:10240
    v_mfma_f32_16x16x32_bf16 v[32:35], v[224:227], v[200:203], v[32:35]
    ds_read_b128 v[216:219], v245 offset:12288
    v_mfma_f32_16x16x32_bf16 v[40:43], v[224:227], v[204:207], v[40:43]
    ds_read_b128 v[220:223], v245 offset:14336
    s_waitcnt lgkmcnt(8)
    v_mfma_f32_16x16x32_bf16 v[4:7], v[228:231], v[192:195], v[4:7]
    v_xor_b32 v245, 64, v245
    v_mfma_f32_16x16x32_bf16 v[12:15], v[228:231], v[196:199], v[12:15]
    v_add_u32 v245, 0xfffe0000, v245
    v_mfma_f32_16x16x32_bf16 v[36:39], v[228:231], v[200:203], v[36:39]
    v_xor_b32 v246, 0x10000, v246
    v_mfma_f32_16x16x32_bf16 v[44:47], v[228:231], v[204:207], v[44:47]
    v_xor_b32 v247, 0x10000, v247
    s_waitcnt lgkmcnt(6)
    v_mfma_f32_16x16x32_bf16 v[16:19], v[232:235], v[192:195], v[16:19]
    v_xor_b32 v248, 0x10000, v248
    v_mfma_f32_16x16x32_bf16 v[24:27], v[232:235], v[196:199], v[24:27]
    v_xor_b32 v249, 0x10000, v249
    v_mfma_f32_16x16x32_bf16 v[48:51], v[232:235], v[200:203], v[48:51]
    v_mfma_f32_16x16x32_bf16 v[56:59], v[232:235], v[204:207], v[56:59]
    s_waitcnt lgkmcnt(4)
    v_mfma_f32_16x16x32_bf16 v[20:23], v[236:239], v[192:195], v[20:23]
    v_mfma_f32_16x16x32_bf16 v[28:31], v[236:239], v[196:199], v[28:31]
    v_mfma_f32_16x16x32_bf16 v[52:55], v[236:239], v[200:203], v[52:55]
    v_mfma_f32_16x16x32_bf16 v[60:63], v[236:239], v[204:207], v[60:63]
    s_waitcnt vmcnt(8) lgkmcnt(0)
    s_barrier
    v_mfma_f32_16x16x32_bf16 v[64:67], v[224:227], v[208:211], v[64:67]
    ds_read_b128 v[192:195], v245 offset:0
    s_add_u32 m0, s83, 114688
    v_mfma_f32_16x16x32_bf16 v[72:75], v[224:227], v[212:215], v[72:75]
    ds_read_b128 v[196:199], v245 offset:2048
    s_add_u32 s89, s88, 31744
    v_mfma_f32_16x16x32_bf16 v[96:99], v[224:227], v[216:219], v[96:99]
    ds_read_b128 v[200:203], v245 offset:4096
    buffer_load_dwordx4 v244, s[36:39], s88 offen nt lds
    v_mfma_f32_16x16x32_bf16 v[104:107], v[224:227], v[220:223], v[104:107]
    ds_read_b64_tr_b16 v[224:225], v246 offset:0
    ds_read_b64_tr_b16 v[226:227], v246 offset:1024
    ds_read_b128 v[204:207], v245 offset:6144
    buffer_load_dwordx4 v244, s[36:39], s89 offen offset:1024 nt lds
    v_mfma_f32_16x16x32_bf16 v[68:71], v[228:231], v[208:211], v[68:71]
    s_add_u32 s88, s88, 262144
    v_mfma_f32_16x16x32_bf16 v[76:79], v[228:231], v[212:215], v[76:79]
    v_mfma_f32_16x16x32_bf16 v[100:103], v[228:231], v[216:219], v[100:103]
    s_add_u32 m0, s83, 122880
    v_mfma_f32_16x16x32_bf16 v[108:111], v[228:231], v[220:223], v[108:111]
    ds_read_b64_tr_b16 v[228:229], v247 offset:0
    ds_read_b64_tr_b16 v[230:231], v247 offset:1024
    s_add_u32 s77, s98, 31744
    v_mfma_f32_16x16x32_bf16 v[80:83], v[232:235], v[208:211], v[80:83]
    buffer_load_dwordx4 v244, s[48:51], s98 offen lds
    v_mfma_f32_16x16x32_bf16 v[88:91], v[232:235], v[212:215], v[88:91]
    buffer_load_dwordx4 v244, s[48:51], s77 offen offset:1024 lds
    v_mfma_f32_16x16x32_bf16 v[112:115], v[232:235], v[216:219], v[112:115]
    v_mfma_f32_16x16x32_bf16 v[120:123], v[232:235], v[220:223], v[120:123]
    ds_read_b64_tr_b16 v[232:233], v248 offset:0
    ds_read_b64_tr_b16 v[234:235], v248 offset:1024
    s_add_u32 m0, s94, 131072
    v_mfma_f32_16x16x32_bf16 v[84:87], v[236:239], v[208:211], v[84:87]
    s_add_u32 s98, s98, 262144
    v_mfma_f32_16x16x32_bf16 v[92:95], v[236:239], v[212:215], v[92:95]
    buffer_load_dwordx4 v241, s[52:55], s99 offen lds
    v_mfma_f32_16x16x32_bf16 v[116:119], v[236:239], v[216:219], v[116:119]
    s_add_u32 s99, s99, 110592
    v_mfma_f32_16x16x32_bf16 v[124:127], v[236:239], v[220:223], v[124:127]
    ds_read_b64_tr_b16 v[236:237], v249 offset:0
    ds_read_b64_tr_b16 v[238:239], v249 offset:1024
    s_waitcnt lgkmcnt(6)
    v_mfma_f32_16x16x32_bf16 v[0:3], v[224:227], v[192:195], v[0:3]
    ds_read_b128 v[208:211], v245 offset:8192
    v_mfma_f32_16x16x32_bf16 v[8:11], v[224:227], v[196:199], v[8:11]
    ds_read_b128 v[212:215], v245 offset:10240
    v_mfma_f32_16x16x32_bf16 v[32:35], v[224:227], v[200:203], v[32:35]
    ds_read_b128 v[216:219], v245 offset:12288
    v_mfma_f32_16x16x32_bf16 v[40:43], v[224:227], v[204:207], v[40:43]
    ds_read_b128 v[220:223], v245 offset:14336
    s_waitcnt lgkmcnt(8)
    v_mfma_f32_16x16x32_bf16 v[4:7], v[228:231], v[192:195], v[4:7]
    v_xor_b32 v245, 64, v245
    v_mfma_f32_16x16x32_bf16 v[12:15], v[228:231], v[196:199], v[12:15]
    v_mfma_f32_16x16x32_bf16 v[36:39], v[228:231], v[200:203], v[36:39]
    v_mfma_f32_16x16x32_bf16 v[44:47], v[228:231], v[204:207], v[44:47]
    s_waitcnt lgkmcnt(6)
    v_mfma_f32_16x16x32_bf16 v[16:19], v[232:235], v[192:195], v[16:19]
    v_mfma_f32_16x16x32_bf16 v[24:27], v[232:235], v[196:199], v[24:27]
    v_mfma_f32_16x16x32_bf16 v[48:51], v[232:235], v[200:203], v[48:51]
    v_mfma_f32_16x16x32_bf16 v[56:59], v[232:235], v[204:207], v[56:59]
    s_waitcnt lgkmcnt(4)
    v_mfma_f32_16x16x32_bf16 v[20:23], v[236:239], v[192:195], v[20:23]
    v_mfma_f32_16x16x32_bf16 v[28:31], v[236:239], v[196:199], v[28:31]
    v_mfma_f32_16x16x32_bf16 v[52:55], v[236:239], v[200:203], v[52:55]
    v_mfma_f32_16x16x32_bf16 v[60:63], v[236:239], v[204:207], v[60:63]
    s_waitcnt vmcnt(11) lgkmcnt(0)
    s_barrier
    v_mfma_f32_16x16x32_bf16 v[64:67], v[224:227], v[208:211], v[64:67]
    s_lshl_b32 s12, s73, 13
    v_mfma_f32_16x16x32_bf16 v[72:75], v[224:227], v[212:215], v[72:75]
    s_add_u32 s12, s12, s22
    v_mfma_f32_16x16x32_bf16 v[96:99], v[224:227], v[216:219], v[96:99]
    s_add_u32 s12, s12, 4096
    v_mfma_f32_16x16x32_bf16 v[104:107], v[224:227], v[220:223], v[104:107]
    ds_read_b64_tr_b16 v[224:225], v246 offset:16384
    ds_read_b64_tr_b16 v[226:227], v246 offset:17408
    v_lshrrev_b32 v254, 9, v240
    v_mfma_f32_16x16x32_bf16 v[68:71], v[228:231], v[208:211], v[68:71]
    v_lshl_or_b32 v254, v254, 26, v240
    v_mfma_f32_16x16x32_bf16 v[76:79], v[228:231], v[212:215], v[76:79]
    v_lshlrev_b32 v254, 4, v254
    v_mfma_f32_16x16x32_bf16 v[100:103], v[228:231], v[216:219], v[100:103]
    buffer_load_dword v254, v254, s[4:7], s12 offen offset:20 sc1
    v_mfma_f32_16x16x32_bf16 v[108:111], v[228:231], v[220:223], v[108:111]
    ds_read_b64_tr_b16 v[228:229], v247 offset:16384
    ds_read_b64_tr_b16 v[230:231], v247 offset:17408
    ds_read_b128 v[192:195], v245 offset:0
    v_mfma_f32_16x16x32_bf16 v[80:83], v[232:235], v[208:211], v[80:83]
    ds_read_b128 v[196:199], v245 offset:2048
    v_mfma_f32_16x16x32_bf16 v[88:91], v[232:235], v[212:215], v[88:91]
    ds_read_b128 v[200:203], v245 offset:4096
    v_mfma_f32_16x16x32_bf16 v[112:115], v[232:235], v[216:219], v[112:115]
    ds_read_b128 v[204:207], v245 offset:6144
    v_mfma_f32_16x16x32_bf16 v[120:123], v[232:235], v[220:223], v[120:123]
    ds_read_b64_tr_b16 v[232:233], v248 offset:16384
    ds_read_b64_tr_b16 v[234:235], v248 offset:17408
    v_mfma_f32_16x16x32_bf16 v[84:87], v[236:239], v[208:211], v[84:87]
    v_mfma_f32_16x16x32_bf16 v[92:95], v[236:239], v[212:215], v[92:95]
    v_mfma_f32_16x16x32_bf16 v[116:119], v[236:239], v[216:219], v[116:119]
    v_mfma_f32_16x16x32_bf16 v[124:127], v[236:239], v[220:223], v[124:127]
    ds_read_b64_tr_b16 v[236:237], v249 offset:16384
    ds_read_b64_tr_b16 v[238:239], v249 offset:17408
    s_waitcnt lgkmcnt(4)
    v_mfma_f32_16x16x32_bf16 v[0:3], v[224:227], v[192:195], v[0:3]
    ds_read_b128 v[208:211], v245 offset:8192
    s_waitcnt vmcnt(28)
    v_lshlrev_b32 v136, 16, v160
    v_mfma_f32_16x16x32_bf16 v[8:11], v[224:227], v[196:199], v[8:11]
    ds_read_b128 v[212:215], v245 offset:10240
    v_and_b32 v137, 0xffff0000, v160
    v_mfma_f32_16x16x32_bf16 v[32:35], v[224:227], v[200:203], v[32:35]
    ds_read_b128 v[216:219], v245 offset:12288
    v_lshlrev_b32 v138, 16, v161
    v_mfma_f32_16x16x32_bf16 v[40:43], v[224:227], v[204:207], v[40:43]
    ds_read_b128 v[220:223], v245 offset:14336
    v_and_b32 v139, 0xffff0000, v161
    v_mfma_f32_16x16x32_bf16 v[4:7], v[228:231], v[192:195], v[4:7]
    v_xor_b32 v245, 64, v245
    v_lshlrev_b32 v140, 16, v162
    v_mfma_f32_16x16x32_bf16 v[12:15], v[228:231], v[196:199], v[12:15]
    v_add_u32 v245, 0x10000, v245
    v_and_b32 v141, 0xffff0000, v162
    v_mfma_f32_16x16x32_bf16 v[36:39], v[228:231], v[200:203], v[36:39]
    v_xor_b32 v246, 0x10000, v246
    v_lshlrev_b32 v142, 16, v163
    v_mfma_f32_16x16x32_bf16 v[44:47], v[228:231], v[204:207], v[44:47]
    v_xor_b32 v247, 0x10000, v247
    v_and_b32 v143, 0xffff0000, v163
    s_waitcnt lgkmcnt(6)
    v_mfma_f32_16x16x32_bf16 v[16:19], v[232:235], v[192:195], v[16:19]
    v_xor_b32 v248, 0x10000, v248
    v_lshlrev_b32 v152, 16, v164
    v_mfma_f32_16x16x32_bf16 v[24:27], v[232:235], v[196:199], v[24:27]
    v_xor_b32 v249, 0x10000, v249
    v_and_b32 v153, 0xffff0000, v164
    v_mfma_f32_16x16x32_bf16 v[48:51], v[232:235], v[200:203], v[48:51]
    v_lshlrev_b32 v154, 16, v165
    v_mfma_f32_16x16x32_bf16 v[56:59], v[232:235], v[204:207], v[56:59]
    v_and_b32 v155, 0xffff0000, v165
    s_waitcnt lgkmcnt(4)
    v_mfma_f32_16x16x32_bf16 v[20:23], v[236:239], v[192:195], v[20:23]
    v_lshlrev_b32 v156, 16, v166
    v_mfma_f32_16x16x32_bf16 v[28:31], v[236:239], v[196:199], v[28:31]
    v_and_b32 v157, 0xffff0000, v166
    v_mfma_f32_16x16x32_bf16 v[52:55], v[236:239], v[200:203], v[52:55]
    v_lshlrev_b32 v158, 16, v167
    v_mfma_f32_16x16x32_bf16 v[60:63], v[236:239], v[204:207], v[60:63]
    v_and_b32 v159, 0xffff0000, v167
    s_waitcnt vmcnt(0) lgkmcnt(0)
    v_cmp_gt_u32 vcc, 1, v254
    s_and_b32 s30, vcc_lo, s15
    s_cbranch_scc0 KB_E14K_OK
    s_mov_b32 s23, 100000
KB_E14K_SPIN:
    s_sleep 10
    s_lshl_b32 s12, s73, 13
    s_add_u32 s12, s12, s22
    s_add_u32 s12, s12, 4096
    v_lshrrev_b32 v254, 9, v240
    v_lshl_or_b32 v254, v254, 26, v240
    v_lshlrev_b32 v254, 4, v254
    buffer_load_dword v254, v254, s[4:7], s12 offen offset:20 sc1
    s_waitcnt vmcnt(0)
    v_cmp_gt_u32 vcc, 1, v254
    s_and_b32 s30, vcc_lo, s15
    s_cbranch_scc0 KB_E14K_OK
    s_sub_u32 s23, s23, 1
    s_cbranch_scc0 KB_E14K_SPIN
KB_E14K_OK:
    s_barrier
    v_mfma_f32_16x16x32_bf16 v[64:67], v[224:227], v[208:211], v[64:67]
    ds_read_b128 v[192:195], v245 offset:0
    s_add_u32 m0, s83, 139264
    s_nop 0
    buffer_load_dwordx4 v240, s[44:47], s100 offen sc1 lds
    v_mfma_f32_16x16x32_bf16 v[72:75], v[224:227], v[212:215], v[72:75]
    ds_read_b128 v[196:199], v245 offset:2048
    buffer_load_dwordx4 v240, s[44:47], s100 offen offset:1024 sc1 lds
    s_add_u32 m0, s83, 147456
    s_add_u32 s100, s100, 2048
    v_mfma_f32_16x16x32_bf16 v[96:99], v[224:227], v[216:219], v[96:99]
    ds_read_b128 v[200:203], v245 offset:4096
    buffer_load_dwordx4 v240, s[44:47], s101 offen sc1 lds
    buffer_load_dwordx4 v240, s[44:47], s101 offen offset:1024 sc1 lds
    v_mfma_f32_16x16x32_bf16 v[104:107], v[224:227], v[220:223], v[104:107]
    ds_read_b64_tr_b16 v[224:225], v246 offset:0
    ds_read_b64_tr_b16 v[226:227], v246 offset:1024
    ds_read_b128 v[204:207], v245 offset:6144
    s_add_u32 s101, s101, 2048
    s_add_u32 m0, s83, 4294959104
    s_add_u32 s77, s98, 31744
    v_mfma_f32_16x16x32_bf16 v[68:71], v[228:231], v[208:211], v[68:71]
    buffer_load_dwordx4 v244, s[48:51], s98 offen lds
    buffer_load_dwordx4 v244, s[48:51], s77 offen offset:1024 lds
    v_mfma_f32_16x16x32_bf16 v[76:79], v[228:231], v[212:215], v[76:79]
    s_add_u32 m0, s94, 0
    s_add_u32 s98, s98, 262144
    buffer_load_dwordx4 v241, s[52:55], s99 offen lds
    v_mfma_f32_16x16x32_bf16 v[100:103], v[228:231], v[216:219], v[100:103]
    s_add_u32 m0, s83, 8192
    s_add_u32 s99, s99, 110592
    v_mfma_f32_16x16x32_bf16 v[108:111], v[228:231], v[220:223], v[108:111]
    ds_read_b64_tr_b16 v[228:229], v247 offset:0
    ds_read_b64_tr_b16 v[230:231], v247 offset:1024
    buffer_load_dwordx4 v240, s[44:47], s100 offen sc1 lds
    buffer_load_dwordx4 v240, s[44:47], s100 offen offset:1024 sc1 lds
    s_add_u32 m0, s83, 16384
    v_mfma_f32_16x16x32_bf16 v[80:83], v[232:235], v[208:211], v[80:83]
    s_add_u32 s100, s100, 2048
    buffer_load_dwordx4 v240, s[44:47], s101 offen sc1 lds
    buffer_load_dwordx4 v240, s[44:47], s101 offen offset:1024 sc1 lds
    v_mfma_f32_16x16x32_bf16 v[88:91], v[232:235], v[212:215], v[88:91]
    s_add_u32 s101, s101, 2048
    s_add_u32 m0, s83, 24576
    v_mfma_f32_16x16x32_bf16 v[112:115], v[232:235], v[216:219], v[112:115]
    s_add_u32 s77, s98, 31744
    buffer_load_dwordx4 v244, s[48:51], s98 offen lds
    buffer_load_dwordx4 v244, s[48:51], s77 offen offset:1024 lds
    v_mfma_f32_16x16x32_bf16 v[120:123], v[232:235], v[220:223], v[120:123]
    ds_read_b64_tr_b16 v[232:233], v248 offset:0
    ds_read_b64_tr_b16 v[234:235], v248 offset:1024
    s_add_u32 m0, s94, 32768
    s_add_u32 s98, s98, 262144
    v_mfma_f32_16x16x32_bf16 v[84:87], v[236:239], v[208:211], v[84:87]
    buffer_load_dwordx4 v241, s[52:55], s99 offen lds
    s_add_u32 m0, s83, 40960
    s_add_u32 s99, s99, 110592
    v_mfma_f32_16x16x32_bf16 v[92:95], v[236:239], v[212:215], v[92:95]
    buffer_load_dwordx4 v240, s[44:47], s100 offen sc1 lds
    buffer_load_dwordx4 v240, s[44:47], s100 offen offset:1024 sc1 lds
    v_mfma_f32_16x16x32_bf16 v[116:119], v[236:239], v[216:219], v[116:119]
    s_add_u32 m0, s83, 49152
    s_add_u32 s100, s100, 2048
    buffer_load_dwordx4 v240, s[44:47], s101 offen sc1 lds
    v_mfma_f32_16x16x32_bf16 v[124:127], v[236:239], v[220:223], v[124:127]
    ds_read_b64_tr_b16 v[236:237], v249 offset:0
    ds_read_b64_tr_b16 v[238:239], v249 offset:1024
    buffer_load_dwordx4 v240, s[44:47], s101 offen offset:1024 sc1 lds
    s_add_u32 s101, s101, 2048
    s_waitcnt lgkmcnt(6)
    v_mfma_f32_16x16x32_bf16 v[0:3], v[224:227], v[192:195], v[0:3]
    ds_read_b128 v[208:211], v245 offset:8192
    v_mfma_f32_16x16x32_bf16 v[8:11], v[224:227], v[196:199], v[8:11]
    ds_read_b128 v[212:215], v245 offset:10240
    v_mfma_f32_16x16x32_bf16 v[32:35], v[224:227], v[200:203], v[32:35]
    ds_read_b128 v[216:219], v245 offset:12288
    v_mfma_f32_16x16x32_bf16 v[40:43], v[224:227], v[204:207], v[40:43]
    ds_read_b128 v[220:223], v245 offset:14336
    s_waitcnt lgkmcnt(8)
    v_mfma_f32_16x16x32_bf16 v[4:7], v[228:231], v[192:195], v[4:7]
    v_xor_b32 v245, 64, v245
    v_mfma_f32_16x16x32_bf16 v[12:15], v[228:231], v[196:199], v[12:15]
    v_mfma_f32_16x16x32_bf16 v[36:39], v[228:231], v[200:203], v[36:39]
    v_mfma_f32_16x16x32_bf16 v[44:47], v[228:231], v[204:207], v[44:47]
    s_waitcnt lgkmcnt(6)
    v_mfma_f32_16x16x32_bf16 v[16:19], v[232:235], v[192:195], v[16:19]
    v_mfma_f32_16x16x32_bf16 v[24:27], v[232:235], v[196:199], v[24:27]
    v_mfma_f32_16x16x32_bf16 v[48:51], v[232:235], v[200:203], v[48:51]
    v_mfma_f32_16x16x32_bf16 v[56:59], v[232:235], v[204:207], v[56:59]
    s_waitcnt lgkmcnt(4)
    v_mfma_f32_16x16x32_bf16 v[20:23], v[236:239], v[192:195], v[20:23]
    v_mfma_f32_16x16x32_bf16 v[28:31], v[236:239], v[196:199], v[28:31]
    v_mfma_f32_16x16x32_bf16 v[52:55], v[236:239], v[200:203], v[52:55]
    v_mfma_f32_16x16x32_bf16 v[60:63], v[236:239], v[204:207], v[60:63]
    s_waitcnt vmcnt(22) lgkmcnt(0)
    s_barrier
    v_mfma_f32_16x16x32_bf16 v[64:67], v[224:227], v[208:211], v[64:67]
    ds_read_b128 v[192:195], v245 offset:0
    v_mfma_f32_16x16x32_bf16 v[72:75], v[224:227], v[212:215], v[72:75]
    ds_read_b128 v[196:199], v245 offset:2048
    v_mfma_f32_16x16x32_bf16 v[96:99], v[224:227], v[216:219], v[96:99]
    ds_read_b128 v[200:203], v245 offset:4096
    v_mfma_f32_16x16x32_bf16 v[104:107], v[224:227], v[220:223], v[104:107]
    ds_read_b64_tr_b16 v[224:225], v246 offset:16384
    ds_read_b64_tr_b16 v[226:227], v246 offset:17408
    ds_read_b128 v[204:207], v245 offset:6144
    v_mfma_f32_16x16x32_bf16 v[68:71], v[228:231], v[208:211], v[68:71]
    v_mfma_f32_16x16x32_bf16 v[76:79], v[228:231], v[212:215], v[76:79]
    v_mfma_f32_16x16x32_bf16 v[100:103], v[228:231], v[216:219], v[100:103]
    v_mfma_f32_16x16x32_bf16 v[108:111], v[228:231], v[220:223], v[108:111]
    ds_read_b64_tr_b16 v[228:229], v247 offset:16384
    ds_read_b64_tr_b16 v[230:231], v247 offset:17408
    v_mfma_f32_16x16x32_bf16 v[80:83], v[232:235], v[208:211], v[80:83]
    v_mfma_f32_16x16x32_bf16 v[88:91], v[232:235], v[212:215], v[88:91]
    v_mfma_f32_16x16x32_bf16 v[112:115], v[232:235], v[216:219], v[112:115]
    v_mfma_f32_16x16x32_bf16 v[120:123], v[232:235], v[220:223], v[120:123]
    ds_read_b64_tr_b16 v[232:233], v248 offset:16384
    ds_read_b64_tr_b16 v[234:235], v248 offset:17408
    v_mfma_f32_16x16x32_bf16 v[84:87], v[236:239], v[208:211], v[84:87]
    v_mfma_f32_16x16x32_bf16 v[92:95], v[236:239], v[212:215], v[92:95]
    v_mfma_f32_16x16x32_bf16 v[116:119], v[236:239], v[216:219], v[116:119]
    v_mfma_f32_16x16x32_bf16 v[124:127], v[236:239], v[220:223], v[124:127]
    ds_read_b64_tr_b16 v[236:237], v249 offset:16384
    ds_read_b64_tr_b16 v[238:239], v249 offset:17408
    s_waitcnt lgkmcnt(6)
    v_mfma_f32_16x16x32_bf16 v[0:3], v[224:227], v[192:195], v[0:3]
    ds_read_b128 v[208:211], v245 offset:8192
    v_mfma_f32_16x16x32_bf16 v[8:11], v[224:227], v[196:199], v[8:11]
    ds_read_b128 v[212:215], v245 offset:10240
    v_mfma_f32_16x16x32_bf16 v[32:35], v[224:227], v[200:203], v[32:35]
    ds_read_b128 v[216:219], v245 offset:12288
    v_mfma_f32_16x16x32_bf16 v[40:43], v[224:227], v[204:207], v[40:43]
    ds_read_b128 v[220:223], v245 offset:14336
    s_waitcnt lgkmcnt(8)
    v_mfma_f32_16x16x32_bf16 v[4:7], v[228:231], v[192:195], v[4:7]
    v_xor_b32 v245, 64, v250
    v_mfma_f32_16x16x32_bf16 v[12:15], v[228:231], v[196:199], v[12:15]
    v_xor_b32 v246, 64, v251
    v_mfma_f32_16x16x32_bf16 v[36:39], v[228:231], v[200:203], v[36:39]
    v_mfma_f32_16x16x32_bf16 v[44:47], v[228:231], v[204:207], v[44:47]
    s_waitcnt lgkmcnt(6)
    v_mfma_f32_16x16x32_bf16 v[16:19], v[232:235], v[192:195], v[16:19]
    v_mfma_f32_16x16x32_bf16 v[24:27], v[232:235], v[196:199], v[24:27]
    v_mfma_f32_16x16x32_bf16 v[48:51], v[232:235], v[200:203], v[48:51]
    v_mfma_f32_16x16x32_bf16 v[56:59], v[232:235], v[204:207], v[56:59]
    s_waitcnt lgkmcnt(4)
    v_mfma_f32_16x16x32_bf16 v[20:23], v[236:239], v[192:195], v[20:23]
    v_mfma_f32_16x16x32_bf16 v[28:31], v[236:239], v[196:199], v[28:31]
    v_mfma_f32_16x16x32_bf16 v[52:55], v[236:239], v[200:203], v[52:55]
    v_mfma_f32_16x16x32_bf16 v[60:63], v[236:239], v[204:207], v[60:63]
    s_waitcnt vmcnt(14) lgkmcnt(0)
    s_barrier
    v_mfma_f32_16x16x32_bf16 v[64:67], v[224:227], v[208:211], v[64:67]
    ds_read_b64_tr_b16 v[192:193], v250 offset:0
    s_add_u32 m0, s83, 57344
    s_add_u32 s77, s98, 31744
    v_mfma_f32_16x16x32_bf16 v[72:75], v[224:227], v[212:215], v[72:75]
    ds_read_b64_tr_b16 v[194:195], v250 offset:512
    buffer_load_dwordx4 v244, s[48:51], s98 offen lds
    buffer_load_dwordx4 v244, s[48:51], s77 offen offset:1024 lds
    v_mfma_f32_16x16x32_bf16 v[96:99], v[224:227], v[216:219], v[96:99]
    ds_read_b64_tr_b16 v[196:197], v251 offset:0
    s_add_u32 m0, s94, 65536
    s_add_u32 s98, s98, 262144
    v_mfma_f32_16x16x32_bf16 v[104:107], v[224:227], v[220:223], v[104:107]
    ds_read_b128 v[224:227], v242 offset:8192
    ds_read_b64_tr_b16 v[198:199], v251 offset:512
    buffer_load_dwordx4 v241, s[52:55], s99 offen lds
    s_add_u32 m0, s83, 73728
    v_mfma_f32_16x16x32_bf16 v[68:71], v[228:231], v[208:211], v[68:71]
    s_add_u32 s99, s99, 110592
    buffer_load_dwordx4 v240, s[44:47], s100 offen sc1 lds
    v_mfma_f32_16x16x32_bf16 v[76:79], v[228:231], v[212:215], v[76:79]
    buffer_load_dwordx4 v240, s[44:47], s100 offen offset:1024 sc1 lds
    s_add_u32 m0, s83, 81920
    v_mfma_f32_16x16x32_bf16 v[100:103], v[228:231], v[216:219], v[100:103]
    s_add_u32 s100, s100, 2048
    buffer_load_dwordx4 v240, s[44:47], s101 offen sc1 lds
    v_mfma_f32_16x16x32_bf16 v[108:111], v[228:231], v[220:223], v[108:111]
    ds_read_b128 v[228:231], v242 offset:9216
    buffer_load_dwordx4 v240, s[44:47], s101 offen offset:1024 sc1 lds
    s_add_u32 s101, s101, 2048
    v_mfma_f32_16x16x32_bf16 v[80:83], v[232:235], v[208:211], v[80:83]
    s_add_u32 m0, s83, 90112
    s_add_u32 s77, s98, 31744
    v_mfma_f32_16x16x32_bf16 v[88:91], v[232:235], v[212:215], v[88:91]
    buffer_load_dwordx4 v244, s[48:51], s98 offen lds
    buffer_load_dwordx4 v244, s[48:51], s77 offen offset:1024 lds
    v_mfma_f32_16x16x32_bf16 v[112:115], v[232:235], v[216:219], v[112:115]
    s_add_u32 m0, s94, 98304
    s_add_u32 s98, s98, 262144
    v_mfma_f32_16x16x32_bf16 v[120:123], v[232:235], v[220:223], v[120:123]
    ds_read_b128 v[232:235], v242 offset:0
    buffer_load_dwordx4 v241, s[52:55], s99 offen lds
    s_add_u32 m0, s83, 106496
    v_mfma_f32_16x16x32_bf16 v[84:87], v[236:239], v[208:211], v[84:87]
    s_add_u32 s99, s99, 110592
    buffer_load_dwordx4 v240, s[44:47], s100 offen sc1 lds
    v_mfma_f32_16x16x32_bf16 v[92:95], v[236:239], v[212:215], v[92:95]
    buffer_load_dwordx4 v240, s[44:47], s100 offen offset:1024 sc1 lds
    s_add_u32 m0, s83, 114688
    v_mfma_f32_16x16x32_bf16 v[116:119], v[236:239], v[216:219], v[116:119]
    s_add_u32 s100, s100, 2048
    buffer_load_dwordx4 v240, s[44:47], s101 offen sc1 lds
    v_mfma_f32_16x16x32_bf16 v[124:127], v[236:239], v[220:223], v[124:127]
    ds_read_b128 v[236:239], v242 offset:1024
    buffer_load_dwordx4 v240, s[44:47], s101 offen offset:1024 sc1 lds
    s_add_u32 s101, s101, 2048
    s_branch KB_YT2
KB_CODE_END:
.section .rodata,"a"
.p2align 6
.amdhsa_kernel ka_kernel
  .amdhsa_next_free_vgpr 256
  .amdhsa_next_free_sgpr 102
  .amdhsa_accum_offset 256
  .amdhsa_group_segment_fixed_size 0
  .amdhsa_kernarg_size 104
  .amdhsa_user_sgpr_count 2
  .amdhsa_user_sgpr_kernarg_segment_ptr 1
  .amdhsa_system_sgpr_workgroup_id_x 1
  .amdhsa_float_denorm_mode_32 3
  .amdhsa_float_denorm_mode_16_64 3
.end_amdhsa_kernel
```
